```python
import torch

def _softmax(x, axis=-1):
    return torch.softmax(x, dim=axis)
def _gelu(x):
    return torch.nn.functional.gelu(x, approximate="tanh")
def _silu(x):
    return torch.nn.functional.silu(x)
def _sigmoid(x):
    return torch.sigmoid(x)
def _layernorm(x, axis=-1, eps=1e-5):
    m = x.mean(dim=axis, keepdim=True)
    v = x.var(dim=axis, keepdim=True, unbiased=False)
    return (x - m) / torch.sqrt(v + eps)
def _scatter_add(tgt, idx, src, axis=0):
    return tgt.clone().index_add_(axis, idx, src)
def _segment_sum(src, seg, n):
    out = torch.zeros((n,) + src.shape[1:], dtype=src.dtype)
    return out.index_add_(0, seg, src)
def _pad(x, pw):
    flat = tuple(v for pair in reversed(pw) for v in pair)
    return torch.nn.functional.pad(x, flat)

kernel_name = 'recurrent_scan__linear_attn_block__dense_activation_gelu__prompt'

def setup_inputs():

    _w = (lambda a: (lambda t: t.to(torch.bfloat16) if t.is_floating_point() else t)(torch.as_tensor(a)))
    def _A_setup():
        B, S, D = 1, 2048, 576
        return {
            "x": _w((lambda *s: torch.randn(*s, dtype=torch.bfloat16) * 0.05)(B, S, D)),
            "wqkv": _w((lambda *s: torch.randn(*s, dtype=torch.bfloat16) * 0.2)(D, 3 * D)),
            "wo": _w((lambda *s: torch.randn(*s, dtype=torch.bfloat16) * 0.2)(D, D)),
        }
    _A_in = _A_setup()

    def _B_setup():
        B, S, D, F = 1, 2048, 576, 4608
        return {
            "x": _w((lambda *s: torch.randn(*s, dtype=torch.bfloat16) * 0.05)(B, S, D)),
            "w1": _w((lambda *s: torch.randn(*s, dtype=torch.bfloat16) * 0.4)(D, F) * (D ** -0.5)),
            "b1": _w((lambda *s: torch.randn(*s, dtype=torch.bfloat16) * 12.8)(F) * 0.01),
            "w2": _w((lambda *s: torch.randn(*s, dtype=torch.bfloat16) * 0.2)(F, D) * (F ** -0.5)),
            "b2": _w((lambda *s: torch.randn(*s, dtype=torch.bfloat16) * 1.6)(D) * 0.01),
        }
    _B_in = _B_setup()

    return {
        "A_x": _A_in["x"],
        "A_wqkv": _A_in["wqkv"],
        "A_wo": _A_in["wo"],
        "B_x": _B_in["x"],
        "B_w1": _B_in["w1"],
        "B_b1": _B_in["b1"],
        "B_w2": _B_in["w2"],
        "B_b2": _B_in["b2"],
    }

def reference(A_x, A_wqkv, A_wo, B_x, B_w1, B_b1, B_w2, B_b2):
    def _A_ref(x, wqkv, wo):
        B, S, D = x.shape
        H = 32; Dh = D // H
        qkv = (lambda x, *d: x.permute(*d))((x @ wqkv).reshape(B, S, 3, H, Dh), 2, 0, 3, 1, 4)
        q, k, v = qkv[0], qkv[1], qkv[2]
        phi = lambda t: torch.where(t > 0, t + 1, torch.exp(t)) + 1e-6
        pq, pk = phi(q), phi(k)
        kv = torch.einsum("bhsd,bhse->bhde", pk, v)
        z = torch.einsum("bhsd->bhd", pk)
        num = torch.einsum("bhqd,bhde->bhqe", pq, kv)
        den = torch.einsum("bhqd,bhd->bhq", pq, z)[..., None] + 1e-6
        o = num / den
        return (lambda x, *d: x.permute(*d))(o, 0, 2, 1, 3).reshape(B, S, D) @ wo

    def _B_ref(x, w1, b1, w2, b2):
        h = torch.einsum("bsd,df->bsf", x, w1) + b1
        h = _gelu(h)
        return torch.einsum("bsf,fd->bsd", h, w2) + b2

    x = A_x
    xn = _layernorm(x, axis=-1)
    s = _A_ref(xn, A_wqkv, A_wo)
    g = _silu(_B_ref(xn, B_w1, B_b1, B_w2, B_b2))
    return x + s * g
```

```asm
; @launch grid=(256,1,1) block=(256,1,1) lds=163840
.amdgcn_target "amdgcn-amd-amdhsa--gfx950"
.text
.globl recurrent_scan__linear_attn_block__dense_activation_gelu__prompt_kernel
.p2align 8
.type recurrent_scan__linear_attn_block__dense_activation_gelu__prompt_kernel,@function
recurrent_scan__linear_attn_block__dense_activation_gelu__prompt_kernel:
  s_cmp_ge_u32 s2, 256
  s_cbranch_scc1 L_end
  s_load_dwordx16 s[64:79], s[0:1], 0
  s_load_dwordx4 s[80:83], s[0:1], 72
  v_readfirstlane_b32 s30, v0
  s_and_b32 s34, s2, 7
  s_lshr_b32 s35, s2, 3
  s_and_b32 s33, s35, 7
  s_and_b32 s28, s34, 1
  s_lshl_b32 s28, s28, 3
  s_add_u32 s28, s28, s33
  s_lshr_b32 s52, s35, 3
  s_lshr_b32 s53, s34, 1
  s_lshr_b32 s30, s30, 6
  s_lshr_b32 s31, s30, 1
  s_and_b32 s32, s30, 1
  v_and_b32 v1, 63, v0
  v_and_b32 v8, 7, v0
  v_bfe_u32 v41, v0, 3, 3
  v_lshrrev_b32 v43, 6, v0
  v_lshl_add_u32 v42, v43, 5, v41
  v_mul_u32_u24 v42, 1152, v42
  v_bfe_u32 v41, v0, 4, 2
  v_xor_b32 v8, v8, v41
  v_lshl_add_u32 v22, v8, 4, v42
  v_xor_b32 v8, 4, v8
  v_lshl_add_u32 v23, v8, 4, v42
  v_add_u32 v23, 8192, v23
  v_add_u32 v24, 16384, v22
  v_add_u32 v25, 16384, v23
  s_mul_i32 s40, s28, 147456
  s_lshl_b32 s3, s30, 12
  s_lshl_b32 s43, s30, 11
  s_cmp_eq_u32 s52, 0
  s_cbranch_scc1 L_attn
  s_mul_i32 s29, s53, 3
  s_add_u32 s29, s29, s52
  s_sub_u32 s29, s29, 1
  s_mul_i32 s41, s29, 768
  v_bfe_u32 v42, v0, 3, 3
  v_lshrrev_b32 v41, 6, v0
  v_lshl_add_u32 v42, v41, 4, v42
  v_mul_u32_u24 v42, 9216, v42
  v_bfe_u32 v41, v0, 4, 1
  v_lshlrev_b32 v41, 2, v41
  v_and_b32 v8, 7, v0
  v_xor_b32 v8, v8, v41
  v_lshl_add_u32 v16, v8, 4, v42
  v_add_u32 v17, 0x11c00, v16
  s_mul_i32 s38, s52, 2
  s_add_u32 s38, s38, s33
  s_cmp_ge_u32 s38, 9
  s_cselect_b32 s37, 9, 0
  s_sub_u32 s38, s38, s37
  s_mov_b32 s35, s38
  s_mul_i32 s54, s35, 0x80
  s_add_u32 s54, s54, s40
  s_add_u32 s35, s35, 1
  s_cmp_ge_u32 s35, 9
  s_cselect_b32 s35, 0, s35
  s_mul_i32 s55, s35, 0x80
  s_add_u32 s55, s55, s40
  s_mov_b32 s35, s38
  s_mul_i32 s24, s35, 0x90000
  s_add_u32 s24, s24, s41
  s_add_u32 s35, s35, 1
  s_cmp_ge_u32 s35, 9
  s_cselect_b32 s35, 0, s35
  s_mul_i32 s25, s35, 0x90000
  s_add_u32 s25, s25, s41
  s_waitcnt lgkmcnt(0)
  s_mov_b32 s4, s64
  s_mov_b32 s5, s65
  s_mov_b32 s6, 0x240000
  s_mov_b32 s7, 0x00020000
  s_mov_b32 s8, s72
  s_mov_b32 s9, s73
  s_mov_b32 s10, 0x510000
  s_mov_b32 s11, 0x00020000
  s_add_u32 s44, s24, 0x0
  s_add_u32 m0, s43, 0x2000
  s_nop 0
  buffer_load_dwordx4 v16, s[8:11], s44 offen lds
  buffer_load_dwordx4 v17, s[8:11], s44 offen offset:1024 lds
  s_add_u32 s45, s54, 0x0
  s_add_u32 m0, s3, 0x18000
  s_nop 0
  buffer_load_dwordx4 v22, s[4:7], s45 offen lds
  buffer_load_dwordx4 v23, s[4:7], s45 offen offset:1024 lds
  buffer_load_dwordx4 v24, s[4:7], s45 offen offset:2048 lds
  buffer_load_dwordx4 v25, s[4:7], s45 offen offset:3072 lds
  s_add_u32 s44, s25, 0x0
  s_add_u32 m0, s43, 0x4000
  s_nop 0
  buffer_load_dwordx4 v16, s[8:11], s44 offen lds
  buffer_load_dwordx4 v17, s[8:11], s44 offen offset:1024 lds
  s_add_u32 s45, s55, 0x0
  s_add_u32 m0, s3, 0x1c000
  s_nop 0
  buffer_load_dwordx4 v22, s[4:7], s45 offen lds
  buffer_load_dwordx4 v23, s[4:7], s45 offen offset:1024 lds
  buffer_load_dwordx4 v24, s[4:7], s45 offen offset:2048 lds
  buffer_load_dwordx4 v25, s[4:7], s45 offen offset:3072 lds
  s_mov_b32 s35, s38
  s_mul_i32 s54, s35, 0x80
  s_add_u32 s54, s54, s40
  s_add_u32 s35, s35, 1
  s_cmp_ge_u32 s35, 9
  s_cselect_b32 s35, 0, s35
  s_mul_i32 s55, s35, 0x80
  s_add_u32 s55, s55, s40
  s_add_u32 s35, s35, 1
  s_cmp_ge_u32 s35, 9
  s_cselect_b32 s35, 0, s35
  s_mul_i32 s56, s35, 0x80
  s_add_u32 s56, s56, s40
  s_add_u32 s35, s35, 1
  s_cmp_ge_u32 s35, 9
  s_cselect_b32 s35, 0, s35
  s_mul_i32 s57, s35, 0x80
  s_add_u32 s57, s57, s40
  s_add_u32 s35, s35, 1
  s_cmp_ge_u32 s35, 9
  s_cselect_b32 s35, 0, s35
  s_mul_i32 s58, s35, 0x80
  s_add_u32 s58, s58, s40
  s_add_u32 s35, s35, 1
  s_cmp_ge_u32 s35, 9
  s_cselect_b32 s35, 0, s35
  s_mul_i32 s59, s35, 0x80
  s_add_u32 s59, s59, s40
  s_add_u32 s35, s35, 1
  s_cmp_ge_u32 s35, 9
  s_cselect_b32 s35, 0, s35
  s_mul_i32 s60, s35, 0x80
  s_add_u32 s60, s60, s40
  s_add_u32 s35, s35, 1
  s_cmp_ge_u32 s35, 9
  s_cselect_b32 s35, 0, s35
  s_mul_i32 s61, s35, 0x80
  s_add_u32 s61, s61, s40
  s_add_u32 s35, s35, 1
  s_cmp_ge_u32 s35, 9
  s_cselect_b32 s35, 0, s35
  s_mul_i32 s62, s35, 0x80
  s_add_u32 s62, s62, s40
  s_mov_b32 s20, s74
  s_mov_b32 s21, s75
  s_mov_b32 s22, 0x2400
  s_mov_b32 s23, 0x00020000
  s_mov_b32 s12, s76
  s_mov_b32 s13, s77
  s_mov_b32 s14, 0x510000
  s_mov_b32 s15, 0x00020000
  s_mov_b32 s16, s82
  s_mov_b32 s17, s83
  s_mov_b32 s18, 0x4000000
  s_mov_b32 s19, 0x00020000
  s_mov_b32 s35, s38
  s_mul_i32 s24, s35, 0x90000
  s_add_u32 s24, s24, s41
  s_add_u32 s35, s35, 1
  s_cmp_ge_u32 s35, 9
  s_cselect_b32 s35, 0, s35
  s_mul_i32 s25, s35, 0x90000
  s_add_u32 s25, s25, s41
  s_add_u32 s35, s35, 1
  s_cmp_ge_u32 s35, 9
  s_cselect_b32 s35, 0, s35
  s_mul_i32 s26, s35, 0x90000
  s_add_u32 s26, s26, s41
  s_add_u32 s35, s35, 1
  s_cmp_ge_u32 s35, 9
  s_cselect_b32 s35, 0, s35
  s_mul_i32 s27, s35, 0x90000
  s_add_u32 s27, s27, s41
  s_add_u32 s35, s35, 1
  s_cmp_ge_u32 s35, 9
  s_cselect_b32 s35, 0, s35
  s_mul_i32 s63, s35, 0x90000
  s_add_u32 s63, s63, s41
  s_add_u32 s35, s35, 1
  s_cmp_ge_u32 s35, 9
  s_cselect_b32 s35, 0, s35
  s_mul_i32 s64, s35, 0x90000
  s_add_u32 s64, s64, s41
  s_add_u32 s35, s35, 1
  s_cmp_ge_u32 s35, 9
  s_cselect_b32 s35, 0, s35
  s_mul_i32 s65, s35, 0x90000
  s_add_u32 s65, s65, s41
  s_add_u32 s35, s35, 1
  s_cmp_ge_u32 s35, 9
  s_cselect_b32 s35, 0, s35
  s_mul_i32 s66, s35, 0x90000
  s_add_u32 s66, s66, s41
  s_add_u32 s35, s35, 1
  s_cmp_ge_u32 s35, 9
  s_cselect_b32 s35, 0, s35
  s_mul_i32 s67, s35, 0x90000
  s_add_u32 s67, s67, s41
  s_getpc_b64 s[82:83]
L_pc0:
  s_sub_u32 s82, s82, L_pc0-recurrent_scan__linear_attn_block__dense_activation_gelu__prompt_kernel
  s_subb_u32 s83, s83, 0
  s_lshr_b32 s34, s2, 3
  s_lshl_b32 s34, s34, 2
  s_add_u32 s34, s34, s30
  s_mul_i32 s34, s34, 7
  v_min_u32 v8, 6, v1
  v_add_u32 v8, s34, v8
  v_lshlrev_b32 v8, 7, v8
  v_min_u32 v8, L_codeend-recurrent_scan__linear_attn_block__dense_activation_gelu__prompt_kernel-4, v8
  global_load_dword v40, v8, s[82:83]
  s_add_u32 s44, s26, 0x0
  s_add_u32 m0, s43, 0x6000
  s_nop 0
  buffer_load_dwordx4 v16, s[8:11], s44 offen lds
  buffer_load_dwordx4 v17, s[8:11], s44 offen offset:1024 lds
  s_add_u32 s45, s56, 0x0
  s_add_u32 m0, s3, 0x20000
  s_nop 0
  buffer_load_dwordx4 v22, s[4:7], s45 offen lds
  buffer_load_dwordx4 v23, s[4:7], s45 offen offset:1024 lds
  buffer_load_dwordx4 v24, s[4:7], s45 offen offset:2048 lds
  buffer_load_dwordx4 v25, s[4:7], s45 offen offset:3072 lds
  s_mov_b32 s50, 0x3f803f80
  s_mov_b32 s51, 0xffff0000
  s_mov_b32 s49, 0x409d30fc
  v_and_b32 v8, 31, v1
  v_lshlrev_b32 v8, 7, v8
  s_lshl_b32 s34, s31, 13
  s_add_u32 s34, s34, 0x18000
  v_add_u32 v8, s34, v8
  v_bfe_u32 v41, v1, 1, 3
  v_lshrrev_b32 v42, 5, v1
  v_xor_b32 v41, v41, v42
  s_lshl_b32 s35, s31, 1
  v_xor_b32 v41, s35, v41
  s_lshl_b32 s34, s32, 12
  v_xor_b32 v42, 0, v41
  v_lshl_add_u32 v9, v42, 4, v8
  v_add_u32 v26, s34, v9
  v_xor_b32 v42, 2, v41
  v_lshl_add_u32 v10, v42, 4, v8
  v_add_u32 v27, s34, v10
  v_xor_b32 v42, 4, v41
  v_lshl_add_u32 v11, v42, 4, v8
  v_add_u32 v28, s34, v11
  v_xor_b32 v42, 6, v41
  v_lshl_add_u32 v12, v42, 4, v8
  v_add_u32 v29, s34, v12
  v_and_b32 v8, 3, v1
  v_lshlrev_b32 v8, 3, v8
  v_bfe_u32 v41, v1, 4, 1
  v_lshl_add_u32 v8, v41, 5, v8
  v_bfe_u32 v41, v1, 2, 2
  v_lshl_add_u32 v8, v41, 7, v8
  v_bfe_u32 v41, v1, 3, 1
  v_xor_b32 v41, s32, v41
  v_lshl_add_u32 v8, v41, 6, v8
  v_lshrrev_b32 v42, 5, v1
  v_lshl_add_u32 v2, v42, 10, v8
  v_lshl_add_u32 v5, v42, 9, v8
  s_lshl_b32 s34, s31, 11
  v_subrev_u32 v4, s34, v2
  v_add_u32 v2, s34, v2
  v_add_u32 v3, 0x10000, v2
  v_add_u32 v33, 0x10000, v4
  v_add_u32 v6, 0x10000, v5
  v_add_u32 v7, 0x20000, v5
  s_mov_b32 vcc_lo, 0x00020001
  s_mov_b32 vcc_hi, 0x00020001
  v_mov_b32 v8, 0x3f803f80
  v_cndmask_b32 v240, 0, v8, vcc
  v_cndmask_b32 v241, 0, v8, vcc
  v_cndmask_b32 v242, 0, v8, vcc
  v_cndmask_b32 v243, 0, v8, vcc
  s_waitcnt vmcnt(13)
  s_barrier
  ds_read_b128 a[0:3], v9 offset:0
  ds_read_b128 a[4:7], v9 offset:4096
  ds_read_b128 a[8:11], v10 offset:0
  ds_read_b128 a[12:15], v10 offset:4096
  ds_read_b64_tr_b16 v[44:45], v2 offset:8192
  ds_read_b64_tr_b16 v[46:47], v2 offset:8704
  ds_read_b64_tr_b16 v[48:49], v4 offset:10240
  ds_read_b64_tr_b16 v[50:51], v4 offset:10752
  ds_read_b64_tr_b16 v[52:53], v2 offset:12288
  ds_read_b64_tr_b16 v[54:55], v2 offset:12800
  s_waitcnt lgkmcnt(4)
  v_mfma_f32_32x32x16_bf16 v[208:223], v[44:47], a[0:3], 0
  s_add_u32 s44, s27, 0x0
  s_add_u32 m0, s43, 0x8000
  ds_read_b128 a[16:19], v11 offset:0
  ds_read_b128 v[112:115], v26 offset:0
  ds_read_b64_tr_b16 v[56:57], v4 offset:14336
  v_mfma_f32_32x32x16_bf16 v[224:239], v[44:47], a[4:7], 0
  ds_read_b128 a[20:23], v11 offset:4096
  ds_read_b128 v[116:119], v27 offset:0
  ds_read_b64_tr_b16 v[58:59], v4 offset:14848
  buffer_load_dwordx4 v16, s[8:11], s44 offen lds
  v_mfma_f32_16x16x32_bf16 v[244:247], v[240:243], v[44:47], 0
  s_waitcnt vmcnt(8) lgkmcnt(4)
  s_barrier
  ds_read_b128 v[120:123], v28 offset:0
  ds_read_b64_tr_b16 v[60:61], v2 offset:16384
  buffer_load_dwordx4 v17, s[8:11], s44 offen offset:1024 lds
  v_mfma_f32_32x32x16_bf16 v[208:223], v[48:51], a[8:11], v[208:223]
  s_add_u32 s45, s57, 0x0
  s_add_u32 m0, s3, 0x24000
  ds_read_b128 a[24:27], v12 offset:0
  ds_read_b128 v[124:127], v29 offset:0
  ds_read_b64_tr_b16 v[62:63], v2 offset:16896
  v_lshlrev_b32 v8, 1, v1
  v_mov_b32 v43, 0x7ff00000
  v_mfma_f32_32x32x16_bf16 v[224:239], v[48:51], a[12:15], v[224:239]
  ds_read_b128 a[28:31], v12 offset:4096
  buffer_load_dwordx4 v22, s[4:7], s45 offen lds
  v_cmp_gt_u32 vcc, 32, v1
  s_lshl_b32 s34, s32, 6
  s_add_u32 s34, s34, s41
  v_mfma_f32_32x32x16_bf16 v[208:223], v[52:55], a[16:19], v[208:223]
  s_waitcnt lgkmcnt(8)
  ds_read_b128 a[32:35], v9 offset:16384
  ds_read_b64_tr_b16 v[44:45], v4 offset:18432
  buffer_load_dwordx4 v23, s[4:7], s45 offen offset:1024 lds
  v_cndmask_b32 v8, v43, v8, vcc
  v_add_u32 v8, s34, v8
  v_mfma_f32_32x32x16_bf16 v[224:239], v[52:55], a[20:23], v[224:239]
  ds_read_b128 a[36:39], v9 offset:20480
  ds_read_b64_tr_b16 v[46:47], v4 offset:18944
  buffer_load_dwordx4 v24, s[4:7], s45 offen offset:2048 lds
  buffer_load_ushort v248, v8, s[20:23], 0 offen
  v_mfma_f32_16x16x32_bf16 v[244:247], v[240:243], v[52:55], v[244:247]
  s_waitcnt lgkmcnt(7)
  ds_read_b64_tr_b16 v[48:49], v2 offset:20480
  buffer_load_dwordx4 v25, s[4:7], s45 offen offset:3072 lds
  v_mfma_f32_32x32x16_bf16 v[208:223], v[56:59], a[24:27], v[208:223]
  s_waitcnt lgkmcnt(5)
  s_add_u32 s44, s63, 0x0
  ds_read_b128 a[40:43], v10 offset:16384
  ds_read_b64_tr_b16 v[50:51], v2 offset:20992
  buffer_load_ushort v249, v8, s[20:23], 0 offen offset:128
  buffer_load_ushort v250, v8, s[20:23], 0 offen offset:256
  v_dot2_f32_bf16 v144, v112, s50, 0
  v_dot2_f32_bf16 v148, v112, v112, 0
  v_dot2_f32_bf16 v145, v113, s50, 0
  v_dot2_f32_bf16 v149, v113, v113, 0
  v_dot2_f32_bf16 v146, v114, s50, 0
  v_dot2_f32_bf16 v150, v114, v114, 0
  v_dot2_f32_bf16 v147, v115, s50, 0
  v_dot2_f32_bf16 v151, v115, v115, 0
  v_dot2_f32_bf16 v144, v116, s50, v144
  v_dot2_f32_bf16 v148, v116, v116, v148
  v_dot2_f32_bf16 v145, v117, s50, v145
  v_dot2_f32_bf16 v149, v117, v117, v149
  v_dot2_f32_bf16 v146, v118, s50, v146
  v_dot2_f32_bf16 v150, v118, v118, v150
  v_dot2_f32_bf16 v147, v119, s50, v147
  v_dot2_f32_bf16 v151, v119, v119, v151
  v_dot2_f32_bf16 v144, v120, s50, v144
  v_dot2_f32_bf16 v148, v120, v120, v148
  v_dot2_f32_bf16 v145, v121, s50, v145
  v_dot2_f32_bf16 v149, v121, v121, v149
  v_dot2_f32_bf16 v146, v122, s50, v146
  v_dot2_f32_bf16 v150, v122, v122, v150
  v_dot2_f32_bf16 v147, v123, s50, v147
  v_dot2_f32_bf16 v151, v123, v123, v151
  v_dot2_f32_bf16 v144, v124, s50, v144
  v_dot2_f32_bf16 v148, v124, v124, v148
  v_dot2_f32_bf16 v145, v125, s50, v145
  v_dot2_f32_bf16 v149, v125, v125, v149
  v_dot2_f32_bf16 v146, v126, s50, v146
  v_dot2_f32_bf16 v150, v126, v126, v150
  v_dot2_f32_bf16 v147, v127, s50, v147
  v_dot2_f32_bf16 v151, v127, v127, v151
  v_mfma_f32_32x32x16_bf16 v[224:239], v[56:59], a[28:31], v[224:239]
  s_waitcnt lgkmcnt(6)
  s_add_u32 m0, s43, 0xa000
  ds_read_b128 a[44:47], v10 offset:20480
  buffer_load_ushort v251, v8, s[20:23], 0 offen offset:384
  buffer_load_ushort v252, v8, s[20:23], 0 offen offset:512
  v_mfma_f32_32x32x16_bf16 v[208:223], v[60:63], a[32:35], v[208:223]
  s_waitcnt lgkmcnt(5)
  ds_read_b128 a[48:51], v11 offset:16384
  ds_read_b128 v[128:131], v26 offset:16384
  ds_read_b64_tr_b16 v[52:53], v4 offset:22528
  buffer_load_dwordx4 v16, s[8:11], s44 offen lds
  v_mfma_f32_32x32x16_bf16 v[224:239], v[60:63], a[36:39], v[224:239]
  ds_read_b128 a[52:55], v11 offset:20480
  ds_read_b128 v[132:135], v27 offset:16384
  ds_read_b64_tr_b16 v[54:55], v4 offset:23040
  buffer_load_dwordx4 v17, s[8:11], s44 offen offset:1024 lds
  v_mfma_f32_16x16x32_bf16 v[244:247], v[240:243], v[60:63], v[244:247]
  s_waitcnt vmcnt(13) lgkmcnt(4)
  s_barrier
  ds_read_b128 v[136:139], v28 offset:16384
  ds_read_b64_tr_b16 v[56:57], v2 offset:24576
  v_mfma_f32_32x32x16_bf16 v[208:223], v[44:47], a[40:43], v[208:223]
  s_add_u32 s45, s64, 0x0
  s_add_u32 m0, s43, 0xc000
  ds_read_b128 a[56:59], v12 offset:16384
  ds_read_b128 v[140:143], v29 offset:16384
  ds_read_b64_tr_b16 v[58:59], v2 offset:25088
  buffer_load_ushort v253, v8, s[20:23], 0 offen offset:640
  v_mfma_f32_32x32x16_bf16 v[224:239], v[44:47], a[44:47], v[224:239]
  ds_read_b128 a[60:63], v12 offset:20480
  buffer_load_dwordx4 v16, s[8:11], s45 offen lds
  s_mov_b32 s20, s80
  s_mov_b32 s21, s81
  s_mov_b32 s22, 0x100
  v_mfma_f32_32x32x16_bf16 v[208:223], v[48:51], a[48:51], v[208:223]
  s_waitcnt lgkmcnt(8)
  ds_read_b128 a[64:67], v9 offset:32768
  ds_read_b64_tr_b16 v[60:61], v4 offset:26624
  buffer_load_dwordx4 v17, s[8:11], s45 offen offset:1024 lds
  s_mov_b32 s23, 0x00020000
  v_bfe_u32 v42, v0, 3, 3
  v_mfma_f32_32x32x16_bf16 v[224:239], v[48:51], a[52:55], v[224:239]
  s_add_u32 s44, s65, 0x0
  s_add_u32 m0, s43, 0xe000
  ds_read_b128 a[68:71], v9 offset:36864
  ds_read_b64_tr_b16 v[62:63], v4 offset:27136
  v_lshrrev_b32 v41, 6, v0
  v_lshl_add_u32 v42, v41, 4, v42
  v_mul_u32_u24 v42, 1152, v42
  v_mfma_f32_16x16x32_bf16 v[244:247], v[240:243], v[48:51], v[244:247]
  s_waitcnt lgkmcnt(7)
  ds_read_b64_tr_b16 v[44:45], v2 offset:28672
  buffer_load_dwordx4 v16, s[8:11], s44 offen lds
  buffer_load_dwordx4 v17, s[8:11], s44 offen offset:1024 lds
  v_mfma_f32_32x32x16_bf16 v[208:223], v[52:55], a[56:59], v[208:223]
  s_waitcnt lgkmcnt(5)
  s_add_u32 s45, s58, 0x0
  s_add_u32 m0, s3, 0x18000
  ds_read_b128 a[72:75], v10 offset:32768
  ds_read_b64_tr_b16 v[46:47], v2 offset:29184
  v_bfe_u32 v41, v0, 4, 1
  v_lshlrev_b32 v41, 2, v41
  v_and_b32 v8, 7, v0
  v_dot2_f32_bf16 v144, v128, s50, v144
  v_dot2_f32_bf16 v148, v128, v128, v148
  v_dot2_f32_bf16 v145, v129, s50, v145
  v_dot2_f32_bf16 v149, v129, v129, v149
  v_dot2_f32_bf16 v146, v130, s50, v146
  v_dot2_f32_bf16 v150, v130, v130, v150
  v_dot2_f32_bf16 v147, v131, s50, v147
  v_dot2_f32_bf16 v151, v131, v131, v151
  v_dot2_f32_bf16 v144, v132, s50, v144
  v_dot2_f32_bf16 v148, v132, v132, v148
  v_dot2_f32_bf16 v145, v133, s50, v145
  v_dot2_f32_bf16 v149, v133, v133, v149
  v_dot2_f32_bf16 v146, v134, s50, v146
  v_dot2_f32_bf16 v150, v134, v134, v150
  v_dot2_f32_bf16 v147, v135, s50, v147
  v_dot2_f32_bf16 v151, v135, v135, v151
  v_dot2_f32_bf16 v144, v136, s50, v144
  v_dot2_f32_bf16 v148, v136, v136, v148
  v_dot2_f32_bf16 v145, v137, s50, v145
  v_dot2_f32_bf16 v149, v137, v137, v149
  v_dot2_f32_bf16 v146, v138, s50, v146
  v_dot2_f32_bf16 v150, v138, v138, v150
  v_dot2_f32_bf16 v147, v139, s50, v147
  v_dot2_f32_bf16 v151, v139, v139, v151
  v_dot2_f32_bf16 v144, v140, s50, v144
  v_dot2_f32_bf16 v148, v140, v140, v148
  v_dot2_f32_bf16 v145, v141, s50, v145
  v_dot2_f32_bf16 v149, v141, v141, v149
  v_dot2_f32_bf16 v146, v142, s50, v146
  v_dot2_f32_bf16 v150, v142, v142, v150
  v_dot2_f32_bf16 v147, v143, s50, v147
  v_dot2_f32_bf16 v151, v143, v143, v151
  v_mfma_f32_32x32x16_bf16 v[224:239], v[52:55], a[60:63], v[224:239]
  s_waitcnt lgkmcnt(6)
  ds_read_b128 a[76:79], v10 offset:36864
  buffer_load_dwordx4 v22, s[4:7], s45 offen lds
  buffer_load_dwordx4 v23, s[4:7], s45 offen offset:1024 lds
  buffer_load_dwordx4 v24, s[4:7], s45 offen offset:2048 lds
  v_mfma_f32_32x32x16_bf16 v[208:223], v[56:59], a[64:67], v[208:223]
  s_waitcnt lgkmcnt(5)
  ds_read_b128 a[80:83], v11 offset:32768
  ds_read_b128 v[112:115], v26 offset:32768
  ds_read_b64_tr_b16 v[48:49], v4 offset:30720
  buffer_load_dwordx4 v25, s[4:7], s45 offen offset:3072 lds
  v_xor_b32 v8, v8, v41
  v_mfma_f32_32x32x16_bf16 v[224:239], v[56:59], a[68:71], v[224:239]
  s_add_u32 s44, s66, 0x0
  ds_read_b128 a[84:87], v11 offset:36864
  ds_read_b128 v[116:119], v27 offset:32768
  ds_read_b64_tr_b16 v[50:51], v4 offset:31232
  v_lshl_add_u32 v18, v8, 4, v42
  v_add_u32 v19, 0x2000, v18
  s_mul_i32 s42, s29, 442368
  v_mfma_f32_16x16x32_bf16 v[244:247], v[240:243], v[56:59], v[244:247]
  s_waitcnt vmcnt(15) lgkmcnt(4)
  s_barrier
  ds_read_b128 v[120:123], v28 offset:32768
  ds_read_b64_tr_b16 v[52:53], v2 offset:32768
  v_mfma_f32_32x32x16_bf16 v[208:223], v[60:63], a[72:75], v[208:223]
  s_add_u32 m0, s43, 0x10000
  ds_read_b128 a[88:91], v12 offset:32768
  ds_read_b128 v[124:127], v29 offset:32768
  ds_read_b64_tr_b16 v[54:55], v2 offset:33280
  s_mov_b32 s35, s33
  s_mul_i32 s70, s35, 0x80
  s_add_u32 s70, s70, s42
  v_mfma_f32_32x32x16_bf16 v[224:239], v[60:63], a[76:79], v[224:239]
  ds_read_b128 a[92:95], v12 offset:36864
  buffer_load_dwordx4 v16, s[8:11], s44 offen lds
  s_add_u32 s35, s35, 1
  s_cmp_ge_u32 s35, 9
  s_cselect_b32 s35, 0, s35
  v_mfma_f32_32x32x16_bf16 v[208:223], v[44:47], a[80:83], v[208:223]
  s_waitcnt lgkmcnt(8)
  ds_read_b128 a[96:99], v9 offset:49152
  ds_read_b64_tr_b16 v[56:57], v4 offset:34816
  buffer_load_dwordx4 v17, s[8:11], s44 offen offset:1024 lds
  s_mul_i32 s71, s35, 0x80
  s_add_u32 s71, s71, s42
  v_mfma_f32_32x32x16_bf16 v[224:239], v[44:47], a[84:87], v[224:239]
  s_add_u32 s45, s59, 0x0
  s_add_u32 m0, s3, 0x1c000
  ds_read_b128 a[100:103], v9 offset:53248
  ds_read_b64_tr_b16 v[58:59], v4 offset:35328
  s_add_u32 s35, s35, 1
  s_cmp_ge_u32 s35, 9
  s_cselect_b32 s35, 0, s35
  v_mfma_f32_16x16x32_bf16 v[244:247], v[240:243], v[44:47], v[244:247]
  s_waitcnt lgkmcnt(7)
  ds_read_b64_tr_b16 v[60:61], v2 offset:36864
  buffer_load_dwordx4 v22, s[4:7], s45 offen lds
  v_mfma_f32_32x32x16_bf16 v[208:223], v[48:51], a[88:91], v[208:223]
  s_waitcnt lgkmcnt(5)
  ds_read_b128 a[104:107], v10 offset:49152
  ds_read_b64_tr_b16 v[62:63], v2 offset:37376
  buffer_load_dwordx4 v23, s[4:7], s45 offen offset:1024 lds
  s_mul_i32 s72, s35, 0x80
  s_add_u32 s72, s72, s42
  v_dot2_f32_bf16 v144, v112, s50, v144
  v_dot2_f32_bf16 v148, v112, v112, v148
  v_dot2_f32_bf16 v145, v113, s50, v145
  v_dot2_f32_bf16 v149, v113, v113, v149
  v_dot2_f32_bf16 v146, v114, s50, v146
  v_dot2_f32_bf16 v150, v114, v114, v150
  v_dot2_f32_bf16 v147, v115, s50, v147
  v_dot2_f32_bf16 v151, v115, v115, v151
  v_dot2_f32_bf16 v144, v116, s50, v144
  v_dot2_f32_bf16 v148, v116, v116, v148
  v_dot2_f32_bf16 v145, v117, s50, v145
  v_dot2_f32_bf16 v149, v117, v117, v149
  v_dot2_f32_bf16 v146, v118, s50, v146
  v_dot2_f32_bf16 v150, v118, v118, v150
  v_dot2_f32_bf16 v147, v119, s50, v147
  v_dot2_f32_bf16 v151, v119, v119, v151
  v_dot2_f32_bf16 v144, v120, s50, v144
  v_dot2_f32_bf16 v148, v120, v120, v148
  v_dot2_f32_bf16 v145, v121, s50, v145
  v_dot2_f32_bf16 v149, v121, v121, v149
  v_dot2_f32_bf16 v146, v122, s50, v146
  v_dot2_f32_bf16 v150, v122, v122, v150
  v_dot2_f32_bf16 v147, v123, s50, v147
  v_dot2_f32_bf16 v151, v123, v123, v151
  v_dot2_f32_bf16 v144, v124, s50, v144
  v_dot2_f32_bf16 v148, v124, v124, v148
  v_dot2_f32_bf16 v145, v125, s50, v145
  v_dot2_f32_bf16 v149, v125, v125, v149
  v_dot2_f32_bf16 v146, v126, s50, v146
  v_dot2_f32_bf16 v150, v126, v126, v150
  v_dot2_f32_bf16 v147, v127, s50, v147
  v_dot2_f32_bf16 v151, v127, v127, v151
  v_mfma_f32_32x32x16_bf16 v[224:239], v[48:51], a[92:95], v[224:239]
  s_waitcnt lgkmcnt(6)
  ds_read_b128 a[108:111], v10 offset:53248
  buffer_load_dwordx4 v24, s[4:7], s45 offen offset:2048 lds
  s_add_u32 s35, s35, 1
  s_cmp_ge_u32 s35, 9
  s_cselect_b32 s35, 0, s35
  v_mfma_f32_32x32x16_bf16 v[208:223], v[52:55], a[96:99], v[208:223]
  s_waitcnt lgkmcnt(5)
  ds_read_b128 a[112:115], v11 offset:49152
  ds_read_b128 v[128:131], v26 offset:49152
  ds_read_b64_tr_b16 v[44:45], v4 offset:38912
  buffer_load_dwordx4 v25, s[4:7], s45 offen offset:3072 lds
  s_mul_i32 s73, s35, 0x80
  s_add_u32 s73, s73, s42
  v_mfma_f32_32x32x16_bf16 v[224:239], v[52:55], a[100:103], v[224:239]
  s_add_u32 s44, s67, 0x0
  ds_read_b128 a[116:119], v11 offset:53248
  ds_read_b128 v[132:135], v27 offset:49152
  ds_read_b64_tr_b16 v[46:47], v4 offset:39424
  s_add_u32 s35, s35, 1
  s_cmp_ge_u32 s35, 9
  s_cselect_b32 s35, 0, s35
  v_mfma_f32_16x16x32_bf16 v[244:247], v[240:243], v[52:55], v[244:247]
  s_waitcnt vmcnt(6) lgkmcnt(4)
  s_barrier
  ds_read_b128 v[136:139], v28 offset:49152
  ds_read_b64_tr_b16 v[48:49], v2 offset:40960
  s_mul_i32 s74, s35, 0x80
  s_add_u32 s74, s74, s42
  v_mfma_f32_32x32x16_bf16 v[208:223], v[56:59], a[104:107], v[208:223]
  s_add_u32 m0, s43, 0x12000
  ds_read_b128 a[120:123], v12 offset:49152
  ds_read_b128 v[140:143], v29 offset:49152
  ds_read_b64_tr_b16 v[50:51], v2 offset:41472
  s_add_u32 s35, s35, 1
  s_cmp_ge_u32 s35, 9
  s_cselect_b32 s35, 0, s35
  v_mfma_f32_32x32x16_bf16 v[224:239], v[56:59], a[108:111], v[224:239]
  ds_read_b128 a[124:127], v12 offset:53248
  buffer_load_dwordx4 v16, s[8:11], s44 offen lds
  s_mul_i32 s75, s35, 0x80
  s_add_u32 s75, s75, s42
  s_add_u32 s35, s35, 1
  v_mfma_f32_32x32x16_bf16 v[208:223], v[60:63], a[112:115], v[208:223]
  s_waitcnt lgkmcnt(8)
  ds_read_b128 a[128:131], v9 offset:0
  ds_read_b64_tr_b16 v[52:53], v4 offset:43008
  buffer_load_dwordx4 v17, s[8:11], s44 offen offset:1024 lds
  s_cmp_ge_u32 s35, 9
  s_cselect_b32 s35, 0, s35
  v_mfma_f32_32x32x16_bf16 v[224:239], v[60:63], a[116:119], v[224:239]
  s_add_u32 s45, s60, 0x0
  s_add_u32 m0, s3, 0x20000
  ds_read_b128 a[132:135], v9 offset:4096
  ds_read_b64_tr_b16 v[54:55], v4 offset:43520
  s_mul_i32 s76, s35, 0x80
  s_add_u32 s76, s76, s42
  s_add_u32 s35, s35, 1
  v_mfma_f32_16x16x32_bf16 v[244:247], v[240:243], v[60:63], v[244:247]
  s_waitcnt lgkmcnt(7)
  ds_read_b64_tr_b16 v[56:57], v2 offset:45056
  buffer_load_dwordx4 v22, s[4:7], s45 offen lds
  s_cmp_ge_u32 s35, 9
  s_cselect_b32 s35, 0, s35
  v_mfma_f32_32x32x16_bf16 v[208:223], v[44:47], a[120:123], v[208:223]
  s_waitcnt lgkmcnt(5)
  ds_read_b128 a[136:139], v10 offset:0
  ds_read_b64_tr_b16 v[58:59], v2 offset:45568
  buffer_load_dwordx4 v23, s[4:7], s45 offen offset:1024 lds
  s_mul_i32 s77, s35, 0x80
  s_add_u32 s77, s77, s42
  v_dot2_f32_bf16 v144, v128, s50, v144
  v_dot2_f32_bf16 v148, v128, v128, v148
  v_dot2_f32_bf16 v145, v129, s50, v145
  v_dot2_f32_bf16 v149, v129, v129, v149
  v_dot2_f32_bf16 v146, v130, s50, v146
  v_dot2_f32_bf16 v150, v130, v130, v150
  v_dot2_f32_bf16 v147, v131, s50, v147
  v_dot2_f32_bf16 v151, v131, v131, v151
  v_dot2_f32_bf16 v144, v132, s50, v144
  v_dot2_f32_bf16 v148, v132, v132, v148
  v_dot2_f32_bf16 v145, v133, s50, v145
  v_dot2_f32_bf16 v149, v133, v133, v149
  v_dot2_f32_bf16 v146, v134, s50, v146
  v_dot2_f32_bf16 v150, v134, v134, v150
  v_dot2_f32_bf16 v147, v135, s50, v147
  v_dot2_f32_bf16 v151, v135, v135, v151
  v_dot2_f32_bf16 v144, v136, s50, v144
  v_dot2_f32_bf16 v148, v136, v136, v148
  v_dot2_f32_bf16 v145, v137, s50, v145
  v_dot2_f32_bf16 v149, v137, v137, v149
  v_dot2_f32_bf16 v146, v138, s50, v146
  v_dot2_f32_bf16 v150, v138, v138, v150
  v_dot2_f32_bf16 v147, v139, s50, v147
  v_dot2_f32_bf16 v151, v139, v139, v151
  v_dot2_f32_bf16 v144, v140, s50, v144
  v_dot2_f32_bf16 v148, v140, v140, v148
  v_dot2_f32_bf16 v145, v141, s50, v145
  v_dot2_f32_bf16 v149, v141, v141, v149
  v_dot2_f32_bf16 v146, v142, s50, v146
  v_dot2_f32_bf16 v150, v142, v142, v150
  v_dot2_f32_bf16 v147, v143, s50, v147
  v_dot2_f32_bf16 v151, v143, v143, v151
  v_mfma_f32_32x32x16_bf16 v[224:239], v[44:47], a[124:127], v[224:239]
  s_waitcnt lgkmcnt(6)
  ds_read_b128 a[140:143], v10 offset:4096
  buffer_load_dwordx4 v24, s[4:7], s45 offen offset:2048 lds
  s_add_u32 s35, s35, 1
  s_cmp_ge_u32 s35, 9
  s_cselect_b32 s35, 0, s35
  v_mfma_f32_32x32x16_bf16 v[208:223], v[48:51], a[128:131], v[208:223]
  s_waitcnt lgkmcnt(5)
  ds_read_b128 a[144:147], v11 offset:0
  ds_read_b128 v[112:115], v26 offset:0
  ds_read_b64_tr_b16 v[60:61], v4 offset:47104
  buffer_load_dwordx4 v25, s[4:7], s45 offen offset:3072 lds
  s_mul_i32 s78, s35, 0x80
  s_add_u32 s78, s78, s42
  v_mfma_f32_32x32x16_bf16 v[224:239], v[48:51], a[132:135], v[224:239]
  s_add_u32 s44, s24, 0x80
  ds_read_b128 a[148:151], v11 offset:4096
  ds_read_b128 v[116:119], v27 offset:0
  ds_read_b64_tr_b16 v[62:63], v4 offset:47616
  s_mul_i32 s46, s29, 2359296
  s_add_u32 s46, s46, s40
  v_min_u32 v8, 1, v0
  v_mfma_f32_16x16x32_bf16 v[244:247], v[240:243], v[48:51], v[244:247]
  s_waitcnt vmcnt(6) lgkmcnt(4)
  s_barrier
  ds_read_b128 v[120:123], v28 offset:0
  ds_read_b64_tr_b16 v[44:45], v2 offset:49152
  v_mul_u32_u24 v41, 442364, v8
  v_mfma_f32_32x32x16_bf16 v[208:223], v[52:55], a[136:139], v[208:223]
  s_add_u32 m0, s43, 0x14000
  ds_read_b128 a[152:155], v12 offset:0
  ds_read_b128 v[124:127], v29 offset:0
  ds_read_b64_tr_b16 v[46:47], v2 offset:49664
  v_mul_u32_u24 v42, 147452, v8
  buffer_load_dword v40, v41, s[12:15], s42 offen
  v_mfma_f32_32x32x16_bf16 v[224:239], v[52:55], a[140:143], v[224:239]
  ds_read_b128 a[156:159], v12 offset:4096
  buffer_load_dwordx4 v16, s[8:11], s44 offen lds
  buffer_load_dword v40, v42, s[16:19], s46 offen
  s_lshl_b32 s34, s42, 5
  v_mfma_f32_32x32x16_bf16 v[208:223], v[56:59], a[144:147], v[208:223]
  s_waitcnt lgkmcnt(8)
  ds_read_b128 a[160:163], v9 offset:16384
  ds_read_b64_tr_b16 v[48:49], v4 offset:51200
  buffer_load_dwordx4 v17, s[8:11], s44 offen offset:1024 lds
  s_sub_u32 s46, s46, s34
  v_lshlrev_b32 v41, 4, v1
  v_mfma_f32_32x32x16_bf16 v[224:239], v[56:59], a[148:151], v[224:239]
  s_add_u32 s45, s61, 0x0
  s_add_u32 m0, s3, 0x24000
  ds_read_b128 a[164:167], v9 offset:20480
  ds_read_b64_tr_b16 v[50:51], v4 offset:51712
  s_add_u32 s34, s3, 0x18000
  v_add_u32 v13, s34, v41
  s_lshl_b32 s34, s31, 13
  v_mfma_f32_16x16x32_bf16 v[244:247], v[240:243], v[56:59], v[244:247]
  s_waitcnt lgkmcnt(7)
  ds_read_b64_tr_b16 v[52:53], v2 offset:53248
  buffer_load_dwordx4 v22, s[4:7], s45 offen lds
  s_add_u32 s34, s34, 0x18000
  v_mfma_f32_32x32x16_bf16 v[208:223], v[60:63], a[152:155], v[208:223]
  s_waitcnt lgkmcnt(5)
  ds_read_b128 a[168:171], v10 offset:16384
  ds_read_b64_tr_b16 v[54:55], v2 offset:53760
  buffer_load_dwordx4 v23, s[4:7], s45 offen offset:1024 lds
  v_add_u32 v14, s34, v41
  s_mul_i32 s34, s31, 73728
  v_dot2_f32_bf16 v144, v112, s50, v144
  v_dot2_f32_bf16 v148, v112, v112, v148
  v_dot2_f32_bf16 v145, v113, s50, v145
  v_dot2_f32_bf16 v149, v113, v113, v149
  v_dot2_f32_bf16 v146, v114, s50, v146
  v_dot2_f32_bf16 v150, v114, v114, v150
  v_dot2_f32_bf16 v147, v115, s50, v147
  v_dot2_f32_bf16 v151, v115, v115, v151
  v_dot2_f32_bf16 v144, v116, s50, v144
  v_dot2_f32_bf16 v148, v116, v116, v148
  v_dot2_f32_bf16 v145, v117, s50, v145
  v_dot2_f32_bf16 v149, v117, v117, v149
  v_dot2_f32_bf16 v146, v118, s50, v146
  v_dot2_f32_bf16 v150, v118, v118, v150
  v_dot2_f32_bf16 v147, v119, s50, v147
  v_dot2_f32_bf16 v151, v119, v119, v151
  v_dot2_f32_bf16 v144, v120, s50, v144
  v_dot2_f32_bf16 v148, v120, v120, v148
  v_dot2_f32_bf16 v145, v121, s50, v145
  v_dot2_f32_bf16 v149, v121, v121, v149
  v_dot2_f32_bf16 v146, v122, s50, v146
  v_dot2_f32_bf16 v150, v122, v122, v150
  v_dot2_f32_bf16 v147, v123, s50, v147
  v_dot2_f32_bf16 v151, v123, v123, v151
  v_dot2_f32_bf16 v144, v124, s50, v144
  v_dot2_f32_bf16 v148, v124, v124, v148
  v_dot2_f32_bf16 v145, v125, s50, v145
  v_dot2_f32_bf16 v149, v125, v125, v149
  v_dot2_f32_bf16 v146, v126, s50, v146
  v_dot2_f32_bf16 v150, v126, v126, v150
  v_dot2_f32_bf16 v147, v127, s50, v147
  v_dot2_f32_bf16 v151, v127, v127, v151
  v_mfma_f32_32x32x16_bf16 v[224:239], v[60:63], a[156:159], v[224:239]
  s_waitcnt lgkmcnt(6)
  ds_read_b128 a[172:175], v10 offset:20480
  buffer_load_dwordx4 v24, s[4:7], s45 offen offset:2048 lds
  s_lshl_b32 s35, s32, 11
  s_add_u32 s34, s34, s35
  v_add_u32 v20, s34, v41
  v_mfma_f32_32x32x16_bf16 v[208:223], v[44:47], a[160:163], v[208:223]
  s_waitcnt lgkmcnt(5)
  ds_read_b128 a[176:179], v11 offset:16384
  ds_read_b128 v[128:131], v26 offset:16384
  ds_read_b64_tr_b16 v[56:57], v4 offset:55296
  buffer_load_dwordx4 v25, s[4:7], s45 offen offset:3072 lds
  v_add_u32 v21, 36864, v20
  v_mfma_f32_32x32x16_bf16 v[224:239], v[44:47], a[164:167], v[224:239]
  s_add_u32 s44, s25, 0x80
  ds_read_b128 a[180:183], v11 offset:20480
  ds_read_b128 v[132:135], v27 offset:16384
  ds_read_b64_tr_b16 v[58:59], v4 offset:55808
  s_lshl_b32 s34, s32, 8
  s_add_u32 s34, s34, 4608
  v_lshl_add_u32 v15, v1, 2, s34
  v_mfma_f32_16x16x32_bf16 v[244:247], v[240:243], v[44:47], v[244:247]
  s_waitcnt vmcnt(8) lgkmcnt(4)
  s_barrier
  ds_read_b128 v[136:139], v28 offset:16384
  ds_read_b64_tr_b16 v[60:61], v2 offset:57344
  s_lshl_b32 s35, s31, 7
  v_mfma_f32_32x32x16_bf16 v[208:223], v[48:51], a[168:171], v[208:223]
  s_add_u32 m0, s43, 0x16000
  ds_read_b128 a[184:187], v12 offset:16384
  ds_read_b128 v[140:143], v29 offset:16384
  ds_read_b64_tr_b16 v[62:63], v2 offset:57856
  v_add_u32 v32, s35, v15
  v_cmp_gt_u32 vcc, 16, v1
  s_nop 1
  v_cndmask_b32 v32, v43, v32, vcc
  v_mfma_f32_32x32x16_bf16 v[224:239], v[48:51], a[172:175], v[224:239]
  ds_read_b128 a[188:191], v12 offset:20480
  buffer_load_dwordx4 v16, s[8:11], s44 offen lds
  v_mov_b32 v107, 0
  s_mov_b32 s36, s29
  s_lshl_b32 s53, s28, 7
  v_mfma_f32_32x32x16_bf16 v[208:223], v[52:55], a[176:179], v[208:223]
  s_waitcnt lgkmcnt(8)
  ds_read_b128 a[192:195], v9 offset:32768
  ds_read_b64_tr_b16 v[44:45], v4 offset:59392
  buffer_load_dwordx4 v17, s[8:11], s44 offen offset:1024 lds
  s_add_u32 s53, s53, 0x2c00000
  s_lshl_b32 s36, s36, 2
  v_mfma_f32_32x32x16_bf16 v[224:239], v[52:55], a[180:183], v[224:239]
  s_add_u32 s45, s62, 0x0
  s_add_u32 m0, s3, 0x18000
  ds_read_b128 a[196:199], v9 offset:36864
  ds_read_b64_tr_b16 v[46:47], v4 offset:59904
  v_mov_b32 v43, s36
  v_mov_b32 v8, 0x7ff00000
  v_cmp_eq_u32 vcc, 0, v0
  v_mfma_f32_16x16x32_bf16 v[244:247], v[240:243], v[52:55], v[244:247]
  s_waitcnt lgkmcnt(7)
  ds_read_b64_tr_b16 v[48:49], v2 offset:61440
  buffer_load_dwordx4 v22, s[4:7], s45 offen lds
  v_mfma_f32_32x32x16_bf16 v[208:223], v[56:59], a[184:187], v[208:223]
  s_waitcnt lgkmcnt(5)
  ds_read_b128 a[200:203], v10 offset:32768
  ds_read_b64_tr_b16 v[50:51], v2 offset:61952
  buffer_load_dwordx4 v23, s[4:7], s45 offen offset:1024 lds
  v_cndmask_b32 v43, v8, v43, vcc
  v_mov_b32 v8, 0
  v_dot2_f32_bf16 v144, v128, s50, v144
  v_dot2_f32_bf16 v148, v128, v128, v148
  v_dot2_f32_bf16 v145, v129, s50, v145
  v_dot2_f32_bf16 v149, v129, v129, v149
  v_dot2_f32_bf16 v146, v130, s50, v146
  v_dot2_f32_bf16 v150, v130, v130, v150
  v_dot2_f32_bf16 v147, v131, s50, v147
  v_dot2_f32_bf16 v151, v131, v131, v151
  v_dot2_f32_bf16 v144, v132, s50, v144
  v_dot2_f32_bf16 v148, v132, v132, v148
  v_dot2_f32_bf16 v145, v133, s50, v145
  v_dot2_f32_bf16 v149, v133, v133, v149
  v_dot2_f32_bf16 v146, v134, s50, v146
  v_dot2_f32_bf16 v150, v134, v134, v150
  v_dot2_f32_bf16 v147, v135, s50, v147
  v_dot2_f32_bf16 v151, v135, v135, v151
  v_dot2_f32_bf16 v144, v136, s50, v144
  v_dot2_f32_bf16 v148, v136, v136, v148
  v_dot2_f32_bf16 v145, v137, s50, v145
  v_dot2_f32_bf16 v149, v137, v137, v149
  v_dot2_f32_bf16 v146, v138, s50, v146
  v_dot2_f32_bf16 v150, v138, v138, v150
  v_dot2_f32_bf16 v147, v139, s50, v147
  v_dot2_f32_bf16 v151, v139, v139, v151
  v_dot2_f32_bf16 v144, v140, s50, v144
  v_dot2_f32_bf16 v148, v140, v140, v148
  v_dot2_f32_bf16 v145, v141, s50, v145
  v_dot2_f32_bf16 v149, v141, v141, v149
  v_dot2_f32_bf16 v146, v142, s50, v146
  v_dot2_f32_bf16 v150, v142, v142, v150
  v_dot2_f32_bf16 v147, v143, s50, v147
  v_dot2_f32_bf16 v151, v143, v143, v151
  v_mfma_f32_32x32x16_bf16 v[224:239], v[56:59], a[188:191], v[224:239]
  s_waitcnt lgkmcnt(6)
  ds_read_b128 a[204:207], v10 offset:36864
  buffer_load_dwordx4 v24, s[4:7], s45 offen offset:2048 lds
  buffer_store_dword v8, v43, s[16:19], s53 offen sc1
  v_mfma_f32_32x32x16_bf16 v[208:223], v[60:63], a[192:195], v[208:223]
  s_waitcnt lgkmcnt(5)
  ds_read_b128 a[208:211], v11 offset:32768
  ds_read_b128 v[112:115], v26 offset:32768
  ds_read_b64_tr_b16 v[52:53], v4 offset:63488
  buffer_load_dwordx4 v25, s[4:7], s45 offen offset:3072 lds
  v_mfma_f32_32x32x16_bf16 v[224:239], v[60:63], a[196:199], v[224:239]
  s_add_u32 s44, s26, 0x80
  s_add_u32 m0, s43, 0x2000
  ds_read_b128 a[212:215], v11 offset:36864
  ds_read_b128 v[116:119], v27 offset:32768
  ds_read_b64_tr_b16 v[54:55], v4 offset:64000
  v_mfma_f32_16x16x32_bf16 v[244:247], v[240:243], v[60:63], v[244:247]
  s_waitcnt vmcnt(7) lgkmcnt(4)
  s_barrier
  ds_read_b128 v[120:123], v28 offset:32768
  ds_read_b64_tr_b16 v[56:57], v3 offset:0
  buffer_load_dwordx4 v16, s[8:11], s44 offen lds
  v_mfma_f32_32x32x16_bf16 v[208:223], v[44:47], a[200:203], v[208:223]
  ds_read_b128 a[216:219], v12 offset:32768
  ds_read_b128 v[124:127], v29 offset:32768
  ds_read_b64_tr_b16 v[58:59], v3 offset:512
  buffer_load_dwordx4 v17, s[8:11], s44 offen offset:1024 lds
  v_mfma_f32_32x32x16_bf16 v[224:239], v[44:47], a[204:207], v[224:239]
  s_add_u32 s45, s27, 0x80
  s_add_u32 m0, s43, 0x4000
  ds_read_b128 a[220:223], v12 offset:36864
  v_mfma_f32_32x32x16_bf16 v[208:223], v[48:51], a[208:211], v[208:223]
  s_waitcnt lgkmcnt(8)
  ds_read_b128 a[224:227], v9 offset:49152
  ds_read_b64_tr_b16 v[60:61], v33 offset:2048
  buffer_load_dwordx4 v16, s[8:11], s45 offen lds
  v_mfma_f32_32x32x16_bf16 v[224:239], v[48:51], a[212:215], v[224:239]
  ds_read_b128 a[228:231], v9 offset:53248
  ds_read_b64_tr_b16 v[62:63], v33 offset:2560
  buffer_load_dwordx4 v17, s[8:11], s45 offen offset:1024 lds
  v_mfma_f32_16x16x32_bf16 v[244:247], v[240:243], v[48:51], v[244:247]
  s_waitcnt lgkmcnt(7)
  s_add_u32 s44, s63, 0x80
  ds_read_b64_tr_b16 v[44:45], v3 offset:4096
  v_mfma_f32_32x32x16_bf16 v[208:223], v[52:55], a[216:219], v[208:223]
  s_waitcnt lgkmcnt(5)
  s_add_u32 m0, s43, 0x6000
  ds_read_b128 a[232:235], v10 offset:49152
  ds_read_b64_tr_b16 v[46:47], v3 offset:4608
  v_dot2_f32_bf16 v144, v112, s50, v144
  v_dot2_f32_bf16 v148, v112, v112, v148
  v_dot2_f32_bf16 v145, v113, s50, v145
  v_dot2_f32_bf16 v149, v113, v113, v149
  v_dot2_f32_bf16 v146, v114, s50, v146
  v_dot2_f32_bf16 v150, v114, v114, v150
  v_dot2_f32_bf16 v147, v115, s50, v147
  v_dot2_f32_bf16 v151, v115, v115, v151
  v_dot2_f32_bf16 v144, v116, s50, v144
  v_dot2_f32_bf16 v148, v116, v116, v148
  v_dot2_f32_bf16 v145, v117, s50, v145
  v_dot2_f32_bf16 v149, v117, v117, v149
  v_dot2_f32_bf16 v146, v118, s50, v146
  v_dot2_f32_bf16 v150, v118, v118, v150
  v_dot2_f32_bf16 v147, v119, s50, v147
  v_dot2_f32_bf16 v151, v119, v119, v151
  v_dot2_f32_bf16 v144, v120, s50, v144
  v_dot2_f32_bf16 v148, v120, v120, v148
  v_dot2_f32_bf16 v145, v121, s50, v145
  v_dot2_f32_bf16 v149, v121, v121, v149
  v_dot2_f32_bf16 v146, v122, s50, v146
  v_dot2_f32_bf16 v150, v122, v122, v150
  v_dot2_f32_bf16 v147, v123, s50, v147
  v_dot2_f32_bf16 v151, v123, v123, v151
  v_dot2_f32_bf16 v144, v124, s50, v144
  v_dot2_f32_bf16 v148, v124, v124, v148
  v_dot2_f32_bf16 v145, v125, s50, v145
  v_dot2_f32_bf16 v149, v125, v125, v149
  v_dot2_f32_bf16 v146, v126, s50, v146
  v_dot2_f32_bf16 v150, v126, v126, v150
  v_dot2_f32_bf16 v147, v127, s50, v147
  v_dot2_f32_bf16 v151, v127, v127, v151
  v_mfma_f32_32x32x16_bf16 v[224:239], v[52:55], a[220:223], v[224:239]
  s_waitcnt lgkmcnt(6)
  ds_read_b128 a[236:239], v10 offset:53248
  buffer_load_dwordx4 v16, s[8:11], s44 offen lds
  v_mfma_f32_32x32x16_bf16 v[208:223], v[56:59], a[224:227], v[208:223]
  s_waitcnt lgkmcnt(5)
  ds_read_b128 a[240:243], v11 offset:49152
  ds_read_b128 v[128:131], v26 offset:49152
  ds_read_b64_tr_b16 v[48:49], v33 offset:6144
  buffer_load_dwordx4 v17, s[8:11], s44 offen offset:1024 lds
  v_mfma_f32_32x32x16_bf16 v[224:239], v[56:59], a[228:231], v[224:239]
  s_add_u32 s45, s64, 0x80
  s_add_u32 m0, s43, 0x8000
  ds_read_b128 a[244:247], v11 offset:53248
  ds_read_b128 v[132:135], v27 offset:49152
  ds_read_b64_tr_b16 v[50:51], v33 offset:6656
  v_mfma_f32_16x16x32_bf16 v[244:247], v[240:243], v[56:59], v[244:247]
  s_waitcnt vmcnt(6) lgkmcnt(4)
  s_barrier
  ds_read_b128 v[136:139], v28 offset:49152
  ds_read_b64_tr_b16 v[52:53], v3 offset:8192
  buffer_load_dwordx4 v16, s[8:11], s45 offen lds
  v_mfma_f32_32x32x16_bf16 v[208:223], v[60:63], a[232:235], v[208:223]
  ds_read_b128 a[248:251], v12 offset:49152
  ds_read_b128 v[140:143], v29 offset:49152
  ds_read_b64_tr_b16 v[54:55], v3 offset:8704
  buffer_load_dwordx4 v17, s[8:11], s45 offen offset:1024 lds
  v_mfma_f32_32x32x16_bf16 v[224:239], v[60:63], a[236:239], v[224:239]
  s_add_u32 s44, s65, 0x80
  s_add_u32 m0, s43, 0xa000
  ds_read_b128 a[252:255], v12 offset:53248
  v_mfma_f32_32x32x16_bf16 v[208:223], v[44:47], a[240:243], v[208:223]
  s_waitcnt lgkmcnt(8)
  ds_read_b128 v[64:67], v9 offset:0
  ds_read_b64_tr_b16 v[56:57], v33 offset:10240
  buffer_load_dwordx4 v16, s[8:11], s44 offen lds
  v_mfma_f32_32x32x16_bf16 v[224:239], v[44:47], a[244:247], v[224:239]
  ds_read_b128 v[68:71], v9 offset:4096
  ds_read_b64_tr_b16 v[58:59], v33 offset:10752
  buffer_load_dwordx4 v17, s[8:11], s44 offen offset:1024 lds
  v_mfma_f32_16x16x32_bf16 v[244:247], v[240:243], v[44:47], v[244:247]
  s_waitcnt lgkmcnt(7)
  s_add_u32 s45, s66, 0x80
  ds_read_b64_tr_b16 v[60:61], v3 offset:12288
  v_mfma_f32_32x32x16_bf16 v[208:223], v[48:51], a[248:251], v[208:223]
  s_waitcnt lgkmcnt(5)
  s_add_u32 m0, s43, 0xc000
  ds_read_b128 v[72:75], v10 offset:0
  ds_read_b64_tr_b16 v[62:63], v3 offset:12800
  v_dot2_f32_bf16 v144, v128, s50, v144
  v_dot2_f32_bf16 v148, v128, v128, v148
  v_dot2_f32_bf16 v145, v129, s50, v145
  v_dot2_f32_bf16 v149, v129, v129, v149
  v_dot2_f32_bf16 v146, v130, s50, v146
  v_dot2_f32_bf16 v150, v130, v130, v150
  v_dot2_f32_bf16 v147, v131, s50, v147
  v_dot2_f32_bf16 v151, v131, v131, v151
  v_dot2_f32_bf16 v144, v132, s50, v144
  v_dot2_f32_bf16 v148, v132, v132, v148
  v_dot2_f32_bf16 v145, v133, s50, v145
  v_dot2_f32_bf16 v149, v133, v133, v149
  v_dot2_f32_bf16 v146, v134, s50, v146
  v_dot2_f32_bf16 v150, v134, v134, v150
  v_dot2_f32_bf16 v147, v135, s50, v147
  v_dot2_f32_bf16 v151, v135, v135, v151
  v_dot2_f32_bf16 v144, v136, s50, v144
  v_dot2_f32_bf16 v148, v136, v136, v148
  v_dot2_f32_bf16 v145, v137, s50, v145
  v_dot2_f32_bf16 v149, v137, v137, v149
  v_dot2_f32_bf16 v146, v138, s50, v146
  v_dot2_f32_bf16 v150, v138, v138, v150
  v_dot2_f32_bf16 v147, v139, s50, v147
  v_dot2_f32_bf16 v151, v139, v139, v151
  v_dot2_f32_bf16 v144, v140, s50, v144
  v_dot2_f32_bf16 v148, v140, v140, v148
  v_dot2_f32_bf16 v145, v141, s50, v145
  v_dot2_f32_bf16 v149, v141, v141, v149
  v_dot2_f32_bf16 v146, v142, s50, v146
  v_dot2_f32_bf16 v150, v142, v142, v150
  v_dot2_f32_bf16 v147, v143, s50, v147
  v_dot2_f32_bf16 v151, v143, v143, v151
  v_mfma_f32_32x32x16_bf16 v[224:239], v[48:51], a[252:255], v[224:239]
  s_waitcnt lgkmcnt(6)
  ds_read_b128 v[76:79], v10 offset:4096
  v_mfma_f32_32x32x16_bf16 v[208:223], v[52:55], v[64:67], v[208:223]
  s_waitcnt lgkmcnt(5)
  ds_read_b128 v[80:83], v11 offset:0
  ds_read_b128 v[112:115], v26 offset:0
  ds_read_b64_tr_b16 v[44:45], v33 offset:14336
  buffer_load_dwordx4 v16, s[8:11], s45 offen lds
  v_mfma_f32_32x32x16_bf16 v[224:239], v[52:55], v[68:71], v[224:239]
  ds_read_b128 v[84:87], v11 offset:4096
  ds_read_b128 v[116:119], v27 offset:0
  ds_read_b64_tr_b16 v[46:47], v33 offset:14848
  v_mfma_f32_16x16x32_bf16 v[244:247], v[240:243], v[52:55], v[244:247]
  s_waitcnt lgkmcnt(8)
  ds_read_b128 v[120:123], v28 offset:0
  ds_read_b64_tr_b16 v[48:49], v3 offset:16384
  v_mfma_f32_32x32x16_bf16 v[208:223], v[56:59], v[72:75], v[208:223]
  s_waitcnt lgkmcnt(8)
  ds_read_b128 v[88:91], v12 offset:0
  ds_read_b128 v[124:127], v29 offset:0
  ds_read_b64_tr_b16 v[50:51], v3 offset:16896
  v_mfma_f32_32x32x16_bf16 v[224:239], v[56:59], v[76:79], v[224:239]
  s_waitcnt lgkmcnt(10)
  ds_read_b128 v[92:95], v12 offset:4096
  buffer_load_dwordx4 v17, s[8:11], s45 offen offset:1024 lds
  v_mfma_f32_32x32x16_bf16 v[208:223], v[60:63], v[80:83], v[208:223]
  s_waitcnt lgkmcnt(8)
  s_add_u32 s44, s67, 0x80
  s_add_u32 m0, s43, 0xe000
  ds_read_b64_tr_b16 v[52:53], v33 offset:18432
  v_mfma_f32_32x32x16_bf16 v[224:239], v[60:63], v[84:87], v[224:239]
  ds_read_b64_tr_b16 v[54:55], v33 offset:18944
  v_mfma_f32_16x16x32_bf16 v[244:247], v[240:243], v[60:63], v[244:247]
  s_waitcnt lgkmcnt(5)
  ds_read_b64_tr_b16 v[56:57], v3 offset:20480
  v_mfma_f32_32x32x16_bf16 v[208:223], v[44:47], v[88:91], v[208:223]
  s_waitcnt lgkmcnt(3)
  s_barrier
  ds_read_b64_tr_b16 v[58:59], v3 offset:20992
  buffer_load_dwordx4 v16, s[8:11], s44 offen lds
  v_dot2_f32_bf16 v144, v112, s50, v144
  v_dot2_f32_bf16 v148, v112, v112, v148
  v_dot2_f32_bf16 v145, v113, s50, v145
  v_dot2_f32_bf16 v149, v113, v113, v149
  v_dot2_f32_bf16 v146, v114, s50, v146
  v_dot2_f32_bf16 v150, v114, v114, v150
  v_dot2_f32_bf16 v147, v115, s50, v147
  v_dot2_f32_bf16 v151, v115, v115, v151
  v_dot2_f32_bf16 v144, v116, s50, v144
  v_dot2_f32_bf16 v148, v116, v116, v148
  v_dot2_f32_bf16 v145, v117, s50, v145
  v_dot2_f32_bf16 v149, v117, v117, v149
  v_dot2_f32_bf16 v146, v118, s50, v146
  v_dot2_f32_bf16 v150, v118, v118, v150
  v_dot2_f32_bf16 v147, v119, s50, v147
  v_dot2_f32_bf16 v151, v119, v119, v151
  v_dot2_f32_bf16 v144, v120, s50, v144
  v_dot2_f32_bf16 v148, v120, v120, v148
  v_dot2_f32_bf16 v145, v121, s50, v145
  v_dot2_f32_bf16 v149, v121, v121, v149
  v_dot2_f32_bf16 v146, v122, s50, v146
  v_dot2_f32_bf16 v150, v122, v122, v150
  v_dot2_f32_bf16 v147, v123, s50, v147
  v_dot2_f32_bf16 v151, v123, v123, v151
  v_dot2_f32_bf16 v144, v124, s50, v144
  v_dot2_f32_bf16 v148, v124, v124, v148
  v_dot2_f32_bf16 v145, v125, s50, v145
  v_dot2_f32_bf16 v149, v125, v125, v149
  v_dot2_f32_bf16 v146, v126, s50, v146
  v_dot2_f32_bf16 v150, v126, v126, v150
  v_dot2_f32_bf16 v147, v127, s50, v147
  v_dot2_f32_bf16 v151, v127, v127, v151
  v_mfma_f32_32x32x16_bf16 v[224:239], v[44:47], v[92:95], v[224:239]
  v_add_f32 v144, v144, v145
  v_add_f32 v148, v148, v149
  v_add_f32 v146, v146, v147
  v_add_f32 v150, v150, v151
  v_add_f32 v144, v144, v146
  v_add_f32 v148, v148, v150
  v_mfma_f32_32x32x16_bf16 v[176:191], v[48:51], a[0:3], 0
  ds_read_b64_tr_b16 v[60:61], v33 offset:22528
  v_mov_b32 v145, v144
  v_mov_b32 v149, v148
  s_nop 0
  v_permlane32_swap_b32 v144, v145
  v_permlane32_swap_b32 v148, v149
  v_add_f32 v144, v144, v145
  v_mfma_f32_32x32x16_bf16 v[192:207], v[48:51], a[4:7], 0
  ds_read_b64_tr_b16 v[62:63], v33 offset:23040
  v_add_f32 v148, v148, v149
  v_mul_f32 v144, 0xbae38e39, v144
  v_mul_f32 v148, 0x3ae38e39, v148
  v_fma_f32 v148, -v144, v144, v148
  v_max_f32 v148, 0, v148
  v_mfma_f32_16x16x32_bf16 v[108:111], v[240:243], v[48:51], 0
  s_waitcnt lgkmcnt(4)
  ds_read_b64_tr_b16 v[44:45], v3 offset:24576
  v_add_f32 v148, 0x3727c5ac, v148
  v_mfma_f32_32x32x16_bf16 v[176:191], v[52:55], a[8:11], v[176:191]
  ds_read_b64_tr_b16 v[46:47], v3 offset:25088
  buffer_load_dwordx4 v17, s[8:11], s44 offen offset:1024 lds
  v_rsq_f32 v30, v148
  v_cvt_pk_bf16_f32 v36, v144, v144
  v_mfma_f32_32x32x16_bf16 v[192:207], v[52:55], a[12:15], v[192:207]
  s_waitcnt lgkmcnt(4)
  v_and_b32 v36, s51, v36
  v_mul_f32 v148, v148, v30
  v_sub_f32 v37, v144, v36
  v_cvt_pk_bf16_f32 v96, v36, v37
  v_cvt_pk_bf16_f32 v97, v36, v148
  v_and_b32 v36, s51, v97
  v_mfma_f32_32x32x16_bf16 v[176:191], v[56:59], a[16:19], v[176:191]
  s_add_u32 s45, s24, 0x100
  ds_read_b64_tr_b16 v[48:49], v33 offset:26624
  v_sub_f32 v37, v148, v36
  v_cvt_pk_bf16_f32 v98, v37, 0
  v_mov_b32 v99, 0
  v_mul_f32 v30, 0x3eeff558, v30
  v_lshlrev_b32 v36, 4, v0
  v_mfma_f32_32x32x16_bf16 v[192:207], v[56:59], a[20:23], v[192:207]
  s_add_u32 m0, s43, 0x10000
  ds_read_b64_tr_b16 v[50:51], v33 offset:27136
  ds_write2_b32 v32, v244, v245 offset0:0 offset1:16
  v_and_b32 v37, 31, v1
  s_lshl_b32 s34, s30, 7
  v_lshl_add_u32 v37, v37, 2, s34
  v_mfma_f32_16x16x32_bf16 v[108:111], v[240:243], v[56:59], v[108:111]
  s_waitcnt lgkmcnt(5)
  ds_read_b64_tr_b16 v[52:53], v3 offset:28672
  v_mfma_f32_32x32x16_bf16 v[176:191], v[60:63], a[24:27], v[176:191]
  ds_read_b64_tr_b16 v[54:55], v3 offset:29184
  buffer_load_dwordx4 v16, s[8:11], s45 offen lds
  v_mfma_f32_32x32x16_bf16 v[192:207], v[60:63], a[28:31], v[192:207]
  s_waitcnt lgkmcnt(5)
  ds_write_b128 v36, v[96:99] offset:0
  v_mfma_f32_32x32x16_bf16 v[176:191], v[44:47], a[32:35], v[176:191]
  ds_read_b64_tr_b16 v[56:57], v33 offset:30720
  ds_write_b32 v37, v30 offset:4096
  s_lshl_b32 s34, s32, 10
  v_subrev_u32 v36, s34, v36
  s_lshl_b32 s34, s32, 7
  v_mfma_f32_32x32x16_bf16 v[192:207], v[44:47], a[36:39], v[192:207]
  ds_read_b64_tr_b16 v[58:59], v33 offset:31232
  v_subrev_u32 v37, s34, v37
  v_mfma_f32_16x16x32_bf16 v[108:111], v[240:243], v[44:47], v[108:111]
  s_waitcnt lgkmcnt(7)
  v_mfma_f32_32x32x16_bf16 v[176:191], v[48:51], a[40:43], v[176:191]
  buffer_load_dwordx4 v17, s[8:11], s45 offen offset:1024 lds
  v_mfma_f32_32x32x16_bf16 v[192:207], v[48:51], a[44:47], v[192:207]
  s_waitcnt vmcnt(10) lgkmcnt(1)
  s_barrier
  ds_read_b64_tr_b16 v[60:61], v2 offset:8192
  ds_read_b32 v38, v15 offset:0
  v_mfma_f32_32x32x16_bf16 v[176:191], v[52:55], a[48:51], v[176:191]
  s_add_u32 s44, s25, 0x100
  s_add_u32 m0, s43, 0x12000
  ds_read_b64_tr_b16 v[62:63], v2 offset:8704
  ds_read_b128 v[96:99], v36 offset:0
  ds_read_b128 v[100:103], v36 offset:1024
  ds_read_b32 v30, v37 offset:4096
  ds_read_b32 v31, v37 offset:4224
  v_mfma_f32_32x32x16_bf16 v[192:207], v[52:55], a[52:55], v[192:207]
  v_mfma_f32_16x16x32_bf16 v[108:111], v[240:243], v[52:55], v[108:111]
  s_waitcnt lgkmcnt(7)
  ds_read_b64_tr_b16 v[44:45], v4 offset:10240
  v_lshlrev_b32 v39, 16, v248
  v_mfma_f32_32x32x16_bf16 v[176:191], v[56:59], a[56:59], v[176:191]
  ds_read_b64_tr_b16 v[46:47], v4 offset:10752
  buffer_load_dwordx4 v16, s[8:11], s44 offen lds
  v_mov_b32 v106, v248
  s_waitcnt lgkmcnt(7)
  v_cvt_pk_bf16_f32 v104, v38, v38
  v_and_b32 v105, s51, v104
  v_sub_f32 v38, v38, v105
  v_cvt_pk_bf16_f32 v105, v38, v39
  v_mfma_f32_32x32x16_bf16 v[192:207], v[56:59], a[60:63], v[192:207]
  s_waitcnt lgkmcnt(5)
  ds_read_b64_tr_b16 v[48:49], v2 offset:12288
  v_mfma_f32_32x32x16_bf16 v[208:223], v[104:107], v[96:99], v[208:223]
  s_waitcnt lgkmcnt(5)
  ds_read_b64_tr_b16 v[50:51], v2 offset:12800
  v_mfma_f32_32x32x16_bf16 v[224:239], v[104:107], v[100:103], v[224:239]
  v_mfma_f32_32x32x16_bf16 v[176:191], v[60:63], a[64:67], v[176:191]
  ds_read_b64_tr_b16 v[52:53], v4 offset:14336
  buffer_load_dwordx4 v17, s[8:11], s44 offen offset:1024 lds
  s_waitcnt lgkmcnt(6)
  s_nop 4
  v_mul_f32 v208, v208, v30
  v_mul_f32 v209, v209, v30
  v_fma_f32 v34, -v208, v208, -s49
  v_mfma_f32_32x32x16_bf16 v[192:207], v[60:63], a[68:71], v[192:207]
  s_add_u32 s45, s26, 0x100
  s_add_u32 m0, s43, 0x14000
  ds_read_b64_tr_b16 v[54:55], v4 offset:14848
  v_fma_f32 v35, -v209, v209, -s49
  v_mul_f32 v34, v208, v34
  v_mul_f32 v35, v209, v35
  v_mfma_f32_16x16x32_bf16 v[108:111], v[240:243], v[60:63], v[108:111]
  s_waitcnt lgkmcnt(4)
  ds_read_b64_tr_b16 v[56:57], v2 offset:16384
  v_mfma_f32_32x32x16_bf16 v[176:191], v[44:47], a[72:75], v[176:191]
  ds_read_b64_tr_b16 v[58:59], v2 offset:16896
  v_exp_f32 v34, v34
  v_exp_f32 v35, v35
  v_add_f32 v34, 1.0, v34
  v_mfma_f32_32x32x16_bf16 v[192:207], v[44:47], a[76:79], v[192:207]
  s_waitcnt lgkmcnt(4)
  buffer_load_dwordx4 v16, s[8:11], s45 offen lds
  v_add_f32 v35, 1.0, v35
  v_rcp_f32 v34, v34
  v_mfma_f32_32x32x16_bf16 v[176:191], v[48:51], a[80:83], v[176:191]
  ds_read_b64_tr_b16 v[60:61], v4 offset:18432
  v_rcp_f32 v35, v35
  v_mul_f32 v34, v208, v34
  v_mul_f32 v35, v209, v35
  v_cvt_pk_bf16_f32 v208, v34, v35
  v_mfma_f32_32x32x16_bf16 v[192:207], v[48:51], a[84:87], v[192:207]
  ds_read_b64_tr_b16 v[62:63], v4 offset:18944
  v_mul_f32 v210, v210, v30
  v_mul_f32 v211, v211, v30
  v_fma_f32 v34, -v210, v210, -s49
  v_fma_f32 v35, -v211, v211, -s49
  v_mul_f32 v34, v210, v34
  v_mfma_f32_16x16x32_bf16 v[108:111], v[240:243], v[48:51], v[108:111]
  s_waitcnt lgkmcnt(4)
  ds_read_b64_tr_b16 v[44:45], v2 offset:20480
  v_mul_f32 v35, v211, v35
  v_mfma_f32_32x32x16_bf16 v[176:191], v[52:55], a[88:91], v[176:191]
  ds_read_b64_tr_b16 v[46:47], v2 offset:20992
  buffer_load_dwordx4 v17, s[8:11], s45 offen offset:1024 lds
  v_exp_f32 v34, v34
  v_mfma_f32_32x32x16_bf16 v[192:207], v[52:55], a[92:95], v[192:207]
  s_waitcnt lgkmcnt(4)
  s_add_u32 s44, s27, 0x100
  v_exp_f32 v35, v35
  v_add_f32 v34, 1.0, v34
  v_add_f32 v35, 1.0, v35
  v_mfma_f32_32x32x16_bf16 v[176:191], v[56:59], a[96:99], v[176:191]
  ds_read_b64_tr_b16 v[48:49], v4 offset:22528
  v_rcp_f32 v34, v34
  v_rcp_f32 v35, v35
  v_mul_f32 v34, v210, v34
  v_mfma_f32_32x32x16_bf16 v[192:207], v[56:59], a[100:103], v[192:207]
  ds_read_b64_tr_b16 v[50:51], v4 offset:23040
  v_mul_f32 v35, v211, v35
  v_cvt_pk_bf16_f32 v209, v34, v35
  v_mul_f32 v212, v212, v30
  v_mul_f32 v213, v213, v30
  v_fma_f32 v34, -v212, v212, -s49
  v_mfma_f32_16x16x32_bf16 v[108:111], v[240:243], v[56:59], v[108:111]
  s_waitcnt lgkmcnt(4)
  ds_read_b64_tr_b16 v[52:53], v2 offset:24576
  v_fma_f32 v35, -v213, v213, -s49
  v_mfma_f32_32x32x16_bf16 v[176:191], v[60:63], a[104:107], v[176:191]
  s_waitcnt vmcnt(10)
  s_barrier
  s_add_u32 m0, s43, 0x16000
  ds_read_b64_tr_b16 v[54:55], v2 offset:25088
  v_mfma_f32_32x32x16_bf16 v[192:207], v[60:63], a[108:111], v[192:207]
  s_waitcnt lgkmcnt(4)
  buffer_load_dwordx4 v16, s[8:11], s44 offen lds
  v_mul_f32 v34, v212, v34
  v_mul_f32 v35, v213, v35
  v_exp_f32 v34, v34
  v_mfma_f32_32x32x16_bf16 v[176:191], v[44:47], a[112:115], v[176:191]
  ds_read_b64_tr_b16 v[56:57], v4 offset:26624
  v_exp_f32 v35, v35
  v_add_f32 v34, 1.0, v34
  v_add_f32 v35, 1.0, v35
  v_mfma_f32_32x32x16_bf16 v[192:207], v[44:47], a[116:119], v[192:207]
  ds_read_b64_tr_b16 v[58:59], v4 offset:27136
  v_rcp_f32 v34, v34
  v_rcp_f32 v35, v35
  v_mul_f32 v34, v212, v34
  v_mfma_f32_16x16x32_bf16 v[108:111], v[240:243], v[44:47], v[108:111]
  s_waitcnt lgkmcnt(4)
  ds_read_b64_tr_b16 v[60:61], v2 offset:28672
  v_mul_f32 v35, v213, v35
  v_mfma_f32_32x32x16_bf16 v[176:191], v[48:51], a[120:123], v[176:191]
  ds_read_b64_tr_b16 v[62:63], v2 offset:29184
  buffer_load_dwordx4 v17, s[8:11], s44 offen offset:1024 lds
  s_lshl_b32 s34, s28, 2
  v_lshlrev_b32 v36, 12, v0
  v_mfma_f32_32x32x16_bf16 v[192:207], v[48:51], a[124:127], v[192:207]
  s_waitcnt lgkmcnt(4)
  v_mov_b32 v37, 1
  buffer_atomic_add v37, v36, s[20:23], s34 offen offset:0
  s_load_dwordx4 s[80:83], s[0:1], 56
  s_nop 0
  v_lshlrev_b32 v36, 7, v1
  v_mfma_f32_32x32x16_bf16 v[176:191], v[52:55], a[128:131], v[176:191]
  s_add_u32 s45, s63, 0x100
  s_add_u32 m0, s43, 0x2000
  ds_read_b64_tr_b16 v[44:45], v4 offset:30720
  v_min_u32 v36, 1024, v36
  s_waitcnt lgkmcnt(0)
  global_load_dword v40, v36, s[80:81]
  v_cvt_pk_bf16_f32 v210, v34, v35
  v_mfma_f32_32x32x16_bf16 v[192:207], v[52:55], a[132:135], v[192:207]
  ds_read_b64_tr_b16 v[46:47], v4 offset:31232
  v_mul_f32 v214, v214, v30
  v_mul_f32 v215, v215, v30
  v_fma_f32 v34, -v214, v214, -s49
  v_fma_f32 v35, -v215, v215, -s49
  v_mul_f32 v34, v214, v34
  v_mfma_f32_16x16x32_bf16 v[108:111], v[240:243], v[52:55], v[108:111]
  ds_read_b64_tr_b16 v[48:49], v2 offset:32768
  v_mul_f32 v35, v215, v35
  v_mfma_f32_32x32x16_bf16 v[176:191], v[56:59], a[136:139], v[176:191]
  ds_read_b64_tr_b16 v[50:51], v2 offset:33280
  buffer_load_dwordx4 v16, s[8:11], s45 offen lds
  v_exp_f32 v34, v34
  v_mfma_f32_32x32x16_bf16 v[192:207], v[56:59], a[140:143], v[192:207]
  v_exp_f32 v35, v35
  v_add_f32 v34, 1.0, v34
  v_add_f32 v35, 1.0, v35
  v_rcp_f32 v34, v34
  v_mfma_f32_32x32x16_bf16 v[176:191], v[60:63], a[144:147], v[176:191]
  ds_read_b64_tr_b16 v[52:53], v4 offset:34816
  v_rcp_f32 v35, v35
  v_mul_f32 v34, v214, v34
  v_mul_f32 v35, v215, v35
  v_cvt_pk_bf16_f32 v211, v34, v35
  v_mfma_f32_32x32x16_bf16 v[192:207], v[60:63], a[148:151], v[192:207]
  ds_read_b64_tr_b16 v[54:55], v4 offset:35328
  ds_write_b128 v13, v[208:211] offset:16384
  v_mfma_f32_16x16x32_bf16 v[108:111], v[240:243], v[60:63], v[108:111]
  s_waitcnt lgkmcnt(5)
  ds_read_b64_tr_b16 v[56:57], v2 offset:36864
  v_mul_f32 v216, v216, v30
  v_mfma_f32_32x32x16_bf16 v[176:191], v[44:47], a[152:155], v[176:191]
  ds_read_b64_tr_b16 v[58:59], v2 offset:37376
  buffer_load_dwordx4 v17, s[8:11], s45 offen offset:1024 lds
  v_mul_f32 v217, v217, v30
  v_fma_f32 v34, -v216, v216, -s49
  v_fma_f32 v35, -v217, v217, -s49
  v_mfma_f32_32x32x16_bf16 v[192:207], v[44:47], a[156:159], v[192:207]
  s_waitcnt lgkmcnt(5)
  s_add_u32 s44, s64, 0x100
  v_mul_f32 v34, v216, v34
  v_mul_f32 v35, v217, v35
  v_exp_f32 v34, v34
  v_mfma_f32_32x32x16_bf16 v[176:191], v[48:51], a[160:163], v[176:191]
  ds_read_b64_tr_b16 v[60:61], v4 offset:38912
  v_exp_f32 v35, v35
  v_add_f32 v34, 1.0, v34
  v_add_f32 v35, 1.0, v35
  v_mfma_f32_32x32x16_bf16 v[192:207], v[48:51], a[164:167], v[192:207]
  ds_read_b64_tr_b16 v[62:63], v4 offset:39424
  v_rcp_f32 v34, v34
  v_rcp_f32 v35, v35
  v_mul_f32 v34, v216, v34
  v_mfma_f32_16x16x32_bf16 v[108:111], v[240:243], v[48:51], v[108:111]
  s_waitcnt lgkmcnt(5)
  ds_read_b64_tr_b16 v[44:45], v2 offset:40960
  v_mul_f32 v35, v217, v35
  v_mfma_f32_32x32x16_bf16 v[176:191], v[52:55], a[168:171], v[176:191]
  ds_read_b64_tr_b16 v[46:47], v2 offset:41472
  v_cvt_pk_bf16_f32 v216, v34, v35
  v_mul_f32 v218, v218, v30
  v_mul_f32 v219, v219, v30
  v_fma_f32 v34, -v218, v218, -s49
  v_fma_f32 v35, -v219, v219, -s49
  v_mfma_f32_32x32x16_bf16 v[192:207], v[52:55], a[172:175], v[192:207]
  s_waitcnt vmcnt(12) lgkmcnt(6)
  s_barrier
  s_waitcnt lgkmcnt(4)
  s_add_u32 m0, s43, 0x4000
  v_mfma_f32_32x32x16_bf16 v[176:191], v[56:59], a[176:179], v[176:191]
  ds_read_b64_tr_b16 v[48:49], v4 offset:43008
  buffer_load_dwordx4 v16, s[8:11], s44 offen lds
  v_mul_f32 v34, v218, v34
  v_mul_f32 v35, v219, v35
  v_mfma_f32_32x32x16_bf16 v[192:207], v[56:59], a[180:183], v[192:207]
  ds_read_b64_tr_b16 v[50:51], v4 offset:43520
  v_exp_f32 v34, v34
  v_exp_f32 v35, v35
  v_add_f32 v34, 1.0, v34
  v_mfma_f32_16x16x32_bf16 v[108:111], v[240:243], v[56:59], v[108:111]
  s_waitcnt lgkmcnt(4)
  ds_read_b64_tr_b16 v[52:53], v2 offset:45056
  v_add_f32 v35, 1.0, v35
  v_mfma_f32_32x32x16_bf16 v[176:191], v[60:63], a[184:187], v[176:191]
  ds_read_b64_tr_b16 v[54:55], v2 offset:45568
  v_rcp_f32 v34, v34
  v_rcp_f32 v35, v35
  v_mul_f32 v34, v218, v34
  v_mfma_f32_32x32x16_bf16 v[192:207], v[60:63], a[188:191], v[192:207]
  s_waitcnt lgkmcnt(4)
  buffer_load_dwordx4 v17, s[8:11], s44 offen offset:1024 lds
  v_mul_f32 v35, v219, v35
  v_cvt_pk_bf16_f32 v217, v34, v35
  v_mul_f32 v220, v220, v30
  v_mul_f32 v221, v221, v30
  v_mfma_f32_32x32x16_bf16 v[176:191], v[44:47], a[192:195], v[176:191]
  s_add_u32 s45, s65, 0x100
  s_add_u32 m0, s43, 0x6000
  ds_read_b64_tr_b16 v[56:57], v4 offset:47104
  v_fma_f32 v34, -v220, v220, -s49
  v_fma_f32 v35, -v221, v221, -s49
  v_mul_f32 v34, v220, v34
  v_mul_f32 v35, v221, v35
  v_mfma_f32_32x32x16_bf16 v[192:207], v[44:47], a[196:199], v[192:207]
  ds_read_b64_tr_b16 v[58:59], v4 offset:47616
  v_exp_f32 v34, v34
  v_exp_f32 v35, v35
  v_add_f32 v34, 1.0, v34
  v_mfma_f32_16x16x32_bf16 v[108:111], v[240:243], v[44:47], v[108:111]
  s_waitcnt lgkmcnt(4)
  ds_read_b64_tr_b16 v[60:61], v2 offset:49152
  v_add_f32 v35, 1.0, v35
  v_mfma_f32_32x32x16_bf16 v[176:191], v[48:51], a[200:203], v[176:191]
  ds_read_b64_tr_b16 v[62:63], v2 offset:49664
  buffer_load_dwordx4 v16, s[8:11], s45 offen lds
  v_rcp_f32 v34, v34
  v_mfma_f32_32x32x16_bf16 v[192:207], v[48:51], a[204:207], v[192:207]
  s_waitcnt lgkmcnt(4)
  v_rcp_f32 v35, v35
  v_mul_f32 v34, v220, v34
  v_mul_f32 v35, v221, v35
  v_cvt_pk_bf16_f32 v218, v34, v35
  v_mul_f32 v222, v222, v30
  v_mfma_f32_32x32x16_bf16 v[176:191], v[52:55], a[208:211], v[176:191]
  ds_read_b64_tr_b16 v[44:45], v4 offset:51200
  v_mul_f32 v223, v223, v30
  v_fma_f32 v34, -v222, v222, -s49
  v_fma_f32 v35, -v223, v223, -s49
  v_mul_f32 v34, v222, v34
  v_mul_f32 v35, v223, v35
  v_mfma_f32_32x32x16_bf16 v[192:207], v[52:55], a[212:215], v[192:207]
  ds_read_b64_tr_b16 v[46:47], v4 offset:51712
  v_exp_f32 v34, v34
  v_exp_f32 v35, v35
  v_add_f32 v34, 1.0, v34
  v_mfma_f32_16x16x32_bf16 v[108:111], v[240:243], v[52:55], v[108:111]
  s_waitcnt lgkmcnt(4)
  ds_read_b64_tr_b16 v[48:49], v2 offset:53248
  v_add_f32 v35, 1.0, v35
  v_mfma_f32_32x32x16_bf16 v[176:191], v[56:59], a[216:219], v[176:191]
  ds_read_b64_tr_b16 v[50:51], v2 offset:53760
  buffer_load_dwordx4 v17, s[8:11], s45 offen offset:1024 lds
  v_rcp_f32 v34, v34
  v_mfma_f32_32x32x16_bf16 v[192:207], v[56:59], a[220:223], v[192:207]
  s_waitcnt lgkmcnt(4)
  s_add_u32 s44, s66, 0x100
  v_rcp_f32 v35, v35
  v_mul_f32 v34, v222, v34
  v_mul_f32 v35, v223, v35
  v_cvt_pk_bf16_f32 v219, v34, v35
  v_mfma_f32_32x32x16_bf16 v[176:191], v[60:63], a[224:227], v[176:191]
  ds_read_b64_tr_b16 v[52:53], v4 offset:55296
  ds_write_b128 v13, v[216:219] offset:17408
  v_mfma_f32_32x32x16_bf16 v[192:207], v[60:63], a[228:231], v[192:207]
  ds_read_b64_tr_b16 v[54:55], v4 offset:55808
  v_mul_f32 v224, v224, v31
  v_mul_f32 v225, v225, v31
  v_fma_f32 v34, -v224, v224, -s49
  v_fma_f32 v35, -v225, v225, -s49
  v_mul_f32 v34, v224, v34
  v_mfma_f32_16x16x32_bf16 v[108:111], v[240:243], v[60:63], v[108:111]
  s_waitcnt lgkmcnt(5)
  ds_read_b64_tr_b16 v[56:57], v2 offset:57344
  v_mul_f32 v35, v225, v35
  v_mfma_f32_32x32x16_bf16 v[176:191], v[44:47], a[232:235], v[176:191]
  ds_read_b64_tr_b16 v[58:59], v2 offset:57856
  v_exp_f32 v34, v34
  v_exp_f32 v35, v35
  v_add_f32 v34, 1.0, v34
  v_mfma_f32_32x32x16_bf16 v[192:207], v[44:47], a[236:239], v[192:207]
  s_waitcnt lgkmcnt(5)
  v_add_f32 v35, 1.0, v35
  v_rcp_f32 v34, v34
  v_rcp_f32 v35, v35
  v_mul_f32 v34, v224, v34
  v_mfma_f32_32x32x16_bf16 v[176:191], v[48:51], a[240:243], v[176:191]
  s_waitcnt vmcnt(12) lgkmcnt(3)
  s_barrier
  ds_read_b64_tr_b16 v[60:61], v4 offset:59392
  v_mul_f32 v35, v225, v35
  v_mfma_f32_32x32x16_bf16 v[192:207], v[48:51], a[244:247], v[192:207]
  s_add_u32 m0, s43, 0x8000
  ds_read_b64_tr_b16 v[62:63], v4 offset:59904
  v_cvt_pk_bf16_f32 v224, v34, v35
  v_mul_f32 v226, v226, v31
  v_mul_f32 v227, v227, v31
  v_fma_f32 v34, -v226, v226, -s49
  v_fma_f32 v35, -v227, v227, -s49
  v_mfma_f32_16x16x32_bf16 v[108:111], v[240:243], v[48:51], v[108:111]
  s_waitcnt lgkmcnt(4)
  ds_read_b64_tr_b16 v[44:45], v2 offset:61440
  v_mul_f32 v34, v226, v34
  v_mfma_f32_32x32x16_bf16 v[176:191], v[52:55], a[248:251], v[176:191]
  ds_read_b64_tr_b16 v[46:47], v2 offset:61952
  buffer_load_dwordx4 v16, s[8:11], s44 offen lds
  v_mul_f32 v35, v227, v35
  v_exp_f32 v34, v34
  v_mfma_f32_32x32x16_bf16 v[192:207], v[52:55], a[252:255], v[192:207]
  s_waitcnt lgkmcnt(4)
  v_exp_f32 v35, v35
  v_add_f32 v34, 1.0, v34
  v_add_f32 v35, 1.0, v35
  v_rcp_f32 v34, v34
  v_mfma_f32_32x32x16_bf16 v[176:191], v[56:59], v[64:67], v[176:191]
  ds_read_b64_tr_b16 v[48:49], v4 offset:63488
  v_rcp_f32 v35, v35
  v_mul_f32 v34, v226, v34
  v_mul_f32 v35, v227, v35
  v_cvt_pk_bf16_f32 v225, v34, v35
  v_mfma_f32_32x32x16_bf16 v[192:207], v[56:59], v[68:71], v[192:207]
  ds_read_b64_tr_b16 v[50:51], v4 offset:64000
  v_mul_f32 v228, v228, v31
  v_mul_f32 v229, v229, v31
  v_fma_f32 v34, -v228, v228, -s49
  v_fma_f32 v35, -v229, v229, -s49
  v_mul_f32 v34, v228, v34
  v_mfma_f32_16x16x32_bf16 v[108:111], v[240:243], v[56:59], v[108:111]
  s_waitcnt lgkmcnt(4)
  ds_read_b64_tr_b16 v[52:53], v3 offset:0
  v_mul_f32 v35, v229, v35
  v_mfma_f32_32x32x16_bf16 v[176:191], v[60:63], v[72:75], v[176:191]
  ds_read_b64_tr_b16 v[54:55], v3 offset:512
  buffer_load_dwordx4 v17, s[8:11], s44 offen offset:1024 lds
  v_exp_f32 v34, v34
  v_mfma_f32_32x32x16_bf16 v[192:207], v[60:63], v[76:79], v[192:207]
  s_waitcnt lgkmcnt(4)
  v_exp_f32 v35, v35
  v_add_f32 v34, 1.0, v34
  v_add_f32 v35, 1.0, v35
  v_rcp_f32 v34, v34
  v_mfma_f32_32x32x16_bf16 v[176:191], v[44:47], v[80:83], v[176:191]
  s_add_u32 s45, s67, 0x100
  ds_read_b64_tr_b16 v[56:57], v33 offset:2048
  v_rcp_f32 v35, v35
  v_mul_f32 v34, v228, v34
  v_mul_f32 v35, v229, v35
  v_cvt_pk_bf16_f32 v226, v34, v35
  v_mfma_f32_32x32x16_bf16 v[192:207], v[44:47], v[84:87], v[192:207]
  s_add_u32 m0, s43, 0xa000
  ds_read_b64_tr_b16 v[58:59], v33 offset:2560
  v_mul_f32 v230, v230, v31
  v_mul_f32 v231, v231, v31
  v_fma_f32 v34, -v230, v230, -s49
  v_fma_f32 v35, -v231, v231, -s49
  v_mul_f32 v34, v230, v34
  v_mfma_f32_16x16x32_bf16 v[108:111], v[240:243], v[44:47], v[108:111]
  s_waitcnt lgkmcnt(4)
  ds_read_b64_tr_b16 v[60:61], v3 offset:4096
  v_mul_f32 v35, v231, v35
  v_mfma_f32_32x32x16_bf16 v[176:191], v[48:51], v[88:91], v[176:191]
  ds_read_b64_tr_b16 v[62:63], v3 offset:4608
  buffer_load_dwordx4 v16, s[8:11], s45 offen lds
  v_exp_f32 v34, v34
  v_mfma_f32_32x32x16_bf16 v[192:207], v[48:51], v[92:95], v[192:207]
  s_waitcnt lgkmcnt(4)
  v_exp_f32 v35, v35
  v_add_f32 v34, 1.0, v34
  v_add_f32 v35, 1.0, v35
  v_rcp_f32 v34, v34
  v_mfma_f32_32x32x16_bf16 v[144:159], v[52:55], a[0:3], 0
  ds_read_b64_tr_b16 v[44:45], v33 offset:6144
  ds_write2_b32 v32, v108, v109 offset0:128 offset1:144
  v_rcp_f32 v35, v35
  v_mul_f32 v34, v230, v34
  v_mfma_f32_32x32x16_bf16 v[160:175], v[52:55], a[4:7], 0
  ds_read_b64_tr_b16 v[46:47], v33 offset:6656
  v_mul_f32 v35, v231, v35
  v_cvt_pk_bf16_f32 v227, v34, v35
  v_mfma_f32_16x16x32_bf16 v[244:247], v[240:243], v[52:55], 0
  s_waitcnt lgkmcnt(5)
  ds_read_b64_tr_b16 v[48:49], v3 offset:8192
  v_mfma_f32_32x32x16_bf16 v[144:159], v[56:59], a[8:11], v[144:159]
  ds_read_b64_tr_b16 v[50:51], v3 offset:8704
  buffer_load_dwordx4 v17, s[8:11], s45 offen offset:1024 lds
  v_mfma_f32_32x32x16_bf16 v[160:175], v[56:59], a[12:15], v[160:175]
  s_waitcnt lgkmcnt(5)
  ds_write_b128 v13, v[224:227] offset:18432
  v_mfma_f32_32x32x16_bf16 v[144:159], v[60:63], a[16:19], v[144:159]
  s_add_u32 s44, s24, 0x180
  v_mul_f32 v232, v232, v31
  v_mul_f32 v233, v233, v31
  v_fma_f32 v34, -v232, v232, -s49
  v_fma_f32 v35, -v233, v233, -s49
  v_mul_f32 v34, v232, v34
  v_mul_f32 v35, v233, v35
  v_mfma_f32_32x32x16_bf16 v[160:175], v[60:63], a[20:23], v[160:175]
  s_waitcnt vmcnt(12) lgkmcnt(0)
  s_barrier
  s_add_u32 m0, s43, 0xc000
  ds_read_b32 v38, v15 offset:512
  v_mfma_f32_16x16x32_bf16 v[244:247], v[240:243], v[60:63], v[244:247]
  ds_read_b64_tr_b16 v[52:53], v33 offset:10240
  v_mfma_f32_32x32x16_bf16 v[144:159], v[44:47], a[24:27], v[144:159]
  ds_read_b64_tr_b16 v[54:55], v33 offset:10752
  buffer_load_dwordx4 v16, s[8:11], s44 offen lds
  v_exp_f32 v34, v34
  v_mfma_f32_32x32x16_bf16 v[160:175], v[44:47], a[28:31], v[160:175]
  ds_read_b64_tr_b16 v[56:57], v3 offset:12288
  v_exp_f32 v35, v35
  v_add_f32 v34, 1.0, v34
  v_add_f32 v35, 1.0, v35
  v_mfma_f32_32x32x16_bf16 v[144:159], v[48:51], a[32:35], v[144:159]
  ds_read_b64_tr_b16 v[58:59], v3 offset:12800
  v_lshlrev_b32 v39, 16, v249
  v_mov_b32 v106, v249
  s_waitcnt lgkmcnt(4)
  v_cvt_pk_bf16_f32 v104, v38, v38
  v_and_b32 v105, s51, v104
  v_sub_f32 v38, v38, v105
  v_mfma_f32_32x32x16_bf16 v[160:175], v[48:51], a[36:39], v[160:175]
  v_cvt_pk_bf16_f32 v105, v38, v39
  v_rcp_f32 v34, v34
  v_rcp_f32 v35, v35
  v_mul_f32 v34, v232, v34
  v_mfma_f32_16x16x32_bf16 v[244:247], v[240:243], v[48:51], v[244:247]
  ds_read_b64_tr_b16 v[60:61], v33 offset:14336
  v_mul_f32 v35, v233, v35
  v_mfma_f32_32x32x16_bf16 v[176:191], v[104:107], v[96:99], v[176:191]
  ds_read_b64_tr_b16 v[62:63], v33 offset:14848
  buffer_load_dwordx4 v17, s[8:11], s44 offen offset:1024 lds
  v_cvt_pk_bf16_f32 v232, v34, v35
  v_mul_f32 v234, v234, v31
  v_mul_f32 v235, v235, v31
  v_mfma_f32_32x32x16_bf16 v[192:207], v[104:107], v[100:103], v[192:207]
  s_waitcnt lgkmcnt(4)
  s_add_u32 s45, s25, 0x180
  ds_read_b64_tr_b16 v[44:45], v3 offset:16384
  v_fma_f32 v34, -v234, v234, -s49
  v_fma_f32 v35, -v235, v235, -s49
  v_mul_f32 v34, v234, v34
  v_mul_f32 v35, v235, v35
  v_mfma_f32_32x32x16_bf16 v[144:159], v[52:55], a[40:43], v[144:159]
  s_add_u32 m0, s43, 0xe000
  ds_read_b64_tr_b16 v[46:47], v3 offset:16896
  v_exp_f32 v34, v34
  v_exp_f32 v35, v35
  v_add_f32 v34, 1.0, v34
  v_mfma_f32_32x32x16_bf16 v[160:175], v[52:55], a[44:47], v[160:175]
  s_waitcnt lgkmcnt(4)
  v_add_f32 v35, 1.0, v35
  v_rcp_f32 v34, v34
  v_rcp_f32 v35, v35
  v_mul_f32 v34, v234, v34
  v_mfma_f32_32x32x16_bf16 v[144:159], v[56:59], a[48:51], v[144:159]
  ds_read_b64_tr_b16 v[48:49], v33 offset:18432
  buffer_load_dwordx4 v16, s[8:11], s45 offen lds
  v_mul_f32 v35, v235, v35
  v_cvt_pk_bf16_f32 v233, v34, v35
  v_mul_f32 v236, v236, v31
  v_mfma_f32_32x32x16_bf16 v[160:175], v[56:59], a[52:55], v[160:175]
  ds_read_b64_tr_b16 v[50:51], v33 offset:18944
  v_mul_f32 v237, v237, v31
  v_fma_f32 v34, -v236, v236, -s49
  v_fma_f32 v35, -v237, v237, -s49
  v_mul_f32 v34, v236, v34
  v_mul_f32 v35, v237, v35
  v_mfma_f32_16x16x32_bf16 v[244:247], v[240:243], v[56:59], v[244:247]
  s_waitcnt lgkmcnt(4)
  ds_read_b64_tr_b16 v[52:53], v3 offset:20480
  v_mfma_f32_32x32x16_bf16 v[144:159], v[60:63], a[56:59], v[144:159]
  ds_read_b64_tr_b16 v[54:55], v3 offset:20992
  v_exp_f32 v34, v34
  v_exp_f32 v35, v35
  v_add_f32 v34, 1.0, v34
  v_mfma_f32_32x32x16_bf16 v[160:175], v[60:63], a[60:63], v[160:175]
  s_waitcnt lgkmcnt(4)
  buffer_load_dwordx4 v17, s[8:11], s45 offen offset:1024 lds
  v_add_f32 v35, 1.0, v35
  v_rcp_f32 v34, v34
  v_mfma_f32_32x32x16_bf16 v[144:159], v[44:47], a[64:67], v[144:159]
  s_add_u32 s44, s26, 0x180
  ds_read_b64_tr_b16 v[56:57], v33 offset:22528
  v_rcp_f32 v35, v35
  v_mul_f32 v34, v236, v34
  v_mul_f32 v35, v237, v35
  v_cvt_pk_bf16_f32 v234, v34, v35
  v_mfma_f32_32x32x16_bf16 v[160:175], v[44:47], a[68:71], v[160:175]
  ds_read_b64_tr_b16 v[58:59], v33 offset:23040
  v_mul_f32 v238, v238, v31
  v_mul_f32 v239, v239, v31
  v_fma_f32 v34, -v238, v238, -s49
  v_fma_f32 v35, -v239, v239, -s49
  v_mul_f32 v34, v238, v34
  v_mfma_f32_16x16x32_bf16 v[244:247], v[240:243], v[44:47], v[244:247]
  s_waitcnt lgkmcnt(4)
  ds_read_b64_tr_b16 v[60:61], v3 offset:24576
  v_mul_f32 v35, v239, v35
  v_mfma_f32_32x32x16_bf16 v[144:159], v[48:51], a[72:75], v[144:159]
  ds_read_b64_tr_b16 v[62:63], v3 offset:25088
  v_exp_f32 v34, v34
  v_exp_f32 v35, v35
  v_add_f32 v34, 1.0, v34
  v_mfma_f32_32x32x16_bf16 v[160:175], v[48:51], a[76:79], v[160:175]
  s_waitcnt lgkmcnt(4)
  v_add_f32 v35, 1.0, v35
  v_rcp_f32 v34, v34
  v_rcp_f32 v35, v35
  v_mul_f32 v34, v238, v34
  v_mfma_f32_32x32x16_bf16 v[144:159], v[52:55], a[80:83], v[144:159]
  ds_read_b64_tr_b16 v[44:45], v33 offset:26624
  v_mul_f32 v35, v239, v35
  v_cvt_pk_bf16_f32 v235, v34, v35
  v_mfma_f32_32x32x16_bf16 v[160:175], v[52:55], a[84:87], v[160:175]
  ds_read_b64_tr_b16 v[46:47], v33 offset:27136
  ds_write_b128 v13, v[232:235] offset:19456
  v_mfma_f32_16x16x32_bf16 v[244:247], v[240:243], v[52:55], v[244:247]
  s_waitcnt lgkmcnt(5)
  ds_read_b64_tr_b16 v[48:49], v3 offset:28672
  v_mul_f32 v176, v176, v30
  v_mfma_f32_32x32x16_bf16 v[144:159], v[56:59], a[88:91], v[144:159]
  s_waitcnt vmcnt(10) lgkmcnt(1)
  s_barrier
  s_add_u32 m0, s43, 0x10000
  ds_read_b64_tr_b16 v[50:51], v3 offset:29184
  v_mfma_f32_32x32x16_bf16 v[160:175], v[56:59], a[92:95], v[160:175]
  buffer_load_dwordx4 v16, s[8:11], s44 offen lds
  v_mul_f32 v177, v177, v30
  v_fma_f32 v34, -v176, v176, -s49
  v_fma_f32 v35, -v177, v177, -s49
  v_mul_f32 v34, v176, v34
  v_mfma_f32_32x32x16_bf16 v[144:159], v[60:63], a[96:99], v[144:159]
  ds_read_b64_tr_b16 v[52:53], v33 offset:30720
  v_mul_f32 v35, v177, v35
  v_exp_f32 v34, v34
  v_exp_f32 v35, v35
  v_mfma_f32_32x32x16_bf16 v[160:175], v[60:63], a[100:103], v[160:175]
  ds_read_b64_tr_b16 v[54:55], v33 offset:31232
  v_add_f32 v34, 1.0, v34
  v_add_f32 v35, 1.0, v35
  v_rcp_f32 v34, v34
  v_mfma_f32_16x16x32_bf16 v[244:247], v[240:243], v[60:63], v[244:247]
  ds_read_b64_tr_b16 v[56:57], v2 offset:8192
  v_mfma_f32_32x32x16_bf16 v[144:159], v[44:47], a[104:107], v[144:159]
  ds_read_b64_tr_b16 v[58:59], v2 offset:8704
  buffer_load_dwordx4 v17, s[8:11], s44 offen offset:1024 lds
  v_rcp_f32 v35, v35
  v_mul_f32 v34, v176, v34
  v_mfma_f32_32x32x16_bf16 v[160:175], v[44:47], a[108:111], v[160:175]
  s_waitcnt lgkmcnt(4)
  s_add_u32 s45, s27, 0x180
  s_add_u32 m0, s43, 0x12000
  v_mul_f32 v35, v177, v35
  v_cvt_pk_bf16_f32 v176, v34, v35
  v_mul_f32 v178, v178, v30
  v_mul_f32 v179, v179, v30
  v_mfma_f32_32x32x16_bf16 v[144:159], v[48:51], a[112:115], v[144:159]
  ds_read_b64_tr_b16 v[60:61], v4 offset:10240
  v_fma_f32 v34, -v178, v178, -s49
  v_fma_f32 v35, -v179, v179, -s49
  v_mul_f32 v34, v178, v34
  v_mul_f32 v35, v179, v35
  v_mfma_f32_32x32x16_bf16 v[160:175], v[48:51], a[116:119], v[160:175]
  ds_read_b64_tr_b16 v[62:63], v4 offset:10752
  v_exp_f32 v34, v34
  v_exp_f32 v35, v35
  v_add_f32 v34, 1.0, v34
  v_mfma_f32_16x16x32_bf16 v[244:247], v[240:243], v[48:51], v[244:247]
  s_waitcnt lgkmcnt(4)
  ds_read_b64_tr_b16 v[44:45], v2 offset:12288
  v_add_f32 v35, 1.0, v35
  v_mfma_f32_32x32x16_bf16 v[144:159], v[52:55], a[120:123], v[144:159]
  ds_read_b64_tr_b16 v[46:47], v2 offset:12800
  buffer_load_dwordx4 v16, s[8:11], s45 offen lds
  v_rcp_f32 v34, v34
  v_mfma_f32_32x32x16_bf16 v[160:175], v[52:55], a[124:127], v[160:175]
  s_waitcnt lgkmcnt(4)
  v_rcp_f32 v35, v35
  v_mul_f32 v34, v178, v34
  v_mul_f32 v35, v179, v35
  v_cvt_pk_bf16_f32 v177, v34, v35
  v_mul_f32 v180, v180, v30
  v_mfma_f32_32x32x16_bf16 v[144:159], v[56:59], a[128:131], v[144:159]
  ds_read_b64_tr_b16 v[48:49], v4 offset:14336
  v_mul_f32 v181, v181, v30
  v_fma_f32 v34, -v180, v180, -s49
  v_fma_f32 v35, -v181, v181, -s49
  v_mul_f32 v34, v180, v34
  v_mul_f32 v35, v181, v35
  v_mfma_f32_32x32x16_bf16 v[160:175], v[56:59], a[132:135], v[160:175]
  ds_read_b64_tr_b16 v[50:51], v4 offset:14848
  v_exp_f32 v34, v34
  v_exp_f32 v35, v35
  v_add_f32 v34, 1.0, v34
  v_mfma_f32_16x16x32_bf16 v[244:247], v[240:243], v[56:59], v[244:247]
  s_waitcnt lgkmcnt(4)
  ds_read_b64_tr_b16 v[52:53], v2 offset:16384
  v_add_f32 v35, 1.0, v35
  v_mfma_f32_32x32x16_bf16 v[144:159], v[60:63], a[136:139], v[144:159]
  ds_read_b64_tr_b16 v[54:55], v2 offset:16896
  buffer_load_dwordx4 v17, s[8:11], s45 offen offset:1024 lds
  v_rcp_f32 v34, v34
  v_mfma_f32_32x32x16_bf16 v[160:175], v[60:63], a[140:143], v[160:175]
  s_waitcnt lgkmcnt(4)
  s_add_u32 s44, s63, 0x180
  v_rcp_f32 v35, v35
  v_mul_f32 v34, v180, v34
  v_mul_f32 v35, v181, v35
  v_cvt_pk_bf16_f32 v178, v34, v35
  v_mfma_f32_32x32x16_bf16 v[144:159], v[44:47], a[144:147], v[144:159]
  ds_read_b64_tr_b16 v[56:57], v4 offset:18432
  v_mul_f32 v182, v182, v30
  v_mul_f32 v183, v183, v30
  v_fma_f32 v34, -v182, v182, -s49
  v_fma_f32 v35, -v183, v183, -s49
  v_mul_f32 v34, v182, v34
  v_mfma_f32_32x32x16_bf16 v[160:175], v[44:47], a[148:151], v[160:175]
  ds_read_b64_tr_b16 v[58:59], v4 offset:18944
  v_mul_f32 v35, v183, v35
  v_exp_f32 v34, v34
  v_exp_f32 v35, v35
  v_mfma_f32_16x16x32_bf16 v[244:247], v[240:243], v[44:47], v[244:247]
  s_waitcnt lgkmcnt(4)
  ds_read_b64_tr_b16 v[60:61], v2 offset:20480
  v_add_f32 v34, 1.0, v34
  v_mfma_f32_32x32x16_bf16 v[144:159], v[48:51], a[152:155], v[144:159]
  ds_read_b64_tr_b16 v[62:63], v2 offset:20992
  v_add_f32 v35, 1.0, v35
  v_rcp_f32 v34, v34
  v_rcp_f32 v35, v35
  v_mfma_f32_32x32x16_bf16 v[160:175], v[48:51], a[156:159], v[160:175]
  s_waitcnt lgkmcnt(4)
  v_mul_f32 v34, v182, v34
  v_mul_f32 v35, v183, v35
  v_cvt_pk_bf16_f32 v179, v34, v35
  v_mfma_f32_32x32x16_bf16 v[144:159], v[52:55], a[160:163], v[144:159]
  ds_read_b64_tr_b16 v[44:45], v4 offset:22528
  ds_write_b128 v13, v[176:179] offset:32768
  v_mfma_f32_32x32x16_bf16 v[160:175], v[52:55], a[164:167], v[160:175]
  s_waitcnt vmcnt(8)
  s_barrier
  s_add_u32 m0, s43, 0x14000
  ds_read_b64_tr_b16 v[46:47], v4 offset:23040
  v_mfma_f32_16x16x32_bf16 v[244:247], v[240:243], v[52:55], v[244:247]
  s_waitcnt lgkmcnt(5)
  ds_read_b64_tr_b16 v[48:49], v2 offset:24576
  v_mul_f32 v184, v184, v30
  v_mfma_f32_32x32x16_bf16 v[144:159], v[56:59], a[168:171], v[144:159]
  ds_read_b64_tr_b16 v[50:51], v2 offset:25088
  buffer_load_dwordx4 v16, s[8:11], s44 offen lds
  v_mul_f32 v185, v185, v30
  v_fma_f32 v34, -v184, v184, -s49
  v_fma_f32 v35, -v185, v185, -s49
  v_mfma_f32_32x32x16_bf16 v[160:175], v[56:59], a[172:175], v[160:175]
  s_waitcnt lgkmcnt(5)
  v_mul_f32 v34, v184, v34
  v_mul_f32 v35, v185, v35
  v_exp_f32 v34, v34
  v_exp_f32 v35, v35
  v_mfma_f32_32x32x16_bf16 v[144:159], v[60:63], a[176:179], v[144:159]
  ds_read_b64_tr_b16 v[52:53], v4 offset:26624
  v_add_f32 v34, 1.0, v34
  v_add_f32 v35, 1.0, v35
  v_rcp_f32 v34, v34
  v_mfma_f32_32x32x16_bf16 v[160:175], v[60:63], a[180:183], v[160:175]
  ds_read_b64_tr_b16 v[54:55], v4 offset:27136
  v_rcp_f32 v35, v35
  v_mul_f32 v34, v184, v34
  v_mul_f32 v35, v185, v35
  v_cvt_pk_bf16_f32 v184, v34, v35
  v_mfma_f32_16x16x32_bf16 v[244:247], v[240:243], v[60:63], v[244:247]
  s_waitcnt lgkmcnt(4)
  ds_read_b64_tr_b16 v[56:57], v2 offset:28672
  v_mul_f32 v186, v186, v30
  v_mfma_f32_32x32x16_bf16 v[144:159], v[44:47], a[184:187], v[144:159]
  ds_read_b64_tr_b16 v[58:59], v2 offset:29184
  buffer_load_dwordx4 v17, s[8:11], s44 offen offset:1024 lds
  v_mul_f32 v187, v187, v30
  v_fma_f32 v34, -v186, v186, -s49
  v_fma_f32 v35, -v187, v187, -s49
  v_mfma_f32_32x32x16_bf16 v[160:175], v[44:47], a[188:191], v[160:175]
  s_waitcnt lgkmcnt(4)
  s_add_u32 s45, s64, 0x180
  s_add_u32 m0, s43, 0x16000
  v_mul_f32 v34, v186, v34
  v_mul_f32 v35, v187, v35
  v_exp_f32 v34, v34
  v_mfma_f32_32x32x16_bf16 v[144:159], v[48:51], a[192:195], v[144:159]
  ds_read_b64_tr_b16 v[60:61], v4 offset:30720
  v_exp_f32 v35, v35
  v_add_f32 v34, 1.0, v34
  v_add_f32 v35, 1.0, v35
  v_mfma_f32_32x32x16_bf16 v[160:175], v[48:51], a[196:199], v[160:175]
  ds_read_b64_tr_b16 v[62:63], v4 offset:31232
  v_rcp_f32 v34, v34
  v_rcp_f32 v35, v35
  v_mul_f32 v34, v186, v34
  v_mfma_f32_16x16x32_bf16 v[244:247], v[240:243], v[48:51], v[244:247]
  s_waitcnt lgkmcnt(4)
  ds_read_b64_tr_b16 v[44:45], v2 offset:32768
  v_mul_f32 v35, v187, v35
  v_mfma_f32_32x32x16_bf16 v[144:159], v[52:55], a[200:203], v[144:159]
  ds_read_b64_tr_b16 v[46:47], v2 offset:33280
  buffer_load_dwordx4 v16, s[8:11], s45 offen lds
  v_cvt_pk_bf16_f32 v185, v34, v35
  v_mul_f32 v188, v188, v30
  v_mul_f32 v189, v189, v30
  v_mfma_f32_32x32x16_bf16 v[160:175], v[52:55], a[204:207], v[160:175]
  s_waitcnt lgkmcnt(4)
  v_fma_f32 v34, -v188, v188, -s49
  v_fma_f32 v35, -v189, v189, -s49
  v_mul_f32 v34, v188, v34
  v_mul_f32 v35, v189, v35
  v_exp_f32 v34, v34
  v_mfma_f32_32x32x16_bf16 v[144:159], v[56:59], a[208:211], v[144:159]
  ds_read_b64_tr_b16 v[48:49], v4 offset:34816
  v_exp_f32 v35, v35
  v_add_f32 v34, 1.0, v34
  v_add_f32 v35, 1.0, v35
  v_mfma_f32_32x32x16_bf16 v[160:175], v[56:59], a[212:215], v[160:175]
  ds_read_b64_tr_b16 v[50:51], v4 offset:35328
  v_rcp_f32 v34, v34
  v_rcp_f32 v35, v35
  v_mul_f32 v34, v188, v34
  v_mfma_f32_16x16x32_bf16 v[244:247], v[240:243], v[56:59], v[244:247]
  s_waitcnt lgkmcnt(4)
  ds_read_b64_tr_b16 v[52:53], v2 offset:36864
  v_mul_f32 v35, v189, v35
  v_mfma_f32_32x32x16_bf16 v[144:159], v[60:63], a[216:219], v[144:159]
  ds_read_b64_tr_b16 v[54:55], v2 offset:37376
  buffer_load_dwordx4 v17, s[8:11], s45 offen offset:1024 lds
  v_cvt_pk_bf16_f32 v186, v34, v35
  v_mul_f32 v190, v190, v30
  v_mul_f32 v191, v191, v30
  v_mfma_f32_32x32x16_bf16 v[160:175], v[60:63], a[220:223], v[160:175]
  s_waitcnt lgkmcnt(4)
  v_fma_f32 v34, -v190, v190, -s49
  v_fma_f32 v35, -v191, v191, -s49
  v_mul_f32 v34, v190, v34
  v_mul_f32 v35, v191, v35
  v_exp_f32 v34, v34
  v_mfma_f32_32x32x16_bf16 v[144:159], v[44:47], a[224:227], v[144:159]
  s_add_u32 s44, s65, 0x180
  s_add_u32 m0, s43, 0x2000
  ds_read_b64_tr_b16 v[56:57], v4 offset:38912
  v_exp_f32 v35, v35
  v_add_f32 v34, 1.0, v34
  v_add_f32 v35, 1.0, v35
  v_mfma_f32_32x32x16_bf16 v[160:175], v[44:47], a[228:231], v[160:175]
  ds_read_b64_tr_b16 v[58:59], v4 offset:39424
  v_rcp_f32 v34, v34
  v_rcp_f32 v35, v35
  v_mul_f32 v34, v190, v34
  v_mfma_f32_16x16x32_bf16 v[244:247], v[240:243], v[44:47], v[244:247]
  s_waitcnt lgkmcnt(4)
  ds_read_b64_tr_b16 v[60:61], v2 offset:40960
  v_mul_f32 v35, v191, v35
  v_mfma_f32_32x32x16_bf16 v[144:159], v[48:51], a[232:235], v[144:159]
  ds_read_b64_tr_b16 v[62:63], v2 offset:41472
  buffer_load_dwordx4 v16, s[8:11], s44 offen lds
  v_cvt_pk_bf16_f32 v187, v34, v35
  v_mfma_f32_32x32x16_bf16 v[160:175], v[48:51], a[236:239], v[160:175]
  s_waitcnt vmcnt(9)
  s_barrier
  s_waitcnt lgkmcnt(4)
  v_mfma_f32_32x32x16_bf16 v[144:159], v[52:55], a[240:243], v[144:159]
  ds_read_b64_tr_b16 v[44:45], v4 offset:43008
  ds_write_b128 v13, v[184:187] offset:33792
  v_mfma_f32_32x32x16_bf16 v[160:175], v[52:55], a[244:247], v[160:175]
  ds_read_b64_tr_b16 v[46:47], v4 offset:43520
  v_mul_f32 v192, v192, v31
  v_mul_f32 v193, v193, v31
  v_fma_f32 v34, -v192, v192, -s49
  v_fma_f32 v35, -v193, v193, -s49
  v_mul_f32 v34, v192, v34
  v_mfma_f32_16x16x32_bf16 v[244:247], v[240:243], v[52:55], v[244:247]
  s_waitcnt lgkmcnt(5)
  ds_read_b64_tr_b16 v[48:49], v2 offset:45056
  v_mul_f32 v35, v193, v35
  v_mfma_f32_32x32x16_bf16 v[144:159], v[56:59], a[248:251], v[144:159]
  ds_read_b64_tr_b16 v[50:51], v2 offset:45568
  buffer_load_dwordx4 v17, s[8:11], s44 offen offset:1024 lds
  v_exp_f32 v34, v34
  v_mfma_f32_32x32x16_bf16 v[160:175], v[56:59], a[252:255], v[160:175]
  s_waitcnt lgkmcnt(5)
  v_exp_f32 v35, v35
  v_add_f32 v34, 1.0, v34
  v_add_f32 v35, 1.0, v35
  v_rcp_f32 v34, v34
  v_mfma_f32_32x32x16_bf16 v[144:159], v[60:63], v[64:67], v[144:159]
  s_add_u32 s45, s66, 0x180
  ds_read_b64_tr_b16 v[52:53], v4 offset:47104
  v_rcp_f32 v35, v35
  v_mul_f32 v34, v192, v34
  v_mul_f32 v35, v193, v35
  v_cvt_pk_bf16_f32 v192, v34, v35
  v_mfma_f32_32x32x16_bf16 v[160:175], v[60:63], v[68:71], v[160:175]
  s_add_u32 m0, s43, 0x4000
  ds_read_b64_tr_b16 v[54:55], v4 offset:47616
  v_mul_f32 v194, v194, v31
  v_mul_f32 v195, v195, v31
  v_fma_f32 v34, -v194, v194, -s49
  v_fma_f32 v35, -v195, v195, -s49
  v_mul_f32 v34, v194, v34
  v_mfma_f32_16x16x32_bf16 v[244:247], v[240:243], v[60:63], v[244:247]
  s_waitcnt lgkmcnt(4)
  ds_read_b64_tr_b16 v[56:57], v2 offset:49152
  v_mul_f32 v35, v195, v35
  v_mfma_f32_32x32x16_bf16 v[144:159], v[44:47], v[72:75], v[144:159]
  ds_read_b64_tr_b16 v[58:59], v2 offset:49664
  buffer_load_dwordx4 v16, s[8:11], s45 offen lds
  v_exp_f32 v34, v34
  v_mfma_f32_32x32x16_bf16 v[160:175], v[44:47], v[76:79], v[160:175]
  s_waitcnt lgkmcnt(4)
  v_exp_f32 v35, v35
  v_add_f32 v34, 1.0, v34
  v_add_f32 v35, 1.0, v35
  v_rcp_f32 v34, v34
  v_mfma_f32_32x32x16_bf16 v[144:159], v[48:51], v[80:83], v[144:159]
  ds_read_b64_tr_b16 v[60:61], v4 offset:51200
  v_rcp_f32 v35, v35
  v_mul_f32 v34, v194, v34
  v_mul_f32 v35, v195, v35
  v_cvt_pk_bf16_f32 v193, v34, v35
  v_mfma_f32_32x32x16_bf16 v[160:175], v[48:51], v[84:87], v[160:175]
  ds_read_b64_tr_b16 v[62:63], v4 offset:51712
  v_mul_f32 v196, v196, v31
  v_mul_f32 v197, v197, v31
  v_fma_f32 v34, -v196, v196, -s49
  v_fma_f32 v35, -v197, v197, -s49
  v_mul_f32 v34, v196, v34
  v_mfma_f32_16x16x32_bf16 v[244:247], v[240:243], v[48:51], v[244:247]
  s_waitcnt lgkmcnt(4)
  ds_read_b64_tr_b16 v[44:45], v2 offset:53248
  v_mul_f32 v35, v197, v35
  v_mfma_f32_32x32x16_bf16 v[144:159], v[52:55], v[88:91], v[144:159]
  ds_read_b64_tr_b16 v[46:47], v2 offset:53760
  buffer_load_dwordx4 v17, s[8:11], s45 offen offset:1024 lds
  v_exp_f32 v34, v34
  v_mfma_f32_32x32x16_bf16 v[160:175], v[52:55], v[92:95], v[160:175]
  s_waitcnt lgkmcnt(4)
  v_exp_f32 v35, v35
  v_add_f32 v34, 1.0, v34
  v_add_f32 v35, 1.0, v35
  v_rcp_f32 v34, v34
  v_mfma_f32_32x32x16_bf16 v[208:223], v[56:59], a[0:3], 0
  s_add_u32 s44, s67, 0x180
  ds_read_b64_tr_b16 v[48:49], v4 offset:55296
  ds_write2_b32 v32, v244, v245 offset0:0 offset1:16
  v_rcp_f32 v35, v35
  v_mul_f32 v34, v196, v34
  v_mfma_f32_32x32x16_bf16 v[224:239], v[56:59], a[4:7], 0
  s_add_u32 m0, s43, 0x6000
  ds_read_b64_tr_b16 v[50:51], v4 offset:55808
  v_mul_f32 v35, v197, v35
  v_cvt_pk_bf16_f32 v194, v34, v35
  v_mul_f32 v198, v198, v31
  v_mul_f32 v199, v199, v31
  v_fma_f32 v34, -v198, v198, -s49
  v_mfma_f32_16x16x32_bf16 v[108:111], v[240:243], v[56:59], 0
  s_waitcnt lgkmcnt(5)
  ds_read_b64_tr_b16 v[52:53], v2 offset:57344
  v_fma_f32 v35, -v199, v199, -s49
  v_mfma_f32_32x32x16_bf16 v[208:223], v[60:63], a[8:11], v[208:223]
  ds_read_b64_tr_b16 v[54:55], v2 offset:57856
  buffer_load_dwordx4 v16, s[8:11], s44 offen lds
  v_mul_f32 v34, v198, v34
  v_mul_f32 v35, v199, v35
  v_mfma_f32_32x32x16_bf16 v[224:239], v[60:63], a[12:15], v[224:239]
  s_waitcnt lgkmcnt(5)
  v_exp_f32 v34, v34
  v_exp_f32 v35, v35
  v_add_f32 v34, 1.0, v34
  v_add_f32 v35, 1.0, v35
  v_mfma_f32_32x32x16_bf16 v[208:223], v[44:47], a[16:19], v[208:223]
  v_rcp_f32 v34, v34
  v_rcp_f32 v35, v35
  v_mul_f32 v34, v198, v34
  v_mul_f32 v35, v199, v35
  v_mfma_f32_32x32x16_bf16 v[224:239], v[44:47], a[20:23], v[224:239]
  s_waitcnt vmcnt(9) lgkmcnt(3)
  s_barrier
  ds_read_b32 v38, v15 offset:0
  v_cvt_pk_bf16_f32 v195, v34, v35
  v_mfma_f32_16x16x32_bf16 v[108:111], v[240:243], v[44:47], v[108:111]
  s_waitcnt lgkmcnt(3)
  ds_read_b64_tr_b16 v[56:57], v4 offset:59392
  v_mfma_f32_32x32x16_bf16 v[208:223], v[48:51], a[24:27], v[208:223]
  ds_read_b64_tr_b16 v[58:59], v4 offset:59904
  buffer_load_dwordx4 v17, s[8:11], s44 offen offset:1024 lds
  v_mfma_f32_32x32x16_bf16 v[224:239], v[48:51], a[28:31], v[224:239]
  s_waitcnt lgkmcnt(3)
  ds_read_b64_tr_b16 v[60:61], v2 offset:61440
  ds_write_b128 v13, v[192:195] offset:34816
  v_mfma_f32_32x32x16_bf16 v[208:223], v[52:55], a[32:35], v[208:223]
  s_add_u32 s45, s24, 0x200
  ds_read_b64_tr_b16 v[62:63], v2 offset:61952
  v_lshlrev_b32 v39, 16, v250
  v_mov_b32 v106, v250
  s_waitcnt lgkmcnt(5)
  v_cvt_pk_bf16_f32 v104, v38, v38
  v_and_b32 v105, s51, v104
  v_sub_f32 v38, v38, v105
  v_mfma_f32_32x32x16_bf16 v[224:239], v[52:55], a[36:39], v[224:239]
  s_add_u32 m0, s43, 0x8000
  v_cvt_pk_bf16_f32 v105, v38, v39
  v_mul_f32 v200, v200, v31
  v_mul_f32 v201, v201, v31
  v_fma_f32 v34, -v200, v200, -s49
  v_fma_f32 v35, -v201, v201, -s49
  v_mul_f32 v34, v200, v34
  v_mfma_f32_16x16x32_bf16 v[108:111], v[240:243], v[52:55], v[108:111]
  ds_read_b64_tr_b16 v[44:45], v4 offset:63488
  v_mul_f32 v35, v201, v35
  v_mfma_f32_32x32x16_bf16 v[144:159], v[104:107], v[96:99], v[144:159]
  ds_read_b64_tr_b16 v[46:47], v4 offset:64000
  buffer_load_dwordx4 v16, s[8:11], s45 offen lds
  v_exp_f32 v34, v34
  v_mfma_f32_32x32x16_bf16 v[160:175], v[104:107], v[100:103], v[160:175]
  s_waitcnt lgkmcnt(5)
  ds_read_b64_tr_b16 v[48:49], v3 offset:0
  v_exp_f32 v35, v35
  v_add_f32 v34, 1.0, v34
  v_add_f32 v35, 1.0, v35
  v_mfma_f32_32x32x16_bf16 v[208:223], v[56:59], a[40:43], v[208:223]
  ds_read_b64_tr_b16 v[50:51], v3 offset:512
  v_rcp_f32 v34, v34
  v_rcp_f32 v35, v35
  v_mul_f32 v34, v200, v34
  v_mfma_f32_32x32x16_bf16 v[224:239], v[56:59], a[44:47], v[224:239]
  s_waitcnt lgkmcnt(4)
  v_mul_f32 v35, v201, v35
  v_cvt_pk_bf16_f32 v200, v34, v35
  v_mul_f32 v202, v202, v31
  v_mul_f32 v203, v203, v31
  v_fma_f32 v34, -v202, v202, -s49
  v_fma_f32 v35, -v203, v203, -s49
  v_mfma_f32_32x32x16_bf16 v[208:223], v[60:63], a[48:51], v[208:223]
  ds_read_b64_tr_b16 v[52:53], v33 offset:2048
  buffer_load_dwordx4 v17, s[8:11], s45 offen offset:1024 lds
  v_mul_f32 v34, v202, v34
  v_mul_f32 v35, v203, v35
  v_mfma_f32_32x32x16_bf16 v[224:239], v[60:63], a[52:55], v[224:239]
  s_add_u32 s44, s25, 0x200
  ds_read_b64_tr_b16 v[54:55], v33 offset:2560
  v_exp_f32 v34, v34
  v_exp_f32 v35, v35
  v_add_f32 v34, 1.0, v34
  v_mfma_f32_16x16x32_bf16 v[108:111], v[240:243], v[60:63], v[108:111]
  s_waitcnt lgkmcnt(4)
  ds_read_b64_tr_b16 v[56:57], v3 offset:4096
  v_add_f32 v35, 1.0, v35
  v_mfma_f32_32x32x16_bf16 v[208:223], v[44:47], a[56:59], v[208:223]
  s_add_u32 m0, s43, 0xa000
  ds_read_b64_tr_b16 v[58:59], v3 offset:4608
  v_rcp_f32 v34, v34
  v_rcp_f32 v35, v35
  v_mul_f32 v34, v202, v34
  v_mfma_f32_32x32x16_bf16 v[224:239], v[44:47], a[60:63], v[224:239]
  s_waitcnt lgkmcnt(4)
  buffer_load_dwordx4 v16, s[8:11], s44 offen lds
  v_mul_f32 v35, v203, v35
  v_cvt_pk_bf16_f32 v201, v34, v35
  v_mul_f32 v204, v204, v31
  v_mul_f32 v205, v205, v31
  v_mfma_f32_32x32x16_bf16 v[208:223], v[48:51], a[64:67], v[208:223]
  ds_read_b64_tr_b16 v[60:61], v33 offset:6144
  v_fma_f32 v34, -v204, v204, -s49
  v_fma_f32 v35, -v205, v205, -s49
  v_mul_f32 v34, v204, v34
  v_mul_f32 v35, v205, v35
  v_mfma_f32_32x32x16_bf16 v[224:239], v[48:51], a[68:71], v[224:239]
  ds_read_b64_tr_b16 v[62:63], v33 offset:6656
  v_exp_f32 v34, v34
  v_exp_f32 v35, v35
  v_add_f32 v34, 1.0, v34
  v_mfma_f32_16x16x32_bf16 v[108:111], v[240:243], v[48:51], v[108:111]
  s_waitcnt lgkmcnt(4)
  ds_read_b64_tr_b16 v[44:45], v3 offset:8192
  v_add_f32 v35, 1.0, v35
  v_mfma_f32_32x32x16_bf16 v[208:223], v[52:55], a[72:75], v[208:223]
  ds_read_b64_tr_b16 v[46:47], v3 offset:8704
  buffer_load_dwordx4 v17, s[8:11], s44 offen offset:1024 lds
  v_rcp_f32 v34, v34
  v_mfma_f32_32x32x16_bf16 v[224:239], v[52:55], a[76:79], v[224:239]
  s_waitcnt lgkmcnt(4)
  v_rcp_f32 v35, v35
  v_mul_f32 v34, v204, v34
  v_mul_f32 v35, v205, v35
  v_cvt_pk_bf16_f32 v202, v34, v35
  v_mul_f32 v206, v206, v31
  v_mfma_f32_32x32x16_bf16 v[208:223], v[56:59], a[80:83], v[208:223]
  s_add_u32 s45, s26, 0x200
  ds_read_b64_tr_b16 v[48:49], v33 offset:10240
  v_mul_f32 v207, v207, v31
  v_fma_f32 v34, -v206, v206, -s49
  v_fma_f32 v35, -v207, v207, -s49
  v_mul_f32 v34, v206, v34
  v_mul_f32 v35, v207, v35
  v_mfma_f32_32x32x16_bf16 v[224:239], v[56:59], a[84:87], v[224:239]
  ds_read_b64_tr_b16 v[50:51], v33 offset:10752
  v_exp_f32 v34, v34
  v_exp_f32 v35, v35
  v_add_f32 v34, 1.0, v34
  v_mfma_f32_16x16x32_bf16 v[108:111], v[240:243], v[56:59], v[108:111]
  s_waitcnt lgkmcnt(4)
  ds_read_b64_tr_b16 v[52:53], v3 offset:12288
  v_add_f32 v35, 1.0, v35
  v_mfma_f32_32x32x16_bf16 v[208:223], v[60:63], a[88:91], v[208:223]
  s_waitcnt vmcnt(10)
  s_barrier
  s_add_u32 m0, s43, 0xc000
  ds_read_b64_tr_b16 v[54:55], v3 offset:12800
  v_mfma_f32_32x32x16_bf16 v[224:239], v[60:63], a[92:95], v[224:239]
  s_waitcnt lgkmcnt(4)
  buffer_load_dwordx4 v16, s[8:11], s45 offen lds
  v_rcp_f32 v34, v34
  v_rcp_f32 v35, v35
  v_mfma_f32_32x32x16_bf16 v[208:223], v[44:47], a[96:99], v[208:223]
  ds_read_b64_tr_b16 v[56:57], v33 offset:14336
  v_mul_f32 v34, v206, v34
  v_mul_f32 v35, v207, v35
  v_cvt_pk_bf16_f32 v203, v34, v35
  v_mfma_f32_32x32x16_bf16 v[224:239], v[44:47], a[100:103], v[224:239]
  ds_read_b64_tr_b16 v[58:59], v33 offset:14848
  ds_write_b128 v13, v[200:203] offset:35840
  v_mfma_f32_16x16x32_bf16 v[108:111], v[240:243], v[44:47], v[108:111]
  s_waitcnt lgkmcnt(5)
  ds_read_b64_tr_b16 v[60:61], v3 offset:16384
  v_mul_f32 v144, v144, v30
  v_mfma_f32_32x32x16_bf16 v[208:223], v[48:51], a[104:107], v[208:223]
  ds_read_b64_tr_b16 v[62:63], v3 offset:16896
  buffer_load_dwordx4 v17, s[8:11], s45 offen offset:1024 lds
  v_mul_f32 v145, v145, v30
  v_fma_f32 v34, -v144, v144, -s49
  v_fma_f32 v35, -v145, v145, -s49
  v_mfma_f32_32x32x16_bf16 v[224:239], v[48:51], a[108:111], v[224:239]
  s_waitcnt lgkmcnt(5)
  s_add_u32 s44, s27, 0x200
  s_add_u32 m0, s43, 0xe000
  v_mul_f32 v34, v144, v34
  v_mul_f32 v35, v145, v35
  v_exp_f32 v34, v34
  v_mfma_f32_32x32x16_bf16 v[208:223], v[52:55], a[112:115], v[208:223]
  ds_read_b64_tr_b16 v[44:45], v33 offset:18432
  v_exp_f32 v35, v35
  v_add_f32 v34, 1.0, v34
  v_add_f32 v35, 1.0, v35
  v_mfma_f32_32x32x16_bf16 v[224:239], v[52:55], a[116:119], v[224:239]
  ds_read_b64_tr_b16 v[46:47], v33 offset:18944
  v_rcp_f32 v34, v34
  v_rcp_f32 v35, v35
  v_mul_f32 v34, v144, v34
  v_mfma_f32_16x16x32_bf16 v[108:111], v[240:243], v[52:55], v[108:111]
  s_waitcnt lgkmcnt(5)
  ds_read_b64_tr_b16 v[48:49], v3 offset:20480
  v_mul_f32 v35, v145, v35
  v_mfma_f32_32x32x16_bf16 v[208:223], v[56:59], a[120:123], v[208:223]
  ds_read_b64_tr_b16 v[50:51], v3 offset:20992
  buffer_load_dwordx4 v16, s[8:11], s44 offen lds
  v_cvt_pk_bf16_f32 v144, v34, v35
  v_mul_f32 v146, v146, v30
  v_mul_f32 v147, v147, v30
  v_mfma_f32_32x32x16_bf16 v[224:239], v[56:59], a[124:127], v[224:239]
  s_waitcnt lgkmcnt(4)
  v_fma_f32 v34, -v146, v146, -s49
  v_fma_f32 v35, -v147, v147, -s49
  v_mul_f32 v34, v146, v34
  v_mul_f32 v35, v147, v35
  v_exp_f32 v34, v34
  v_mfma_f32_32x32x16_bf16 v[208:223], v[60:63], a[128:131], v[208:223]
  ds_read_b64_tr_b16 v[52:53], v33 offset:22528
  v_exp_f32 v35, v35
  v_add_f32 v34, 1.0, v34
  v_add_f32 v35, 1.0, v35
  v_mfma_f32_32x32x16_bf16 v[224:239], v[60:63], a[132:135], v[224:239]
  ds_read_b64_tr_b16 v[54:55], v33 offset:23040
  v_rcp_f32 v34, v34
  v_rcp_f32 v35, v35
  v_mul_f32 v34, v146, v34
  v_mfma_f32_16x16x32_bf16 v[108:111], v[240:243], v[60:63], v[108:111]
  s_waitcnt lgkmcnt(4)
  ds_read_b64_tr_b16 v[56:57], v3 offset:24576
  v_mul_f32 v35, v147, v35
  v_mfma_f32_32x32x16_bf16 v[208:223], v[44:47], a[136:139], v[208:223]
  ds_read_b64_tr_b16 v[58:59], v3 offset:25088
  buffer_load_dwordx4 v17, s[8:11], s44 offen offset:1024 lds
  v_cvt_pk_bf16_f32 v145, v34, v35
  v_mul_f32 v148, v148, v30
  v_mul_f32 v149, v149, v30
  v_mfma_f32_32x32x16_bf16 v[224:239], v[44:47], a[140:143], v[224:239]
  s_waitcnt lgkmcnt(4)
  s_add_u32 s45, s63, 0x200
  v_fma_f32 v34, -v148, v148, -s49
  v_fma_f32 v35, -v149, v149, -s49
  v_mul_f32 v34, v148, v34
  v_mul_f32 v35, v149, v35
  v_mfma_f32_32x32x16_bf16 v[208:223], v[48:51], a[144:147], v[208:223]
  ds_read_b64_tr_b16 v[60:61], v33 offset:26624
  v_exp_f32 v34, v34
  v_exp_f32 v35, v35
  v_add_f32 v34, 1.0, v34
  v_mfma_f32_32x32x16_bf16 v[224:239], v[48:51], a[148:151], v[224:239]
  ds_read_b64_tr_b16 v[62:63], v33 offset:27136
  v_add_f32 v35, 1.0, v35
  v_rcp_f32 v34, v34
  v_rcp_f32 v35, v35
  v_mfma_f32_16x16x32_bf16 v[108:111], v[240:243], v[48:51], v[108:111]
  s_waitcnt lgkmcnt(4)
  ds_read_b64_tr_b16 v[44:45], v3 offset:28672
  v_mul_f32 v34, v148, v34
  v_mfma_f32_32x32x16_bf16 v[208:223], v[52:55], a[152:155], v[208:223]
  ds_read_b64_tr_b16 v[46:47], v3 offset:29184
  v_mul_f32 v35, v149, v35
  v_cvt_pk_bf16_f32 v146, v34, v35
  v_mul_f32 v150, v150, v30
  v_mul_f32 v151, v151, v30
  v_fma_f32 v34, -v150, v150, -s49
  v_mfma_f32_32x32x16_bf16 v[224:239], v[52:55], a[156:159], v[224:239]
  s_waitcnt lgkmcnt(4)
  v_fma_f32 v35, -v151, v151, -s49
  v_mul_f32 v34, v150, v34
  v_mul_f32 v35, v151, v35
  v_exp_f32 v34, v34
  v_mfma_f32_32x32x16_bf16 v[208:223], v[56:59], a[160:163], v[208:223]
  ds_read_b64_tr_b16 v[48:49], v33 offset:30720
  v_exp_f32 v35, v35
  v_add_f32 v34, 1.0, v34
  v_add_f32 v35, 1.0, v35
  v_mfma_f32_32x32x16_bf16 v[224:239], v[56:59], a[164:167], v[224:239]
  s_waitcnt vmcnt(8)
  s_barrier
  s_add_u32 m0, s43, 0x10000
  ds_read_b64_tr_b16 v[50:51], v33 offset:31232
  v_mfma_f32_16x16x32_bf16 v[108:111], v[240:243], v[56:59], v[108:111]
  s_waitcnt lgkmcnt(4)
  ds_read_b64_tr_b16 v[52:53], v2 offset:8192
  v_mfma_f32_32x32x16_bf16 v[208:223], v[60:63], a[168:171], v[208:223]
  ds_read_b64_tr_b16 v[54:55], v2 offset:8704
  buffer_load_dwordx4 v16, s[8:11], s45 offen lds
  v_rcp_f32 v34, v34
  v_mfma_f32_32x32x16_bf16 v[224:239], v[60:63], a[172:175], v[224:239]
  s_waitcnt lgkmcnt(4)
  v_rcp_f32 v35, v35
  v_mul_f32 v34, v150, v34
  v_mul_f32 v35, v151, v35
  v_cvt_pk_bf16_f32 v147, v34, v35
  v_mfma_f32_32x32x16_bf16 v[208:223], v[44:47], a[176:179], v[208:223]
  ds_read_b64_tr_b16 v[56:57], v4 offset:10240
  ds_write_b128 v13, v[144:147] offset:49152
  v_mfma_f32_32x32x16_bf16 v[224:239], v[44:47], a[180:183], v[224:239]
  ds_read_b64_tr_b16 v[58:59], v4 offset:10752
  v_mul_f32 v152, v152, v30
  v_mul_f32 v153, v153, v30
  v_fma_f32 v34, -v152, v152, -s49
  v_fma_f32 v35, -v153, v153, -s49
  v_mul_f32 v34, v152, v34
  v_mfma_f32_16x16x32_bf16 v[108:111], v[240:243], v[44:47], v[108:111]
  s_waitcnt lgkmcnt(5)
  ds_read_b64_tr_b16 v[60:61], v2 offset:12288
  v_mul_f32 v35, v153, v35
  v_mfma_f32_32x32x16_bf16 v[208:223], v[48:51], a[184:187], v[208:223]
  ds_read_b64_tr_b16 v[62:63], v2 offset:12800
  buffer_load_dwordx4 v17, s[8:11], s45 offen offset:1024 lds
  v_exp_f32 v34, v34
  v_mfma_f32_32x32x16_bf16 v[224:239], v[48:51], a[188:191], v[224:239]
  s_waitcnt lgkmcnt(5)
  s_add_u32 s44, s64, 0x200
  s_add_u32 m0, s43, 0x12000
  v_exp_f32 v35, v35
  v_add_f32 v34, 1.0, v34
  v_add_f32 v35, 1.0, v35
  v_mfma_f32_32x32x16_bf16 v[208:223], v[52:55], a[192:195], v[208:223]
  ds_read_b64_tr_b16 v[44:45], v4 offset:14336
  v_rcp_f32 v34, v34
  v_rcp_f32 v35, v35
  v_mul_f32 v34, v152, v34
  v_mfma_f32_32x32x16_bf16 v[224:239], v[52:55], a[196:199], v[224:239]
  ds_read_b64_tr_b16 v[46:47], v4 offset:14848
  v_mul_f32 v35, v153, v35
  v_cvt_pk_bf16_f32 v152, v34, v35
  v_mul_f32 v154, v154, v30
  v_mul_f32 v155, v155, v30
  v_fma_f32 v34, -v154, v154, -s49
  v_mfma_f32_16x16x32_bf16 v[108:111], v[240:243], v[52:55], v[108:111]
  s_waitcnt lgkmcnt(4)
  ds_read_b64_tr_b16 v[48:49], v2 offset:16384
  v_fma_f32 v35, -v155, v155, -s49
  v_mfma_f32_32x32x16_bf16 v[208:223], v[56:59], a[200:203], v[208:223]
  ds_read_b64_tr_b16 v[50:51], v2 offset:16896
  buffer_load_dwordx4 v16, s[8:11], s44 offen lds
  v_mul_f32 v34, v154, v34
  v_mul_f32 v35, v155, v35
  v_mfma_f32_32x32x16_bf16 v[224:239], v[56:59], a[204:207], v[224:239]
  s_waitcnt lgkmcnt(4)
  v_exp_f32 v34, v34
  v_exp_f32 v35, v35
  v_add_f32 v34, 1.0, v34
  v_add_f32 v35, 1.0, v35
  v_mfma_f32_32x32x16_bf16 v[208:223], v[60:63], a[208:211], v[208:223]
  ds_read_b64_tr_b16 v[52:53], v4 offset:18432
  v_rcp_f32 v34, v34
  v_rcp_f32 v35, v35
  v_mul_f32 v34, v154, v34
  v_mfma_f32_32x32x16_bf16 v[224:239], v[60:63], a[212:215], v[224:239]
  ds_read_b64_tr_b16 v[54:55], v4 offset:18944
  v_mul_f32 v35, v155, v35
  v_cvt_pk_bf16_f32 v153, v34, v35
  v_mul_f32 v156, v156, v30
  v_mul_f32 v157, v157, v30
  v_fma_f32 v34, -v156, v156, -s49
  v_mfma_f32_16x16x32_bf16 v[108:111], v[240:243], v[60:63], v[108:111]
  s_waitcnt lgkmcnt(4)
  ds_read_b64_tr_b16 v[56:57], v2 offset:20480
  v_fma_f32 v35, -v157, v157, -s49
  v_mfma_f32_32x32x16_bf16 v[208:223], v[44:47], a[216:219], v[208:223]
  ds_read_b64_tr_b16 v[58:59], v2 offset:20992
  buffer_load_dwordx4 v17, s[8:11], s44 offen offset:1024 lds
  v_mul_f32 v34, v156, v34
  v_mul_f32 v35, v157, v35
  v_mfma_f32_32x32x16_bf16 v[224:239], v[44:47], a[220:223], v[224:239]
  s_waitcnt lgkmcnt(4)
  v_exp_f32 v34, v34
  v_exp_f32 v35, v35
  v_add_f32 v34, 1.0, v34
  v_add_f32 v35, 1.0, v35
  v_mfma_f32_32x32x16_bf16 v[208:223], v[48:51], a[224:227], v[208:223]
  s_add_u32 s45, s65, 0x200
  ds_read_b64_tr_b16 v[60:61], v4 offset:22528
  v_rcp_f32 v34, v34
  v_rcp_f32 v35, v35
  v_mul_f32 v34, v156, v34
  v_mfma_f32_32x32x16_bf16 v[224:239], v[48:51], a[228:231], v[224:239]
  s_add_u32 m0, s43, 0x14000
  ds_read_b64_tr_b16 v[62:63], v4 offset:23040
  v_mul_f32 v35, v157, v35
  v_cvt_pk_bf16_f32 v154, v34, v35
  v_mul_f32 v158, v158, v30
  v_mul_f32 v159, v159, v30
  v_fma_f32 v34, -v158, v158, -s49
  v_mfma_f32_16x16x32_bf16 v[108:111], v[240:243], v[48:51], v[108:111]
  s_waitcnt lgkmcnt(4)
  ds_read_b64_tr_b16 v[44:45], v2 offset:24576
  v_fma_f32 v35, -v159, v159, -s49
  v_mfma_f32_32x32x16_bf16 v[208:223], v[52:55], a[232:235], v[208:223]
  ds_read_b64_tr_b16 v[46:47], v2 offset:25088
  buffer_load_dwordx4 v16, s[8:11], s45 offen lds
  v_mul_f32 v34, v158, v34
  v_mul_f32 v35, v159, v35
  v_mfma_f32_32x32x16_bf16 v[224:239], v[52:55], a[236:239], v[224:239]
  s_waitcnt vmcnt(9)
  s_barrier
  s_waitcnt lgkmcnt(4)
  v_mfma_f32_32x32x16_bf16 v[208:223], v[56:59], a[240:243], v[208:223]
  ds_read_b64_tr_b16 v[48:49], v4 offset:26624
  v_exp_f32 v34, v34
  v_exp_f32 v35, v35
  v_add_f32 v34, 1.0, v34
  v_mfma_f32_32x32x16_bf16 v[224:239], v[56:59], a[244:247], v[224:239]
  ds_read_b64_tr_b16 v[50:51], v4 offset:27136
  v_add_f32 v35, 1.0, v35
  v_rcp_f32 v34, v34
  v_rcp_f32 v35, v35
  v_mfma_f32_16x16x32_bf16 v[108:111], v[240:243], v[56:59], v[108:111]
  s_waitcnt lgkmcnt(4)
  ds_read_b64_tr_b16 v[52:53], v2 offset:28672
  v_mul_f32 v34, v158, v34
  v_mfma_f32_32x32x16_bf16 v[208:223], v[60:63], a[248:251], v[208:223]
  ds_read_b64_tr_b16 v[54:55], v2 offset:29184
  buffer_load_dwordx4 v17, s[8:11], s45 offen offset:1024 lds
  v_mul_f32 v35, v159, v35
  v_cvt_pk_bf16_f32 v155, v34, v35
  v_mfma_f32_32x32x16_bf16 v[224:239], v[60:63], a[252:255], v[224:239]
  s_waitcnt lgkmcnt(4)
  ds_write_b128 v13, v[152:155] offset:50176
  v_mfma_f32_32x32x16_bf16 v[208:223], v[44:47], v[64:67], v[208:223]
  s_add_u32 s44, s66, 0x200
  ds_read_b64_tr_b16 v[56:57], v4 offset:30720
  v_mul_f32 v160, v160, v31
  v_mul_f32 v161, v161, v31
  v_fma_f32 v34, -v160, v160, -s49
  v_fma_f32 v35, -v161, v161, -s49
  v_mul_f32 v34, v160, v34
  v_mfma_f32_32x32x16_bf16 v[224:239], v[44:47], v[68:71], v[224:239]
  s_add_u32 m0, s43, 0x16000
  ds_read_b64_tr_b16 v[58:59], v4 offset:31232
  v_mul_f32 v35, v161, v35
  v_exp_f32 v34, v34
  v_exp_f32 v35, v35
  v_mfma_f32_16x16x32_bf16 v[108:111], v[240:243], v[44:47], v[108:111]
  s_waitcnt lgkmcnt(5)
  ds_read_b64_tr_b16 v[60:61], v2 offset:32768
  v_add_f32 v34, 1.0, v34
  v_mfma_f32_32x32x16_bf16 v[208:223], v[48:51], v[72:75], v[208:223]
  ds_read_b64_tr_b16 v[62:63], v2 offset:33280
  buffer_load_dwordx4 v16, s[8:11], s44 offen lds
  v_add_f32 v35, 1.0, v35
  v_rcp_f32 v34, v34
  v_mfma_f32_32x32x16_bf16 v[224:239], v[48:51], v[76:79], v[224:239]
  s_waitcnt lgkmcnt(5)
  v_rcp_f32 v35, v35
  v_mul_f32 v34, v160, v34
  v_mul_f32 v35, v161, v35
  v_cvt_pk_bf16_f32 v160, v34, v35
  v_mul_f32 v162, v162, v31
  v_mfma_f32_32x32x16_bf16 v[208:223], v[52:55], v[80:83], v[208:223]
  ds_read_b64_tr_b16 v[44:45], v4 offset:34816
  v_mul_f32 v163, v163, v31
  v_fma_f32 v34, -v162, v162, -s49
  v_fma_f32 v35, -v163, v163, -s49
  v_mul_f32 v34, v162, v34
  v_mul_f32 v35, v163, v35
  v_mfma_f32_32x32x16_bf16 v[224:239], v[52:55], v[84:87], v[224:239]
  ds_read_b64_tr_b16 v[46:47], v4 offset:35328
  v_exp_f32 v34, v34
  v_exp_f32 v35, v35
  v_add_f32 v34, 1.0, v34
  v_mfma_f32_16x16x32_bf16 v[108:111], v[240:243], v[52:55], v[108:111]
  s_waitcnt lgkmcnt(4)
  ds_read_b64_tr_b16 v[48:49], v2 offset:36864
  v_add_f32 v35, 1.0, v35
  v_mfma_f32_32x32x16_bf16 v[208:223], v[56:59], v[88:91], v[208:223]
  ds_read_b64_tr_b16 v[50:51], v2 offset:37376
  buffer_load_dwordx4 v17, s[8:11], s44 offen offset:1024 lds
  v_rcp_f32 v34, v34
  v_mfma_f32_32x32x16_bf16 v[224:239], v[56:59], v[92:95], v[224:239]
  s_waitcnt lgkmcnt(4)
  v_rcp_f32 v35, v35
  v_mul_f32 v34, v162, v34
  v_mul_f32 v35, v163, v35
  v_cvt_pk_bf16_f32 v161, v34, v35
  v_mul_f32 v164, v164, v31
  v_mfma_f32_32x32x16_bf16 v[176:191], v[60:63], a[0:3], 0
  s_add_u32 s45, s67, 0x200
  ds_read_b64_tr_b16 v[52:53], v4 offset:38912
  ds_write2_b32 v32, v108, v109 offset0:128 offset1:144
  v_mul_f32 v165, v165, v31
  v_fma_f32 v34, -v164, v164, -s49
  v_fma_f32 v35, -v165, v165, -s49
  v_mfma_f32_32x32x16_bf16 v[192:207], v[60:63], a[4:7], 0
  s_add_u32 m0, s43, 0x2000
  ds_read_b64_tr_b16 v[54:55], v4 offset:39424
  v_mul_f32 v34, v164, v34
  v_mul_f32 v35, v165, v35
  v_exp_f32 v34, v34
  v_mfma_f32_16x16x32_bf16 v[244:247], v[240:243], v[60:63], 0
  s_waitcnt lgkmcnt(5)
  ds_read_b64_tr_b16 v[56:57], v2 offset:40960
  v_mfma_f32_32x32x16_bf16 v[176:191], v[44:47], a[8:11], v[176:191]
  ds_read_b64_tr_b16 v[58:59], v2 offset:41472
  buffer_load_dwordx4 v16, s[8:11], s45 offen lds
  v_exp_f32 v35, v35
  v_add_f32 v34, 1.0, v34
  v_mfma_f32_32x32x16_bf16 v[192:207], v[44:47], a[12:15], v[192:207]
  s_waitcnt lgkmcnt(5)
  v_add_f32 v35, 1.0, v35
  v_rcp_f32 v34, v34
  v_rcp_f32 v35, v35
  v_mul_f32 v34, v164, v34
  v_mfma_f32_32x32x16_bf16 v[176:191], v[48:51], a[16:19], v[176:191]
  v_mul_f32 v35, v165, v35
  v_cvt_pk_bf16_f32 v162, v34, v35
  v_mul_f32 v166, v166, v31
  v_mul_f32 v167, v167, v31
  v_fma_f32 v34, -v166, v166, -s49
  v_fma_f32 v35, -v167, v167, -s49
  v_mfma_f32_32x32x16_bf16 v[192:207], v[48:51], a[20:23], v[192:207]
  s_waitcnt vmcnt(9) lgkmcnt(3)
  s_barrier
  ds_read_b32 v38, v15 offset:512
  v_mul_f32 v34, v166, v34
  v_mfma_f32_16x16x32_bf16 v[244:247], v[240:243], v[48:51], v[244:247]
  s_waitcnt lgkmcnt(3)
  ds_read_b64_tr_b16 v[60:61], v4 offset:43008
  v_mul_f32 v35, v167, v35
  v_mfma_f32_32x32x16_bf16 v[176:191], v[52:55], a[24:27], v[176:191]
  ds_read_b64_tr_b16 v[62:63], v4 offset:43520
  buffer_load_dwordx4 v17, s[8:11], s45 offen offset:1024 lds
  v_exp_f32 v34, v34
  v_mfma_f32_32x32x16_bf16 v[192:207], v[52:55], a[28:31], v[192:207]
  s_waitcnt lgkmcnt(3)
  s_add_u32 s44, s24, 0x280
  ds_read_b64_tr_b16 v[44:45], v2 offset:45056
  v_exp_f32 v35, v35
  v_add_f32 v34, 1.0, v34
  v_add_f32 v35, 1.0, v35
  v_mfma_f32_32x32x16_bf16 v[176:191], v[56:59], a[32:35], v[176:191]
  s_add_u32 m0, s43, 0x4000
  ds_read_b64_tr_b16 v[46:47], v2 offset:45568
  v_lshlrev_b32 v39, 16, v251
  v_mov_b32 v106, v251
  s_waitcnt lgkmcnt(4)
  v_cvt_pk_bf16_f32 v104, v38, v38
  v_and_b32 v105, s51, v104
  v_sub_f32 v38, v38, v105
  v_mfma_f32_32x32x16_bf16 v[192:207], v[56:59], a[36:39], v[192:207]
  v_cvt_pk_bf16_f32 v105, v38, v39
  v_rcp_f32 v34, v34
  v_rcp_f32 v35, v35
  v_mul_f32 v34, v166, v34
  v_mfma_f32_16x16x32_bf16 v[244:247], v[240:243], v[56:59], v[244:247]
  ds_read_b64_tr_b16 v[48:49], v4 offset:47104
  v_mul_f32 v35, v167, v35
  v_mfma_f32_32x32x16_bf16 v[208:223], v[104:107], v[96:99], v[208:223]
  ds_read_b64_tr_b16 v[50:51], v4 offset:47616
  buffer_load_dwordx4 v16, s[8:11], s44 offen lds
  v_cvt_pk_bf16_f32 v163, v34, v35
  v_mfma_f32_32x32x16_bf16 v[224:239], v[104:107], v[100:103], v[224:239]
  s_waitcnt lgkmcnt(4)
  ds_read_b64_tr_b16 v[52:53], v2 offset:49152
  ds_write_b128 v13, v[160:163] offset:51200
  v_mfma_f32_32x32x16_bf16 v[176:191], v[60:63], a[40:43], v[176:191]
  ds_read_b64_tr_b16 v[54:55], v2 offset:49664
  v_mul_f32 v168, v168, v31
  v_mul_f32 v169, v169, v31
  v_fma_f32 v34, -v168, v168, -s49
  v_fma_f32 v35, -v169, v169, -s49
  v_mul_f32 v34, v168, v34
  v_mfma_f32_32x32x16_bf16 v[192:207], v[60:63], a[44:47], v[192:207]
  s_waitcnt lgkmcnt(5)
  v_mul_f32 v35, v169, v35
  v_exp_f32 v34, v34
  v_exp_f32 v35, v35
  v_add_f32 v34, 1.0, v34
  v_mfma_f32_32x32x16_bf16 v[176:191], v[44:47], a[48:51], v[176:191]
  ds_read_b64_tr_b16 v[56:57], v4 offset:51200
  buffer_load_dwordx4 v17, s[8:11], s44 offen offset:1024 lds
  v_add_f32 v35, 1.0, v35
  v_rcp_f32 v34, v34
  v_mfma_f32_32x32x16_bf16 v[192:207], v[44:47], a[52:55], v[192:207]
  s_add_u32 s45, s25, 0x280
  ds_read_b64_tr_b16 v[58:59], v4 offset:51712
  v_rcp_f32 v35, v35
  v_mul_f32 v34, v168, v34
  v_mul_f32 v35, v169, v35
  v_cvt_pk_bf16_f32 v168, v34, v35
  v_mfma_f32_16x16x32_bf16 v[244:247], v[240:243], v[44:47], v[244:247]
  s_waitcnt lgkmcnt(5)
  ds_read_b64_tr_b16 v[60:61], v2 offset:53248
  v_mul_f32 v170, v170, v31
  v_mfma_f32_32x32x16_bf16 v[176:191], v[48:51], a[56:59], v[176:191]
  s_add_u32 m0, s43, 0x6000
  ds_read_b64_tr_b16 v[62:63], v2 offset:53760
  v_mul_f32 v171, v171, v31
  v_fma_f32 v34, -v170, v170, -s49
  v_fma_f32 v35, -v171, v171, -s49
  v_mul_f32 v34, v170, v34
  v_mul_f32 v35, v171, v35
  v_mfma_f32_32x32x16_bf16 v[192:207], v[48:51], a[60:63], v[192:207]
  s_waitcnt lgkmcnt(4)
  buffer_load_dwordx4 v16, s[8:11], s45 offen lds
  v_exp_f32 v34, v34
  v_exp_f32 v35, v35
  v_mfma_f32_32x32x16_bf16 v[176:191], v[52:55], a[64:67], v[176:191]
  ds_read_b64_tr_b16 v[44:45], v4 offset:55296
  v_add_f32 v34, 1.0, v34
  v_add_f32 v35, 1.0, v35
  v_rcp_f32 v34, v34
  v_mfma_f32_32x32x16_bf16 v[192:207], v[52:55], a[68:71], v[192:207]
  ds_read_b64_tr_b16 v[46:47], v4 offset:55808
  v_rcp_f32 v35, v35
  v_mul_f32 v34, v170, v34
  v_mul_f32 v35, v171, v35
  v_cvt_pk_bf16_f32 v169, v34, v35
  v_mfma_f32_16x16x32_bf16 v[244:247], v[240:243], v[52:55], v[244:247]
  s_waitcnt lgkmcnt(4)
  ds_read_b64_tr_b16 v[48:49], v2 offset:57344
  v_mul_f32 v172, v172, v31
  v_mfma_f32_32x32x16_bf16 v[176:191], v[56:59], a[72:75], v[176:191]
  ds_read_b64_tr_b16 v[50:51], v2 offset:57856
  buffer_load_dwordx4 v17, s[8:11], s45 offen offset:1024 lds
  v_mul_f32 v173, v173, v31
  v_fma_f32 v34, -v172, v172, -s49
  v_fma_f32 v35, -v173, v173, -s49
  v_mfma_f32_32x32x16_bf16 v[192:207], v[56:59], a[76:79], v[192:207]
  s_waitcnt lgkmcnt(4)
  v_mul_f32 v34, v172, v34
  v_mul_f32 v35, v173, v35
  v_exp_f32 v34, v34
  v_exp_f32 v35, v35
  v_mfma_f32_32x32x16_bf16 v[176:191], v[60:63], a[80:83], v[176:191]
  s_add_u32 s44, s26, 0x280
  ds_read_b64_tr_b16 v[52:53], v4 offset:59392
  v_add_f32 v34, 1.0, v34
  v_add_f32 v35, 1.0, v35
  v_rcp_f32 v34, v34
  v_mfma_f32_32x32x16_bf16 v[192:207], v[60:63], a[84:87], v[192:207]
  ds_read_b64_tr_b16 v[54:55], v4 offset:59904
  v_rcp_f32 v35, v35
  v_mul_f32 v34, v172, v34
  v_mul_f32 v35, v173, v35
  v_cvt_pk_bf16_f32 v170, v34, v35
  v_mfma_f32_16x16x32_bf16 v[244:247], v[240:243], v[60:63], v[244:247]
  s_waitcnt lgkmcnt(4)
  ds_read_b64_tr_b16 v[56:57], v2 offset:61440
  v_mul_f32 v174, v174, v31
  v_mfma_f32_32x32x16_bf16 v[176:191], v[44:47], a[88:91], v[176:191]
  s_waitcnt vmcnt(10)
  s_barrier
  ds_read_b64_tr_b16 v[58:59], v2 offset:61952
  v_mul_f32 v175, v175, v31
  v_mfma_f32_32x32x16_bf16 v[192:207], v[44:47], a[92:95], v[192:207]
  s_waitcnt lgkmcnt(4)
  v_fma_f32 v34, -v174, v174, -s49
  v_fma_f32 v35, -v175, v175, -s49
  v_mul_f32 v34, v174, v34
  v_mul_f32 v35, v175, v35
  v_exp_f32 v34, v34
  v_mfma_f32_32x32x16_bf16 v[176:191], v[48:51], a[96:99], v[176:191]
  s_add_u32 m0, s43, 0x8000
  ds_read_b64_tr_b16 v[60:61], v4 offset:63488
  v_exp_f32 v35, v35
  v_add_f32 v34, 1.0, v34
  v_add_f32 v35, 1.0, v35
  v_mfma_f32_32x32x16_bf16 v[192:207], v[48:51], a[100:103], v[192:207]
  ds_read_b64_tr_b16 v[62:63], v4 offset:64000
  buffer_load_dwordx4 v16, s[8:11], s44 offen lds
  v_rcp_f32 v34, v34
  v_mfma_f32_16x16x32_bf16 v[244:247], v[240:243], v[48:51], v[244:247]
  s_waitcnt lgkmcnt(4)
  ds_read_b64_tr_b16 v[44:45], v3 offset:0
  v_mfma_f32_32x32x16_bf16 v[176:191], v[52:55], a[104:107], v[176:191]
  ds_read_b64_tr_b16 v[46:47], v3 offset:512
  v_rcp_f32 v35, v35
  v_mul_f32 v34, v174, v34
  v_mul_f32 v35, v175, v35
  v_cvt_pk_bf16_f32 v171, v34, v35
  v_mfma_f32_32x32x16_bf16 v[192:207], v[52:55], a[108:111], v[192:207]
  s_waitcnt lgkmcnt(4)
  ds_write_b128 v13, v[168:171] offset:52224
  v_mfma_f32_32x32x16_bf16 v[176:191], v[56:59], a[112:115], v[176:191]
  ds_read_b64_tr_b16 v[48:49], v33 offset:2048
  buffer_load_dwordx4 v17, s[8:11], s44 offen offset:1024 lds
  v_mul_f32 v208, v208, v30
  v_mul_f32 v209, v209, v30
  v_fma_f32 v34, -v208, v208, -s49
  v_mfma_f32_32x32x16_bf16 v[192:207], v[56:59], a[116:119], v[192:207]
  s_add_u32 s45, s27, 0x280
  s_add_u32 m0, s43, 0xa000
  ds_read_b64_tr_b16 v[50:51], v33 offset:2560
  v_fma_f32 v35, -v209, v209, -s49
  v_mul_f32 v34, v208, v34
  v_mul_f32 v35, v209, v35
  v_mfma_f32_16x16x32_bf16 v[244:247], v[240:243], v[56:59], v[244:247]
  s_waitcnt lgkmcnt(5)
  ds_read_b64_tr_b16 v[52:53], v3 offset:4096
  v_mfma_f32_32x32x16_bf16 v[176:191], v[60:63], a[120:123], v[176:191]
  ds_read_b64_tr_b16 v[54:55], v3 offset:4608
  v_exp_f32 v34, v34
  v_exp_f32 v35, v35
  v_add_f32 v34, 1.0, v34
  v_mfma_f32_32x32x16_bf16 v[192:207], v[60:63], a[124:127], v[192:207]
  s_waitcnt lgkmcnt(5)
  buffer_load_dwordx4 v16, s[8:11], s45 offen lds
  v_add_f32 v35, 1.0, v35
  v_rcp_f32 v34, v34
  v_mfma_f32_32x32x16_bf16 v[176:191], v[44:47], a[128:131], v[176:191]
  ds_read_b64_tr_b16 v[56:57], v33 offset:6144
  v_rcp_f32 v35, v35
  v_mul_f32 v34, v208, v34
  v_mul_f32 v35, v209, v35
  v_cvt_pk_bf16_f32 v208, v34, v35
  v_mfma_f32_32x32x16_bf16 v[192:207], v[44:47], a[132:135], v[192:207]
  ds_read_b64_tr_b16 v[58:59], v33 offset:6656
  v_mul_f32 v210, v210, v30
  v_mul_f32 v211, v211, v30
  v_fma_f32 v34, -v210, v210, -s49
  v_fma_f32 v35, -v211, v211, -s49
  v_mul_f32 v34, v210, v34
  v_mfma_f32_16x16x32_bf16 v[244:247], v[240:243], v[44:47], v[244:247]
  s_waitcnt lgkmcnt(4)
  ds_read_b64_tr_b16 v[60:61], v3 offset:8192
  v_mul_f32 v35, v211, v35
  v_mfma_f32_32x32x16_bf16 v[176:191], v[48:51], a[136:139], v[176:191]
  ds_read_b64_tr_b16 v[62:63], v3 offset:8704
  buffer_load_dwordx4 v17, s[8:11], s45 offen offset:1024 lds
  v_exp_f32 v34, v34
  v_mfma_f32_32x32x16_bf16 v[192:207], v[48:51], a[140:143], v[192:207]
  s_waitcnt lgkmcnt(4)
  s_add_u32 s44, s63, 0x280
  v_exp_f32 v35, v35
  v_add_f32 v34, 1.0, v34
  v_add_f32 v35, 1.0, v35
  v_mfma_f32_32x32x16_bf16 v[176:191], v[52:55], a[144:147], v[176:191]
  ds_read_b64_tr_b16 v[44:45], v33 offset:10240
  v_rcp_f32 v34, v34
  v_rcp_f32 v35, v35
  v_mul_f32 v34, v210, v34
  v_mfma_f32_32x32x16_bf16 v[192:207], v[52:55], a[148:151], v[192:207]
  ds_read_b64_tr_b16 v[46:47], v33 offset:10752
  v_mul_f32 v35, v211, v35
  v_cvt_pk_bf16_f32 v209, v34, v35
  v_mul_f32 v212, v212, v30
  v_mul_f32 v213, v213, v30
  v_fma_f32 v34, -v212, v212, -s49
  v_mfma_f32_16x16x32_bf16 v[244:247], v[240:243], v[52:55], v[244:247]
  s_waitcnt lgkmcnt(4)
  ds_read_b64_tr_b16 v[48:49], v3 offset:12288
  v_fma_f32 v35, -v213, v213, -s49
  v_mfma_f32_32x32x16_bf16 v[176:191], v[56:59], a[152:155], v[176:191]
  ds_read_b64_tr_b16 v[50:51], v3 offset:12800
  v_mul_f32 v34, v212, v34
  v_mul_f32 v35, v213, v35
  v_exp_f32 v34, v34
  v_mfma_f32_32x32x16_bf16 v[192:207], v[56:59], a[156:159], v[192:207]
  s_waitcnt lgkmcnt(4)
  v_exp_f32 v35, v35
  v_add_f32 v34, 1.0, v34
  v_add_f32 v35, 1.0, v35
  v_rcp_f32 v34, v34
  v_mfma_f32_32x32x16_bf16 v[176:191], v[60:63], a[160:163], v[176:191]
  ds_read_b64_tr_b16 v[52:53], v33 offset:14336
  v_rcp_f32 v35, v35
  v_mul_f32 v34, v212, v34
  v_mul_f32 v35, v213, v35
  v_cvt_pk_bf16_f32 v210, v34, v35
  v_mfma_f32_32x32x16_bf16 v[192:207], v[60:63], a[164:167], v[192:207]
  s_waitcnt vmcnt(8)
  s_barrier
  s_add_u32 m0, s43, 0xc000
  ds_read_b64_tr_b16 v[54:55], v33 offset:14848
  v_mfma_f32_16x16x32_bf16 v[244:247], v[240:243], v[60:63], v[244:247]
  s_waitcnt lgkmcnt(4)
  ds_read_b64_tr_b16 v[56:57], v3 offset:16384
  v_mul_f32 v214, v214, v30
  v_mfma_f32_32x32x16_bf16 v[176:191], v[44:47], a[168:171], v[176:191]
  ds_read_b64_tr_b16 v[58:59], v3 offset:16896
  buffer_load_dwordx4 v16, s[8:11], s44 offen lds
  v_mul_f32 v215, v215, v30
  v_fma_f32 v34, -v214, v214, -s49
  v_fma_f32 v35, -v215, v215, -s49
  v_mfma_f32_32x32x16_bf16 v[192:207], v[44:47], a[172:175], v[192:207]
  s_waitcnt lgkmcnt(4)
  v_mul_f32 v34, v214, v34
  v_mul_f32 v35, v215, v35
  v_exp_f32 v34, v34
  v_exp_f32 v35, v35
  v_mfma_f32_32x32x16_bf16 v[176:191], v[48:51], a[176:179], v[176:191]
  ds_read_b64_tr_b16 v[60:61], v33 offset:18432
  v_add_f32 v34, 1.0, v34
  v_add_f32 v35, 1.0, v35
  v_rcp_f32 v34, v34
  v_mfma_f32_32x32x16_bf16 v[192:207], v[48:51], a[180:183], v[192:207]
  ds_read_b64_tr_b16 v[62:63], v33 offset:18944
  v_rcp_f32 v35, v35
  v_mul_f32 v34, v214, v34
  v_mul_f32 v35, v215, v35
  v_cvt_pk_bf16_f32 v211, v34, v35
  v_mfma_f32_16x16x32_bf16 v[244:247], v[240:243], v[48:51], v[244:247]
  s_waitcnt lgkmcnt(4)
  ds_read_b64_tr_b16 v[44:45], v3 offset:20480
  v_mfma_f32_32x32x16_bf16 v[176:191], v[52:55], a[184:187], v[176:191]
  ds_read_b64_tr_b16 v[46:47], v3 offset:20992
  buffer_load_dwordx4 v17, s[8:11], s44 offen offset:1024 lds
  v_mfma_f32_32x32x16_bf16 v[192:207], v[52:55], a[188:191], v[192:207]
  s_waitcnt lgkmcnt(4)
  s_add_u32 s45, s64, 0x280
  s_add_u32 m0, s43, 0xe000
  ds_write_b128 v13, v[208:211] offset:0
  v_mfma_f32_32x32x16_bf16 v[176:191], v[56:59], a[192:195], v[176:191]
  ds_read_b64_tr_b16 v[48:49], v33 offset:22528
  v_mul_f32 v216, v216, v30
  v_mul_f32 v217, v217, v30
  v_fma_f32 v34, -v216, v216, -s49
  v_fma_f32 v35, -v217, v217, -s49
  v_mul_f32 v34, v216, v34
  v_mfma_f32_32x32x16_bf16 v[192:207], v[56:59], a[196:199], v[192:207]
  ds_read_b64_tr_b16 v[50:51], v33 offset:23040
  v_mul_f32 v35, v217, v35
  v_exp_f32 v34, v34
  v_exp_f32 v35, v35
  v_mfma_f32_16x16x32_bf16 v[244:247], v[240:243], v[56:59], v[244:247]
  s_waitcnt lgkmcnt(5)
  ds_read_b64_tr_b16 v[52:53], v3 offset:24576
  v_add_f32 v34, 1.0, v34
  v_mfma_f32_32x32x16_bf16 v[176:191], v[60:63], a[200:203], v[176:191]
  ds_read_b64_tr_b16 v[54:55], v3 offset:25088
  buffer_load_dwordx4 v16, s[8:11], s45 offen lds
  v_add_f32 v35, 1.0, v35
  v_rcp_f32 v34, v34
  v_mfma_f32_32x32x16_bf16 v[192:207], v[60:63], a[204:207], v[192:207]
  s_waitcnt lgkmcnt(5)
  v_rcp_f32 v35, v35
  v_mul_f32 v34, v216, v34
  v_mul_f32 v35, v217, v35
  v_cvt_pk_bf16_f32 v216, v34, v35
  v_mul_f32 v218, v218, v30
  v_mfma_f32_32x32x16_bf16 v[176:191], v[44:47], a[208:211], v[176:191]
  ds_read_b64_tr_b16 v[56:57], v33 offset:26624
  v_mul_f32 v219, v219, v30
  v_fma_f32 v34, -v218, v218, -s49
  v_fma_f32 v35, -v219, v219, -s49
  v_mul_f32 v34, v218, v34
  v_mul_f32 v35, v219, v35
  v_mfma_f32_32x32x16_bf16 v[192:207], v[44:47], a[212:215], v[192:207]
  ds_read_b64_tr_b16 v[58:59], v33 offset:27136
  v_exp_f32 v34, v34
  v_exp_f32 v35, v35
  v_add_f32 v34, 1.0, v34
  v_mfma_f32_16x16x32_bf16 v[244:247], v[240:243], v[44:47], v[244:247]
  s_waitcnt lgkmcnt(4)
  ds_read_b64_tr_b16 v[60:61], v3 offset:28672
  v_add_f32 v35, 1.0, v35
  v_mfma_f32_32x32x16_bf16 v[176:191], v[48:51], a[216:219], v[176:191]
  ds_read_b64_tr_b16 v[62:63], v3 offset:29184
  buffer_load_dwordx4 v17, s[8:11], s45 offen offset:1024 lds
  v_rcp_f32 v34, v34
  v_mfma_f32_32x32x16_bf16 v[192:207], v[48:51], a[220:223], v[192:207]
  s_waitcnt lgkmcnt(4)
  v_rcp_f32 v35, v35
  v_mul_f32 v34, v218, v34
  v_mul_f32 v35, v219, v35
  v_cvt_pk_bf16_f32 v217, v34, v35
  v_mul_f32 v220, v220, v30
  v_mfma_f32_32x32x16_bf16 v[176:191], v[52:55], a[224:227], v[176:191]
  s_add_u32 s44, s65, 0x280
  ds_read_b64_tr_b16 v[44:45], v33 offset:30720
  v_mul_f32 v221, v221, v30
  v_fma_f32 v34, -v220, v220, -s49
  v_fma_f32 v35, -v221, v221, -s49
  v_mul_f32 v34, v220, v34
  v_mul_f32 v35, v221, v35
  v_mfma_f32_32x32x16_bf16 v[192:207], v[52:55], a[228:231], v[192:207]
  s_add_u32 m0, s43, 0x10000
  ds_read_b64_tr_b16 v[46:47], v33 offset:31232
  v_exp_f32 v34, v34
  v_exp_f32 v35, v35
  v_add_f32 v34, 1.0, v34
  v_mfma_f32_16x16x32_bf16 v[244:247], v[240:243], v[52:55], v[244:247]
  s_waitcnt lgkmcnt(4)
  ds_read_b64_tr_b16 v[48:49], v2 offset:8192
  v_add_f32 v35, 1.0, v35
  v_mfma_f32_32x32x16_bf16 v[176:191], v[56:59], a[232:235], v[176:191]
  ds_read_b64_tr_b16 v[50:51], v2 offset:8704
  buffer_load_dwordx4 v16, s[8:11], s44 offen lds
  v_rcp_f32 v34, v34
  v_mfma_f32_32x32x16_bf16 v[192:207], v[56:59], a[236:239], v[192:207]
  s_waitcnt vmcnt(9)
  s_barrier
  s_waitcnt lgkmcnt(4)
  v_mfma_f32_32x32x16_bf16 v[176:191], v[60:63], a[240:243], v[176:191]
  ds_read_b64_tr_b16 v[52:53], v4 offset:10240
  v_rcp_f32 v35, v35
  v_mul_f32 v34, v220, v34
  v_mul_f32 v35, v221, v35
  v_cvt_pk_bf16_f32 v218, v34, v35
  v_mfma_f32_32x32x16_bf16 v[192:207], v[60:63], a[244:247], v[192:207]
  ds_read_b64_tr_b16 v[54:55], v4 offset:10752
  v_mul_f32 v222, v222, v30
  v_mul_f32 v223, v223, v30
  v_fma_f32 v34, -v222, v222, -s49
  v_fma_f32 v35, -v223, v223, -s49
  v_mul_f32 v34, v222, v34
  v_mfma_f32_16x16x32_bf16 v[244:247], v[240:243], v[60:63], v[244:247]
  s_waitcnt lgkmcnt(4)
  ds_read_b64_tr_b16 v[56:57], v2 offset:12288
  v_mul_f32 v35, v223, v35
  v_mfma_f32_32x32x16_bf16 v[176:191], v[44:47], a[248:251], v[176:191]
  ds_read_b64_tr_b16 v[58:59], v2 offset:12800
  buffer_load_dwordx4 v17, s[8:11], s44 offen offset:1024 lds
  v_exp_f32 v34, v34
  v_mfma_f32_32x32x16_bf16 v[192:207], v[44:47], a[252:255], v[192:207]
  s_waitcnt lgkmcnt(4)
  v_exp_f32 v35, v35
  v_add_f32 v34, 1.0, v34
  v_add_f32 v35, 1.0, v35
  v_rcp_f32 v34, v34
  v_mfma_f32_32x32x16_bf16 v[176:191], v[48:51], v[64:67], v[176:191]
  s_add_u32 s45, s66, 0x280
  ds_read_b64_tr_b16 v[60:61], v4 offset:14336
  v_rcp_f32 v35, v35
  v_mul_f32 v34, v222, v34
  v_mul_f32 v35, v223, v35
  v_cvt_pk_bf16_f32 v219, v34, v35
  v_mfma_f32_32x32x16_bf16 v[192:207], v[48:51], v[68:71], v[192:207]
  s_add_u32 m0, s43, 0x12000
  ds_read_b64_tr_b16 v[62:63], v4 offset:14848
  ds_write_b128 v13, v[216:219] offset:1024
  v_mfma_f32_16x16x32_bf16 v[244:247], v[240:243], v[48:51], v[244:247]
  s_waitcnt lgkmcnt(5)
  ds_read_b64_tr_b16 v[44:45], v2 offset:16384
  v_mul_f32 v224, v224, v31
  v_mfma_f32_32x32x16_bf16 v[176:191], v[52:55], v[72:75], v[176:191]
  ds_read_b64_tr_b16 v[46:47], v2 offset:16896
  buffer_load_dwordx4 v16, s[8:11], s45 offen lds
  v_mul_f32 v225, v225, v31
  v_fma_f32 v34, -v224, v224, -s49
  v_fma_f32 v35, -v225, v225, -s49
  v_mfma_f32_32x32x16_bf16 v[192:207], v[52:55], v[76:79], v[192:207]
  s_waitcnt lgkmcnt(5)
  v_mul_f32 v34, v224, v34
  v_mul_f32 v35, v225, v35
  v_exp_f32 v34, v34
  v_exp_f32 v35, v35
  v_mfma_f32_32x32x16_bf16 v[176:191], v[56:59], v[80:83], v[176:191]
  ds_read_b64_tr_b16 v[48:49], v4 offset:18432
  v_add_f32 v34, 1.0, v34
  v_add_f32 v35, 1.0, v35
  v_rcp_f32 v34, v34
  v_mfma_f32_32x32x16_bf16 v[192:207], v[56:59], v[84:87], v[192:207]
  ds_read_b64_tr_b16 v[50:51], v4 offset:18944
  v_rcp_f32 v35, v35
  v_mul_f32 v34, v224, v34
  v_mul_f32 v35, v225, v35
  v_cvt_pk_bf16_f32 v224, v34, v35
  v_mfma_f32_16x16x32_bf16 v[244:247], v[240:243], v[56:59], v[244:247]
  s_waitcnt lgkmcnt(5)
  ds_read_b64_tr_b16 v[52:53], v2 offset:20480
  v_mul_f32 v226, v226, v31
  v_mfma_f32_32x32x16_bf16 v[176:191], v[60:63], v[88:91], v[176:191]
  ds_read_b64_tr_b16 v[54:55], v2 offset:20992
  buffer_load_dwordx4 v17, s[8:11], s45 offen offset:1024 lds
  v_mul_f32 v227, v227, v31
  v_fma_f32 v34, -v226, v226, -s49
  v_fma_f32 v35, -v227, v227, -s49
  v_mfma_f32_32x32x16_bf16 v[192:207], v[60:63], v[92:95], v[192:207]
  s_waitcnt lgkmcnt(4)
  v_mul_f32 v34, v226, v34
  v_mul_f32 v35, v227, v35
  v_exp_f32 v34, v34
  v_exp_f32 v35, v35
  v_mfma_f32_32x32x16_bf16 v[144:159], v[44:47], a[0:3], 0
  s_add_u32 s44, s67, 0x280
  s_add_u32 m0, s43, 0x14000
  ds_read_b64_tr_b16 v[56:57], v4 offset:22528
  ds_write2_b32 v32, v244, v245 offset0:0 offset1:16
  v_add_f32 v34, 1.0, v34
  v_add_f32 v35, 1.0, v35
  v_mfma_f32_32x32x16_bf16 v[160:175], v[44:47], a[4:7], 0
  ds_read_b64_tr_b16 v[58:59], v4 offset:23040
  ds_read_b128 a[0:3], v14 offset:16384
  ds_read_b128 a[4:7], v14 offset:18432
  v_rcp_f32 v34, v34
  v_mfma_f32_16x16x32_bf16 v[108:111], v[240:243], v[44:47], 0
  s_waitcnt lgkmcnt(7)
  ds_read_b64_tr_b16 v[60:61], v2 offset:24576
  v_mfma_f32_32x32x16_bf16 v[144:159], v[48:51], a[8:11], v[144:159]
  ds_read_b64_tr_b16 v[62:63], v2 offset:25088
  buffer_load_dwordx4 v16, s[8:11], s44 offen lds
  v_rcp_f32 v35, v35
  v_mul_f32 v34, v226, v34
  v_mfma_f32_32x32x16_bf16 v[160:175], v[48:51], a[12:15], v[160:175]
  s_waitcnt lgkmcnt(7)
  ds_read_b128 a[8:11], v14 offset:17408
  ds_read_b128 a[12:15], v14 offset:19456
  v_mul_f32 v35, v227, v35
  v_cvt_pk_bf16_f32 v225, v34, v35
  v_mul_f32 v228, v228, v31
  v_mul_f32 v229, v229, v31
  v_mfma_f32_32x32x16_bf16 v[144:159], v[52:55], a[16:19], v[144:159]
  v_fma_f32 v34, -v228, v228, -s49
  v_fma_f32 v35, -v229, v229, -s49
  v_mul_f32 v34, v228, v34
  v_mul_f32 v35, v229, v35
  v_exp_f32 v34, v34
  v_mfma_f32_32x32x16_bf16 v[160:175], v[52:55], a[20:23], v[160:175]
  s_waitcnt lgkmcnt(0)
  s_barrier
  ds_read_b32 v38, v15 offset:0
  ds_read_b128 a[16:19], v14 offset:20480
  v_mfma_f32_16x16x32_bf16 v[108:111], v[240:243], v[52:55], v[108:111]
  ds_read_b64_tr_b16 v[44:45], v4 offset:26624
  ds_read_b128 a[20:23], v14 offset:22528
  v_mfma_f32_32x32x16_bf16 v[144:159], v[56:59], a[24:27], v[144:159]
  ds_read_b64_tr_b16 v[46:47], v4 offset:27136
  buffer_load_dwordx4 v17, s[8:11], s44 offen offset:1024 lds
  v_exp_f32 v35, v35
  v_add_f32 v34, 1.0, v34
  v_mfma_f32_32x32x16_bf16 v[160:175], v[56:59], a[28:31], v[160:175]
  ds_read_b64_tr_b16 v[48:49], v2 offset:28672
  ds_read_b128 a[24:27], v14 offset:21504
  ds_read_b128 a[28:31], v14 offset:23552
  v_add_f32 v35, 1.0, v35
  v_rcp_f32 v34, v34
  v_mfma_f32_32x32x16_bf16 v[144:159], v[60:63], a[32:35], v[144:159]
  s_add_u32 s45, s70, 0x0
  ds_read_b64_tr_b16 v[50:51], v2 offset:29184
  v_lshlrev_b32 v39, 16, v252
  v_mov_b32 v106, v252
  s_waitcnt lgkmcnt(8)
  v_cvt_pk_bf16_f32 v104, v38, v38
  v_and_b32 v105, s51, v104
  v_sub_f32 v38, v38, v105
  v_mfma_f32_32x32x16_bf16 v[160:175], v[60:63], a[36:39], v[160:175]
  s_add_u32 m0, s43, 0x16000
  v_cvt_pk_bf16_f32 v105, v38, v39
  v_rcp_f32 v35, v35
  v_mul_f32 v34, v228, v34
  v_mul_f32 v35, v229, v35
  v_cvt_pk_bf16_f32 v226, v34, v35
  v_mfma_f32_16x16x32_bf16 v[108:111], v[240:243], v[60:63], v[108:111]
  ds_read_b64_tr_b16 v[52:53], v4 offset:30720
  v_mul_f32 v230, v230, v31
  v_mfma_f32_32x32x16_bf16 v[176:191], v[104:107], v[96:99], v[176:191]
  s_waitcnt vmcnt(10) lgkmcnt(2)
  s_barrier
  ds_read_b64_tr_b16 v[54:55], v4 offset:31232
  v_mul_f32 v231, v231, v31
  v_mfma_f32_32x32x16_bf16 v[192:207], v[104:107], v[100:103], v[192:207]
  ds_read_b64_tr_b16 v[56:57], v2 offset:32768
  buffer_load_dwordx4 v18, s[12:15], s45 offen lds
  v_fma_f32 v34, -v230, v230, -s49
  v_fma_f32 v35, -v231, v231, -s49
  v_mul_f32 v34, v230, v34
  v_mfma_f32_32x32x16_bf16 v[144:159], v[44:47], a[40:43], v[144:159]
  ds_read_b64_tr_b16 v[58:59], v2 offset:33280
  v_mul_f32 v35, v231, v35
  v_exp_f32 v34, v34
  v_exp_f32 v35, v35
  v_mfma_f32_32x32x16_bf16 v[160:175], v[44:47], a[44:47], v[160:175]
  s_waitcnt lgkmcnt(4)
  v_add_f32 v34, 1.0, v34
  v_add_f32 v35, 1.0, v35
  v_rcp_f32 v34, v34
  v_rcp_f32 v35, v35
  v_mfma_f32_32x32x16_bf16 v[144:159], v[48:51], a[48:51], v[144:159]
  ds_read_b64_tr_b16 v[60:61], v4 offset:34816
  ds_read_b128 a[32:35], v14 offset:32768
  ds_read_b128 a[36:39], v14 offset:34816
  v_mul_f32 v34, v230, v34
  v_mul_f32 v35, v231, v35
  v_cvt_pk_bf16_f32 v227, v34, v35
  v_mfma_f32_32x32x16_bf16 v[160:175], v[48:51], a[52:55], v[160:175]
  ds_read_b64_tr_b16 v[62:63], v4 offset:35328
  buffer_load_dwordx4 v19, s[12:15], s45 offen offset:1024 lds
  ds_read_b128 a[40:43], v14 offset:33792
  ds_read_b128 a[44:47], v14 offset:35840
  ds_read_b128 a[48:51], v14 offset:36864
  v_mfma_f32_16x16x32_bf16 v[108:111], v[240:243], v[48:51], v[108:111]
  s_waitcnt lgkmcnt(9)
  ds_read_b64_tr_b16 v[44:45], v2 offset:36864
  ds_read_b128 a[52:55], v14 offset:38912
  v_mfma_f32_32x32x16_bf16 v[144:159], v[52:55], a[56:59], v[144:159]
  s_add_u32 s44, s71, 0x0
  ds_read_b64_tr_b16 v[46:47], v2 offset:37376
  ds_write_b128 v13, v[224:227] offset:2048
  v_mfma_f32_32x32x16_bf16 v[160:175], v[52:55], a[60:63], v[160:175]
  s_waitcnt lgkmcnt(11)
  ds_read_b128 a[56:59], v14 offset:37888
  ds_read_b128 a[60:63], v14 offset:39936
  v_mul_f32 v232, v232, v31
  v_mul_f32 v233, v233, v31
  v_fma_f32 v34, -v232, v232, -s49
  v_fma_f32 v35, -v233, v233, -s49
  v_mfma_f32_32x32x16_bf16 v[144:159], v[56:59], a[64:67], v[144:159]
  s_add_u32 m0, s43, 0x2000
  ds_read_b64_tr_b16 v[48:49], v4 offset:38912
  v_mul_f32 v34, v232, v34
  v_mul_f32 v35, v233, v35
  v_exp_f32 v34, v34
  v_mfma_f32_32x32x16_bf16 v[160:175], v[56:59], a[68:71], v[160:175]
  ds_read_b64_tr_b16 v[50:51], v4 offset:39424
  buffer_load_dwordx4 v18, s[12:15], s44 offen lds
  v_exp_f32 v35, v35
  v_add_f32 v34, 1.0, v34
  v_mfma_f32_16x16x32_bf16 v[108:111], v[240:243], v[56:59], v[108:111]
  s_waitcnt lgkmcnt(11)
  ds_read_b64_tr_b16 v[52:53], v2 offset:40960
  v_add_f32 v35, 1.0, v35
  v_mfma_f32_32x32x16_bf16 v[144:159], v[60:63], a[72:75], v[144:159]
  s_waitcnt vmcnt(11) lgkmcnt(3)
  s_barrier
  ds_read_b64_tr_b16 v[54:55], v2 offset:41472
  ds_read_b128 a[64:67], v14 offset:49152
  v_mfma_f32_32x32x16_bf16 v[160:175], v[60:63], a[76:79], v[160:175]
  v_rcp_f32 v34, v34
  v_rcp_f32 v35, v35
  v_mul_f32 v34, v232, v34
  v_mul_f32 v35, v233, v35
  v_mfma_f32_32x32x16_bf16 v[144:159], v[44:47], a[80:83], v[144:159]
  ds_read_b64_tr_b16 v[56:57], v4 offset:43008
  buffer_load_dwordx4 v19, s[12:15], s44 offen offset:1024 lds
  v_cvt_pk_bf16_f32 v232, v34, v35
  v_mul_f32 v234, v234, v31
  v_mul_f32 v235, v235, v31
  v_mfma_f32_32x32x16_bf16 v[160:175], v[44:47], a[84:87], v[160:175]
  s_add_u32 s45, s70, 0x12000
  s_add_u32 m0, s43, 0x4000
  ds_read_b64_tr_b16 v[58:59], v4 offset:43520
  v_fma_f32 v34, -v234, v234, -s49
  v_fma_f32 v35, -v235, v235, -s49
  v_mul_f32 v34, v234, v34
  v_mul_f32 v35, v235, v35
  v_mfma_f32_16x16x32_bf16 v[108:111], v[240:243], v[44:47], v[108:111]
  s_waitcnt lgkmcnt(5)
  ds_read_b64_tr_b16 v[60:61], v2 offset:45056
  ds_read_b128 a[68:71], v14 offset:51200
  v_mfma_f32_32x32x16_bf16 v[144:159], v[48:51], a[88:91], v[144:159]
  ds_read_b64_tr_b16 v[62:63], v2 offset:45568
  v_exp_f32 v34, v34
  v_exp_f32 v35, v35
  v_add_f32 v34, 1.0, v34
  v_mfma_f32_32x32x16_bf16 v[160:175], v[48:51], a[92:95], v[160:175]
  s_waitcnt lgkmcnt(6)
  buffer_load_dwordx4 v18, s[12:15], s45 offen lds
  ds_read_b128 a[72:75], v14 offset:50176
  v_add_f32 v35, 1.0, v35
  v_rcp_f32 v34, v34
  v_mfma_f32_32x32x16_bf16 v[144:159], v[52:55], a[96:99], v[144:159]
  ds_read_b64_tr_b16 v[44:45], v4 offset:47104
  v_rcp_f32 v35, v35
  v_mul_f32 v34, v234, v34
  v_mul_f32 v35, v235, v35
  v_cvt_pk_bf16_f32 v233, v34, v35
  v_mfma_f32_32x32x16_bf16 v[160:175], v[52:55], a[100:103], v[160:175]
  ds_read_b64_tr_b16 v[46:47], v4 offset:47616
  v_mul_f32 v236, v236, v31
  v_mul_f32 v237, v237, v31
  v_fma_f32 v34, -v236, v236, -s49
  v_fma_f32 v35, -v237, v237, -s49
  v_mul_f32 v34, v236, v34
  v_mfma_f32_16x16x32_bf16 v[108:111], v[240:243], v[52:55], v[108:111]
  s_waitcnt lgkmcnt(6)
  ds_read_b64_tr_b16 v[48:49], v2 offset:49152
  v_mul_f32 v35, v237, v35
  v_mfma_f32_32x32x16_bf16 v[144:159], v[56:59], a[104:107], v[144:159]
  ds_read_b64_tr_b16 v[50:51], v2 offset:49664
  buffer_load_dwordx4 v19, s[12:15], s45 offen offset:1024 lds
  ds_read_b128 a[76:79], v14 offset:52224
  v_exp_f32 v34, v34
  v_mfma_f32_32x32x16_bf16 v[160:175], v[56:59], a[108:111], v[160:175]
  s_waitcnt lgkmcnt(6)
  v_exp_f32 v35, v35
  v_add_f32 v34, 1.0, v34
  v_add_f32 v35, 1.0, v35
  v_rcp_f32 v34, v34
  v_rcp_f32 v35, v35
  v_mul_f32 v34, v236, v34
  v_mul_f32 v35, v237, v35
  v_cvt_pk_bf16_f32 v234, v34, v35
  v_mul_f32 v238, v238, v31
  v_mul_f32 v239, v239, v31
  v_fma_f32 v34, -v238, v238, -s49
  v_fma_f32 v35, -v239, v239, -s49
  v_mul_f32 v34, v238, v34
  v_mul_f32 v35, v239, v35
  v_exp_f32 v34, v34
  v_exp_f32 v35, v35
  v_add_f32 v34, 1.0, v34
  v_add_f32 v35, 1.0, v35
  v_rcp_f32 v34, v34
  v_rcp_f32 v35, v35
  v_mul_f32 v34, v238, v34
  v_mul_f32 v35, v239, v35
  v_cvt_pk_bf16_f32 v235, v34, v35
  v_mfma_f32_32x32x16_bf16 v[144:159], v[60:63], a[112:115], v[144:159]
  s_waitcnt vmcnt(12) lgkmcnt(0)
  s_barrier
  ds_read_b64_tr_b16 v[52:53], v4 offset:51200
  ds_write_b128 v13, v[232:235] offset:3072
  v_mfma_f32_32x32x16_bf16 v[160:175], v[60:63], a[116:119], v[160:175]
  s_add_u32 s44, s71, 0x12000
  s_add_u32 m0, s43, 0x6000
  ds_read_b64_tr_b16 v[54:55], v4 offset:51712
  v_mul_f32 v176, v176, v30
  v_mul_f32 v177, v177, v30
  v_fma_f32 v34, -v176, v176, -s49
  v_fma_f32 v35, -v177, v177, -s49
  v_mfma_f32_16x16x32_bf16 v[108:111], v[240:243], v[60:63], v[108:111]
  ds_read_b64_tr_b16 v[56:57], v2 offset:53248
  v_mul_f32 v34, v176, v34
  v_mfma_f32_32x32x16_bf16 v[144:159], v[44:47], a[120:123], v[144:159]
  ds_read_b64_tr_b16 v[58:59], v2 offset:53760
  buffer_load_dwordx4 v18, s[12:15], s44 offen lds
  v_mul_f32 v35, v177, v35
  v_exp_f32 v34, v34
  v_mfma_f32_32x32x16_bf16 v[160:175], v[44:47], a[124:127], v[160:175]
  v_exp_f32 v35, v35
  v_add_f32 v34, 1.0, v34
  v_add_f32 v35, 1.0, v35
  v_rcp_f32 v34, v34
  v_mfma_f32_32x32x16_bf16 v[144:159], v[48:51], a[128:131], v[144:159]
  ds_read_b64_tr_b16 v[60:61], v4 offset:55296
  v_rcp_f32 v35, v35
  v_mul_f32 v34, v176, v34
  v_mul_f32 v35, v177, v35
  v_cvt_pk_bf16_f32 v176, v34, v35
  v_mfma_f32_32x32x16_bf16 v[160:175], v[48:51], a[132:135], v[160:175]
  ds_read_b64_tr_b16 v[62:63], v4 offset:55808
  v_mul_f32 v178, v178, v30
  v_mul_f32 v179, v179, v30
  v_fma_f32 v34, -v178, v178, -s49
  v_fma_f32 v35, -v179, v179, -s49
  v_mul_f32 v34, v178, v34
  v_mfma_f32_16x16x32_bf16 v[108:111], v[240:243], v[48:51], v[108:111]
  s_waitcnt lgkmcnt(4)
  ds_read_b64_tr_b16 v[44:45], v2 offset:57344
  v_mul_f32 v35, v179, v35
  v_mfma_f32_32x32x16_bf16 v[144:159], v[52:55], a[136:139], v[144:159]
  ds_read_b64_tr_b16 v[46:47], v2 offset:57856
  buffer_load_dwordx4 v19, s[12:15], s44 offen offset:1024 lds
  ds_read_b128 a[80:83], v14 offset:53248
  v_exp_f32 v34, v34
  v_mfma_f32_32x32x16_bf16 v[160:175], v[52:55], a[140:143], v[160:175]
  s_waitcnt lgkmcnt(5)
  s_add_u32 s45, s70, 0x24000
  s_add_u32 m0, s43, 0x8000
  v_exp_f32 v35, v35
  v_add_f32 v34, 1.0, v34
  v_add_f32 v35, 1.0, v35
  v_mfma_f32_32x32x16_bf16 v[144:159], v[56:59], a[144:147], v[144:159]
  ds_read_b64_tr_b16 v[48:49], v4 offset:59392
  v_rcp_f32 v34, v34
  v_rcp_f32 v35, v35
  v_mul_f32 v34, v178, v34
  v_mfma_f32_32x32x16_bf16 v[160:175], v[56:59], a[148:151], v[160:175]
  s_waitcnt vmcnt(12) lgkmcnt(1)
  s_barrier
  ds_read_b64_tr_b16 v[50:51], v4 offset:59904
  v_mul_f32 v35, v179, v35
  v_mfma_f32_16x16x32_bf16 v[108:111], v[240:243], v[56:59], v[108:111]
  ds_read_b64_tr_b16 v[52:53], v2 offset:61440
  v_cvt_pk_bf16_f32 v177, v34, v35
  v_mfma_f32_32x32x16_bf16 v[144:159], v[60:63], a[152:155], v[144:159]
  ds_read_b64_tr_b16 v[54:55], v2 offset:61952
  buffer_load_dwordx4 v18, s[12:15], s45 offen lds
  v_mul_f32 v180, v180, v30
  v_mul_f32 v181, v181, v30
  v_fma_f32 v34, -v180, v180, -s49
  v_mfma_f32_32x32x16_bf16 v[160:175], v[60:63], a[156:159], v[160:175]
  ds_read_b128 a[84:87], v14 offset:55296
  v_fma_f32 v35, -v181, v181, -s49
  v_mul_f32 v34, v180, v34
  v_mul_f32 v35, v181, v35
  v_exp_f32 v34, v34
  v_mfma_f32_32x32x16_bf16 v[144:159], v[44:47], a[160:163], v[144:159]
  ds_read_b64_tr_b16 v[56:57], v4 offset:63488
  ds_read_b128 a[88:91], v14 offset:54272
  v_exp_f32 v35, v35
  v_add_f32 v34, 1.0, v34
  v_add_f32 v35, 1.0, v35
  v_mfma_f32_32x32x16_bf16 v[160:175], v[44:47], a[164:167], v[160:175]
  ds_read_b64_tr_b16 v[58:59], v4 offset:64000
  v_rcp_f32 v34, v34
  v_rcp_f32 v35, v35
  v_mul_f32 v34, v180, v34
  v_mfma_f32_16x16x32_bf16 v[108:111], v[240:243], v[44:47], v[108:111]
  s_waitcnt lgkmcnt(6)
  ds_read_b64_tr_b16 v[60:61], v3 offset:0
  v_mul_f32 v35, v181, v35
  v_mfma_f32_32x32x16_bf16 v[144:159], v[48:51], a[168:171], v[144:159]
  ds_read_b64_tr_b16 v[62:63], v3 offset:512
  buffer_load_dwordx4 v19, s[12:15], s45 offen offset:1024 lds
  v_cvt_pk_bf16_f32 v178, v34, v35
  v_mul_f32 v182, v182, v30
  v_mul_f32 v183, v183, v30
  v_mfma_f32_32x32x16_bf16 v[160:175], v[48:51], a[172:175], v[160:175]
  s_waitcnt lgkmcnt(6)
  s_add_u32 s44, s71, 0x24000
  s_add_u32 m0, s43, 0xa000
  v_fma_f32 v34, -v182, v182, -s49
  v_fma_f32 v35, -v183, v183, -s49
  v_mul_f32 v34, v182, v34
  v_mul_f32 v35, v183, v35
  v_mfma_f32_32x32x16_bf16 v[144:159], v[52:55], a[176:179], v[144:159]
  ds_read_b64_tr_b16 v[44:45], v33 offset:2048
  v_exp_f32 v34, v34
  v_exp_f32 v35, v35
  v_add_f32 v34, 1.0, v34
  v_mfma_f32_32x32x16_bf16 v[160:175], v[52:55], a[180:183], v[160:175]
  ds_read_b64_tr_b16 v[46:47], v33 offset:2560
  v_add_f32 v35, 1.0, v35
  v_rcp_f32 v34, v34
  v_rcp_f32 v35, v35
  v_mfma_f32_16x16x32_bf16 v[108:111], v[240:243], v[52:55], v[108:111]
  s_waitcnt lgkmcnt(4)
  ds_read_b64_tr_b16 v[48:49], v3 offset:4096
  v_mul_f32 v34, v182, v34
  v_mfma_f32_32x32x16_bf16 v[144:159], v[56:59], a[184:187], v[144:159]
  ds_read_b64_tr_b16 v[50:51], v3 offset:4608
  buffer_load_dwordx4 v18, s[12:15], s44 offen lds
  ds_read_b128 a[92:95], v14 offset:56320
  v_mul_f32 v35, v183, v35
  v_cvt_pk_bf16_f32 v179, v34, v35
  v_mfma_f32_32x32x16_bf16 v[160:175], v[56:59], a[188:191], v[160:175]
  s_waitcnt vmcnt(13)
  s_barrier
  s_waitcnt lgkmcnt(5)
  ds_read_b128 a[96:99], v14 offset:0
  v_mfma_f32_32x32x16_bf16 v[144:159], v[60:63], a[192:195], v[144:159]
  ds_read_b64_tr_b16 v[52:53], v33 offset:6144
  ds_write_b128 v13, v[176:179] offset:16384
  v_mfma_f32_32x32x16_bf16 v[160:175], v[60:63], a[196:199], v[160:175]
  ds_read_b64_tr_b16 v[54:55], v33 offset:6656
  v_mul_f32 v184, v184, v30
  v_mul_f32 v185, v185, v30
  v_fma_f32 v34, -v184, v184, -s49
  v_fma_f32 v35, -v185, v185, -s49
  v_mul_f32 v34, v184, v34
  v_mfma_f32_16x16x32_bf16 v[108:111], v[240:243], v[60:63], v[108:111]
  s_waitcnt lgkmcnt(7)
  ds_read_b64_tr_b16 v[56:57], v3 offset:8192
  v_mul_f32 v35, v185, v35
  v_mfma_f32_32x32x16_bf16 v[144:159], v[44:47], a[200:203], v[144:159]
  ds_read_b64_tr_b16 v[58:59], v3 offset:8704
  buffer_load_dwordx4 v19, s[12:15], s44 offen offset:1024 lds
  ds_read_b128 a[100:103], v14 offset:2048
  v_exp_f32 v34, v34
  v_mfma_f32_32x32x16_bf16 v[160:175], v[44:47], a[204:207], v[160:175]
  s_waitcnt lgkmcnt(8)
  s_add_u32 s45, s70, 0x36000
  s_add_u32 m0, s43, 0xc000
  v_exp_f32 v35, v35
  v_add_f32 v34, 1.0, v34
  v_add_f32 v35, 1.0, v35
  v_mfma_f32_32x32x16_bf16 v[144:159], v[48:51], a[208:211], v[144:159]
  ds_read_b64_tr_b16 v[60:61], v33 offset:10240
  v_rcp_f32 v34, v34
  v_rcp_f32 v35, v35
  v_mul_f32 v34, v184, v34
  v_mfma_f32_32x32x16_bf16 v[160:175], v[48:51], a[212:215], v[160:175]
  ds_read_b64_tr_b16 v[62:63], v33 offset:10752
  v_mul_f32 v35, v185, v35
  v_cvt_pk_bf16_f32 v184, v34, v35
  v_mul_f32 v186, v186, v30
  v_mul_f32 v187, v187, v30
  v_fma_f32 v34, -v186, v186, -s49
  v_mfma_f32_16x16x32_bf16 v[108:111], v[240:243], v[48:51], v[108:111]
  s_waitcnt lgkmcnt(5)
  ds_read_b64_tr_b16 v[44:45], v3 offset:12288
  v_fma_f32 v35, -v187, v187, -s49
  v_mfma_f32_32x32x16_bf16 v[144:159], v[52:55], a[216:219], v[144:159]
  ds_read_b64_tr_b16 v[46:47], v3 offset:12800
  buffer_load_dwordx4 v18, s[12:15], s45 offen lds
  ds_read_b128 a[104:107], v14 offset:1024
  v_mul_f32 v34, v186, v34
  v_mul_f32 v35, v187, v35
  v_mfma_f32_32x32x16_bf16 v[160:175], v[52:55], a[220:223], v[160:175]
  s_waitcnt lgkmcnt(6)
  v_exp_f32 v34, v34
  v_exp_f32 v35, v35
  v_add_f32 v34, 1.0, v34
  v_add_f32 v35, 1.0, v35
  v_mfma_f32_32x32x16_bf16 v[144:159], v[56:59], a[224:227], v[144:159]
  ds_read_b64_tr_b16 v[48:49], v33 offset:14336
  v_rcp_f32 v34, v34
  v_rcp_f32 v35, v35
  v_mul_f32 v34, v186, v34
  v_mfma_f32_32x32x16_bf16 v[160:175], v[56:59], a[228:231], v[160:175]
  s_waitcnt vmcnt(11) lgkmcnt(1)
  s_barrier
  ds_read_b64_tr_b16 v[50:51], v33 offset:14848
  v_mul_f32 v35, v187, v35
  v_mfma_f32_16x16x32_bf16 v[108:111], v[240:243], v[56:59], v[108:111]
  ds_read_b64_tr_b16 v[52:53], v3 offset:16384
  v_cvt_pk_bf16_f32 v185, v34, v35
  v_mfma_f32_32x32x16_bf16 v[144:159], v[60:63], a[232:235], v[144:159]
  ds_read_b64_tr_b16 v[54:55], v3 offset:16896
  buffer_load_dwordx4 v19, s[12:15], s45 offen offset:1024 lds
  v_mul_f32 v188, v188, v30
  v_mul_f32 v189, v189, v30
  v_fma_f32 v34, -v188, v188, -s49
  v_mfma_f32_32x32x16_bf16 v[160:175], v[60:63], a[236:239], v[160:175]
  s_add_u32 s44, s71, 0x36000
  s_add_u32 m0, s43, 0xe000
  ds_read_b128 a[108:111], v14 offset:3072
  v_fma_f32 v35, -v189, v189, -s49
  v_mul_f32 v34, v188, v34
  v_mul_f32 v35, v189, v35
  v_mfma_f32_32x32x16_bf16 v[144:159], v[44:47], a[240:243], v[144:159]
  ds_read_b64_tr_b16 v[56:57], v33 offset:18432
  v_exp_f32 v34, v34
  v_exp_f32 v35, v35
  v_add_f32 v34, 1.0, v34
  v_mfma_f32_32x32x16_bf16 v[160:175], v[44:47], a[244:247], v[160:175]
  ds_read_b64_tr_b16 v[58:59], v33 offset:18944
  v_add_f32 v35, 1.0, v35
  v_rcp_f32 v34, v34
  v_rcp_f32 v35, v35
  v_mfma_f32_16x16x32_bf16 v[108:111], v[240:243], v[44:47], v[108:111]
  s_waitcnt lgkmcnt(5)
  ds_read_b64_tr_b16 v[60:61], v3 offset:20480
  v_mul_f32 v34, v188, v34
  v_mfma_f32_32x32x16_bf16 v[144:159], v[48:51], a[248:251], v[144:159]
  ds_read_b64_tr_b16 v[62:63], v3 offset:20992
  buffer_load_dwordx4 v18, s[12:15], s44 offen lds
  v_mul_f32 v35, v189, v35
  v_cvt_pk_bf16_f32 v186, v34, v35
  v_mul_f32 v190, v190, v30
  v_mfma_f32_32x32x16_bf16 v[160:175], v[48:51], a[252:255], v[160:175]
  s_waitcnt lgkmcnt(5)
  ds_read_b128 a[112:115], v14 offset:4096
  v_mul_f32 v191, v191, v30
  v_fma_f32 v34, -v190, v190, -s49
  v_fma_f32 v35, -v191, v191, -s49
  v_mul_f32 v34, v190, v34
  v_mul_f32 v35, v191, v35
  v_mfma_f32_32x32x16_bf16 v[144:159], v[52:55], v[64:67], v[144:159]
  ds_read_b64_tr_b16 v[44:45], v33 offset:22528
  v_exp_f32 v34, v34
  v_exp_f32 v35, v35
  v_add_f32 v34, 1.0, v34
  v_mfma_f32_32x32x16_bf16 v[160:175], v[52:55], v[68:71], v[160:175]
  ds_read_b64_tr_b16 v[46:47], v33 offset:23040
  v_add_f32 v35, 1.0, v35
  v_rcp_f32 v34, v34
  v_rcp_f32 v35, v35
  v_mfma_f32_16x16x32_bf16 v[108:111], v[240:243], v[52:55], v[108:111]
  s_waitcnt lgkmcnt(5)
  ds_read_b64_tr_b16 v[48:49], v6 offset:24576
  v_mul_f32 v34, v190, v34
  v_mfma_f32_32x32x16_bf16 v[144:159], v[56:59], v[72:75], v[144:159]
  s_waitcnt vmcnt(11) lgkmcnt(3)
  s_barrier
  ds_read_b64_tr_b16 v[50:51], v6 offset:25600
  v_mul_f32 v35, v191, v35
  v_mfma_f32_32x32x16_bf16 v[160:175], v[56:59], v[76:79], v[160:175]
  ds_read_b64_tr_b16 v[52:53], v5 offset:8192
  buffer_load_dwordx4 v19, s[12:15], s44 offen offset:1024 lds
  ds_read_b128 a[116:119], v14 offset:6144
  ds_read_b128 a[120:123], v14 offset:5120
  v_cvt_pk_bf16_f32 v187, v34, v35
  v_mfma_f32_32x32x16_bf16 v[144:159], v[60:63], v[80:83], v[144:159]
  s_add_u32 s45, s70, 0x48000
  ds_read_b64_tr_b16 v[54:55], v5 offset:9216
  ds_write_b128 v13, v[184:187] offset:17408
  v_mfma_f32_32x32x16_bf16 v[160:175], v[60:63], v[84:87], v[160:175]
  s_add_u32 m0, s43, 0x10000
  ds_read_b64_tr_b16 v[56:57], v6 offset:26624
  v_mul_f32 v192, v192, v31
  v_mul_f32 v193, v193, v31
  v_fma_f32 v34, -v192, v192, -s49
  v_fma_f32 v35, -v193, v193, -s49
  v_mul_f32 v34, v192, v34
  v_mfma_f32_16x16x32_bf16 v[108:111], v[240:243], v[60:63], v[108:111]
  s_waitcnt lgkmcnt(8)
  ds_read_b64_tr_b16 v[58:59], v6 offset:27648
  v_mul_f32 v35, v193, v35
  v_mfma_f32_32x32x16_bf16 v[144:159], v[44:47], v[88:91], v[144:159]
  ds_read_b64_tr_b16 v[60:61], v5 offset:10240
  buffer_load_dwordx4 v18, s[12:15], s45 offen lds
  ds_read_b128 a[124:127], v14 offset:7168
  v_exp_f32 v34, v34
  v_mfma_f32_32x32x16_bf16 v[160:175], v[44:47], v[92:95], v[160:175]
  s_waitcnt lgkmcnt(9)
  ds_read_b64_tr_b16 v[62:63], v5 offset:11264
  v_exp_f32 v35, v35
  v_add_f32 v34, 1.0, v34
  v_add_f32 v35, 1.0, v35
  v_mfma_f32_32x32x16_bf16 v[208:223], v[48:51], a[0:3], 0
  ds_read_b64_tr_b16 v[44:45], v6 offset:28672
  ds_write2_b32 v32, v108, v109 offset0:128 offset1:144
  v_rcp_f32 v34, v34
  v_mfma_f32_32x32x16_bf16 v[224:239], v[48:51], a[4:7], 0
  s_waitcnt lgkmcnt(8)
  ds_read_b64_tr_b16 v[46:47], v6 offset:29696
  v_rcp_f32 v35, v35
  v_mul_f32 v34, v192, v34
  v_mul_f32 v35, v193, v35
  v_cvt_pk_bf16_f32 v192, v34, v35
  v_mfma_f32_32x32x16_bf16 v[112:127], v[52:55], a[0:3], 0
  ds_read_b64_tr_b16 v[48:49], v5 offset:12288
  buffer_load_dwordx4 v19, s[12:15], s45 offen offset:1024 lds
  v_mul_f32 v194, v194, v31
  v_mul_f32 v195, v195, v31
  v_fma_f32 v34, -v194, v194, -s49
  v_mfma_f32_32x32x16_bf16 v[128:143], v[52:55], a[4:7], 0
  s_waitcnt lgkmcnt(7)
  ds_read_b64_tr_b16 v[50:51], v5 offset:13312
  v_fma_f32 v35, -v195, v195, -s49
  v_mul_f32 v34, v194, v34
  v_mul_f32 v35, v195, v35
  v_exp_f32 v34, v34
  v_mfma_f32_32x32x16_bf16 v[208:223], v[56:59], a[8:11], v[208:223]
  s_add_u32 s44, s71, 0x48000
  v_exp_f32 v35, v35
  v_add_f32 v34, 1.0, v34
  v_add_f32 v35, 1.0, v35
  v_rcp_f32 v34, v34
  v_mfma_f32_32x32x16_bf16 v[224:239], v[56:59], a[12:15], v[224:239]
  s_waitcnt lgkmcnt(5)
  v_rcp_f32 v35, v35
  v_mul_f32 v34, v194, v34
  v_mul_f32 v35, v195, v35
  v_cvt_pk_bf16_f32 v193, v34, v35
  v_mul_f32 v196, v196, v31
  v_mfma_f32_32x32x16_bf16 v[112:127], v[60:63], a[8:11], v[112:127]
  s_waitcnt vmcnt(10) lgkmcnt(3)
  s_barrier
  ds_read_b64_tr_b16 v[52:53], v6 offset:30720
  ds_read_b32 v38, v15 offset:512
  v_mfma_f32_32x32x16_bf16 v[128:143], v[60:63], a[12:15], v[128:143]
  s_waitcnt lgkmcnt(4)
  ds_read_b64_tr_b16 v[54:55], v6 offset:31744
  v_mul_f32 v197, v197, v31
  v_fma_f32 v34, -v196, v196, -s49
  v_fma_f32 v35, -v197, v197, -s49
  v_mul_f32 v34, v196, v34
  v_mul_f32 v35, v197, v35
  v_mfma_f32_32x32x16_bf16 v[208:223], v[44:47], a[16:19], v[208:223]
  s_add_u32 m0, s43, 0x24000
  ds_read_b64_tr_b16 v[56:57], v5 offset:14336
  v_exp_f32 v34, v34
  v_exp_f32 v35, v35
  v_add_f32 v34, 1.0, v34
  v_mfma_f32_32x32x16_bf16 v[224:239], v[44:47], a[20:23], v[224:239]
  s_waitcnt lgkmcnt(4)
  ds_read_b64_tr_b16 v[58:59], v5 offset:15360
  buffer_load_dwordx4 v18, s[12:15], s44 offen lds
  v_lshlrev_b32 v39, 16, v253
  v_mov_b32 v106, v253
  s_waitcnt lgkmcnt(3)
  v_cvt_pk_bf16_f32 v104, v38, v38
  v_mfma_f32_32x32x16_bf16 v[112:127], v[48:51], a[16:19], v[112:127]
  ds_read_b64_tr_b16 v[60:61], v5 offset:16384
  v_and_b32 v105, s51, v104
  v_sub_f32 v38, v38, v105
  v_cvt_pk_bf16_f32 v105, v38, v39
  v_add_f32 v35, 1.0, v35
  v_mfma_f32_32x32x16_bf16 v[128:143], v[48:51], a[20:23], v[128:143]
  ds_read_b64_tr_b16 v[62:63], v5 offset:17408
  v_rcp_f32 v34, v34
  v_rcp_f32 v35, v35
  v_mul_f32 v34, v196, v34
  v_mfma_f32_32x32x16_bf16 v[144:159], v[104:107], v[96:99], v[144:159]
  ds_read_b64_tr_b16 v[44:45], v5 offset:24576
  v_mul_f32 v35, v197, v35
  v_cvt_pk_bf16_f32 v194, v34, v35
  v_mul_f32 v198, v198, v31
  v_mul_f32 v199, v199, v31
  v_fma_f32 v34, -v198, v198, -s49
  v_mfma_f32_32x32x16_bf16 v[160:175], v[104:107], v[100:103], v[160:175]
  s_waitcnt lgkmcnt(5)
  ds_read_b64_tr_b16 v[46:47], v5 offset:25600
  buffer_load_dwordx4 v19, s[12:15], s44 offen offset:1024 lds
  v_fma_f32 v35, -v199, v199, -s49
  v_mul_f32 v34, v198, v34
  v_mul_f32 v35, v199, v35
  v_mfma_f32_32x32x16_bf16 v[208:223], v[52:55], a[24:27], v[208:223]
  s_add_u32 s45, s70, 0x5a000
  ds_read_b64_tr_b16 v[48:49], v5 offset:18432
  v_exp_f32 v34, v34
  v_exp_f32 v35, v35
  v_add_f32 v34, 1.0, v34
  v_mfma_f32_32x32x16_bf16 v[224:239], v[52:55], a[28:31], v[224:239]
  s_waitcnt lgkmcnt(5)
  ds_read_b64_tr_b16 v[50:51], v5 offset:19456
  v_add_f32 v35, 1.0, v35
  v_rcp_f32 v34, v34
  v_rcp_f32 v35, v35
  v_mfma_f32_32x32x16_bf16 v[112:127], v[56:59], a[24:27], v[112:127]
  s_add_u32 m0, s43, 0x26000
  ds_read_b64_tr_b16 v[52:53], v5 offset:26624
  v_mul_f32 v34, v198, v34
  v_mul_f32 v35, v199, v35
  v_cvt_pk_bf16_f32 v195, v34, v35
  v_mfma_f32_32x32x16_bf16 v[128:143], v[56:59], a[28:31], v[128:143]
  s_waitcnt lgkmcnt(5)
  ds_read_b64_tr_b16 v[54:55], v5 offset:27648
  buffer_load_dwordx4 v18, s[12:15], s45 offen lds
  v_mfma_f32_32x32x16_bf16 v[208:223], v[60:63], a[32:35], v[208:223]
  s_waitcnt vmcnt(9)
  s_barrier
  ds_read_b64_tr_b16 v[56:57], v5 offset:20480
  v_mfma_f32_32x32x16_bf16 v[224:239], v[60:63], a[36:39], v[224:239]
  s_waitcnt lgkmcnt(5)
  ds_read_b64_tr_b16 v[58:59], v5 offset:21504
  ds_write_b128 v13, v[192:195] offset:18432
  v_mfma_f32_32x32x16_bf16 v[112:127], v[44:47], a[32:35], v[112:127]
  ds_read_b64_tr_b16 v[60:61], v5 offset:28672
  v_mul_f32 v200, v200, v31
  v_mul_f32 v201, v201, v31
  v_fma_f32 v34, -v200, v200, -s49
  v_fma_f32 v35, -v201, v201, -s49
  v_mul_f32 v34, v200, v34
  v_mfma_f32_32x32x16_bf16 v[128:143], v[44:47], a[36:39], v[128:143]
  s_waitcnt lgkmcnt(6)
  ds_read_b64_tr_b16 v[62:63], v5 offset:29696
  buffer_load_dwordx4 v19, s[12:15], s45 offen offset:1024 lds
  v_mul_f32 v35, v201, v35
  v_exp_f32 v34, v34
  v_mfma_f32_32x32x16_bf16 v[208:223], v[48:51], a[40:43], v[208:223]
  s_add_u32 s44, s71, 0x5a000
  s_add_u32 m0, s43, 0x12000
  ds_read_b64_tr_b16 v[44:45], v5 offset:22528
  v_exp_f32 v35, v35
  v_add_f32 v34, 1.0, v34
  v_add_f32 v35, 1.0, v35
  v_mfma_f32_32x32x16_bf16 v[224:239], v[48:51], a[44:47], v[224:239]
  s_waitcnt lgkmcnt(6)
  ds_read_b64_tr_b16 v[46:47], v5 offset:23552
  v_rcp_f32 v34, v34
  v_rcp_f32 v35, v35
  v_mul_f32 v34, v200, v34
  v_mfma_f32_32x32x16_bf16 v[112:127], v[52:55], a[40:43], v[112:127]
  ds_read_b64_tr_b16 v[48:49], v5 offset:30720
  v_mul_f32 v35, v201, v35
  v_cvt_pk_bf16_f32 v200, v34, v35
  v_mul_f32 v202, v202, v31
  v_mul_f32 v203, v203, v31
  v_fma_f32 v34, -v202, v202, -s49
  v_mfma_f32_32x32x16_bf16 v[128:143], v[52:55], a[44:47], v[128:143]
  s_waitcnt lgkmcnt(6)
  ds_read_b64_tr_b16 v[50:51], v5 offset:31744
  buffer_load_dwordx4 v18, s[12:15], s44 offen lds
  v_fma_f32 v35, -v203, v203, -s49
  v_mul_f32 v34, v202, v34
  v_mul_f32 v35, v203, v35
  v_mfma_f32_32x32x16_bf16 v[208:223], v[56:59], a[48:51], v[208:223]
  ds_read_b64_tr_b16 v[52:53], v5 offset:32768
  v_exp_f32 v34, v34
  v_exp_f32 v35, v35
  v_add_f32 v34, 1.0, v34
  v_mfma_f32_32x32x16_bf16 v[224:239], v[56:59], a[52:55], v[224:239]
  s_waitcnt lgkmcnt(5)
  ds_read_b64_tr_b16 v[54:55], v5 offset:33792
  v_add_f32 v35, 1.0, v35
  v_rcp_f32 v34, v34
  v_rcp_f32 v35, v35
  v_mfma_f32_32x32x16_bf16 v[112:127], v[60:63], a[48:51], v[112:127]
  ds_read_b64_tr_b16 v[56:57], v5 offset:40960
  v_mul_f32 v34, v202, v34
  v_mul_f32 v35, v203, v35
  v_cvt_pk_bf16_f32 v201, v34, v35
  v_mul_f32 v204, v204, v31
  v_mul_f32 v205, v205, v31
  v_mfma_f32_32x32x16_bf16 v[128:143], v[60:63], a[52:55], v[128:143]
  s_waitcnt lgkmcnt(5)
  ds_read_b64_tr_b16 v[58:59], v5 offset:41984
  buffer_load_dwordx4 v19, s[12:15], s44 offen offset:1024 lds
  v_fma_f32 v34, -v204, v204, -s49
  v_fma_f32 v35, -v205, v205, -s49
  v_mul_f32 v34, v204, v34
  v_mfma_f32_32x32x16_bf16 v[208:223], v[44:47], a[56:59], v[208:223]
  s_barrier
  ds_read_b64_tr_b16 v[60:61], v5 offset:34816
  v_mul_f32 v35, v205, v35
  v_mfma_f32_32x32x16_bf16 v[224:239], v[44:47], a[60:63], v[224:239]
  s_waitcnt lgkmcnt(5)
  ds_read_b64_tr_b16 v[62:63], v5 offset:35840
  v_exp_f32 v34, v34
  v_exp_f32 v35, v35
  v_add_f32 v34, 1.0, v34
  v_mfma_f32_32x32x16_bf16 v[112:127], v[48:51], a[56:59], v[112:127]
  s_add_u32 s45, s72, 0x0
  ds_read_b64_tr_b16 v[44:45], v5 offset:43008
  v_add_f32 v35, 1.0, v35
  v_rcp_f32 v34, v34
  v_rcp_f32 v35, v35
  v_mfma_f32_32x32x16_bf16 v[128:143], v[48:51], a[60:63], v[128:143]
  s_waitcnt lgkmcnt(5)
  ds_read_b64_tr_b16 v[46:47], v5 offset:44032
  v_mul_f32 v34, v204, v34
  v_mul_f32 v35, v205, v35
  v_cvt_pk_bf16_f32 v202, v34, v35
  v_mul_f32 v206, v206, v31
  v_mul_f32 v207, v207, v31
  v_mfma_f32_32x32x16_bf16 v[208:223], v[52:55], a[64:67], v[208:223]
  s_add_u32 m0, s43, 0x14000
  ds_read_b64_tr_b16 v[48:49], v5 offset:36864
  v_fma_f32 v34, -v206, v206, -s49
  v_fma_f32 v35, -v207, v207, -s49
  v_mul_f32 v34, v206, v34
  v_mul_f32 v35, v207, v35
  v_mfma_f32_32x32x16_bf16 v[224:239], v[52:55], a[68:71], v[224:239]
  s_waitcnt lgkmcnt(5)
  ds_read_b64_tr_b16 v[50:51], v5 offset:37888
  buffer_load_dwordx4 v18, s[12:15], s45 offen lds
  v_exp_f32 v34, v34
  v_exp_f32 v35, v35
  v_add_f32 v34, 1.0, v34
  v_add_f32 v35, 1.0, v35
  v_rcp_f32 v34, v34
  v_rcp_f32 v35, v35
  v_mul_f32 v34, v206, v34
  v_mul_f32 v35, v207, v35
  v_cvt_pk_bf16_f32 v203, v34, v35
  v_mfma_f32_32x32x16_bf16 v[112:127], v[56:59], a[64:67], v[112:127]
  ds_read_b64_tr_b16 v[52:53], v5 offset:45056
  ds_write_b128 v13, v[200:203] offset:19456
  v_mfma_f32_32x32x16_bf16 v[128:143], v[56:59], a[68:71], v[128:143]
  s_waitcnt lgkmcnt(6)
  ds_read_b64_tr_b16 v[54:55], v5 offset:46080
  v_mul_f32 v144, v144, v30
  v_mul_f32 v145, v145, v30
  v_fma_f32 v34, -v144, v144, -s49
  v_fma_f32 v35, -v145, v145, -s49
  v_mul_f32 v34, v144, v34
  v_mfma_f32_32x32x16_bf16 v[208:223], v[60:63], a[72:75], v[208:223]
  ds_read_b64_tr_b16 v[56:57], v5 offset:38912
  v_mul_f32 v35, v145, v35
  v_exp_f32 v34, v34
  v_exp_f32 v35, v35
  v_mfma_f32_32x32x16_bf16 v[224:239], v[60:63], a[76:79], v[224:239]
  s_waitcnt lgkmcnt(6)
  ds_read_b64_tr_b16 v[58:59], v5 offset:39936
  buffer_load_dwordx4 v19, s[12:15], s45 offen offset:1024 lds
  v_add_f32 v34, 1.0, v34
  v_add_f32 v35, 1.0, v35
  v_mfma_f32_32x32x16_bf16 v[112:127], v[44:47], a[72:75], v[112:127]
  s_add_u32 s44, s72, 0x12000
  ds_read_b64_tr_b16 v[60:61], v5 offset:47104
  v_rcp_f32 v34, v34
  v_rcp_f32 v35, v35
  v_mul_f32 v34, v144, v34
  v_mfma_f32_32x32x16_bf16 v[128:143], v[44:47], a[76:79], v[128:143]
  s_waitcnt lgkmcnt(6)
  ds_read_b64_tr_b16 v[62:63], v5 offset:48128
  v_mul_f32 v35, v145, v35
  v_cvt_pk_bf16_f32 v144, v34, v35
  v_mul_f32 v146, v146, v30
  v_mul_f32 v147, v147, v30
  v_fma_f32 v34, -v146, v146, -s49
  v_mfma_f32_32x32x16_bf16 v[208:223], v[48:51], a[80:83], v[208:223]
  s_waitcnt vmcnt(10) lgkmcnt(5)
  s_barrier
  ds_read_b64_tr_b16 v[44:45], v5 offset:49152
  ds_read_b128 a[128:131], v14 offset:16384
  v_mfma_f32_32x32x16_bf16 v[224:239], v[48:51], a[84:87], v[224:239]
  s_waitcnt lgkmcnt(6)
  ds_read_b64_tr_b16 v[46:47], v5 offset:50176
  ds_read_b128 a[132:135], v14 offset:18432
  ds_read_b128 a[136:139], v14 offset:17408
  v_fma_f32 v35, -v147, v147, -s49
  v_mul_f32 v34, v146, v34
  v_mul_f32 v35, v147, v35
  v_mfma_f32_32x32x16_bf16 v[112:127], v[52:55], a[80:83], v[112:127]
  s_add_u32 m0, s43, 0x18000
  ds_read_b64_tr_b16 v[48:49], v5 offset:57344
  v_exp_f32 v34, v34
  v_exp_f32 v35, v35
  v_add_f32 v34, 1.0, v34
  v_mfma_f32_32x32x16_bf16 v[128:143], v[52:55], a[84:87], v[128:143]
  s_waitcnt lgkmcnt(8)
  ds_read_b64_tr_b16 v[50:51], v5 offset:58368
  buffer_load_dwordx4 v18, s[12:15], s44 offen lds
  v_add_f32 v35, 1.0, v35
  v_rcp_f32 v34, v34
  v_mfma_f32_32x32x16_bf16 v[208:223], v[56:59], a[88:91], v[208:223]
  ds_read_b64_tr_b16 v[52:53], v5 offset:51200
  v_rcp_f32 v35, v35
  v_mul_f32 v34, v146, v34
  v_mul_f32 v35, v147, v35
  v_cvt_pk_bf16_f32 v145, v34, v35
  v_mfma_f32_32x32x16_bf16 v[224:239], v[56:59], a[92:95], v[224:239]
  s_waitcnt lgkmcnt(8)
  ds_read_b64_tr_b16 v[54:55], v5 offset:52224
  v_mul_f32 v148, v148, v30
  v_mul_f32 v149, v149, v30
  v_fma_f32 v34, -v148, v148, -s49
  v_fma_f32 v35, -v149, v149, -s49
  v_mul_f32 v34, v148, v34
  v_mfma_f32_32x32x16_bf16 v[112:127], v[60:63], a[88:91], v[112:127]
  ds_read_b64_tr_b16 v[56:57], v5 offset:59392
  v_mul_f32 v35, v149, v35
  v_exp_f32 v34, v34
  v_exp_f32 v35, v35
  v_mfma_f32_32x32x16_bf16 v[128:143], v[60:63], a[92:95], v[128:143]
  s_waitcnt lgkmcnt(7)
  ds_read_b64_tr_b16 v[58:59], v5 offset:60416
  buffer_load_dwordx4 v19, s[12:15], s44 offen offset:1024 lds
  ds_read_b128 a[140:143], v14 offset:19456
  v_add_f32 v34, 1.0, v34
  v_add_f32 v35, 1.0, v35
  v_mfma_f32_32x32x16_bf16 v[208:223], v[44:47], a[96:99], v[208:223]
  s_add_u32 s45, s72, 0x24000
  ds_read_b64_tr_b16 v[60:61], v5 offset:53248
  v_rcp_f32 v34, v34
  v_rcp_f32 v35, v35
  v_mul_f32 v34, v148, v34
  v_mfma_f32_32x32x16_bf16 v[224:239], v[44:47], a[100:103], v[224:239]
  s_waitcnt lgkmcnt(6)
  ds_read_b64_tr_b16 v[62:63], v5 offset:54272
  v_mul_f32 v35, v149, v35
  v_cvt_pk_bf16_f32 v146, v34, v35
  v_mul_f32 v150, v150, v30
  v_mul_f32 v151, v151, v30
  v_fma_f32 v34, -v150, v150, -s49
  v_mfma_f32_32x32x16_bf16 v[112:127], v[48:51], a[96:99], v[112:127]
  s_add_u32 m0, s43, 0x1a000
  ds_read_b64_tr_b16 v[44:45], v5 offset:61440
  v_fma_f32 v35, -v151, v151, -s49
  v_mul_f32 v34, v150, v34
  v_mul_f32 v35, v151, v35
  v_exp_f32 v34, v34
  v_mfma_f32_32x32x16_bf16 v[128:143], v[48:51], a[100:103], v[128:143]
  s_waitcnt lgkmcnt(6)
  ds_read_b64_tr_b16 v[46:47], v5 offset:62464
  buffer_load_dwordx4 v18, s[12:15], s45 offen lds
  v_exp_f32 v35, v35
  v_add_f32 v34, 1.0, v34
  v_mfma_f32_32x32x16_bf16 v[208:223], v[52:55], a[104:107], v[208:223]
  s_waitcnt vmcnt(9) lgkmcnt(4)
  s_barrier
  ds_read_b64_tr_b16 v[48:49], v5 offset:55296
  v_add_f32 v35, 1.0, v35
  v_mfma_f32_32x32x16_bf16 v[224:239], v[52:55], a[108:111], v[224:239]
  ds_read_b64_tr_b16 v[50:51], v5 offset:56320
  v_rcp_f32 v34, v34
  v_rcp_f32 v35, v35
  v_mul_f32 v34, v150, v34
  v_mfma_f32_32x32x16_bf16 v[112:127], v[56:59], a[104:107], v[112:127]
  ds_read_b64_tr_b16 v[52:53], v5 offset:63488
  ds_read_b128 a[144:147], v14 offset:20480
  ds_read_b128 a[148:151], v14 offset:22528
  ds_read_b128 a[152:155], v14 offset:21504
  v_mul_f32 v35, v151, v35
  v_cvt_pk_bf16_f32 v147, v34, v35
  v_mfma_f32_32x32x16_bf16 v[128:143], v[56:59], a[108:111], v[128:143]
  s_waitcnt lgkmcnt(8)
  ds_read_b64_tr_b16 v[54:55], v5 offset:64512
  buffer_load_dwordx4 v19, s[12:15], s45 offen offset:1024 lds
  ds_read_b128 a[156:159], v14 offset:23552
  v_mfma_f32_32x32x16_bf16 v[208:223], v[60:63], a[112:115], v[208:223]
  s_add_u32 s44, s72, 0x36000
  ds_read_b64_tr_b16 v[56:57], v6 offset:0
  ds_write_b128 v13, v[144:147] offset:32768
  v_mfma_f32_32x32x16_bf16 v[224:239], v[60:63], a[116:119], v[224:239]
  s_waitcnt lgkmcnt(10)
  ds_read_b64_tr_b16 v[58:59], v6 offset:1024
  v_mul_f32 v152, v152, v30
  v_mul_f32 v153, v153, v30
  v_fma_f32 v34, -v152, v152, -s49
  v_fma_f32 v35, -v153, v153, -s49
  v_mul_f32 v34, v152, v34
  v_mfma_f32_32x32x16_bf16 v[112:127], v[44:47], a[112:115], v[112:127]
  s_add_u32 m0, s43, 0x16000
  ds_read_b64_tr_b16 v[60:61], v7 offset:16384
  v_mul_f32 v35, v153, v35
  v_exp_f32 v34, v34
  v_exp_f32 v35, v35
  v_mfma_f32_32x32x16_bf16 v[128:143], v[44:47], a[116:119], v[128:143]
  s_waitcnt lgkmcnt(10)
  ds_read_b64_tr_b16 v[62:63], v7 offset:17408
  buffer_load_dwordx4 v18, s[12:15], s44 offen lds
  v_add_f32 v34, 1.0, v34
  v_add_f32 v35, 1.0, v35
  v_mfma_f32_32x32x16_bf16 v[208:223], v[48:51], a[120:123], v[208:223]
  ds_read_b64_tr_b16 v[44:45], v6 offset:2048
  v_rcp_f32 v34, v34
  v_rcp_f32 v35, v35
  v_mul_f32 v34, v152, v34
  v_mfma_f32_32x32x16_bf16 v[224:239], v[48:51], a[124:127], v[224:239]
  s_waitcnt lgkmcnt(7)
  ds_read_b64_tr_b16 v[46:47], v6 offset:3072
  v_mul_f32 v35, v153, v35
  v_cvt_pk_bf16_f32 v152, v34, v35
  v_mul_f32 v154, v154, v30
  v_mul_f32 v155, v155, v30
  v_fma_f32 v34, -v154, v154, -s49
  v_mfma_f32_32x32x16_bf16 v[112:127], v[52:55], a[120:123], v[112:127]
  ds_read_b64_tr_b16 v[48:49], v7 offset:18432
  v_fma_f32 v35, -v155, v155, -s49
  v_mul_f32 v34, v154, v34
  v_mul_f32 v35, v155, v35
  v_exp_f32 v34, v34
  v_mfma_f32_32x32x16_bf16 v[128:143], v[52:55], a[124:127], v[128:143]
  s_waitcnt lgkmcnt(5)
  ds_read_b64_tr_b16 v[50:51], v7 offset:19456
  buffer_load_dwordx4 v19, s[12:15], s44 offen offset:1024 lds
  v_exp_f32 v35, v35
  v_add_f32 v34, 1.0, v34
  v_mfma_f32_32x32x16_bf16 v[208:223], v[56:59], a[128:131], v[208:223]
  s_waitcnt vmcnt(8)
  s_barrier
  ds_read_b64_tr_b16 v[52:53], v6 offset:4096
  v_add_f32 v35, 1.0, v35
  v_mfma_f32_32x32x16_bf16 v[224:239], v[56:59], a[132:135], v[224:239]
  s_waitcnt lgkmcnt(5)
  ds_read_b64_tr_b16 v[54:55], v6 offset:5120
  v_rcp_f32 v34, v34
  v_rcp_f32 v35, v35
  v_mul_f32 v34, v154, v34
  v_mfma_f32_32x32x16_bf16 v[112:127], v[60:63], a[128:131], v[112:127]
  s_add_u32 s45, s72, 0x48000
  ds_read_b64_tr_b16 v[56:57], v7 offset:20480
  v_mul_f32 v35, v155, v35
  v_cvt_pk_bf16_f32 v153, v34, v35
  v_mul_f32 v156, v156, v30
  v_mul_f32 v157, v157, v30
  v_fma_f32 v34, -v156, v156, -s49
  v_fma_f32 v35, -v157, v157, -s49
  v_mul_f32 v34, v156, v34
  v_mul_f32 v35, v157, v35
  v_exp_f32 v34, v34
  v_exp_f32 v35, v35
  v_add_f32 v34, 1.0, v34
  v_add_f32 v35, 1.0, v35
  v_rcp_f32 v34, v34
  v_rcp_f32 v35, v35
  v_mul_f32 v34, v156, v34
  v_mul_f32 v35, v157, v35
  v_cvt_pk_bf16_f32 v154, v34, v35
  v_mul_f32 v158, v158, v30
  v_mul_f32 v159, v159, v30
  v_fma_f32 v34, -v158, v158, -s49
  v_fma_f32 v35, -v159, v159, -s49
  v_mul_f32 v34, v158, v34
  v_mul_f32 v35, v159, v35
  v_exp_f32 v34, v34
  v_exp_f32 v35, v35
  v_add_f32 v34, 1.0, v34
  v_add_f32 v35, 1.0, v35
  v_rcp_f32 v34, v34
  v_rcp_f32 v35, v35
  v_mul_f32 v34, v158, v34
  v_mul_f32 v35, v159, v35
  v_cvt_pk_bf16_f32 v155, v34, v35
  v_mfma_f32_32x32x16_bf16 v[128:143], v[60:63], a[132:135], v[128:143]
  s_waitcnt lgkmcnt(5)
  ds_read_b64_tr_b16 v[58:59], v7 offset:21504
  ds_write_b128 v13, v[152:155] offset:33792
  v_mfma_f32_32x32x16_bf16 v[208:223], v[44:47], a[136:139], v[208:223]
  s_add_u32 m0, s43, 0x2000
  ds_read_b64_tr_b16 v[60:61], v6 offset:6144
  v_mul_f32 v160, v160, v31
  v_mul_f32 v161, v161, v31
  v_fma_f32 v34, -v160, v160, -s49
  v_fma_f32 v35, -v161, v161, -s49
  v_mul_f32 v34, v160, v34
  v_mfma_f32_32x32x16_bf16 v[224:239], v[44:47], a[140:143], v[224:239]
  s_waitcnt lgkmcnt(6)
  ds_read_b64_tr_b16 v[62:63], v6 offset:7168
  buffer_load_dwordx4 v18, s[12:15], s45 offen lds
  v_mul_f32 v35, v161, v35
  v_exp_f32 v34, v34
  v_exp_f32 v35, v35
  v_add_f32 v34, 1.0, v34
  v_add_f32 v35, 1.0, v35
  v_rcp_f32 v34, v34
  v_rcp_f32 v35, v35
  v_mul_f32 v34, v160, v34
  v_mul_f32 v35, v161, v35
  v_cvt_pk_bf16_f32 v160, v34, v35
  v_mul_f32 v162, v162, v31
  v_mul_f32 v163, v163, v31
  v_fma_f32 v34, -v162, v162, -s49
  v_fma_f32 v35, -v163, v163, -s49
  v_mul_f32 v34, v162, v34
  v_mul_f32 v35, v163, v35
  v_exp_f32 v34, v34
  v_exp_f32 v35, v35
  v_add_f32 v34, 1.0, v34
  v_add_f32 v35, 1.0, v35
  v_rcp_f32 v34, v34
  v_rcp_f32 v35, v35
  v_mul_f32 v34, v162, v34
  v_mul_f32 v35, v163, v35
  v_cvt_pk_bf16_f32 v161, v34, v35
  v_mul_f32 v164, v164, v31
  v_mul_f32 v165, v165, v31
  v_fma_f32 v34, -v164, v164, -s49
  v_fma_f32 v35, -v165, v165, -s49
  v_mul_f32 v34, v164, v34
  v_mul_f32 v35, v165, v35
  v_exp_f32 v34, v34
  v_exp_f32 v35, v35
  v_add_f32 v34, 1.0, v34
  v_add_f32 v35, 1.0, v35
  v_rcp_f32 v34, v34
  v_rcp_f32 v35, v35
  v_mul_f32 v34, v164, v34
  v_mul_f32 v35, v165, v35
  v_cvt_pk_bf16_f32 v162, v34, v35
  v_mul_f32 v166, v166, v31
  v_mul_f32 v167, v167, v31
  v_fma_f32 v34, -v166, v166, -s49
  v_fma_f32 v35, -v167, v167, -s49
  v_mul_f32 v34, v166, v34
  v_mul_f32 v35, v167, v35
  v_exp_f32 v34, v34
  v_exp_f32 v35, v35
  v_add_f32 v34, 1.0, v34
  v_add_f32 v35, 1.0, v35
  v_rcp_f32 v34, v34
  v_rcp_f32 v35, v35
  v_mul_f32 v34, v166, v34
  v_mul_f32 v35, v167, v35
  v_cvt_pk_bf16_f32 v163, v34, v35
  v_mfma_f32_32x32x16_bf16 v[112:127], v[48:51], a[136:139], v[112:127]
  ds_read_b64_tr_b16 v[44:45], v7 offset:22528
  ds_write_b128 v13, v[160:163] offset:34816
  v_mfma_f32_32x32x16_bf16 v[128:143], v[48:51], a[140:143], v[128:143]
  s_waitcnt lgkmcnt(7)
  ds_read_b64_tr_b16 v[46:47], v7 offset:23552
  v_mul_f32 v168, v168, v31
  v_mul_f32 v169, v169, v31
  v_fma_f32 v34, -v168, v168, -s49
  v_fma_f32 v35, -v169, v169, -s49
  v_mul_f32 v34, v168, v34
  v_mfma_f32_32x32x16_bf16 v[208:223], v[52:55], a[144:147], v[208:223]
  ds_read_b64_tr_b16 v[48:49], v7 offset:24576
  v_mul_f32 v35, v169, v35
  v_exp_f32 v34, v34
  v_exp_f32 v35, v35
  v_add_f32 v34, 1.0, v34
  v_add_f32 v35, 1.0, v35
  v_rcp_f32 v34, v34
  v_rcp_f32 v35, v35
  v_mul_f32 v34, v168, v34
  v_mul_f32 v35, v169, v35
  v_cvt_pk_bf16_f32 v168, v34, v35
  v_mul_f32 v170, v170, v31
  v_mul_f32 v171, v171, v31
  v_fma_f32 v34, -v170, v170, -s49
  v_fma_f32 v35, -v171, v171, -s49
  v_mul_f32 v34, v170, v34
  v_mul_f32 v35, v171, v35
  v_exp_f32 v34, v34
  v_exp_f32 v35, v35
  v_add_f32 v34, 1.0, v34
  v_add_f32 v35, 1.0, v35
  v_rcp_f32 v34, v34
  v_rcp_f32 v35, v35
  v_mul_f32 v34, v170, v34
  v_mul_f32 v35, v171, v35
  v_cvt_pk_bf16_f32 v169, v34, v35
  v_mul_f32 v172, v172, v31
  v_mul_f32 v173, v173, v31
  v_fma_f32 v34, -v172, v172, -s49
  v_fma_f32 v35, -v173, v173, -s49
  v_mul_f32 v34, v172, v34
  v_mul_f32 v35, v173, v35
  v_exp_f32 v34, v34
  v_exp_f32 v35, v35
  v_add_f32 v34, 1.0, v34
  v_add_f32 v35, 1.0, v35
  v_rcp_f32 v34, v34
  v_rcp_f32 v35, v35
  v_mul_f32 v34, v172, v34
  v_mul_f32 v35, v173, v35
  v_cvt_pk_bf16_f32 v170, v34, v35
  v_mul_f32 v174, v174, v31
  v_mul_f32 v175, v175, v31
  v_fma_f32 v34, -v174, v174, -s49
  v_fma_f32 v35, -v175, v175, -s49
  v_mul_f32 v34, v174, v34
  v_mul_f32 v35, v175, v35
  v_exp_f32 v34, v34
  v_exp_f32 v35, v35
  v_add_f32 v34, 1.0, v34
  v_add_f32 v35, 1.0, v35
  v_rcp_f32 v34, v34
  v_rcp_f32 v35, v35
  v_mul_f32 v34, v174, v34
  v_mul_f32 v35, v175, v35
  v_cvt_pk_bf16_f32 v171, v34, v35
  v_mfma_f32_32x32x16_bf16 v[224:239], v[52:55], a[148:151], v[224:239]
  s_waitcnt lgkmcnt(7)
  ds_read_b64_tr_b16 v[50:51], v7 offset:25600
  buffer_load_dwordx4 v19, s[12:15], s45 offen offset:1024 lds
  ds_write_b128 v13, v[168:171] offset:35840
  v_mfma_f32_32x32x16_bf16 v[112:127], v[56:59], a[144:147], v[112:127]
  s_add_u32 s44, s72, 0x5a000
  s_add_u32 m0, s43, 0x4000
  ds_read_b64_tr_b16 v[52:53], v6 offset:8192
  v_mfma_f32_32x32x16_bf16 v[128:143], v[56:59], a[148:151], v[128:143]
  s_waitcnt lgkmcnt(7)
  ds_read_b64_tr_b16 v[54:55], v6 offset:9216
  v_mfma_f32_32x32x16_bf16 v[208:223], v[60:63], a[152:155], v[208:223]
  s_waitcnt lgkmcnt(2)
  s_barrier
  ds_read_b64_tr_b16 v[56:57], v7 offset:26624
  ds_read_b128 a[160:163], v14 offset:32768
  v_mfma_f32_32x32x16_bf16 v[224:239], v[60:63], a[156:159], v[224:239]
  ds_read_b64_tr_b16 v[58:59], v7 offset:27648
  buffer_load_dwordx4 v18, s[12:15], s44 offen lds
  ds_read_b128 a[164:167], v14 offset:34816
  ds_read_b128 a[168:171], v14 offset:33792
  ds_read_b128 a[172:175], v14 offset:35840
  v_mfma_f32_32x32x16_bf16 v[112:127], v[44:47], a[152:155], v[112:127]
  ds_read_b64_tr_b16 v[60:61], v6 offset:10240
  ds_read_b128 a[176:179], v14 offset:36864
  ds_read_b128 a[180:183], v14 offset:38912
  ds_read_b128 a[184:187], v14 offset:37888
  ds_read_b128 a[188:191], v14 offset:39936
  v_mfma_f32_32x32x16_bf16 v[128:143], v[44:47], a[156:159], v[128:143]
  s_waitcnt lgkmcnt(9)
  ds_read_b64_tr_b16 v[62:63], v6 offset:11264
  v_mfma_f32_32x32x16_bf16 v[208:223], v[48:51], a[160:163], v[208:223]
  s_waitcnt lgkmcnt(8)
  ds_read_b64_tr_b16 v[44:45], v7 offset:28672
  v_mfma_f32_32x32x16_bf16 v[224:239], v[48:51], a[164:167], v[224:239]
  ds_read_b64_tr_b16 v[46:47], v7 offset:29696
  buffer_load_dwordx4 v19, s[12:15], s44 offen offset:1024 lds
  v_mfma_f32_32x32x16_bf16 v[112:127], v[52:55], a[160:163], v[112:127]
  s_add_u32 s45, s73, 0x0
  s_add_u32 m0, s43, 0x6000
  ds_read_b64_tr_b16 v[48:49], v6 offset:12288
  v_mfma_f32_32x32x16_bf16 v[128:143], v[52:55], a[164:167], v[128:143]
  s_waitcnt lgkmcnt(10)
  ds_read_b64_tr_b16 v[50:51], v6 offset:13312
  v_mfma_f32_32x32x16_bf16 v[208:223], v[56:59], a[168:171], v[208:223]
  s_waitcnt lgkmcnt(10)
  ds_read_b64_tr_b16 v[52:53], v7 offset:30720
  v_mfma_f32_32x32x16_bf16 v[224:239], v[56:59], a[172:175], v[224:239]
  s_waitcnt lgkmcnt(5)
  ds_read_b64_tr_b16 v[54:55], v7 offset:31744
  buffer_load_dwordx4 v18, s[12:15], s45 offen lds
  v_mfma_f32_32x32x16_bf16 v[112:127], v[60:63], a[168:171], v[112:127]
  ds_read_b64_tr_b16 v[56:57], v6 offset:14336
  v_mfma_f32_32x32x16_bf16 v[128:143], v[60:63], a[172:175], v[128:143]
  s_waitcnt lgkmcnt(5)
  s_lshl_b32 s47, s70, 5
  s_add_u32 s47, s47, s46
  ds_read_b64_tr_b16 v[58:59], v6 offset:15360
  v_mfma_f32_32x32x16_bf16 v[208:223], v[44:47], a[176:179], v[208:223]
  s_waitcnt vmcnt(9)
  s_barrier
  ds_read_b64_tr_b16 v[60:61], v6 offset:16384
  v_mfma_f32_32x32x16_bf16 v[224:239], v[44:47], a[180:183], v[224:239]
  s_waitcnt lgkmcnt(5)
  ds_read_b64_tr_b16 v[62:63], v6 offset:17408
  buffer_load_dwordx4 v19, s[12:15], s45 offen offset:1024 lds
  v_mfma_f32_32x32x16_bf16 v[112:127], v[48:51], a[176:179], v[112:127]
  s_add_u32 s44, s73, 0x12000
  s_add_u32 m0, s43, 0x8000
  ds_read_b64_tr_b16 v[44:45], v6 offset:18432
  v_mfma_f32_32x32x16_bf16 v[128:143], v[48:51], a[180:183], v[128:143]
  s_waitcnt lgkmcnt(5)
  ds_read_b64_tr_b16 v[46:47], v6 offset:19456
  v_mfma_f32_32x32x16_bf16 v[208:223], v[52:55], a[184:187], v[208:223]
  ds_read_b64_tr_b16 v[48:49], v6 offset:20480
  v_mfma_f32_32x32x16_bf16 v[224:239], v[52:55], a[188:191], v[224:239]
  s_waitcnt lgkmcnt(5)
  ds_read_b64_tr_b16 v[50:51], v6 offset:21504
  buffer_load_dwordx4 v18, s[12:15], s44 offen lds
  v_mfma_f32_32x32x16_bf16 v[112:127], v[56:59], a[184:187], v[112:127]
  ds_read_b64_tr_b16 v[52:53], v6 offset:22528
  v_mfma_f32_32x32x16_bf16 v[128:143], v[56:59], a[188:191], v[128:143]
  s_waitcnt lgkmcnt(5)
  ds_read_b64_tr_b16 v[54:55], v6 offset:23552
  s_nop 1
  v_cvt_pk_bf16_f32 v208, v208, v209
  v_cvt_pk_bf16_f32 v209, v210, v211
  v_cvt_pk_bf16_f32 v210, v212, v213
  v_cvt_pk_bf16_f32 v211, v214, v215
  v_mfma_f32_32x32x16_bf16 v[64:79], v[60:63], a[0:3], 0
  ds_read_b64_tr_b16 v[56:57], v6 offset:32768
  buffer_store_dwordx4 v[208:211], v20, s[16:19], s47 offen sc1
  v_cvt_pk_bf16_f32 v216, v216, v217
  v_mfma_f32_32x32x16_bf16 v[80:95], v[60:63], a[4:7], 0
  s_waitcnt lgkmcnt(5)
  ds_read_b64_tr_b16 v[58:59], v6 offset:33792
  buffer_load_dwordx4 v19, s[12:15], s44 offen offset:1024 lds
  v_cvt_pk_bf16_f32 v217, v218, v219
  v_cvt_pk_bf16_f32 v218, v220, v221
  v_cvt_pk_bf16_f32 v219, v222, v223
  v_mfma_f32_32x32x16_bf16 v[64:79], v[44:47], a[8:11], v[64:79]
  s_add_u32 s45, s73, 0x24000
  s_add_u32 m0, s43, 0xa000
  ds_read_b64_tr_b16 v[60:61], v6 offset:34816
  v_mfma_f32_32x32x16_bf16 v[80:95], v[44:47], a[12:15], v[80:95]
  s_waitcnt lgkmcnt(5)
  ds_read_b64_tr_b16 v[62:63], v6 offset:35840
  buffer_store_dwordx4 v[216:219], v20, s[16:19], s47 offen offset:1024 sc1
  v_cvt_pk_bf16_f32 v224, v224, v225
  v_mfma_f32_32x32x16_bf16 v[64:79], v[48:51], a[16:19], v[64:79]
  s_waitcnt vmcnt(8)
  s_barrier
  ds_read_b64_tr_b16 v[44:45], v6 offset:36864
  v_min_u32 v24, 15, v1
  v_mfma_f32_32x32x16_bf16 v[80:95], v[48:51], a[20:23], v[80:95]
  s_waitcnt lgkmcnt(5)
  ds_read_b64_tr_b16 v[46:47], v6 offset:37888
  buffer_load_dwordx4 v18, s[12:15], s45 offen lds
  v_lshlrev_b32 v24, 2, v24
  v_mov_b32 v22, 0
  v_mov_b32 v23, 3
  v_mfma_f32_32x32x16_bf16 v[64:79], v[52:55], a[24:27], v[64:79]
  ds_read_b64_tr_b16 v[48:49], v6 offset:38912
  v_cmp_gt_u32 vcc, 12, v1
  s_nop 1
  v_cndmask_b32 v22, v22, v23, vcc
  s_lshl_b32 s34, s28, 2
  v_mov_b32 v25, s34
  v_mov_b32 v23, 64
  v_mfma_f32_32x32x16_bf16 v[80:95], v[52:55], a[28:31], v[80:95]
  s_waitcnt lgkmcnt(5)
  ds_read_b64_tr_b16 v[50:51], v6 offset:39936
  v_cvt_pk_bf16_f32 v225, v226, v227
  v_cvt_pk_bf16_f32 v226, v228, v229
  v_cvt_pk_bf16_f32 v227, v230, v231
  v_cmp_eq_u32 vcc, 1, v1
  s_nop 1
  v_cndmask_b32 v25, v25, v23, vcc
  v_mfma_f32_32x32x16_bf16 v[64:79], v[56:59], a[32:35], v[64:79]
  ds_read_b64_tr_b16 v[52:53], v6 offset:40960
  buffer_store_dwordx4 v[224:227], v21, s[16:19], s47 offen sc1
  v_cvt_pk_bf16_f32 v232, v232, v233
  v_mfma_f32_32x32x16_bf16 v[80:95], v[56:59], a[36:39], v[80:95]
  s_waitcnt lgkmcnt(5)
  ds_read_b64_tr_b16 v[54:55], v6 offset:41984
  buffer_load_dwordx4 v19, s[12:15], s45 offen offset:1024 lds
  v_cvt_pk_bf16_f32 v233, v234, v235
  v_cvt_pk_bf16_f32 v234, v236, v237
  v_cvt_pk_bf16_f32 v235, v238, v239
  v_mfma_f32_32x32x16_bf16 v[64:79], v[60:63], a[40:43], v[64:79]
  s_add_u32 s44, s73, 0x36000
  s_add_u32 m0, s43, 0xc000
  ds_read_b64_tr_b16 v[56:57], v6 offset:43008
  v_mov_b32 v23, 64
  v_cndmask_b32 v23, 16, v23, vcc
  s_mul_i32 s37, s29, 11
  s_lshr_b32 s37, s37, 5
  v_mfma_f32_32x32x16_bf16 v[80:95], v[60:63], a[44:47], v[80:95]
  s_waitcnt lgkmcnt(5)
  ds_read_b64_tr_b16 v[58:59], v6 offset:44032
  buffer_store_dwordx4 v[232:235], v21, s[16:19], s47 offen offset:1024 sc1
  s_mul_i32 s34, s37, 3
  v_mfma_f32_32x32x16_bf16 v[64:79], v[44:47], a[48:51], v[64:79]
  s_lshl_b32 s48, s71, 5
  s_add_u32 s48, s48, s46
  ds_read_b64_tr_b16 v[60:61], v6 offset:45056
  v_cvt_pk_bf16_f32 v112, v112, v113
  v_cvt_pk_bf16_f32 v113, v114, v115
  v_cvt_pk_bf16_f32 v114, v116, v117
  v_cvt_pk_bf16_f32 v115, v118, v119
  v_mfma_f32_32x32x16_bf16 v[80:95], v[44:47], a[52:55], v[80:95]
  s_waitcnt lgkmcnt(5)
  ds_read_b64_tr_b16 v[62:63], v6 offset:46080
  buffer_load_dwordx4 v18, s[12:15], s44 offen lds
  s_sub_u32 s41, s29, s34
  s_mul_i32 s36, s30, 36864
  s_add_u32 s36, s36, s40
  v_mfma_f32_32x32x16_bf16 v[64:79], v[48:51], a[56:59], v[64:79]
  ds_read_b64_tr_b16 v[44:45], v6 offset:47104
  buffer_store_dwordx4 v[112:115], v20, s[16:19], s48 offen sc1
  v_cvt_pk_bf16_f32 v120, v120, v121
  v_mfma_f32_32x32x16_bf16 v[80:95], v[48:51], a[60:63], v[80:95]
  s_waitcnt lgkmcnt(5)
  ds_read_b64_tr_b16 v[46:47], v6 offset:48128
  v_cvt_pk_bf16_f32 v121, v122, v123
  v_cvt_pk_bf16_f32 v122, v124, v125
  v_cvt_pk_bf16_f32 v123, v126, v127
  s_add_u32 s66, s36, 0x2000000
  s_add_u32 s34, s41, s33
  v_mfma_f32_32x32x16_bf16 v[64:79], v[52:55], a[64:67], v[64:79]
  ds_read_b64_tr_b16 v[48:49], v6 offset:24576
  s_add_u32 s34, s34, 0
  s_cmp_ge_u32 s34, 9
  s_cselect_b32 s35, 9, 0
  s_sub_u32 s34, s34, s35
  s_lshl_b32 s34, s34, 2
  v_mfma_f32_32x32x16_bf16 v[80:95], v[52:55], a[68:71], v[80:95]
  s_waitcnt lgkmcnt(5)
  ds_read_b64_tr_b16 v[50:51], v6 offset:25600
  buffer_load_dwordx4 v19, s[12:15], s44 offen offset:1024 lds
  s_add_u32 s34, s34, s37
  s_lshl_b32 s54, s34, 10
  s_add_u32 s54, s54, s36
  v_mfma_f32_32x32x16_bf16 v[64:79], v[56:59], a[72:75], v[64:79]
  s_add_u32 s45, s73, 0x48000
  s_add_u32 m0, s43, 0xe000
  ds_read_b64_tr_b16 v[52:53], v6 offset:26624
  buffer_store_dwordx4 v[120:123], v20, s[16:19], s48 offen offset:1024 sc1
  v_mfma_f32_32x32x16_bf16 v[80:95], v[56:59], a[76:79], v[80:95]
  s_waitcnt lgkmcnt(5)
  ds_read_b64_tr_b16 v[54:55], v6 offset:27648
  v_cvt_pk_bf16_f32 v128, v128, v129
  v_cvt_pk_bf16_f32 v129, v130, v131
  v_cvt_pk_bf16_f32 v130, v132, v133
  v_cvt_pk_bf16_f32 v131, v134, v135
  s_mul_i32 s57, s34, 18432
  v_mfma_f32_32x32x16_bf16 v[64:79], v[60:63], a[80:83], v[64:79]
  ds_read_b64_tr_b16 v[56:57], v6 offset:28672
  s_add_u32 s57, s57, 0x2400000
  s_lshl_b32 s63, s34, 5
  s_add_u32 s60, s63, s36
  s_add_u32 s34, s41, s33
  s_add_u32 s34, s34, 3
  v_mfma_f32_32x32x16_bf16 v[80:95], v[60:63], a[84:87], v[80:95]
  s_waitcnt lgkmcnt(5)
  ds_read_b64_tr_b16 v[58:59], v6 offset:29696
  buffer_load_dwordx4 v18, s[12:15], s45 offen lds
  s_cmp_ge_u32 s34, 9
  s_cselect_b32 s35, 9, 0
  s_sub_u32 s34, s34, s35
  v_mfma_f32_32x32x16_bf16 v[64:79], v[44:47], a[88:91], v[64:79]
  ds_read_b64_tr_b16 v[60:61], v6 offset:30720
  buffer_store_dwordx4 v[128:131], v21, s[16:19], s48 offen sc1
  v_cvt_pk_bf16_f32 v136, v136, v137
  v_mfma_f32_32x32x16_bf16 v[80:95], v[44:47], a[92:95], v[80:95]
  s_waitcnt lgkmcnt(5)
  ds_read_b64_tr_b16 v[62:63], v6 offset:31744
  v_cvt_pk_bf16_f32 v137, v138, v139
  v_cvt_pk_bf16_f32 v138, v140, v141
  v_cvt_pk_bf16_f32 v139, v142, v143
  s_lshl_b32 s34, s34, 2
  s_add_u32 s34, s34, s37
  v_mfma_f32_32x32x16_bf16 v[64:79], v[48:51], a[96:99], v[64:79]
  ds_read_b64_tr_b16 v[44:45], v5 offset:8192
  s_lshl_b32 s55, s34, 10
  s_add_u32 s55, s55, s36
  s_mul_i32 s58, s34, 18432
  s_add_u32 s58, s58, 0x2400000
  s_lshl_b32 s64, s34, 5
  v_mfma_f32_32x32x16_bf16 v[80:95], v[48:51], a[100:103], v[80:95]
  s_waitcnt lgkmcnt(5)
  ds_read_b64_tr_b16 v[46:47], v5 offset:9216
  buffer_load_dwordx4 v19, s[12:15], s45 offen offset:1024 lds
  s_add_u32 s61, s64, s36
  s_add_u32 s34, s41, s33
  s_add_u32 s34, s34, 6
  v_mfma_f32_32x32x16_bf16 v[64:79], v[52:55], a[104:107], v[64:79]
  s_add_u32 s44, s73, 0x5a000
  s_add_u32 m0, s43, 0x1c000
  ds_read_b64_tr_b16 v[48:49], v5 offset:10240
  buffer_store_dwordx4 v[136:139], v21, s[16:19], s48 offen offset:1024 sc1
  v_mfma_f32_32x32x16_bf16 v[80:95], v[52:55], a[108:111], v[80:95]
  s_waitcnt lgkmcnt(5)
  ds_read_b64_tr_b16 v[50:51], v5 offset:11264
  s_cmp_ge_u32 s34, 9
  s_cselect_b32 s35, 9, 0
  s_sub_u32 s34, s34, s35
  s_lshl_b32 s34, s34, 2
  s_add_u32 s34, s34, s37
  v_mfma_f32_32x32x16_bf16 v[64:79], v[56:59], a[112:115], v[64:79]
  s_waitcnt vmcnt(13)
  s_barrier
  ds_read_b64_tr_b16 v[52:53], v5 offset:12288
  s_lshl_b32 s56, s34, 10
  v_mfma_f32_32x32x16_bf16 v[80:95], v[56:59], a[116:119], v[80:95]
  s_waitcnt lgkmcnt(5)
  ds_read_b64_tr_b16 v[54:55], v5 offset:13312
  buffer_load_dwordx4 v18, s[12:15], s44 offen lds
  s_add_u32 s56, s56, s36
  s_mul_i32 s59, s34, 18432
  s_add_u32 s59, s59, 0x2400000
  v_mfma_f32_32x32x16_bf16 v[64:79], v[60:63], a[120:123], v[64:79]
  ds_read_b64_tr_b16 v[56:57], v5 offset:14336
  s_lshl_b32 s65, s34, 5
  s_add_u32 s62, s65, s36
  v_lshlrev_b32 v28, 4, v1
  v_add_u32 v2, s43, v28
  v_add_u32 v3, 0x10000, v28
  v_mfma_f32_32x32x16_bf16 v[80:95], v[60:63], a[124:127], v[80:95]
  s_waitcnt lgkmcnt(5)
  ds_read_b64_tr_b16 v[58:59], v5 offset:15360
  v_add_u32 v4, 0x20000, v28
  v_and_b32 v31, 31, v1
  v_mul_u32_u24 v31, 1152, v31
  v_lshrrev_b32 v32, 5, v1
  v_lshl_add_u32 v31, v32, 4, v31
  v_mfma_f32_32x32x16_bf16 v[64:79], v[44:47], a[128:131], v[64:79]
  ds_read_b64_tr_b16 v[60:61], v5 offset:16384
  v_lshlrev_b32 v32, 3, v32
  s_mov_b32 s24, s80
  s_mov_b32 s25, s81
  s_mov_b32 s26, 0x480
  s_mov_b32 s27, 0x00020000
  v_mfma_f32_32x32x16_bf16 v[80:95], v[44:47], a[132:135], v[80:95]
  s_waitcnt lgkmcnt(5)
  ds_read_b64_tr_b16 v[62:63], v5 offset:17408
  buffer_load_dwordx4 v19, s[12:15], s44 offen offset:1024 lds
  s_mov_b32 s8, s82
  s_mov_b32 s9, s83
  s_mov_b32 s10, 0x240000
  v_mfma_f32_32x32x16_bf16 v[64:79], v[48:51], a[136:139], v[64:79]
  s_add_u32 s45, s74, 0x0
  s_add_u32 m0, s43, 0x1e000
  ds_read_b64_tr_b16 v[44:45], v5 offset:18432
  s_mov_b32 s11, 0x00020000
  s_lshr_b32 s67, s2, 3
  s_lshl_b32 s67, s67, 2
  s_add_u32 s67, s67, s30
  v_mfma_f32_32x32x16_bf16 v[80:95], v[48:51], a[140:143], v[80:95]
  s_waitcnt lgkmcnt(5)
  ds_read_b64_tr_b16 v[46:47], v5 offset:19456
  s_mul_i32 s67, s67, 6912
  s_add_u32 s67, s67, 0x23ca000
  v_min_u32 v29, 53, v1
  v_lshlrev_b32 v29, 7, v29
  v_mfma_f32_32x32x16_bf16 v[64:79], v[52:55], a[144:147], v[64:79]
  ds_read_b64_tr_b16 v[48:49], v5 offset:20480
  v_mfma_f32_32x32x16_bf16 v[80:95], v[52:55], a[148:151], v[80:95]
  s_waitcnt lgkmcnt(5)
  ds_read_b64_tr_b16 v[50:51], v5 offset:21504
  buffer_load_dwordx4 v18, s[12:15], s45 offen lds
  v_mfma_f32_32x32x16_bf16 v[64:79], v[56:59], a[152:155], v[64:79]
  ds_read_b64_tr_b16 v[52:53], v5 offset:22528
  v_mfma_f32_32x32x16_bf16 v[80:95], v[56:59], a[156:159], v[80:95]
  s_waitcnt lgkmcnt(5)
  ds_read_b64_tr_b16 v[54:55], v5 offset:23552
  v_mfma_f32_32x32x16_bf16 v[64:79], v[60:63], a[160:163], v[64:79]
  ds_read_b64_tr_b16 v[56:57], v5 offset:24576
  v_mfma_f32_32x32x16_bf16 v[80:95], v[60:63], a[164:167], v[80:95]
  s_waitcnt lgkmcnt(5)
  s_lshl_b32 s47, s72, 5
  s_add_u32 s47, s47, s46
  ds_read_b64_tr_b16 v[58:59], v5 offset:25600
  buffer_load_dwordx4 v19, s[12:15], s45 offen offset:1024 lds
  v_mfma_f32_32x32x16_bf16 v[64:79], v[44:47], a[168:171], v[64:79]
  s_add_u32 s44, s74, 0x12000
  s_add_u32 m0, s43, 0x10000
  ds_read_b64_tr_b16 v[60:61], v5 offset:26624
  v_mfma_f32_32x32x16_bf16 v[80:95], v[44:47], a[172:175], v[80:95]
  s_waitcnt lgkmcnt(5)
  ds_read_b64_tr_b16 v[62:63], v5 offset:27648
  v_mfma_f32_32x32x16_bf16 v[64:79], v[48:51], a[176:179], v[64:79]
  ds_read_b64_tr_b16 v[44:45], v5 offset:28672
  v_mfma_f32_32x32x16_bf16 v[80:95], v[48:51], a[180:183], v[80:95]
  s_waitcnt lgkmcnt(5)
  ds_read_b64_tr_b16 v[46:47], v5 offset:29696
  buffer_load_dwordx4 v18, s[12:15], s44 offen lds
  v_mfma_f32_32x32x16_bf16 v[64:79], v[52:55], a[184:187], v[64:79]
  ds_read_b64_tr_b16 v[48:49], v5 offset:30720
  v_mfma_f32_32x32x16_bf16 v[80:95], v[52:55], a[188:191], v[80:95]
  s_waitcnt lgkmcnt(5)
  ds_read_b64_tr_b16 v[50:51], v5 offset:31744
  v_mfma_f32_32x32x16_bf16 v[176:191], v[56:59], a[0:3], 0
  ds_read_b64_tr_b16 v[52:53], v5 offset:32768
  v_mfma_f32_32x32x16_bf16 v[192:207], v[56:59], a[4:7], 0
  s_waitcnt lgkmcnt(5)
  ds_read_b64_tr_b16 v[54:55], v5 offset:33792
  buffer_load_dwordx4 v19, s[12:15], s44 offen offset:1024 lds
  s_nop 1
  v_cvt_pk_bf16_f32 v64, v64, v65
  v_cvt_pk_bf16_f32 v65, v66, v67
  v_cvt_pk_bf16_f32 v66, v68, v69
  v_mfma_f32_32x32x16_bf16 v[176:191], v[60:63], a[8:11], v[176:191]
  s_add_u32 s45, s74, 0x24000
  s_add_u32 m0, s43, 0x24000
  ds_read_b64_tr_b16 v[56:57], v5 offset:34816
  v_cvt_pk_bf16_f32 v67, v70, v71
  v_mfma_f32_32x32x16_bf16 v[192:207], v[60:63], a[12:15], v[192:207]
  s_waitcnt lgkmcnt(5)
  ds_read_b64_tr_b16 v[58:59], v5 offset:35840
  buffer_store_dwordx4 v[64:67], v20, s[16:19], s47 offen sc1
  v_cvt_pk_bf16_f32 v72, v72, v73
  v_mfma_f32_32x32x16_bf16 v[176:191], v[44:47], a[16:19], v[176:191]
  s_waitcnt vmcnt(8)
  s_barrier
  ds_read_b64_tr_b16 v[60:61], v5 offset:36864
  v_cvt_pk_bf16_f32 v73, v74, v75
  v_mfma_f32_32x32x16_bf16 v[192:207], v[44:47], a[20:23], v[192:207]
  s_waitcnt lgkmcnt(5)
  ds_read_b64_tr_b16 v[62:63], v5 offset:37888
  buffer_load_dwordx4 v18, s[12:15], s45 offen lds
  v_cvt_pk_bf16_f32 v74, v76, v77
  v_cvt_pk_bf16_f32 v75, v78, v79
  v_mfma_f32_32x32x16_bf16 v[176:191], v[48:51], a[24:27], v[176:191]
  ds_read_b64_tr_b16 v[44:45], v5 offset:38912
  buffer_store_dwordx4 v[72:75], v20, s[16:19], s47 offen offset:1024 sc1
  v_cvt_pk_bf16_f32 v80, v80, v81
  v_mfma_f32_32x32x16_bf16 v[192:207], v[48:51], a[28:31], v[192:207]
  s_waitcnt lgkmcnt(5)
  ds_read_b64_tr_b16 v[46:47], v5 offset:39936
  v_cvt_pk_bf16_f32 v81, v82, v83
  v_cvt_pk_bf16_f32 v82, v84, v85
  v_cvt_pk_bf16_f32 v83, v86, v87
  v_mfma_f32_32x32x16_bf16 v[176:191], v[52:55], a[32:35], v[176:191]
  ds_read_b64_tr_b16 v[48:49], v5 offset:40960
  v_mfma_f32_32x32x16_bf16 v[192:207], v[52:55], a[36:39], v[192:207]
  s_waitcnt lgkmcnt(5)
  ds_read_b64_tr_b16 v[50:51], v5 offset:41984
  buffer_load_dwordx4 v19, s[12:15], s45 offen offset:1024 lds
  v_mfma_f32_32x32x16_bf16 v[176:191], v[56:59], a[40:43], v[176:191]
  s_add_u32 s44, s74, 0x36000
  s_add_u32 m0, s43, 0x20000
  ds_read_b64_tr_b16 v[52:53], v5 offset:43008
  buffer_store_dwordx4 v[80:83], v21, s[16:19], s47 offen sc1
  v_mfma_f32_32x32x16_bf16 v[192:207], v[56:59], a[44:47], v[192:207]
  s_waitcnt lgkmcnt(5)
  ds_read_b64_tr_b16 v[54:55], v5 offset:44032
  v_cvt_pk_bf16_f32 v88, v88, v89
  v_cvt_pk_bf16_f32 v89, v90, v91
  v_cvt_pk_bf16_f32 v90, v92, v93
  v_cvt_pk_bf16_f32 v91, v94, v95
  v_mfma_f32_32x32x16_bf16 v[176:191], v[60:63], a[48:51], v[176:191]
  ds_read_b64_tr_b16 v[56:57], v5 offset:45056
  v_mfma_f32_32x32x16_bf16 v[192:207], v[60:63], a[52:55], v[192:207]
  s_waitcnt lgkmcnt(5)
  ds_read_b64_tr_b16 v[58:59], v5 offset:46080
  buffer_load_dwordx4 v18, s[12:15], s44 offen lds
  v_mfma_f32_32x32x16_bf16 v[176:191], v[44:47], a[56:59], v[176:191]
  ds_read_b64_tr_b16 v[60:61], v5 offset:47104
  buffer_store_dwordx4 v[88:91], v21, s[16:19], s47 offen offset:1024 sc1
  v_mfma_f32_32x32x16_bf16 v[192:207], v[44:47], a[60:63], v[192:207]
  s_waitcnt lgkmcnt(5)
  ds_read_b64_tr_b16 v[62:63], v5 offset:48128
  v_mfma_f32_32x32x16_bf16 v[176:191], v[48:51], a[64:67], v[176:191]
  ds_read_b64_tr_b16 v[44:45], v5 offset:49152
  v_mfma_f32_32x32x16_bf16 v[192:207], v[48:51], a[68:71], v[192:207]
  s_waitcnt lgkmcnt(5)
  ds_read_b64_tr_b16 v[46:47], v5 offset:50176
  buffer_load_dwordx4 v19, s[12:15], s44 offen offset:1024 lds
  v_mfma_f32_32x32x16_bf16 v[176:191], v[52:55], a[72:75], v[176:191]
  s_add_u32 s45, s74, 0x48000
  s_add_u32 m0, s43, 0x22000
  ds_read_b64_tr_b16 v[48:49], v5 offset:51200
  v_mfma_f32_32x32x16_bf16 v[192:207], v[52:55], a[76:79], v[192:207]
  s_waitcnt lgkmcnt(5)
  ds_read_b64_tr_b16 v[50:51], v5 offset:52224
  v_mfma_f32_32x32x16_bf16 v[176:191], v[56:59], a[80:83], v[176:191]
  ds_read_b64_tr_b16 v[52:53], v5 offset:53248
  v_mfma_f32_32x32x16_bf16 v[192:207], v[56:59], a[84:87], v[192:207]
  s_waitcnt lgkmcnt(5)
  ds_read_b64_tr_b16 v[54:55], v5 offset:54272
  buffer_load_dwordx4 v18, s[12:15], s45 offen lds
  v_mfma_f32_32x32x16_bf16 v[176:191], v[60:63], a[88:91], v[176:191]
  ds_read_b64_tr_b16 v[56:57], v5 offset:55296
  v_mfma_f32_32x32x16_bf16 v[192:207], v[60:63], a[92:95], v[192:207]
  s_waitcnt lgkmcnt(5)
  ds_read_b64_tr_b16 v[58:59], v5 offset:56320
  v_mfma_f32_32x32x16_bf16 v[176:191], v[44:47], a[96:99], v[176:191]
  ds_read_b64_tr_b16 v[60:61], v5 offset:57344
  v_mfma_f32_32x32x16_bf16 v[192:207], v[44:47], a[100:103], v[192:207]
  s_waitcnt lgkmcnt(5)
  ds_read_b64_tr_b16 v[62:63], v5 offset:58368
  buffer_load_dwordx4 v19, s[12:15], s45 offen offset:1024 lds
  v_mfma_f32_32x32x16_bf16 v[176:191], v[48:51], a[104:107], v[176:191]
  s_add_u32 s44, s74, 0x5a000
  s_add_u32 m0, s43, 0x26000
  ds_read_b64_tr_b16 v[44:45], v5 offset:59392
  v_mfma_f32_32x32x16_bf16 v[192:207], v[48:51], a[108:111], v[192:207]
  s_waitcnt lgkmcnt(5)
  ds_read_b64_tr_b16 v[46:47], v5 offset:60416
  v_mfma_f32_32x32x16_bf16 v[176:191], v[52:55], a[112:115], v[176:191]
  s_waitcnt vmcnt(10)
  s_barrier
  ds_read_b64_tr_b16 v[48:49], v5 offset:61440
  v_mfma_f32_32x32x16_bf16 v[192:207], v[52:55], a[116:119], v[192:207]
  s_waitcnt lgkmcnt(5)
  ds_read_b64_tr_b16 v[50:51], v5 offset:62464
  buffer_load_dwordx4 v18, s[12:15], s44 offen lds
  v_mfma_f32_32x32x16_bf16 v[176:191], v[56:59], a[120:123], v[176:191]
  ds_read_b64_tr_b16 v[52:53], v5 offset:63488
  v_mfma_f32_32x32x16_bf16 v[192:207], v[56:59], a[124:127], v[192:207]
  s_waitcnt lgkmcnt(5)
  ds_read_b64_tr_b16 v[54:55], v5 offset:64512
  v_mfma_f32_32x32x16_bf16 v[176:191], v[60:63], a[128:131], v[176:191]
  ds_read_b64_tr_b16 v[56:57], v6 offset:49152
  v_mfma_f32_32x32x16_bf16 v[192:207], v[60:63], a[132:135], v[192:207]
  s_waitcnt lgkmcnt(5)
  ds_read_b64_tr_b16 v[58:59], v6 offset:50176
  buffer_load_dwordx4 v19, s[12:15], s44 offen offset:1024 lds
  v_mfma_f32_32x32x16_bf16 v[176:191], v[44:47], a[136:139], v[176:191]
  s_add_u32 s45, s75, 0x0
  s_add_u32 m0, s43, 0x12000
  ds_read_b64_tr_b16 v[60:61], v6 offset:51200
  v_mfma_f32_32x32x16_bf16 v[192:207], v[44:47], a[140:143], v[192:207]
  s_waitcnt lgkmcnt(5)
  ds_read_b64_tr_b16 v[62:63], v6 offset:52224
  v_mfma_f32_32x32x16_bf16 v[176:191], v[48:51], a[144:147], v[176:191]
  ds_read_b64_tr_b16 v[44:45], v6 offset:53248
  v_mfma_f32_32x32x16_bf16 v[192:207], v[48:51], a[148:151], v[192:207]
  s_waitcnt lgkmcnt(5)
  ds_read_b64_tr_b16 v[46:47], v6 offset:54272
  buffer_load_dwordx4 v18, s[12:15], s45 offen lds
  v_mfma_f32_32x32x16_bf16 v[176:191], v[52:55], a[152:155], v[176:191]
  ds_read_b64_tr_b16 v[48:49], v6 offset:55296
  v_mfma_f32_32x32x16_bf16 v[192:207], v[52:55], a[156:159], v[192:207]
  s_waitcnt lgkmcnt(5)
  ds_read_b64_tr_b16 v[50:51], v6 offset:56320
  v_mfma_f32_32x32x16_bf16 v[176:191], v[56:59], a[160:163], v[176:191]
  ds_read_b64_tr_b16 v[52:53], v6 offset:57344
  v_mfma_f32_32x32x16_bf16 v[192:207], v[56:59], a[164:167], v[192:207]
  s_waitcnt lgkmcnt(5)
  s_lshl_b32 s48, s73, 5
  s_add_u32 s48, s48, s46
  ds_read_b64_tr_b16 v[54:55], v6 offset:58368
  buffer_load_dwordx4 v19, s[12:15], s45 offen offset:1024 lds
  v_mfma_f32_32x32x16_bf16 v[176:191], v[60:63], a[168:171], v[176:191]
  s_add_u32 s44, s75, 0x12000
  s_add_u32 m0, s43, 0x14000
  ds_read_b64_tr_b16 v[56:57], v6 offset:59392
  v_mfma_f32_32x32x16_bf16 v[192:207], v[60:63], a[172:175], v[192:207]
  s_waitcnt lgkmcnt(5)
  ds_read_b64_tr_b16 v[58:59], v6 offset:60416
  v_mfma_f32_32x32x16_bf16 v[176:191], v[44:47], a[176:179], v[176:191]
  ds_read_b64_tr_b16 v[60:61], v6 offset:61440
  v_mfma_f32_32x32x16_bf16 v[192:207], v[44:47], a[180:183], v[192:207]
  s_waitcnt lgkmcnt(5)
  ds_read_b64_tr_b16 v[62:63], v6 offset:62464
  buffer_load_dwordx4 v18, s[12:15], s44 offen lds
  v_mfma_f32_32x32x16_bf16 v[176:191], v[48:51], a[184:187], v[176:191]
  ds_read_b64_tr_b16 v[44:45], v6 offset:63488
  v_mfma_f32_32x32x16_bf16 v[192:207], v[48:51], a[188:191], v[192:207]
  s_waitcnt lgkmcnt(5)
  ds_read_b64_tr_b16 v[46:47], v6 offset:64512
  v_mfma_f32_32x32x16_bf16 v[144:159], v[52:55], a[0:3], 0
  ds_read_b64_tr_b16 v[48:49], v6 offset:0
  buffer_load_dwordx2 a[204:205], v32, s[24:27], s63 offen
  v_mfma_f32_32x32x16_bf16 v[160:175], v[52:55], a[4:7], 0
  s_waitcnt lgkmcnt(5)
  ds_read_b64_tr_b16 v[50:51], v6 offset:1024
  buffer_load_dwordx4 v19, s[12:15], s44 offen offset:1024 lds
  s_nop 0
  v_cvt_pk_bf16_f32 v176, v176, v177
  v_cvt_pk_bf16_f32 v177, v178, v179
  v_cvt_pk_bf16_f32 v178, v180, v181
  v_mfma_f32_32x32x16_bf16 v[144:159], v[56:59], a[8:11], v[144:159]
  s_add_u32 s45, s75, 0x24000
  s_add_u32 m0, s43, 0x18000
  ds_read_b64_tr_b16 v[52:53], v6 offset:2048
  v_cvt_pk_bf16_f32 v179, v182, v183
  v_mfma_f32_32x32x16_bf16 v[160:175], v[56:59], a[12:15], v[160:175]
  s_waitcnt lgkmcnt(5)
  s_waitcnt vmcnt(10)
  ds_read_b64_tr_b16 v[54:55], v6 offset:3072
  v_mov_b32 v39, 3
  v_mfma_f32_32x32x16_bf16 v[144:159], v[60:63], a[16:19], v[144:159]
  s_waitcnt vmcnt(7)
  s_barrier
  ds_read_b64_tr_b16 v[56:57], v6 offset:4096
  buffer_store_dword v39, v43, s[16:19], s53 offen sc1
  v_mfma_f32_32x32x16_bf16 v[160:175], v[60:63], a[20:23], v[160:175]
  s_waitcnt lgkmcnt(5)
  ds_read_b64_tr_b16 v[58:59], v6 offset:5120
  buffer_load_dwordx4 v18, s[12:15], s45 offen lds
  buffer_load_dwordx2 a[206:207], v32, s[24:27], s63 offen offset:16
  v_mfma_f32_32x32x16_bf16 v[144:159], v[44:47], a[24:27], v[144:159]
  ds_read_b64_tr_b16 v[60:61], v6 offset:6144
  buffer_store_dwordx4 v[176:179], v20, s[16:19], s48 offen sc1
  v_cvt_pk_bf16_f32 v184, v184, v185
  v_mfma_f32_32x32x16_bf16 v[160:175], v[44:47], a[28:31], v[160:175]
  s_waitcnt lgkmcnt(5)
  ds_read_b64_tr_b16 v[62:63], v6 offset:7168
  v_cvt_pk_bf16_f32 v185, v186, v187
  v_cvt_pk_bf16_f32 v186, v188, v189
  v_cvt_pk_bf16_f32 v187, v190, v191
  v_mfma_f32_32x32x16_bf16 v[144:159], v[48:51], a[32:35], v[144:159]
  ds_read_b64_tr_b16 v[44:45], v7 offset:16384
  buffer_load_dwordx4 a[192:195], v31, s[4:7], s60 offen
  v_mfma_f32_32x32x16_bf16 v[160:175], v[48:51], a[36:39], v[160:175]
  s_waitcnt lgkmcnt(5)
  ds_read_b64_tr_b16 v[46:47], v7 offset:17408
  buffer_load_dwordx4 v19, s[12:15], s45 offen offset:1024 lds
  v_mfma_f32_32x32x16_bf16 v[144:159], v[52:55], a[40:43], v[144:159]
  s_add_u32 s44, s75, 0x36000
  s_add_u32 m0, s43, 0x1a000
  ds_read_b64_tr_b16 v[48:49], v7 offset:18432
  buffer_store_dwordx4 v[184:187], v20, s[16:19], s48 offen offset:1024 sc1
  v_mfma_f32_32x32x16_bf16 v[160:175], v[52:55], a[44:47], v[160:175]
  s_waitcnt lgkmcnt(5)
  ds_read_b64_tr_b16 v[50:51], v7 offset:19456
  v_cvt_pk_bf16_f32 v192, v192, v193
  v_cvt_pk_bf16_f32 v193, v194, v195
  v_cvt_pk_bf16_f32 v194, v196, v197
  v_cvt_pk_bf16_f32 v195, v198, v199
  v_mfma_f32_32x32x16_bf16 v[144:159], v[56:59], a[48:51], v[144:159]
  ds_read_b64_tr_b16 v[52:53], v7 offset:20480
  buffer_load_dwordx2 a[208:209], v32, s[24:27], s64 offen
  v_mfma_f32_32x32x16_bf16 v[160:175], v[56:59], a[52:55], v[160:175]
  s_waitcnt lgkmcnt(5)
  ds_read_b64_tr_b16 v[54:55], v7 offset:21504
  buffer_load_dwordx4 v18, s[12:15], s44 offen lds
  v_mfma_f32_32x32x16_bf16 v[144:159], v[60:63], a[56:59], v[144:159]
  ds_read_b64_tr_b16 v[56:57], v7 offset:22528
  buffer_store_dwordx4 v[192:195], v21, s[16:19], s48 offen sc1
  v_cvt_pk_bf16_f32 v200, v200, v201
  v_mfma_f32_32x32x16_bf16 v[160:175], v[60:63], a[60:63], v[160:175]
  s_waitcnt lgkmcnt(5)
  ds_read_b64_tr_b16 v[58:59], v7 offset:23552
  v_cvt_pk_bf16_f32 v201, v202, v203
  v_cvt_pk_bf16_f32 v202, v204, v205
  v_cvt_pk_bf16_f32 v203, v206, v207
  v_mfma_f32_32x32x16_bf16 v[144:159], v[44:47], a[64:67], v[144:159]
  ds_read_b64_tr_b16 v[60:61], v7 offset:0
  buffer_load_dwordx2 a[210:211], v32, s[24:27], s64 offen offset:16
  v_mfma_f32_32x32x16_bf16 v[160:175], v[44:47], a[68:71], v[160:175]
  s_waitcnt lgkmcnt(5)
  ds_read_b64_tr_b16 v[62:63], v7 offset:1024
  buffer_load_dwordx4 v19, s[12:15], s44 offen offset:1024 lds
  v_mfma_f32_32x32x16_bf16 v[144:159], v[48:51], a[72:75], v[144:159]
  s_add_u32 s45, s75, 0x48000
  s_add_u32 m0, s43, 0x16000
  ds_read_b64_tr_b16 v[44:45], v7 offset:2048
  buffer_store_dwordx4 v[200:203], v21, s[16:19], s48 offen offset:1024 sc1
  v_mfma_f32_32x32x16_bf16 v[160:175], v[48:51], a[76:79], v[160:175]
  s_waitcnt lgkmcnt(5)
  ds_read_b64_tr_b16 v[46:47], v7 offset:3072
  v_mfma_f32_32x32x16_bf16 v[144:159], v[52:55], a[80:83], v[144:159]
  ds_read_b64_tr_b16 v[48:49], v7 offset:4096
  buffer_load_dwordx4 a[196:199], v31, s[4:7], s61 offen
  v_mfma_f32_32x32x16_bf16 v[160:175], v[52:55], a[84:87], v[160:175]
  s_waitcnt lgkmcnt(5)
  ds_read_b64_tr_b16 v[50:51], v7 offset:5120
  buffer_load_dwordx4 v18, s[12:15], s45 offen lds
  v_mfma_f32_32x32x16_bf16 v[144:159], v[56:59], a[88:91], v[144:159]
  ds_read_b64_tr_b16 v[52:53], v7 offset:6144
  v_mfma_f32_32x32x16_bf16 v[160:175], v[56:59], a[92:95], v[160:175]
  s_waitcnt lgkmcnt(5)
  ds_read_b64_tr_b16 v[54:55], v7 offset:7168
  v_mfma_f32_32x32x16_bf16 v[144:159], v[60:63], a[96:99], v[144:159]
  ds_read_b64_tr_b16 v[56:57], v7 offset:8192
  buffer_load_dwordx2 a[212:213], v32, s[24:27], s65 offen
  v_mfma_f32_32x32x16_bf16 v[160:175], v[60:63], a[100:103], v[160:175]
  s_waitcnt lgkmcnt(5)
  ds_read_b64_tr_b16 v[58:59], v7 offset:9216
  buffer_load_dwordx4 v19, s[12:15], s45 offen offset:1024 lds
  v_mfma_f32_32x32x16_bf16 v[144:159], v[44:47], a[104:107], v[144:159]
  s_add_u32 s44, s75, 0x5a000
  s_add_u32 m0, s43, 0x2000
  ds_read_b64_tr_b16 v[60:61], v7 offset:10240
  v_mfma_f32_32x32x16_bf16 v[160:175], v[44:47], a[108:111], v[160:175]
  s_waitcnt lgkmcnt(5)
  ds_read_b64_tr_b16 v[62:63], v7 offset:11264
  v_mfma_f32_32x32x16_bf16 v[144:159], v[48:51], a[112:115], v[144:159]
  s_waitcnt vmcnt(17)
  s_barrier
  ds_read_b64_tr_b16 v[44:45], v7 offset:12288
  v_mfma_f32_32x32x16_bf16 v[160:175], v[48:51], a[116:119], v[160:175]
  s_waitcnt lgkmcnt(5)
  ds_read_b64_tr_b16 v[46:47], v7 offset:13312
  buffer_load_dwordx4 v18, s[12:15], s44 offen lds
  buffer_load_dwordx2 a[214:215], v32, s[24:27], s65 offen offset:16
  v_mfma_f32_32x32x16_bf16 v[144:159], v[52:55], a[120:123], v[144:159]
  ds_read_b64_tr_b16 v[48:49], v7 offset:14336
  v_mfma_f32_32x32x16_bf16 v[160:175], v[52:55], a[124:127], v[160:175]
  s_waitcnt lgkmcnt(5)
  ds_read_b64_tr_b16 v[50:51], v7 offset:15360
  v_mfma_f32_32x32x16_bf16 v[144:159], v[56:59], a[128:131], v[144:159]
  ds_read_b64_tr_b16 v[52:53], v7 offset:24576
  buffer_load_dwordx4 a[200:203], v31, s[4:7], s62 offen
  buffer_load_dword v27, v25, s[20:23], 0 offen sc1
  v_mfma_f32_32x32x16_bf16 v[160:175], v[56:59], a[132:135], v[160:175]
  s_waitcnt lgkmcnt(5)
  ds_read_b64_tr_b16 v[54:55], v7 offset:25600
  buffer_load_dwordx4 v19, s[12:15], s44 offen offset:1024 lds
  v_mfma_f32_32x32x16_bf16 v[144:159], v[60:63], a[136:139], v[144:159]
  s_add_u32 s45, s76, 0x0
  s_add_u32 m0, s43, 0x4000
  ds_read_b64_tr_b16 v[56:57], v7 offset:26624
  v_mfma_f32_32x32x16_bf16 v[160:175], v[60:63], a[140:143], v[160:175]
  s_waitcnt lgkmcnt(5)
  ds_read_b64_tr_b16 v[58:59], v7 offset:27648
  v_mfma_f32_32x32x16_bf16 v[144:159], v[44:47], a[144:147], v[144:159]
  ds_read_b64_tr_b16 v[60:61], v7 offset:28672
  v_mfma_f32_32x32x16_bf16 v[160:175], v[44:47], a[148:151], v[160:175]
  s_waitcnt lgkmcnt(5)
  ds_read_b64_tr_b16 v[62:63], v7 offset:29696
  buffer_load_dwordx4 v18, s[12:15], s45 offen lds
  v_mfma_f32_32x32x16_bf16 v[144:159], v[48:51], a[152:155], v[144:159]
  ds_read_b64_tr_b16 v[44:45], v7 offset:30720
  v_mfma_f32_32x32x16_bf16 v[160:175], v[48:51], a[156:159], v[160:175]
  s_waitcnt lgkmcnt(5)
  ds_read_b64_tr_b16 v[46:47], v7 offset:31744
  v_mfma_f32_32x32x16_bf16 v[144:159], v[52:55], a[160:163], v[144:159]
  ds_read_b64_tr_b16 v[48:49], v6 offset:8192
  v_mfma_f32_32x32x16_bf16 v[160:175], v[52:55], a[164:167], v[160:175]
  s_waitcnt lgkmcnt(5)
  s_lshl_b32 s47, s74, 5
  s_add_u32 s47, s47, s46
  ds_read_b64_tr_b16 v[50:51], v6 offset:9216
  buffer_load_dwordx4 v19, s[12:15], s45 offen offset:1024 lds
  v_mfma_f32_32x32x16_bf16 v[144:159], v[56:59], a[168:171], v[144:159]
  s_add_u32 s44, s76, 0x12000
  s_add_u32 m0, s43, 0x6000
  ds_read_b64_tr_b16 v[52:53], v6 offset:10240
  v_mfma_f32_32x32x16_bf16 v[160:175], v[56:59], a[172:175], v[160:175]
  s_waitcnt lgkmcnt(5)
  ds_read_b64_tr_b16 v[54:55], v6 offset:11264
  v_mfma_f32_32x32x16_bf16 v[144:159], v[60:63], a[176:179], v[144:159]
  ds_read_b64_tr_b16 v[56:57], v6 offset:12288
  v_mfma_f32_32x32x16_bf16 v[160:175], v[60:63], a[180:183], v[160:175]
  s_waitcnt lgkmcnt(5)
  ds_read_b64_tr_b16 v[58:59], v6 offset:13312
  buffer_load_dwordx4 v18, s[12:15], s44 offen lds
  v_mfma_f32_32x32x16_bf16 v[144:159], v[44:47], a[184:187], v[144:159]
  ds_read_b64_tr_b16 v[60:61], v6 offset:14336
  v_mfma_f32_32x32x16_bf16 v[160:175], v[44:47], a[188:191], v[160:175]
  s_waitcnt lgkmcnt(5)
  ds_read_b64_tr_b16 v[62:63], v6 offset:15360
  v_mfma_f32_32x32x16_bf16 v[208:223], v[48:51], a[0:3], 0
  ds_read_b64_tr_b16 v[44:45], v6 offset:16384
  v_mfma_f32_32x32x16_bf16 v[224:239], v[48:51], a[4:7], 0
  s_waitcnt lgkmcnt(5)
  ds_read_b64_tr_b16 v[46:47], v6 offset:17408
  buffer_load_dwordx4 v19, s[12:15], s44 offen offset:1024 lds
  s_nop 1
  v_cvt_pk_bf16_f32 v144, v144, v145
  v_cvt_pk_bf16_f32 v145, v146, v147
  v_cvt_pk_bf16_f32 v146, v148, v149
  v_mfma_f32_32x32x16_bf16 v[208:223], v[52:55], a[8:11], v[208:223]
  s_add_u32 s45, s76, 0x24000
  s_add_u32 m0, s43, 0x8000
  ds_read_b64_tr_b16 v[48:49], v6 offset:18432
  v_cvt_pk_bf16_f32 v147, v150, v151
  v_mfma_f32_32x32x16_bf16 v[224:239], v[52:55], a[12:15], v[224:239]
  s_waitcnt lgkmcnt(5)
  ds_read_b64_tr_b16 v[50:51], v6 offset:19456
  buffer_store_dwordx4 v[144:147], v20, s[16:19], s47 offen sc1
  v_cvt_pk_bf16_f32 v152, v152, v153
  v_mfma_f32_32x32x16_bf16 v[208:223], v[56:59], a[16:19], v[208:223]
  s_waitcnt vmcnt(10)
  s_barrier
  ds_read_b64_tr_b16 v[52:53], v6 offset:20480
  v_cvt_pk_bf16_f32 v153, v154, v155
  v_mfma_f32_32x32x16_bf16 v[224:239], v[56:59], a[20:23], v[224:239]
  s_waitcnt lgkmcnt(5)
  ds_read_b64_tr_b16 v[54:55], v6 offset:21504
  buffer_load_dwordx4 v18, s[12:15], s45 offen lds
  v_cvt_pk_bf16_f32 v154, v156, v157
  v_cvt_pk_bf16_f32 v155, v158, v159
  v_mfma_f32_32x32x16_bf16 v[208:223], v[60:63], a[24:27], v[208:223]
  ds_read_b64_tr_b16 v[56:57], v6 offset:22528
  buffer_store_dwordx4 v[152:155], v20, s[16:19], s47 offen offset:1024 sc1
  v_cvt_pk_bf16_f32 v160, v160, v161
  v_mfma_f32_32x32x16_bf16 v[224:239], v[60:63], a[28:31], v[224:239]
  s_waitcnt lgkmcnt(5)
  ds_read_b64_tr_b16 v[58:59], v6 offset:23552
  v_cvt_pk_bf16_f32 v161, v162, v163
  v_cvt_pk_bf16_f32 v162, v164, v165
  v_cvt_pk_bf16_f32 v163, v166, v167
  v_mfma_f32_32x32x16_bf16 v[208:223], v[44:47], a[32:35], v[208:223]
  ds_read_b64_tr_b16 v[60:61], v6 offset:32768
  v_mfma_f32_32x32x16_bf16 v[224:239], v[44:47], a[36:39], v[224:239]
  s_waitcnt lgkmcnt(5)
  ds_read_b64_tr_b16 v[62:63], v6 offset:33792
  buffer_load_dwordx4 v19, s[12:15], s45 offen offset:1024 lds
  v_mfma_f32_32x32x16_bf16 v[208:223], v[48:51], a[40:43], v[208:223]
  s_add_u32 s44, s76, 0x36000
  s_add_u32 m0, s43, 0xa000
  ds_read_b64_tr_b16 v[44:45], v6 offset:34816
  buffer_store_dwordx4 v[160:163], v21, s[16:19], s47 offen sc1
  v_mfma_f32_32x32x16_bf16 v[224:239], v[48:51], a[44:47], v[224:239]
  s_waitcnt lgkmcnt(5)
  ds_read_b64_tr_b16 v[46:47], v6 offset:35840
  v_cvt_pk_bf16_f32 v168, v168, v169
  v_cvt_pk_bf16_f32 v169, v170, v171
  v_cvt_pk_bf16_f32 v170, v172, v173
  v_cvt_pk_bf16_f32 v171, v174, v175
  v_mfma_f32_32x32x16_bf16 v[208:223], v[52:55], a[48:51], v[208:223]
  ds_read_b64_tr_b16 v[48:49], v6 offset:36864
  v_mfma_f32_32x32x16_bf16 v[224:239], v[52:55], a[52:55], v[224:239]
  s_waitcnt lgkmcnt(5)
  ds_read_b64_tr_b16 v[50:51], v6 offset:37888
  buffer_load_dwordx4 v18, s[12:15], s44 offen lds
  v_mfma_f32_32x32x16_bf16 v[208:223], v[56:59], a[56:59], v[208:223]
  ds_read_b64_tr_b16 v[52:53], v6 offset:38912
  buffer_store_dwordx4 v[168:171], v21, s[16:19], s47 offen offset:1024 sc1
  v_mfma_f32_32x32x16_bf16 v[224:239], v[56:59], a[60:63], v[224:239]
  s_waitcnt lgkmcnt(5)
  ds_read_b64_tr_b16 v[54:55], v6 offset:39936
  v_mfma_f32_32x32x16_bf16 v[208:223], v[60:63], a[64:67], v[208:223]
  ds_read_b64_tr_b16 v[56:57], v6 offset:40960
  v_mfma_f32_32x32x16_bf16 v[224:239], v[60:63], a[68:71], v[224:239]
  s_waitcnt lgkmcnt(5)
  ds_read_b64_tr_b16 v[58:59], v6 offset:41984
  buffer_load_dwordx4 v19, s[12:15], s44 offen offset:1024 lds
  v_mfma_f32_32x32x16_bf16 v[208:223], v[44:47], a[72:75], v[208:223]
  s_add_u32 s45, s76, 0x48000
  s_add_u32 m0, s43, 0xc000
  ds_read_b64_tr_b16 v[60:61], v6 offset:43008
  v_mfma_f32_32x32x16_bf16 v[224:239], v[44:47], a[76:79], v[224:239]
  s_waitcnt lgkmcnt(5)
  ds_read_b64_tr_b16 v[62:63], v6 offset:44032
  v_mfma_f32_32x32x16_bf16 v[208:223], v[48:51], a[80:83], v[208:223]
  ds_read_b64_tr_b16 v[44:45], v6 offset:45056
  v_mfma_f32_32x32x16_bf16 v[224:239], v[48:51], a[84:87], v[224:239]
  s_waitcnt lgkmcnt(5)
  ds_read_b64_tr_b16 v[46:47], v6 offset:46080
  buffer_load_dwordx4 v18, s[12:15], s45 offen lds
  v_mfma_f32_32x32x16_bf16 v[208:223], v[52:55], a[88:91], v[208:223]
  ds_read_b64_tr_b16 v[48:49], v6 offset:47104
  v_mfma_f32_32x32x16_bf16 v[224:239], v[52:55], a[92:95], v[224:239]
  s_waitcnt lgkmcnt(5)
  ds_read_b64_tr_b16 v[50:51], v6 offset:48128
  v_mfma_f32_32x32x16_bf16 v[208:223], v[56:59], a[96:99], v[208:223]
  ds_read_b64_tr_b16 v[52:53], v6 offset:24576
  v_mfma_f32_32x32x16_bf16 v[224:239], v[56:59], a[100:103], v[224:239]
  s_waitcnt lgkmcnt(5)
  ds_read_b64_tr_b16 v[54:55], v6 offset:25600
  buffer_load_dwordx4 v19, s[12:15], s45 offen offset:1024 lds
  v_mfma_f32_32x32x16_bf16 v[208:223], v[60:63], a[104:107], v[208:223]
  s_add_u32 s44, s76, 0x5a000
  s_waitcnt vmcnt(15)
  s_add_u32 m0, s43, 0xe000
  ds_read_b64_tr_b16 v[56:57], v6 offset:26624
  buffer_load_dword v26, v24, s[16:19], s53 offen sc1
  v_mfma_f32_32x32x16_bf16 v[224:239], v[60:63], a[108:111], v[224:239]
  s_waitcnt lgkmcnt(5)
  ds_read_b64_tr_b16 v[58:59], v6 offset:27648
  v_mfma_f32_32x32x16_bf16 v[208:223], v[44:47], a[112:115], v[208:223]
  s_waitcnt vmcnt(11)
  s_barrier
  ds_read_b64_tr_b16 v[60:61], v6 offset:28672
  v_mfma_f32_32x32x16_bf16 v[224:239], v[44:47], a[116:119], v[224:239]
  s_waitcnt lgkmcnt(5)
  ds_read_b64_tr_b16 v[62:63], v6 offset:29696
  buffer_load_dwordx4 v18, s[12:15], s44 offen lds
  v_mfma_f32_32x32x16_bf16 v[208:223], v[48:51], a[120:123], v[208:223]
  ds_read_b64_tr_b16 v[44:45], v6 offset:30720
  v_mfma_f32_32x32x16_bf16 v[224:239], v[48:51], a[124:127], v[224:239]
  s_waitcnt lgkmcnt(5)
  ds_read_b64_tr_b16 v[46:47], v6 offset:31744
  v_mfma_f32_32x32x16_bf16 v[208:223], v[52:55], a[128:131], v[208:223]
  ds_read_b64_tr_b16 v[48:49], v5 offset:8192
  v_mfma_f32_32x32x16_bf16 v[224:239], v[52:55], a[132:135], v[224:239]
  s_waitcnt lgkmcnt(5)
  ds_read_b64_tr_b16 v[50:51], v5 offset:9216
  buffer_load_dwordx4 v19, s[12:15], s44 offen offset:1024 lds
  v_mfma_f32_32x32x16_bf16 v[208:223], v[56:59], a[136:139], v[208:223]
  s_add_u32 s45, s77, 0x0
  s_add_u32 m0, s43, 0x1c000
  ds_read_b64_tr_b16 v[52:53], v5 offset:10240
  v_mfma_f32_32x32x16_bf16 v[224:239], v[56:59], a[140:143], v[224:239]
  s_waitcnt lgkmcnt(5)
  ds_read_b64_tr_b16 v[54:55], v5 offset:11264
  v_mfma_f32_32x32x16_bf16 v[208:223], v[60:63], a[144:147], v[208:223]
  ds_read_b64_tr_b16 v[56:57], v5 offset:12288
  v_mfma_f32_32x32x16_bf16 v[224:239], v[60:63], a[148:151], v[224:239]
  s_waitcnt lgkmcnt(5)
  ds_read_b64_tr_b16 v[58:59], v5 offset:13312
  buffer_load_dwordx4 v18, s[12:15], s45 offen lds
  v_mfma_f32_32x32x16_bf16 v[208:223], v[44:47], a[152:155], v[208:223]
  ds_read_b64_tr_b16 v[60:61], v5 offset:14336
  v_mfma_f32_32x32x16_bf16 v[224:239], v[44:47], a[156:159], v[224:239]
  s_waitcnt lgkmcnt(5)
  ds_read_b64_tr_b16 v[62:63], v5 offset:15360
  v_mfma_f32_32x32x16_bf16 v[208:223], v[48:51], a[160:163], v[208:223]
  ds_read_b64_tr_b16 v[44:45], v5 offset:16384
  v_mfma_f32_32x32x16_bf16 v[224:239], v[48:51], a[164:167], v[224:239]
  s_waitcnt lgkmcnt(5)
  s_lshl_b32 s48, s75, 5
  s_add_u32 s48, s48, s46
  ds_read_b64_tr_b16 v[46:47], v5 offset:17408
  buffer_load_dwordx4 v19, s[12:15], s45 offen offset:1024 lds
  v_mfma_f32_32x32x16_bf16 v[208:223], v[52:55], a[168:171], v[208:223]
  s_add_u32 s44, s77, 0x12000
  s_add_u32 m0, s43, 0x1e000
  ds_read_b64_tr_b16 v[48:49], v5 offset:18432
  v_mfma_f32_32x32x16_bf16 v[224:239], v[52:55], a[172:175], v[224:239]
  s_waitcnt lgkmcnt(5)
  ds_read_b64_tr_b16 v[50:51], v5 offset:19456
  v_mfma_f32_32x32x16_bf16 v[208:223], v[56:59], a[176:179], v[208:223]
  ds_read_b64_tr_b16 v[52:53], v5 offset:20480
  v_mfma_f32_32x32x16_bf16 v[224:239], v[56:59], a[180:183], v[224:239]
  s_waitcnt lgkmcnt(5)
  ds_read_b64_tr_b16 v[54:55], v5 offset:21504
  buffer_load_dwordx4 v18, s[12:15], s44 offen lds
  v_mfma_f32_32x32x16_bf16 v[208:223], v[60:63], a[184:187], v[208:223]
  ds_read_b64_tr_b16 v[56:57], v5 offset:22528
  v_mfma_f32_32x32x16_bf16 v[224:239], v[60:63], a[188:191], v[224:239]
  s_waitcnt lgkmcnt(5)
  ds_read_b64_tr_b16 v[58:59], v5 offset:23552
  v_mfma_f32_32x32x16_bf16 v[112:127], v[44:47], a[0:3], 0
  ds_read_b64_tr_b16 v[60:61], v5 offset:24576
  s_mov_b32 s35, 0
  s_waitcnt vmcnt(5)
L_fa:
  v_cmp_ge_u32 vcc, v26, v22
  v_cmp_ge_u32 s[36:37], v27, v23
  s_nop 3
  s_and_b64 vcc, vcc, s[36:37]
  s_cmp_eq_u64 vcc, -1
  s_cbranch_scc1 L_fa_x
  s_sleep 3
L_fa_l:
  buffer_load_dword v27, v25, s[20:23], 0 offen sc1
  s_waitcnt vmcnt(0)
  buffer_load_dword v26, v24, s[16:19], s53 offen sc1
  s_add_u32 s35, s35, 1
  s_cmp_ge_u32 s35, 0x100000
  s_waitcnt vmcnt(0)
  s_cbranch_scc0 L_fa
L_fa_x:
  v_mfma_f32_32x32x16_bf16 v[128:143], v[44:47], a[4:7], 0
  s_waitcnt lgkmcnt(5)
  ds_read_b64_tr_b16 v[62:63], v5 offset:25600
  buffer_load_dwordx4 v19, s[12:15], s44 offen offset:1024 lds
  v_cvt_pk_bf16_f32 v208, v208, v209
  v_cvt_pk_bf16_f32 v209, v210, v211
  v_cvt_pk_bf16_f32 v210, v212, v213
  v_mfma_f32_32x32x16_bf16 v[112:127], v[48:51], a[8:11], v[112:127]
  s_add_u32 s45, s77, 0x24000
  s_add_u32 m0, s43, 0x10000
  ds_read_b64_tr_b16 v[44:45], v5 offset:26624
  buffer_load_dwordx4 v[144:147], v28, s[16:19], s54 offen sc1
  v_mfma_f32_32x32x16_bf16 v[128:143], v[48:51], a[12:15], v[128:143]
  s_waitcnt lgkmcnt(5)
  s_add_u32 s54, s54, 0x240000
  ds_read_b64_tr_b16 v[46:47], v5 offset:27648
  v_cvt_pk_bf16_f32 v211, v214, v215
  v_mfma_f32_32x32x16_bf16 v[112:127], v[52:55], a[16:19], v[112:127]
  s_barrier
  ds_read_b64_tr_b16 v[48:49], v5 offset:28672
  v_mfma_f32_32x32x16_bf16 v[128:143], v[52:55], a[20:23], v[128:143]
  s_waitcnt lgkmcnt(5)
  ds_read_b64_tr_b16 v[50:51], v5 offset:29696
  buffer_load_dwordx4 v18, s[12:15], s45 offen lds
  buffer_load_dwordx4 v[148:151], v28, s[16:19], s54 offen sc1
  v_mfma_f32_32x32x16_bf16 v[112:127], v[56:59], a[24:27], v[112:127]
  s_add_u32 s54, s54, 0x240000
  ds_read_b64_tr_b16 v[52:53], v5 offset:30720
  buffer_store_dwordx4 v[208:211], v20, s[16:19], s48 offen sc1
  v_cvt_pk_bf16_f32 v216, v216, v217
  v_mfma_f32_32x32x16_bf16 v[128:143], v[56:59], a[28:31], v[128:143]
  s_waitcnt lgkmcnt(5)
  ds_read_b64_tr_b16 v[54:55], v5 offset:31744
  buffer_load_dwordx4 v[152:155], v28, s[16:19], s54 offen sc1
  v_cvt_pk_bf16_f32 v217, v218, v219
  v_cvt_pk_bf16_f32 v218, v220, v221
  v_cvt_pk_bf16_f32 v219, v222, v223
  v_mfma_f32_32x32x16_bf16 v[112:127], v[60:63], a[32:35], v[112:127]
  s_add_u32 s54, s54, 0x240000
  ds_read_b64_tr_b16 v[56:57], v5 offset:32768
  v_mfma_f32_32x32x16_bf16 v[128:143], v[60:63], a[36:39], v[128:143]
  s_waitcnt lgkmcnt(5)
  ds_read_b64_tr_b16 v[58:59], v5 offset:33792
  buffer_load_dwordx4 v19, s[12:15], s45 offen offset:1024 lds
  v_mfma_f32_32x32x16_bf16 v[112:127], v[44:47], a[40:43], v[112:127]
  s_add_u32 s44, s77, 0x36000
  s_add_u32 m0, s43, 0x24000
  ds_read_b64_tr_b16 v[60:61], v5 offset:34816
  buffer_load_dwordx4 v[156:159], v28, s[16:19], s54 offen sc1
  v_mfma_f32_32x32x16_bf16 v[128:143], v[44:47], a[44:47], v[128:143]
  s_waitcnt lgkmcnt(5)
  s_add_u32 s54, s54, 0x240000
  ds_read_b64_tr_b16 v[62:63], v5 offset:35840
  buffer_store_dwordx4 v[216:219], v20, s[16:19], s48 offen offset:1024 sc1
  v_mfma_f32_32x32x16_bf16 v[112:127], v[48:51], a[48:51], v[112:127]
  ds_read_b64_tr_b16 v[44:45], v5 offset:36864
  v_cvt_pk_bf16_f32 v224, v224, v225
  v_cvt_pk_bf16_f32 v225, v226, v227
  v_cvt_pk_bf16_f32 v226, v228, v229
  v_cvt_pk_bf16_f32 v227, v230, v231
  v_mfma_f32_32x32x16_bf16 v[128:143], v[48:51], a[52:55], v[128:143]
  s_waitcnt lgkmcnt(5)
  ds_read_b64_tr_b16 v[46:47], v5 offset:37888
  buffer_load_dwordx4 v18, s[12:15], s44 offen lds
  buffer_load_dwordx4 v[160:163], v28, s[16:19], s54 offen sc1
  v_mfma_f32_32x32x16_bf16 v[112:127], v[52:55], a[56:59], v[112:127]
  s_add_u32 s54, s54, 0x240000
  ds_read_b64_tr_b16 v[48:49], v5 offset:38912
  buffer_store_dwordx4 v[224:227], v21, s[16:19], s48 offen sc1
  v_cvt_pk_bf16_f32 v232, v232, v233
  v_mfma_f32_32x32x16_bf16 v[128:143], v[52:55], a[60:63], v[128:143]
  s_waitcnt lgkmcnt(5)
  ds_read_b64_tr_b16 v[50:51], v5 offset:39936
  v_cvt_pk_bf16_f32 v233, v234, v235
  v_cvt_pk_bf16_f32 v234, v236, v237
  v_cvt_pk_bf16_f32 v235, v238, v239
  v_mfma_f32_32x32x16_bf16 v[112:127], v[56:59], a[64:67], v[112:127]
  ds_read_b64_tr_b16 v[52:53], v5 offset:40960
  buffer_load_dwordx4 v[164:167], v28, s[16:19], s54 offen sc1
  v_mfma_f32_32x32x16_bf16 v[128:143], v[56:59], a[68:71], v[128:143]
  s_waitcnt lgkmcnt(5)
  s_add_u32 s54, s54, 0x240000
  ds_read_b64_tr_b16 v[54:55], v5 offset:41984
  buffer_load_dwordx4 v19, s[12:15], s44 offen offset:1024 lds
  v_mfma_f32_32x32x16_bf16 v[112:127], v[60:63], a[72:75], v[112:127]
  s_add_u32 s45, s77, 0x48000
  s_add_u32 m0, s43, 0x20000
  ds_read_b64_tr_b16 v[56:57], v5 offset:43008
  buffer_store_dwordx4 v[232:235], v21, s[16:19], s48 offen offset:1024 sc1
  v_mfma_f32_32x32x16_bf16 v[128:143], v[60:63], a[76:79], v[128:143]
  s_waitcnt lgkmcnt(5)
  ds_read_b64_tr_b16 v[58:59], v5 offset:44032
  buffer_load_dwordx4 v[168:171], v28, s[16:19], s54 offen sc1
  v_mfma_f32_32x32x16_bf16 v[112:127], v[44:47], a[80:83], v[112:127]
  s_add_u32 s54, s54, 0x240000
  ds_read_b64_tr_b16 v[60:61], v5 offset:45056
  v_mfma_f32_32x32x16_bf16 v[128:143], v[44:47], a[84:87], v[128:143]
  s_waitcnt lgkmcnt(5)
  ds_read_b64_tr_b16 v[62:63], v5 offset:46080
  buffer_load_dwordx4 v18, s[12:15], s45 offen lds
  v_mfma_f32_32x32x16_bf16 v[112:127], v[48:51], a[88:91], v[112:127]
  ds_read_b64_tr_b16 v[44:45], v5 offset:47104
  buffer_load_dwordx4 v[172:175], v28, s[16:19], s54 offen sc1
  v_mfma_f32_32x32x16_bf16 v[128:143], v[48:51], a[92:95], v[128:143]
  s_waitcnt lgkmcnt(5)
  s_add_u32 s54, s54, 0x240000
  ds_read_b64_tr_b16 v[46:47], v5 offset:48128
  v_mfma_f32_32x32x16_bf16 v[112:127], v[52:55], a[96:99], v[112:127]
  ds_read_b64_tr_b16 v[48:49], v5 offset:49152
  v_mfma_f32_32x32x16_bf16 v[128:143], v[52:55], a[100:103], v[128:143]
  s_waitcnt lgkmcnt(5)
  ds_read_b64_tr_b16 v[50:51], v5 offset:50176
  buffer_load_dwordx4 v19, s[12:15], s45 offen offset:1024 lds
  buffer_load_dwordx4 v[240:243], v28, s[16:19], s54 offen sc1
  v_mfma_f32_32x32x16_bf16 v[112:127], v[56:59], a[104:107], v[112:127]
  s_add_u32 s44, s77, 0x5a000
  s_add_u32 s54, s54, 0x240000
  s_add_u32 m0, s43, 0x22000
  ds_read_b64_tr_b16 v[52:53], v5 offset:51200
  v_mfma_f32_32x32x16_bf16 v[128:143], v[56:59], a[108:111], v[128:143]
  s_waitcnt lgkmcnt(5)
  ds_read_b64_tr_b16 v[54:55], v5 offset:52224
  v_mfma_f32_32x32x16_bf16 v[112:127], v[60:63], a[112:115], v[112:127]
  s_waitcnt vmcnt(19)
  s_barrier
  ds_read_b64_tr_b16 v[56:57], v5 offset:53248
  v_mfma_f32_32x32x16_bf16 v[128:143], v[60:63], a[116:119], v[128:143]
  s_waitcnt lgkmcnt(5)
  ds_read_b64_tr_b16 v[58:59], v5 offset:54272
  buffer_load_dwordx4 v18, s[12:15], s44 offen lds
  buffer_load_dwordx4 v[244:247], v28, s[16:19], s54 offen sc1
  v_mfma_f32_32x32x16_bf16 v[112:127], v[44:47], a[120:123], v[112:127]
  s_add_u32 s54, s54, 0x240000
  ds_read_b64_tr_b16 v[60:61], v5 offset:55296
  v_mfma_f32_32x32x16_bf16 v[128:143], v[44:47], a[124:127], v[128:143]
  s_waitcnt lgkmcnt(5)
  ds_read_b64_tr_b16 v[62:63], v5 offset:56320
  buffer_load_dwordx4 v[248:251], v28, s[16:19], s54 offen sc1
  v_mfma_f32_32x32x16_bf16 v[112:127], v[48:51], a[128:131], v[112:127]
  s_add_u32 s54, s54, 0x240000
  ds_read_b64_tr_b16 v[44:45], v5 offset:57344
  v_mfma_f32_32x32x16_bf16 v[128:143], v[48:51], a[132:135], v[128:143]
  s_waitcnt lgkmcnt(5)
  ds_read_b64_tr_b16 v[46:47], v5 offset:58368
  buffer_load_dwordx4 v19, s[12:15], s44 offen offset:1024 lds
  v_mfma_f32_32x32x16_bf16 v[112:127], v[52:55], a[136:139], v[112:127]
  s_add_u32 s45, s78, 0x0
  s_add_u32 m0, s43, 0x26000
  ds_read_b64_tr_b16 v[48:49], v5 offset:59392
  buffer_load_dwordx4 v[252:255], v28, s[16:19], s54 offen sc1
  v_mfma_f32_32x32x16_bf16 v[128:143], v[52:55], a[140:143], v[128:143]
  s_waitcnt lgkmcnt(5)
  s_add_u32 s54, s54, 0x240000
  ds_read_b64_tr_b16 v[50:51], v5 offset:60416
  v_mfma_f32_32x32x16_bf16 v[112:127], v[56:59], a[144:147], v[112:127]
  ds_read_b64_tr_b16 v[52:53], v5 offset:61440
  s_waitcnt vmcnt(23)
  v_lshlrev_b32 v96, 16, v144
  v_and_b32 v97, s51, v144
  v_lshlrev_b32 v98, 16, v145
  v_and_b32 v99, s51, v145
  v_lshlrev_b32 v100, 16, v146
  v_mfma_f32_32x32x16_bf16 v[128:143], v[56:59], a[148:151], v[128:143]
  s_waitcnt lgkmcnt(5)
  ds_read_b64_tr_b16 v[54:55], v5 offset:62464
  buffer_load_dwordx4 v18, s[12:15], s45 offen lds
  v_and_b32 v101, s51, v146
  v_lshlrev_b32 v102, 16, v147
  v_and_b32 v103, s51, v147
  v_mfma_f32_32x32x16_bf16 v[112:127], v[60:63], a[152:155], v[112:127]
  ds_read_b64_tr_b16 v[56:57], v5 offset:63488
  v_mfma_f32_32x32x16_bf16 v[128:143], v[60:63], a[156:159], v[128:143]
  s_waitcnt lgkmcnt(5)
  ds_read_b64_tr_b16 v[58:59], v5 offset:64512
  s_waitcnt vmcnt(22)
  v_lshlrev_b32 v38, 16, v148
  v_and_b32 v148, s51, v148
  v_add_f32 v96, v96, v38
  v_add_f32 v97, v97, v148
  v_lshlrev_b32 v38, 16, v149
  v_mfma_f32_32x32x16_bf16 v[112:127], v[44:47], a[160:163], v[112:127]
  ds_read_b64_tr_b16 v[60:61], v6 offset:49152
  v_and_b32 v149, s51, v149
  v_add_f32 v98, v98, v38
  v_add_f32 v99, v99, v149
  v_lshlrev_b32 v38, 16, v150
  v_and_b32 v150, s51, v150
  v_mfma_f32_32x32x16_bf16 v[128:143], v[44:47], a[164:167], v[128:143]
  s_waitcnt lgkmcnt(5)
  s_lshl_b32 s47, s76, 5
  s_add_u32 s47, s47, s46
  ds_read_b64_tr_b16 v[62:63], v6 offset:50176
  buffer_load_dwordx4 v19, s[12:15], s45 offen offset:1024 lds
  v_add_f32 v100, v100, v38
  v_mfma_f32_32x32x16_bf16 v[112:127], v[48:51], a[168:171], v[112:127]
  s_add_u32 s44, s78, 0x12000
  s_add_u32 m0, s43, 0x12000
  ds_read_b64_tr_b16 v[44:45], v6 offset:51200
  v_add_f32 v101, v101, v150
  v_lshlrev_b32 v38, 16, v151
  v_and_b32 v151, s51, v151
  v_add_f32 v102, v102, v38
  v_mfma_f32_32x32x16_bf16 v[128:143], v[48:51], a[172:175], v[128:143]
  s_waitcnt lgkmcnt(5)
  ds_read_b64_tr_b16 v[46:47], v6 offset:52224
  v_add_f32 v103, v103, v151
  s_waitcnt vmcnt(21)
  v_lshlrev_b32 v38, 16, v152
  v_and_b32 v152, s51, v152
  v_add_f32 v96, v96, v38
  v_add_f32 v97, v97, v152
  v_mfma_f32_32x32x16_bf16 v[112:127], v[52:55], a[176:179], v[112:127]
  ds_read_b64_tr_b16 v[48:49], v6 offset:53248
  v_lshlrev_b32 v38, 16, v153
  v_and_b32 v153, s51, v153
  v_add_f32 v98, v98, v38
  v_add_f32 v99, v99, v153
  v_lshlrev_b32 v38, 16, v154
  v_mfma_f32_32x32x16_bf16 v[128:143], v[52:55], a[180:183], v[128:143]
  s_waitcnt lgkmcnt(5)
  ds_read_b64_tr_b16 v[50:51], v6 offset:54272
  buffer_load_dwordx4 v18, s[12:15], s44 offen lds
  v_and_b32 v154, s51, v154
  v_add_f32 v100, v100, v38
  v_add_f32 v101, v101, v154
  v_mfma_f32_32x32x16_bf16 v[112:127], v[56:59], a[184:187], v[112:127]
  ds_read_b64_tr_b16 v[52:53], v6 offset:55296
  v_lshlrev_b32 v38, 16, v155
  v_and_b32 v155, s51, v155
  v_add_f32 v102, v102, v38
  v_add_f32 v103, v103, v155
  s_waitcnt vmcnt(20)
  v_lshlrev_b32 v38, 16, v156
  v_mfma_f32_32x32x16_bf16 v[128:143], v[56:59], a[188:191], v[128:143]
  s_waitcnt lgkmcnt(5)
  ds_read_b64_tr_b16 v[54:55], v6 offset:56320
  v_and_b32 v156, s51, v156
  v_add_f32 v96, v96, v38
  v_add_f32 v97, v97, v156
  v_lshlrev_b32 v38, 16, v157
  v_and_b32 v157, s51, v157
  v_mfma_f32_32x32x16_bf16 v[64:79], v[60:63], a[0:3], 0
  ds_read_b64_tr_b16 v[56:57], v6 offset:57344
  v_add_f32 v98, v98, v38
  v_add_f32 v99, v99, v157
  v_lshlrev_b32 v38, 16, v158
  v_and_b32 v158, s51, v158
  v_add_f32 v100, v100, v38
  v_mfma_f32_32x32x16_bf16 v[80:95], v[60:63], a[4:7], 0
  s_waitcnt lgkmcnt(5)
  ds_read_b64_tr_b16 v[58:59], v6 offset:58368
  buffer_load_dwordx4 v19, s[12:15], s44 offen offset:1024 lds
  v_cvt_pk_bf16_f32 v112, v112, v113
  v_cvt_pk_bf16_f32 v113, v114, v115
  v_cvt_pk_bf16_f32 v114, v116, v117
  v_mfma_f32_32x32x16_bf16 v[64:79], v[44:47], a[8:11], v[64:79]
  s_add_u32 s45, s78, 0x24000
  s_add_u32 m0, s43, 0x14000
  ds_read_b64_tr_b16 v[60:61], v6 offset:59392
  v_cvt_pk_bf16_f32 v115, v118, v119
  v_add_f32 v101, v101, v158
  v_lshlrev_b32 v38, 16, v159
  v_and_b32 v159, s51, v159
  v_mfma_f32_32x32x16_bf16 v[80:95], v[44:47], a[12:15], v[80:95]
  s_waitcnt lgkmcnt(5)
  s_waitcnt vmcnt(14)
  ds_read_b64_tr_b16 v[62:63], v6 offset:60416
  v_mov_b32 v39, 6
  v_add_f32 v102, v102, v38
  v_add_f32 v103, v103, v159
  v_lshlrev_b32 v38, 16, v160
  v_mfma_f32_32x32x16_bf16 v[64:79], v[48:51], a[16:19], v[64:79]
  s_waitcnt vmcnt(10)
  s_barrier
  ds_read_b64_tr_b16 v[44:45], v6 offset:61440
  buffer_store_dword v39, v43, s[16:19], s53 offen sc1
  v_mfma_f32_32x32x16_bf16 v[80:95], v[48:51], a[20:23], v[80:95]
  s_waitcnt lgkmcnt(5)
  ds_read_b64_tr_b16 v[46:47], v6 offset:62464
  buffer_load_dwordx4 v18, s[12:15], s45 offen lds
  v_and_b32 v160, s51, v160
  v_add_f32 v96, v96, v38
  v_add_f32 v97, v97, v160
  v_mfma_f32_32x32x16_bf16 v[64:79], v[52:55], a[24:27], v[64:79]
  ds_read_b64_tr_b16 v[48:49], v6 offset:63488
  buffer_store_dwordx4 v[112:115], v20, s[16:19], s47 offen sc1
  v_cvt_pk_bf16_f32 v120, v120, v121
  v_mfma_f32_32x32x16_bf16 v[80:95], v[52:55], a[28:31], v[80:95]
  s_waitcnt lgkmcnt(5)
  ds_read_b64_tr_b16 v[50:51], v6 offset:64512
  v_cvt_pk_bf16_f32 v121, v122, v123
  v_cvt_pk_bf16_f32 v122, v124, v125
  v_cvt_pk_bf16_f32 v123, v126, v127
  v_lshlrev_b32 v38, 16, v161
  v_and_b32 v161, s51, v161
  v_mfma_f32_32x32x16_bf16 v[64:79], v[56:59], a[32:35], v[64:79]
  ds_read_b64_tr_b16 v[52:53], v6 offset:0
  v_add_f32 v98, v98, v38
  v_add_f32 v99, v99, v161
  v_lshlrev_b32 v38, 16, v162
  v_and_b32 v162, s51, v162
  v_add_f32 v100, v100, v38
  v_mfma_f32_32x32x16_bf16 v[80:95], v[56:59], a[36:39], v[80:95]
  s_waitcnt lgkmcnt(5)
  ds_read_b64_tr_b16 v[54:55], v6 offset:1024
  buffer_load_dwordx4 v19, s[12:15], s45 offen offset:1024 lds
  v_add_f32 v101, v101, v162
  v_lshlrev_b32 v38, 16, v163
  v_and_b32 v163, s51, v163
  v_mfma_f32_32x32x16_bf16 v[64:79], v[60:63], a[40:43], v[64:79]
  s_add_u32 s44, s78, 0x36000
  s_add_u32 m0, s43, 0x18000
  ds_read_b64_tr_b16 v[56:57], v6 offset:2048
  buffer_store_dwordx4 v[120:123], v20, s[16:19], s47 offen offset:1024 sc1
  v_mfma_f32_32x32x16_bf16 v[80:95], v[60:63], a[44:47], v[80:95]
  s_waitcnt lgkmcnt(5)
  ds_read_b64_tr_b16 v[58:59], v6 offset:3072
  v_cvt_pk_bf16_f32 v128, v128, v129
  v_cvt_pk_bf16_f32 v129, v130, v131
  v_cvt_pk_bf16_f32 v130, v132, v133
  v_cvt_pk_bf16_f32 v131, v134, v135
  v_add_f32 v102, v102, v38
  v_mfma_f32_32x32x16_bf16 v[64:79], v[44:47], a[48:51], v[64:79]
  ds_read_b64_tr_b16 v[60:61], v6 offset:4096
  v_add_f32 v103, v103, v163
  v_lshlrev_b32 v38, 16, v164
  v_and_b32 v164, s51, v164
  v_add_f32 v96, v96, v38
  v_add_f32 v97, v97, v164
  v_mfma_f32_32x32x16_bf16 v[80:95], v[44:47], a[52:55], v[80:95]
  s_waitcnt lgkmcnt(5)
  ds_read_b64_tr_b16 v[62:63], v6 offset:5120
  buffer_load_dwordx4 v18, s[12:15], s44 offen lds
  v_lshlrev_b32 v38, 16, v165
  v_and_b32 v165, s51, v165
  v_add_f32 v98, v98, v38
  v_mfma_f32_32x32x16_bf16 v[64:79], v[48:51], a[56:59], v[64:79]
  ds_read_b64_tr_b16 v[44:45], v6 offset:6144
  buffer_store_dwordx4 v[128:131], v21, s[16:19], s47 offen sc1
  v_cvt_pk_bf16_f32 v136, v136, v137
  v_mfma_f32_32x32x16_bf16 v[80:95], v[48:51], a[60:63], v[80:95]
  s_waitcnt lgkmcnt(5)
  ds_read_b64_tr_b16 v[46:47], v6 offset:7168
  v_cvt_pk_bf16_f32 v137, v138, v139
  v_cvt_pk_bf16_f32 v138, v140, v141
  v_cvt_pk_bf16_f32 v139, v142, v143
  v_add_f32 v99, v99, v165
  v_lshlrev_b32 v38, 16, v166
  v_mfma_f32_32x32x16_bf16 v[64:79], v[52:55], a[64:67], v[64:79]
  ds_read_b64_tr_b16 v[48:49], v7 offset:16384
  v_and_b32 v166, s51, v166
  v_add_f32 v100, v100, v38
  v_add_f32 v101, v101, v166
  v_lshlrev_b32 v38, 16, v167
  v_and_b32 v167, s51, v167
  v_mfma_f32_32x32x16_bf16 v[80:95], v[52:55], a[68:71], v[80:95]
  s_waitcnt lgkmcnt(5)
  ds_read_b64_tr_b16 v[50:51], v7 offset:17408
  buffer_load_dwordx4 v19, s[12:15], s44 offen offset:1024 lds
  v_add_f32 v102, v102, v38
  v_add_f32 v103, v103, v167
  v_lshlrev_b32 v38, 16, v168
  v_mfma_f32_32x32x16_bf16 v[64:79], v[56:59], a[72:75], v[64:79]
  s_add_u32 s45, s78, 0x48000
  s_add_u32 m0, s43, 0x1a000
  ds_read_b64_tr_b16 v[52:53], v7 offset:18432
  buffer_store_dwordx4 v[136:139], v21, s[16:19], s47 offen offset:1024 sc1
  v_mfma_f32_32x32x16_bf16 v[80:95], v[56:59], a[76:79], v[80:95]
  s_waitcnt lgkmcnt(5)
  ds_read_b64_tr_b16 v[54:55], v7 offset:19456
  v_and_b32 v168, s51, v168
  v_add_f32 v96, v96, v38
  v_add_f32 v97, v97, v168
  v_lshlrev_b32 v38, 16, v169
  v_and_b32 v169, s51, v169
  v_mfma_f32_32x32x16_bf16 v[64:79], v[60:63], a[80:83], v[64:79]
  ds_read_b64_tr_b16 v[56:57], v7 offset:20480
  v_add_f32 v98, v98, v38
  v_add_f32 v99, v99, v169
  v_lshlrev_b32 v38, 16, v170
  v_and_b32 v170, s51, v170
  v_add_f32 v100, v100, v38
  v_mfma_f32_32x32x16_bf16 v[80:95], v[60:63], a[84:87], v[80:95]
  s_waitcnt lgkmcnt(5)
  ds_read_b64_tr_b16 v[58:59], v7 offset:21504
  buffer_load_dwordx4 v18, s[12:15], s45 offen lds
  v_add_f32 v101, v101, v170
  v_lshlrev_b32 v38, 16, v171
  v_and_b32 v171, s51, v171
  v_mfma_f32_32x32x16_bf16 v[64:79], v[44:47], a[88:91], v[64:79]
  ds_read_b64_tr_b16 v[60:61], v7 offset:22528
  v_add_f32 v102, v102, v38
  v_add_f32 v103, v103, v171
  v_lshlrev_b32 v38, 16, v172
  v_and_b32 v172, s51, v172
  v_add_f32 v96, v96, v38
  v_mfma_f32_32x32x16_bf16 v[80:95], v[44:47], a[92:95], v[80:95]
  s_waitcnt lgkmcnt(5)
  ds_read_b64_tr_b16 v[62:63], v7 offset:23552
  v_add_f32 v97, v97, v172
  v_lshlrev_b32 v38, 16, v173
  v_and_b32 v173, s51, v173
  v_add_f32 v98, v98, v38
  v_add_f32 v99, v99, v173
  v_mfma_f32_32x32x16_bf16 v[64:79], v[48:51], a[96:99], v[64:79]
  ds_read_b64_tr_b16 v[44:45], v7 offset:0
  v_lshlrev_b32 v38, 16, v174
  v_and_b32 v174, s51, v174
  v_add_f32 v100, v100, v38
  v_add_f32 v101, v101, v174
  v_lshlrev_b32 v38, 16, v175
  v_mfma_f32_32x32x16_bf16 v[80:95], v[48:51], a[100:103], v[80:95]
  s_waitcnt lgkmcnt(5)
  ds_read_b64_tr_b16 v[46:47], v7 offset:1024
  buffer_load_dwordx4 v19, s[12:15], s45 offen offset:1024 lds
  v_and_b32 v175, s51, v175
  v_add_f32 v102, v102, v38
  v_add_f32 v103, v103, v175
  v_mfma_f32_32x32x16_bf16 v[64:79], v[52:55], a[104:107], v[64:79]
  s_add_u32 s44, s78, 0x5a000
  ds_read_b64_tr_b16 v[48:49], v7 offset:2048
  s_waitcnt vmcnt(20)
  v_lshlrev_b32 v38, 16, v240
  v_and_b32 v240, s51, v240
  v_add_f32 v96, v96, v38
  v_add_f32 v97, v97, v240
  v_lshlrev_b32 v38, 16, v241
  v_mfma_f32_32x32x16_bf16 v[80:95], v[52:55], a[108:111], v[80:95]
  s_waitcnt lgkmcnt(5)
  ds_read_b64_tr_b16 v[50:51], v7 offset:3072
  v_and_b32 v241, s51, v241
  v_add_f32 v98, v98, v38
  v_add_f32 v99, v99, v241
  v_lshlrev_b32 v38, 16, v242
  v_and_b32 v242, s51, v242
  v_mfma_f32_32x32x16_bf16 v[64:79], v[56:59], a[112:115], v[64:79]
  s_waitcnt vmcnt(11)
  s_barrier
  ds_read_b64_tr_b16 v[52:53], v7 offset:4096
  v_add_f32 v100, v100, v38
  v_mfma_f32_32x32x16_bf16 v[80:95], v[56:59], a[116:119], v[80:95]
  s_waitcnt lgkmcnt(5)
  ds_read_b64_tr_b16 v[54:55], v7 offset:5120
  v_add_f32 v101, v101, v242
  v_lshlrev_b32 v38, 16, v243
  v_and_b32 v243, s51, v243
  v_add_f32 v102, v102, v38
  v_add_f32 v103, v103, v243
  v_mfma_f32_32x32x16_bf16 v[64:79], v[60:63], a[120:123], v[64:79]
  s_add_u32 m0, s43, 0x16000
  ds_read_b64_tr_b16 v[56:57], v7 offset:6144
  v_lshlrev_b32 v38, 16, v244
  v_and_b32 v244, s51, v244
  v_add_f32 v96, v96, v38
  v_add_f32 v97, v97, v244
  v_lshlrev_b32 v38, 16, v245
  v_mfma_f32_32x32x16_bf16 v[80:95], v[60:63], a[124:127], v[80:95]
  s_waitcnt lgkmcnt(5)
  ds_read_b64_tr_b16 v[58:59], v7 offset:7168
  buffer_load_dwordx4 v18, s[12:15], s44 offen lds
  v_and_b32 v245, s51, v245
  v_add_f32 v98, v98, v38
  v_add_f32 v99, v99, v245
  v_mfma_f32_32x32x16_bf16 v[64:79], v[44:47], a[128:131], v[64:79]
  ds_read_b64_tr_b16 v[60:61], v7 offset:8192
  v_mov_b32 v37, 0
  v_mov_b32 v22, 6
  v_cmp_gt_u32 vcc, 12, v1
  s_nop 1
  v_cndmask_b32 v22, v37, v22, vcc
  v_lshlrev_b32 v38, 16, v246
  v_mfma_f32_32x32x16_bf16 v[80:95], v[44:47], a[132:135], v[80:95]
  s_waitcnt lgkmcnt(5)
  ds_read_b64_tr_b16 v[62:63], v7 offset:9216
  v_and_b32 v246, s51, v246
  v_add_f32 v100, v100, v38
  v_add_f32 v101, v101, v246
  v_lshlrev_b32 v38, 16, v247
  v_and_b32 v247, s51, v247
  v_mfma_f32_32x32x16_bf16 v[64:79], v[48:51], a[136:139], v[64:79]
  ds_read_b64_tr_b16 v[44:45], v7 offset:10240
  v_add_f32 v102, v102, v38
  v_add_f32 v103, v103, v247
  v_lshlrev_b32 v38, 16, v248
  v_and_b32 v248, s51, v248
  v_add_f32 v96, v96, v38
  v_mfma_f32_32x32x16_bf16 v[80:95], v[48:51], a[140:143], v[80:95]
  s_waitcnt lgkmcnt(5)
  ds_read_b64_tr_b16 v[46:47], v7 offset:11264
  buffer_load_dwordx4 v19, s[12:15], s44 offen offset:1024 lds
  v_add_f32 v97, v97, v248
  v_lshlrev_b32 v38, 16, v249
  v_and_b32 v249, s51, v249
  v_mfma_f32_32x32x16_bf16 v[64:79], v[52:55], a[144:147], v[64:79]
  s_add_u32 s45, s57, 0x0
  ds_read_b64_tr_b16 v[48:49], v7 offset:12288
  buffer_load_dword v26, v24, s[16:19], s53 offen sc1
  v_add_f32 v98, v98, v38
  v_add_f32 v99, v99, v249
  v_lshlrev_b32 v38, 16, v250
  v_mfma_f32_32x32x16_bf16 v[80:95], v[52:55], a[148:151], v[80:95]
  s_waitcnt lgkmcnt(5)
  ds_read_b64_tr_b16 v[50:51], v7 offset:13312
  v_and_b32 v250, s51, v250
  v_add_f32 v100, v100, v38
  v_add_f32 v101, v101, v250
  v_lshlrev_b32 v38, 16, v251
  v_and_b32 v251, s51, v251
  v_mfma_f32_32x32x16_bf16 v[64:79], v[56:59], a[152:155], v[64:79]
  s_add_u32 m0, s43, 0x2000
  ds_read_b64_tr_b16 v[52:53], v7 offset:14336
  v_add_f32 v102, v102, v38
  v_add_f32 v103, v103, v251
  v_lshlrev_b32 v38, 16, v252
  v_and_b32 v252, s51, v252
  v_add_f32 v96, v96, v38
  v_mfma_f32_32x32x16_bf16 v[80:95], v[56:59], a[156:159], v[80:95]
  s_waitcnt lgkmcnt(5)
  ds_read_b64_tr_b16 v[54:55], v7 offset:15360
  buffer_load_dwordx4 v2, s[16:19], s45 offen sc1 lds
  v_add_f32 v97, v97, v252
  v_lshlrev_b32 v38, 16, v253
  v_and_b32 v253, s51, v253
  v_mfma_f32_32x32x16_bf16 v[64:79], v[60:63], a[160:163], v[64:79]
  ds_read_b64_tr_b16 v[56:57], v7 offset:24576
  v_add_f32 v98, v98, v38
  v_add_f32 v99, v99, v253
  v_lshlrev_b32 v38, 16, v254
  v_and_b32 v254, s51, v254
  v_add_f32 v100, v100, v38
  v_mfma_f32_32x32x16_bf16 v[80:95], v[60:63], a[164:167], v[80:95]
  s_waitcnt lgkmcnt(5)
  ds_read_b64_tr_b16 v[58:59], v7 offset:25600
  v_add_f32 v101, v101, v254
  v_lshlrev_b32 v38, 16, v255
  v_and_b32 v255, s51, v255
  v_add_f32 v102, v102, v38
  v_add_f32 v103, v103, v255
  v_mfma_f32_32x32x16_bf16 v[64:79], v[44:47], a[168:171], v[64:79]
  s_lshl_b32 s48, s77, 5
  s_add_u32 s48, s48, s46
  ds_read_b64_tr_b16 v[60:61], v7 offset:26624
  v_mfma_f32_32x32x16_bf16 v[80:95], v[44:47], a[172:175], v[80:95]
  s_waitcnt lgkmcnt(5)
  ds_read_b64_tr_b16 v[62:63], v7 offset:27648
  buffer_load_dwordx4 v2, s[16:19], s45 offen offset:1024 sc1 lds
  v_mfma_f32_32x32x16_bf16 v[64:79], v[48:51], a[176:179], v[64:79]
  s_add_u32 s44, s58, 0x0
  s_add_u32 m0, s43, 0x4000
  ds_read_b64_tr_b16 v[44:45], v7 offset:28672
  v_mfma_f32_32x32x16_bf16 v[80:95], v[48:51], a[180:183], v[80:95]
  s_waitcnt lgkmcnt(5)
  ds_read_b64_tr_b16 v[46:47], v7 offset:29696
  v_mfma_f32_32x32x16_bf16 v[64:79], v[52:55], a[184:187], v[64:79]
  ds_read_b64_tr_b16 v[48:49], v7 offset:30720
  v_mfma_f32_32x32x16_bf16 v[80:95], v[52:55], a[188:191], v[80:95]
  s_waitcnt lgkmcnt(5)
  ds_read_b64_tr_b16 v[50:51], v7 offset:31744
  buffer_load_dwordx4 v2, s[16:19], s44 offen sc1 lds
  v_mfma_f32_32x32x16_bf16 v[176:191], v[56:59], a[0:3], 0
  ds_read_b64_tr_b16 v[52:53], v6 offset:8192
  v_mfma_f32_32x32x16_bf16 v[192:207], v[56:59], a[4:7], 0
  s_waitcnt lgkmcnt(5)
  ds_read_b64_tr_b16 v[54:55], v6 offset:9216
  s_nop 1
  v_cvt_pk_bf16_f32 v64, v64, v65
  v_cvt_pk_bf16_f32 v65, v66, v67
  v_cvt_pk_bf16_f32 v66, v68, v69
  v_cvt_pk_bf16_f32 v67, v70, v71
  v_mfma_f32_32x32x16_bf16 v[176:191], v[60:63], a[8:11], v[176:191]
  ds_read_b64_tr_b16 v[56:57], v6 offset:10240
  buffer_store_dwordx4 v[64:67], v20, s[16:19], s48 offen sc1
  v_cvt_pk_bf16_f32 v72, v72, v73
  v_mfma_f32_32x32x16_bf16 v[192:207], v[60:63], a[12:15], v[192:207]
  s_waitcnt lgkmcnt(5)
  ds_read_b64_tr_b16 v[58:59], v6 offset:11264
  buffer_load_dwordx4 v2, s[16:19], s44 offen offset:1024 sc1 lds
  v_cvt_pk_bf16_f32 v73, v74, v75
  v_cvt_pk_bf16_f32 v74, v76, v77
  v_cvt_pk_bf16_f32 v75, v78, v79
  v_mfma_f32_32x32x16_bf16 v[176:191], v[44:47], a[16:19], v[176:191]
  s_waitcnt vmcnt(8)
  s_barrier
  s_add_u32 s45, s59, 0x0
  ds_read_b64_tr_b16 v[60:61], v6 offset:12288
  v_mfma_f32_32x32x16_bf16 v[192:207], v[44:47], a[20:23], v[192:207]
  s_waitcnt lgkmcnt(5)
  ds_read_b64_tr_b16 v[62:63], v6 offset:13312
  buffer_store_dwordx4 v[72:75], v20, s[16:19], s48 offen offset:1024 sc1
  v_cvt_pk_bf16_f32 v80, v80, v81
  v_mfma_f32_32x32x16_bf16 v[176:191], v[48:51], a[24:27], v[176:191]
  s_add_u32 m0, s43, 0x6000
  ds_read_b64_tr_b16 v[44:45], v6 offset:14336
  v_cvt_pk_bf16_f32 v81, v82, v83
  v_cvt_pk_bf16_f32 v82, v84, v85
  v_cvt_pk_bf16_f32 v83, v86, v87
  v_mfma_f32_32x32x16_bf16 v[192:207], v[48:51], a[28:31], v[192:207]
  s_waitcnt lgkmcnt(5)
  ds_read_b64_tr_b16 v[46:47], v6 offset:15360
  buffer_load_dwordx4 v2, s[16:19], s45 offen sc1 lds
  v_mfma_f32_32x32x16_bf16 v[176:191], v[52:55], a[32:35], v[176:191]
  ds_read_b64_tr_b16 v[48:49], v6 offset:16384
  s_mov_b32 s35, 0
  s_waitcnt vmcnt(7)
L_fb:
  v_cmp_ge_u32 vcc, v26, v22
  s_nop 3
  s_cmp_eq_u64 vcc, -1
  s_cbranch_scc1 L_fb_x
  s_sleep 3
  buffer_load_dword v26, v24, s[16:19], s53 offen sc1
  s_add_u32 s35, s35, 1
  s_cmp_ge_u32 s35, 0x100000
  s_waitcnt vmcnt(0)
  s_cbranch_scc0 L_fb
L_fb_x:
  v_mfma_f32_32x32x16_bf16 v[192:207], v[52:55], a[36:39], v[192:207]
  s_waitcnt lgkmcnt(5)
  ds_read_b64_tr_b16 v[50:51], v6 offset:17408
  buffer_load_dwordx4 v[144:147], v28, s[16:19], s55 offen sc1
  v_mfma_f32_32x32x16_bf16 v[176:191], v[56:59], a[40:43], v[176:191]
  s_add_u32 s55, s55, 0x240000
  ds_read_b64_tr_b16 v[52:53], v6 offset:18432
  buffer_store_dwordx4 v[80:83], v21, s[16:19], s48 offen sc1
  v_cvt_pk_bf16_f32 v88, v88, v89
  v_mfma_f32_32x32x16_bf16 v[192:207], v[56:59], a[44:47], v[192:207]
  s_waitcnt lgkmcnt(5)
  ds_read_b64_tr_b16 v[54:55], v6 offset:19456
  buffer_load_dwordx4 v2, s[16:19], s45 offen offset:1024 sc1 lds
  v_cvt_pk_bf16_f32 v89, v90, v91
  v_cvt_pk_bf16_f32 v90, v92, v93
  v_cvt_pk_bf16_f32 v91, v94, v95
  v_mfma_f32_32x32x16_bf16 v[176:191], v[60:63], a[48:51], v[176:191]
  s_add_u32 s44, s57, 0x2000
  s_add_u32 m0, s43, 0x8000
  ds_read_b64_tr_b16 v[56:57], v6 offset:20480
  buffer_load_dwordx4 v[148:151], v28, s[16:19], s55 offen sc1
  v_mfma_f32_32x32x16_bf16 v[192:207], v[60:63], a[52:55], v[192:207]
  s_waitcnt lgkmcnt(5)
  s_add_u32 s55, s55, 0x240000
  ds_read_b64_tr_b16 v[58:59], v6 offset:21504
  buffer_store_dwordx4 v[88:91], v21, s[16:19], s48 offen offset:1024 sc1
  v_mfma_f32_32x32x16_bf16 v[176:191], v[44:47], a[56:59], v[176:191]
  ds_read_b64_tr_b16 v[60:61], v6 offset:22528
  v_mfma_f32_32x32x16_bf16 v[192:207], v[44:47], a[60:63], v[192:207]
  s_waitcnt lgkmcnt(5)
  ds_read_b64_tr_b16 v[62:63], v6 offset:23552
  buffer_load_dwordx4 v2, s[16:19], s44 offen sc1 lds
  buffer_load_dwordx4 v[152:155], v28, s[16:19], s55 offen sc1
  v_mfma_f32_32x32x16_bf16 v[176:191], v[48:51], a[64:67], v[176:191]
  s_add_u32 s55, s55, 0x240000
  ds_read_b64_tr_b16 v[44:45], v6 offset:32768
  v_mfma_f32_32x32x16_bf16 v[192:207], v[48:51], a[68:71], v[192:207]
  s_waitcnt lgkmcnt(5)
  ds_read_b64_tr_b16 v[46:47], v6 offset:33792
  v_mfma_f32_32x32x16_bf16 v[176:191], v[52:55], a[72:75], v[176:191]
  ds_read_b64_tr_b16 v[48:49], v6 offset:34816
  buffer_load_dwordx4 v[156:159], v28, s[16:19], s55 offen sc1
  v_mfma_f32_32x32x16_bf16 v[192:207], v[52:55], a[76:79], v[192:207]
  s_waitcnt lgkmcnt(5)
  s_add_u32 s55, s55, 0x240000
  ds_read_b64_tr_b16 v[50:51], v6 offset:35840
  buffer_load_dwordx4 v2, s[16:19], s44 offen offset:1024 sc1 lds
  v_mfma_f32_32x32x16_bf16 v[176:191], v[56:59], a[80:83], v[176:191]
  s_add_u32 s45, s58, 0x2000
  s_add_u32 m0, s43, 0xa000
  ds_read_b64_tr_b16 v[52:53], v6 offset:36864
  v_mfma_f32_32x32x16_bf16 v[192:207], v[56:59], a[84:87], v[192:207]
  s_waitcnt lgkmcnt(5)
  ds_read_b64_tr_b16 v[54:55], v6 offset:37888
  buffer_load_dwordx4 v[160:163], v28, s[16:19], s55 offen sc1
  v_mfma_f32_32x32x16_bf16 v[176:191], v[60:63], a[88:91], v[176:191]
  s_add_u32 s55, s55, 0x240000
  ds_read_b64_tr_b16 v[56:57], v6 offset:38912
  v_mfma_f32_32x32x16_bf16 v[192:207], v[60:63], a[92:95], v[192:207]
  s_waitcnt lgkmcnt(5)
  ds_read_b64_tr_b16 v[58:59], v6 offset:39936
  buffer_load_dwordx4 v2, s[16:19], s45 offen sc1 lds
  v_mfma_f32_32x32x16_bf16 v[176:191], v[44:47], a[96:99], v[176:191]
  ds_read_b64_tr_b16 v[60:61], v6 offset:40960
  buffer_load_dwordx4 v[164:167], v28, s[16:19], s55 offen sc1
  v_mfma_f32_32x32x16_bf16 v[192:207], v[44:47], a[100:103], v[192:207]
  s_waitcnt lgkmcnt(5)
  s_add_u32 s55, s55, 0x240000
  ds_read_b64_tr_b16 v[62:63], v6 offset:41984
  v_mfma_f32_32x32x16_bf16 v[176:191], v[48:51], a[104:107], v[176:191]
  ds_read_b64_tr_b16 v[44:45], v6 offset:43008
  v_mfma_f32_32x32x16_bf16 v[192:207], v[48:51], a[108:111], v[192:207]
  s_waitcnt lgkmcnt(5)
  ds_read_b64_tr_b16 v[46:47], v6 offset:44032
  buffer_load_dwordx4 v2, s[16:19], s45 offen offset:1024 sc1 lds
  buffer_load_dwordx4 v[168:171], v28, s[16:19], s55 offen sc1
  v_mfma_f32_32x32x16_bf16 v[176:191], v[52:55], a[112:115], v[176:191]
  s_barrier
  s_add_u32 s55, s55, 0x240000
  ds_read_b64_tr_b16 v[48:49], v6 offset:45056
  v_mfma_f32_32x32x16_bf16 v[192:207], v[52:55], a[116:119], v[192:207]
  s_waitcnt lgkmcnt(5)
  s_add_u32 s44, s59, 0x2000
  s_add_u32 m0, s43, 0xc000
  ds_read_b64_tr_b16 v[50:51], v6 offset:46080
  v_mfma_f32_32x32x16_bf16 v[176:191], v[56:59], a[120:123], v[176:191]
  ds_read_b64_tr_b16 v[52:53], v6 offset:47104
  buffer_load_dwordx4 v[172:175], v28, s[16:19], s55 offen sc1
  v_mfma_f32_32x32x16_bf16 v[192:207], v[56:59], a[124:127], v[192:207]
  s_waitcnt lgkmcnt(5)
  s_add_u32 s55, s55, 0x240000
  ds_read_b64_tr_b16 v[54:55], v6 offset:48128
  buffer_load_dwordx4 v2, s[16:19], s44 offen sc1 lds
  v_mfma_f32_32x32x16_bf16 v[176:191], v[60:63], a[128:131], v[176:191]
  ds_read_b64_tr_b16 v[56:57], v6 offset:24576
  v_mfma_f32_32x32x16_bf16 v[192:207], v[60:63], a[132:135], v[192:207]
  s_waitcnt lgkmcnt(5)
  ds_read_b64_tr_b16 v[58:59], v6 offset:25600
  buffer_load_dwordx4 v[240:243], v28, s[16:19], s55 offen sc1
  v_mfma_f32_32x32x16_bf16 v[176:191], v[44:47], a[136:139], v[176:191]
  s_add_u32 s55, s55, 0x240000
  ds_read_b64_tr_b16 v[60:61], v6 offset:26624
  v_mfma_f32_32x32x16_bf16 v[192:207], v[44:47], a[140:143], v[192:207]
  s_waitcnt lgkmcnt(5)
  ds_read_b64_tr_b16 v[62:63], v6 offset:27648
  buffer_load_dwordx4 v2, s[16:19], s44 offen offset:1024 sc1 lds
  v_mfma_f32_32x32x16_bf16 v[176:191], v[48:51], a[144:147], v[176:191]
  s_add_u32 s45, s57, 0x4000
  s_add_u32 m0, s43, 0xe000
  ds_read_b64_tr_b16 v[44:45], v6 offset:28672
  buffer_load_dwordx4 v[244:247], v28, s[16:19], s55 offen sc1
  v_mfma_f32_32x32x16_bf16 v[192:207], v[48:51], a[148:151], v[192:207]
  s_waitcnt lgkmcnt(5)
  s_add_u32 s55, s55, 0x240000
  ds_read_b64_tr_b16 v[46:47], v6 offset:29696
  v_mfma_f32_32x32x16_bf16 v[176:191], v[52:55], a[152:155], v[176:191]
  ds_read_b64_tr_b16 v[48:49], v6 offset:30720
  v_mfma_f32_32x32x16_bf16 v[192:207], v[52:55], a[156:159], v[192:207]
  s_waitcnt lgkmcnt(5)
  ds_read_b64_tr_b16 v[50:51], v6 offset:31744
  buffer_load_dwordx4 v2, s[16:19], s45 offen sc1 lds
  buffer_load_dwordx4 v[248:251], v28, s[16:19], s55 offen sc1
  v_mfma_f32_32x32x16_bf16 v[176:191], v[56:59], a[160:163], v[176:191]
  s_add_u32 s55, s55, 0x240000
  v_mfma_f32_32x32x16_bf16 v[192:207], v[56:59], a[164:167], v[192:207]
  s_waitcnt lgkmcnt(4)
  s_lshl_b32 s47, s78, 5
  s_add_u32 s47, s47, s46
  v_mfma_f32_32x32x16_bf16 v[176:191], v[60:63], a[168:171], v[176:191]
  buffer_load_dwordx4 v[252:255], v28, s[16:19], s55 offen sc1
  v_mfma_f32_32x32x16_bf16 v[192:207], v[60:63], a[172:175], v[192:207]
  s_waitcnt lgkmcnt(2)
  s_add_u32 s55, s55, 0x240000
  buffer_load_dwordx4 v2, s[16:19], s45 offen offset:1024 sc1 lds
  v_mfma_f32_32x32x16_bf16 v[176:191], v[44:47], a[176:179], v[176:191]
  s_add_u32 s44, s58, 0x4000
  s_add_u32 m0, s43, 0x1c000
  buffer_load_dword v26, v24, s[16:19], s53 offen sc1
  v_mfma_f32_32x32x16_bf16 v[192:207], v[44:47], a[180:183], v[192:207]
  s_waitcnt lgkmcnt(0)
  v_mfma_f32_32x32x16_bf16 v[176:191], v[48:51], a[184:187], v[176:191]
  v_mfma_f32_32x32x16_bf16 v[192:207], v[48:51], a[188:191], v[192:207]
  buffer_load_dwordx4 v2, s[16:19], s44 offen sc1 lds
  s_nop 9
  v_cvt_pk_bf16_f32 v176, v176, v177
  v_cvt_pk_bf16_f32 v177, v178, v179
  v_cvt_pk_bf16_f32 v178, v180, v181
  v_cvt_pk_bf16_f32 v179, v182, v183
  buffer_store_dwordx4 v[176:179], v20, s[16:19], s47 offen sc1
  v_cvt_pk_bf16_f32 v184, v184, v185
  v_cvt_pk_bf16_f32 v185, v186, v187
  v_cvt_pk_bf16_f32 v186, v188, v189
  v_cvt_pk_bf16_f32 v187, v190, v191
  buffer_load_dwordx4 v2, s[16:19], s44 offen offset:1024 sc1 lds
  s_add_u32 s45, s59, 0x4000
  s_add_u32 m0, s43, 0x1e000
  buffer_store_dwordx4 v[184:187], v20, s[16:19], s47 offen offset:1024 sc1
  v_cvt_pk_bf16_f32 v192, v192, v193
  v_cvt_pk_bf16_f32 v193, v194, v195
  v_cvt_pk_bf16_f32 v194, v196, v197
  v_cvt_pk_bf16_f32 v195, v198, v199
  buffer_load_dwordx4 v2, s[16:19], s45 offen sc1 lds
  buffer_store_dwordx4 v[192:195], v21, s[16:19], s47 offen sc1
  v_cvt_pk_bf16_f32 v200, v200, v201
  v_cvt_pk_bf16_f32 v201, v202, v203
  v_cvt_pk_bf16_f32 v202, v204, v205
  v_cvt_pk_bf16_f32 v203, v206, v207
  buffer_load_dwordx4 v2, s[16:19], s45 offen offset:1024 sc1 lds
  buffer_store_dwordx4 v[200:203], v21, s[16:19], s47 offen offset:1024 sc1
  s_mov_b32 s78, 0x00003f80
  s_mov_b32 s79, 0x3f800000
  s_mov_b32 s49, 0x40088e99
  s_add_u32 s70, s66, 18432
  v_mov_b32 v34, 1
  v_mov_b32 v22, 0
  v_cmp_gt_u32 vcc, 12, v1
  s_nop 1
  v_cndmask_b32 v22, v34, v22, vcc
  s_mov_b32 s35, 0
  s_waitcnt vmcnt(8)
L_fo:
  v_cmp_ge_u32 vcc, v26, v22
  s_nop 3
  s_cmp_eq_u64 vcc, -1
  s_cbranch_scc1 L_fo_x
  s_sleep 3
  buffer_load_dword v26, v24, s[16:19], s53 offen sc1
  s_add_u32 s35, s35, 1
  s_cmp_ge_u32 s35, 0x100000
  s_waitcnt vmcnt(0)
  s_cbranch_scc0 L_fo
L_fo_x:
  buffer_load_dwordx4 a[0:3], v28, s[16:19], s66 offen sc1
  v_mov_b32 v34, 1
  v_mov_b32 v22, 9
  v_cmp_gt_u32 vcc, 12, v1
  s_nop 1
  v_cndmask_b32 v22, v34, v22, vcc
  v_accvgpr_read_b32 v232, a204
  v_accvgpr_read_b32 v233, a205
  v_accvgpr_read_b32 v234, a206
  v_accvgpr_read_b32 v235, a207
  v_lshlrev_b32 v208, 16, v232
  v_and_b32 v209, s51, v232
  v_lshlrev_b32 v210, 16, v233
  v_and_b32 v211, s51, v233
  v_lshlrev_b32 v212, 16, v234
  buffer_load_dwordx4 a[4:7], v28, s[16:19], s70 offen sc1
  v_and_b32 v213, s51, v234
  v_lshlrev_b32 v214, 16, v235
  v_and_b32 v215, s51, v235
  v_fma_f32 v96, v96, s49, v208
  v_fma_f32 v97, v97, s49, v209
  v_fma_f32 v98, v98, s49, v210
  v_fma_f32 v99, v99, s49, v211
  v_fma_f32 v100, v100, s49, v212
  v_fma_f32 v101, v101, s49, v213
  v_fma_f32 v102, v102, s49, v214
  v_fma_f32 v103, v103, s49, v215
  v_mul_f32 v208, 0xbfb8aa3b, v96
  v_mul_f32 v209, 0xbfb8aa3b, v97
  buffer_load_dwordx4 a[8:11], v28, s[16:19], s66 offen offset:1024 sc1
  v_mul_f32 v210, 0xbfb8aa3b, v98
  v_mul_f32 v211, 0xbfb8aa3b, v99
  v_mul_f32 v212, 0xbfb8aa3b, v100
  v_mul_f32 v213, 0xbfb8aa3b, v101
  v_mul_f32 v214, 0xbfb8aa3b, v102
  v_mul_f32 v215, 0xbfb8aa3b, v103
  v_exp_f32 v208, v208
  v_exp_f32 v209, v209
  v_exp_f32 v210, v210
  v_exp_f32 v211, v211
  v_exp_f32 v212, v212
  v_exp_f32 v213, v213
  v_exp_f32 v214, v214
  buffer_load_dwordx4 a[12:15], v28, s[16:19], s70 offen offset:1024 sc1
  v_exp_f32 v215, v215
  v_accvgpr_read_b32 v232, a192
  v_accvgpr_read_b32 v233, a193
  v_accvgpr_read_b32 v234, a194
  v_accvgpr_read_b32 v235, a195
  v_add_f32 v208, 1.0, v208
  v_add_f32 v209, 1.0, v209
  v_add_f32 v210, 1.0, v210
  v_add_f32 v211, 1.0, v211
  v_add_f32 v212, 1.0, v212
  v_add_f32 v213, 1.0, v213
  v_add_f32 v214, 1.0, v214
  v_add_f32 v215, 1.0, v215
  buffer_load_dwordx4 a[16:19], v28, s[16:19], s66 offen offset:2048 sc1
  v_rcp_f32 v208, v208
  v_rcp_f32 v209, v209
  v_rcp_f32 v210, v210
  v_rcp_f32 v211, v211
  v_rcp_f32 v212, v212
  v_rcp_f32 v213, v213
  v_rcp_f32 v214, v214
  v_rcp_f32 v215, v215
  v_mul_f32 v96, v96, v208
  v_mul_f32 v97, v97, v209
  v_mul_f32 v98, v98, v210
  v_mul_f32 v99, v99, v211
  v_mul_f32 v100, v100, v212
  buffer_load_dwordx4 a[20:23], v28, s[16:19], s70 offen offset:2048 sc1
  v_mul_f32 v101, v101, v213
  v_mul_f32 v102, v102, v214
  v_mul_f32 v103, v103, v215
  v_lshlrev_b32 v208, 16, v232
  v_and_b32 v209, s51, v232
  v_lshlrev_b32 v210, 16, v233
  v_and_b32 v211, s51, v233
  v_lshlrev_b32 v212, 16, v234
  v_and_b32 v213, s51, v234
  v_lshlrev_b32 v214, 16, v235
  v_and_b32 v215, s51, v235
  v_dot2_f32_bf16 v104, v144, s78, 0
  v_dot2_f32_bf16 v105, v144, s79, 0
  buffer_load_dwordx4 a[24:27], v28, s[16:19], s66 offen offset:3072 sc1
  s_add_u32 s66, s66, 4096
  v_dot2_f32_bf16 v106, v145, s78, 0
  v_dot2_f32_bf16 v107, v145, s79, 0
  v_dot2_f32_bf16 v108, v146, s78, 0
  v_dot2_f32_bf16 v109, v146, s79, 0
  v_dot2_f32_bf16 v110, v147, s78, 0
  v_dot2_f32_bf16 v111, v147, s79, 0
  v_dot2_f32_bf16 v104, v148, s78, v104
  v_dot2_f32_bf16 v105, v148, s79, v105
  v_dot2_f32_bf16 v106, v149, s78, v106
  v_dot2_f32_bf16 v107, v149, s79, v107
  v_dot2_f32_bf16 v108, v150, s78, v108
  v_dot2_f32_bf16 v109, v150, s79, v109
  v_dot2_f32_bf16 v110, v151, s78, v110
  buffer_load_dwordx4 a[28:31], v28, s[16:19], s70 offen offset:3072 sc1
  s_add_u32 s70, s70, 4096
  v_dot2_f32_bf16 v111, v151, s79, v111
  v_dot2_f32_bf16 v104, v152, s78, v104
  v_dot2_f32_bf16 v105, v152, s79, v105
  v_dot2_f32_bf16 v106, v153, s78, v106
  v_dot2_f32_bf16 v107, v153, s79, v107
  v_dot2_f32_bf16 v108, v154, s78, v108
  v_dot2_f32_bf16 v109, v154, s79, v109
  v_dot2_f32_bf16 v110, v155, s78, v110
  v_dot2_f32_bf16 v111, v155, s79, v111
  v_dot2_f32_bf16 v104, v156, s78, v104
  v_dot2_f32_bf16 v105, v156, s79, v105
  v_dot2_f32_bf16 v106, v157, s78, v106
  v_dot2_f32_bf16 v107, v157, s79, v107
  buffer_load_dwordx4 a[32:35], v28, s[16:19], s66 offen sc1
  v_dot2_f32_bf16 v108, v158, s78, v108
  v_dot2_f32_bf16 v109, v158, s79, v109
  v_dot2_f32_bf16 v110, v159, s78, v110
  v_dot2_f32_bf16 v111, v159, s79, v111
  v_dot2_f32_bf16 v104, v160, s78, v104
  v_dot2_f32_bf16 v105, v160, s79, v105
  v_dot2_f32_bf16 v106, v161, s78, v106
  v_dot2_f32_bf16 v107, v161, s79, v107
  v_dot2_f32_bf16 v108, v162, s78, v108
  v_dot2_f32_bf16 v109, v162, s79, v109
  v_dot2_f32_bf16 v110, v163, s78, v110
  v_dot2_f32_bf16 v111, v163, s79, v111
  v_dot2_f32_bf16 v104, v164, s78, v104
  buffer_load_dwordx4 a[36:39], v28, s[16:19], s70 offen sc1
  v_dot2_f32_bf16 v105, v164, s79, v105
  v_dot2_f32_bf16 v106, v165, s78, v106
  v_dot2_f32_bf16 v107, v165, s79, v107
  v_dot2_f32_bf16 v108, v166, s78, v108
  v_dot2_f32_bf16 v109, v166, s79, v109
  v_dot2_f32_bf16 v110, v167, s78, v110
  v_dot2_f32_bf16 v111, v167, s79, v111
  v_dot2_f32_bf16 v104, v168, s78, v104
  v_dot2_f32_bf16 v105, v168, s79, v105
  v_dot2_f32_bf16 v106, v169, s78, v106
  v_dot2_f32_bf16 v107, v169, s79, v107
  v_dot2_f32_bf16 v108, v170, s78, v108
  v_dot2_f32_bf16 v109, v170, s79, v109
  s_waitcnt vmcnt(10)
  s_barrier
  v_mov_b32 v37, 9
  buffer_store_dword v37, v43, s[16:19], s53 offen sc1
  buffer_load_dwordx4 a[40:43], v28, s[16:19], s66 offen offset:1024 sc1
  v_dot2_f32_bf16 v110, v171, s78, v110
  v_dot2_f32_bf16 v111, v171, s79, v111
  v_dot2_f32_bf16 v104, v172, s78, v104
  v_dot2_f32_bf16 v105, v172, s79, v105
  v_dot2_f32_bf16 v106, v173, s78, v106
  v_dot2_f32_bf16 v107, v173, s79, v107
  v_dot2_f32_bf16 v108, v174, s78, v108
  v_dot2_f32_bf16 v109, v174, s79, v109
  v_dot2_f32_bf16 v110, v175, s78, v110
  v_dot2_f32_bf16 v111, v175, s79, v111
  v_dot2_f32_bf16 v104, v240, s78, v104
  v_dot2_f32_bf16 v105, v240, s79, v105
  v_dot2_f32_bf16 v106, v241, s78, v106
  buffer_load_dwordx4 a[44:47], v28, s[16:19], s70 offen offset:1024 sc1
  v_dot2_f32_bf16 v107, v241, s79, v107
  v_dot2_f32_bf16 v108, v242, s78, v108
  v_dot2_f32_bf16 v109, v242, s79, v109
  v_dot2_f32_bf16 v110, v243, s78, v110
  v_dot2_f32_bf16 v111, v243, s79, v111
  v_dot2_f32_bf16 v104, v244, s78, v104
  v_dot2_f32_bf16 v105, v244, s79, v105
  v_dot2_f32_bf16 v106, v245, s78, v106
  v_dot2_f32_bf16 v107, v245, s79, v107
  v_dot2_f32_bf16 v108, v246, s78, v108
  v_dot2_f32_bf16 v109, v246, s79, v109
  v_dot2_f32_bf16 v110, v247, s78, v110
  v_dot2_f32_bf16 v111, v247, s79, v111
  buffer_load_dwordx4 a[48:51], v28, s[16:19], s66 offen offset:2048 sc1
  v_dot2_f32_bf16 v104, v248, s78, v104
  v_dot2_f32_bf16 v105, v248, s79, v105
  v_dot2_f32_bf16 v106, v249, s78, v106
  v_dot2_f32_bf16 v107, v249, s79, v107
  v_dot2_f32_bf16 v108, v250, s78, v108
  v_dot2_f32_bf16 v109, v250, s79, v109
  v_dot2_f32_bf16 v110, v251, s78, v110
  v_dot2_f32_bf16 v111, v251, s79, v111
  v_dot2_f32_bf16 v104, v252, s78, v104
  v_dot2_f32_bf16 v105, v252, s79, v105
  v_dot2_f32_bf16 v106, v253, s78, v106
  v_dot2_f32_bf16 v107, v253, s79, v107
  v_dot2_f32_bf16 v108, v254, s78, v108
  buffer_load_dwordx4 a[52:55], v28, s[16:19], s70 offen offset:2048 sc1
  v_dot2_f32_bf16 v109, v254, s79, v109
  v_dot2_f32_bf16 v110, v255, s78, v110
  v_dot2_f32_bf16 v111, v255, s79, v111
  v_accvgpr_read_b32 v232, a208
  v_accvgpr_read_b32 v233, a209
  v_accvgpr_read_b32 v234, a210
  v_accvgpr_read_b32 v235, a211
  v_lshlrev_b32 v216, 16, v232
  v_and_b32 v217, s51, v232
  v_lshlrev_b32 v218, 16, v233
  v_and_b32 v219, s51, v233
  v_lshlrev_b32 v220, 16, v234
  v_and_b32 v221, s51, v234
  buffer_load_dwordx4 a[56:59], v28, s[16:19], s66 offen offset:3072 sc1
  s_add_u32 s66, s66, 4096
  v_lshlrev_b32 v222, 16, v235
  v_and_b32 v223, s51, v235
  v_fma_f32 v104, v104, s49, v216
  v_fma_f32 v105, v105, s49, v217
  v_fma_f32 v106, v106, s49, v218
  v_fma_f32 v107, v107, s49, v219
  v_fma_f32 v108, v108, s49, v220
  v_fma_f32 v109, v109, s49, v221
  v_fma_f32 v110, v110, s49, v222
  v_fma_f32 v111, v111, s49, v223
  v_mul_f32 v216, 0xbfb8aa3b, v104
  v_mul_f32 v217, 0xbfb8aa3b, v105
  v_mul_f32 v218, 0xbfb8aa3b, v106
  buffer_load_dwordx4 a[60:63], v28, s[16:19], s70 offen offset:3072 sc1
  s_add_u32 s70, s70, 4096
  v_mul_f32 v219, 0xbfb8aa3b, v107
  v_mul_f32 v220, 0xbfb8aa3b, v108
  v_mul_f32 v221, 0xbfb8aa3b, v109
  v_mul_f32 v222, 0xbfb8aa3b, v110
  v_mul_f32 v223, 0xbfb8aa3b, v111
  v_exp_f32 v216, v216
  v_exp_f32 v217, v217
  v_exp_f32 v218, v218
  v_exp_f32 v219, v219
  v_exp_f32 v220, v220
  v_exp_f32 v221, v221
  v_exp_f32 v222, v222
  v_exp_f32 v223, v223
  buffer_load_dwordx4 a[64:67], v28, s[16:19], s66 offen sc1
  v_accvgpr_read_b32 v232, a196
  v_accvgpr_read_b32 v233, a197
  v_accvgpr_read_b32 v234, a198
  v_accvgpr_read_b32 v235, a199
  v_add_f32 v216, 1.0, v216
  v_add_f32 v217, 1.0, v217
  v_add_f32 v218, 1.0, v218
  v_add_f32 v219, 1.0, v219
  v_add_f32 v220, 1.0, v220
  v_add_f32 v221, 1.0, v221
  v_add_f32 v222, 1.0, v222
  v_add_f32 v223, 1.0, v223
  v_rcp_f32 v216, v216
  buffer_load_dwordx4 a[68:71], v28, s[16:19], s70 offen sc1
  v_rcp_f32 v217, v217
  v_rcp_f32 v218, v218
  v_rcp_f32 v219, v219
  v_rcp_f32 v220, v220
  v_rcp_f32 v221, v221
  v_rcp_f32 v222, v222
  v_rcp_f32 v223, v223
  v_mul_f32 v104, v104, v216
  v_mul_f32 v105, v105, v217
  v_mul_f32 v106, v106, v218
  v_mul_f32 v107, v107, v219
  v_mul_f32 v108, v108, v220
  v_mul_f32 v109, v109, v221
  buffer_load_dwordx4 a[72:75], v28, s[16:19], s66 offen offset:1024 sc1
  v_mul_f32 v110, v110, v222
  v_mul_f32 v111, v111, v223
  v_lshlrev_b32 v216, 16, v232
  v_and_b32 v217, s51, v232
  v_lshlrev_b32 v218, 16, v233
  v_and_b32 v219, s51, v233
  v_lshlrev_b32 v220, 16, v234
  v_and_b32 v221, s51, v234
  v_lshlrev_b32 v222, 16, v235
  v_and_b32 v223, s51, v235
  buffer_load_dwordx4 a[76:79], v28, s[16:19], s70 offen offset:1024 sc1
  ds_read_b128 v[144:147], v28 offset:8192
  ds_read_b128 v[148:151], v28 offset:16384
  ds_read_b128 v[152:155], v28 offset:24576
  ds_read_b128 v[156:159], v28 offset:9216
  s_waitcnt vmcnt(20) lgkmcnt(3)
  v_mfma_f32_16x16x32_bf16 v[120:123], v[144:147], a[0:3], 0
  ds_read_b128 v[160:163], v28 offset:17408
  s_waitcnt vmcnt(19)
  v_mfma_f32_16x16x32_bf16 v[124:127], v[144:147], a[4:7], 0
  buffer_load_dwordx4 a[80:83], v28, s[16:19], s66 offen offset:2048 sc1
  s_waitcnt lgkmcnt(3)
  v_mfma_f32_16x16x32_bf16 v[128:131], v[148:151], a[0:3], 0
  ds_read_b128 v[164:167], v28 offset:25600
  v_mfma_f32_16x16x32_bf16 v[132:135], v[148:151], a[4:7], 0
  buffer_load_dwordx4 a[84:87], v28, s[16:19], s70 offen offset:2048 sc1
  s_waitcnt lgkmcnt(3)
  v_mfma_f32_16x16x32_bf16 v[136:139], v[152:155], a[0:3], 0
  ds_read_b128 v[144:147], v28 offset:10240
  v_mfma_f32_16x16x32_bf16 v[140:143], v[152:155], a[4:7], 0
  buffer_load_dwordx4 a[88:91], v28, s[16:19], s66 offen offset:3072 sc1
  s_add_u32 s66, s66, 4096
  s_waitcnt vmcnt(21) lgkmcnt(3)
  v_mfma_f32_16x16x32_bf16 v[120:123], v[156:159], a[8:11], v[120:123]
  ds_read_b128 v[148:151], v28 offset:18432
  s_waitcnt vmcnt(20)
  v_mfma_f32_16x16x32_bf16 v[124:127], v[156:159], a[12:15], v[124:127]
  buffer_load_dwordx4 a[92:95], v28, s[16:19], s70 offen offset:3072 sc1
  s_add_u32 s70, s70, 4096
  s_waitcnt lgkmcnt(3)
  v_mfma_f32_16x16x32_bf16 v[128:131], v[160:163], a[8:11], v[128:131]
  ds_read_b128 v[152:155], v28 offset:26624
  v_mfma_f32_16x16x32_bf16 v[132:135], v[160:163], a[12:15], v[132:135]
  buffer_load_dwordx4 a[96:99], v28, s[16:19], s66 offen sc1
  s_waitcnt lgkmcnt(3)
  v_mfma_f32_16x16x32_bf16 v[136:139], v[164:167], a[8:11], v[136:139]
  ds_read_b128 v[156:159], v28 offset:11264
  v_mfma_f32_16x16x32_bf16 v[140:143], v[164:167], a[12:15], v[140:143]
  buffer_load_dwordx4 a[100:103], v28, s[16:19], s70 offen sc1
  s_waitcnt vmcnt(22) lgkmcnt(3)
  v_mfma_f32_16x16x32_bf16 v[120:123], v[144:147], a[16:19], v[120:123]
  ds_read_b128 v[160:163], v28 offset:19456
  s_waitcnt vmcnt(21)
  v_mfma_f32_16x16x32_bf16 v[124:127], v[144:147], a[20:23], v[124:127]
  buffer_load_dwordx4 a[104:107], v28, s[16:19], s66 offen offset:1024 sc1
  s_waitcnt lgkmcnt(3)
  v_mfma_f32_16x16x32_bf16 v[128:131], v[148:151], a[16:19], v[128:131]
  ds_read_b128 v[164:167], v28 offset:27648
  v_mfma_f32_16x16x32_bf16 v[132:135], v[148:151], a[20:23], v[132:135]
  buffer_load_dwordx4 a[108:111], v28, s[16:19], s70 offen offset:1024 sc1
  s_waitcnt lgkmcnt(3)
  v_mfma_f32_16x16x32_bf16 v[136:139], v[152:155], a[16:19], v[136:139]
  ds_read_b128 v[144:147], v28 offset:12288
  v_mfma_f32_16x16x32_bf16 v[140:143], v[152:155], a[20:23], v[140:143]
  buffer_load_dwordx4 a[112:115], v28, s[16:19], s66 offen offset:2048 sc1
  s_waitcnt vmcnt(23) lgkmcnt(3)
  v_mfma_f32_16x16x32_bf16 v[120:123], v[156:159], a[24:27], v[120:123]
  ds_read_b128 v[148:151], v28 offset:20480
  s_waitcnt vmcnt(22)
  v_mfma_f32_16x16x32_bf16 v[124:127], v[156:159], a[28:31], v[124:127]
  buffer_load_dwordx4 a[116:119], v28, s[16:19], s70 offen offset:2048 sc1
  s_waitcnt lgkmcnt(3)
  v_mfma_f32_16x16x32_bf16 v[128:131], v[160:163], a[24:27], v[128:131]
  ds_read_b128 v[152:155], v28 offset:28672
  v_mfma_f32_16x16x32_bf16 v[132:135], v[160:163], a[28:31], v[132:135]
  buffer_load_dwordx4 a[120:123], v28, s[16:19], s66 offen offset:3072 sc1
  s_add_u32 s66, s66, 4096
  s_waitcnt lgkmcnt(3)
  v_mfma_f32_16x16x32_bf16 v[136:139], v[164:167], a[24:27], v[136:139]
  ds_read_b128 v[156:159], v28 offset:13312
  v_mfma_f32_16x16x32_bf16 v[140:143], v[164:167], a[28:31], v[140:143]
  buffer_load_dwordx4 a[124:127], v28, s[16:19], s70 offen offset:3072 sc1
  s_add_u32 s70, s70, 4096
  s_waitcnt vmcnt(24) lgkmcnt(3)
  v_mfma_f32_16x16x32_bf16 v[120:123], v[144:147], a[32:35], v[120:123]
  ds_read_b128 v[160:163], v28 offset:21504
  s_waitcnt vmcnt(23)
  v_mfma_f32_16x16x32_bf16 v[124:127], v[144:147], a[36:39], v[124:127]
  buffer_load_dwordx4 a[128:131], v28, s[16:19], s66 offen sc1
  s_waitcnt lgkmcnt(3)
  v_mfma_f32_16x16x32_bf16 v[128:131], v[148:151], a[32:35], v[128:131]
  ds_read_b128 v[164:167], v28 offset:29696
  v_mfma_f32_16x16x32_bf16 v[132:135], v[148:151], a[36:39], v[132:135]
  buffer_load_dwordx4 a[132:135], v28, s[16:19], s70 offen sc1
  s_waitcnt lgkmcnt(3)
  v_mfma_f32_16x16x32_bf16 v[136:139], v[152:155], a[32:35], v[136:139]
  ds_read_b128 v[144:147], v28 offset:14336
  v_mfma_f32_16x16x32_bf16 v[140:143], v[152:155], a[36:39], v[140:143]
  buffer_load_dwordx4 a[136:139], v28, s[16:19], s66 offen offset:1024 sc1
  s_waitcnt vmcnt(24) lgkmcnt(3)
  v_mfma_f32_16x16x32_bf16 v[120:123], v[156:159], a[40:43], v[120:123]
  ds_read_b128 v[148:151], v28 offset:22528
  s_waitcnt vmcnt(23)
  v_mfma_f32_16x16x32_bf16 v[124:127], v[156:159], a[44:47], v[124:127]
  buffer_load_dwordx4 a[140:143], v28, s[16:19], s70 offen offset:1024 sc1
  s_waitcnt lgkmcnt(3)
  v_mfma_f32_16x16x32_bf16 v[128:131], v[160:163], a[40:43], v[128:131]
  ds_read_b128 v[152:155], v28 offset:30720
  v_mfma_f32_16x16x32_bf16 v[132:135], v[160:163], a[44:47], v[132:135]
  s_waitcnt lgkmcnt(3)
  v_mfma_f32_16x16x32_bf16 v[136:139], v[164:167], a[40:43], v[136:139]
  ds_read_b128 v[156:159], v28 offset:15360
  v_mfma_f32_16x16x32_bf16 v[140:143], v[164:167], a[44:47], v[140:143]
  s_waitcnt vmcnt(23) lgkmcnt(3)
  v_mfma_f32_16x16x32_bf16 v[120:123], v[144:147], a[48:51], v[120:123]
  ds_read_b128 v[160:163], v28 offset:23552
  s_waitcnt vmcnt(22)
  v_mfma_f32_16x16x32_bf16 v[124:127], v[144:147], a[52:55], v[124:127]
  s_waitcnt lgkmcnt(3)
  v_mfma_f32_16x16x32_bf16 v[128:131], v[148:151], a[48:51], v[128:131]
  ds_read_b128 v[164:167], v28 offset:31744
  v_mfma_f32_16x16x32_bf16 v[132:135], v[148:151], a[52:55], v[132:135]
  s_waitcnt lgkmcnt(3)
  v_mfma_f32_16x16x32_bf16 v[136:139], v[152:155], a[48:51], v[136:139]
  ds_read_b128 v[144:147], v28 offset:32768
  v_mfma_f32_16x16x32_bf16 v[140:143], v[152:155], a[52:55], v[140:143]
  s_waitcnt vmcnt(21) lgkmcnt(3)
  v_mfma_f32_16x16x32_bf16 v[120:123], v[156:159], a[56:59], v[120:123]
  ds_read_b128 v[148:151], v28 offset:40960
  s_waitcnt vmcnt(20)
  v_mfma_f32_16x16x32_bf16 v[124:127], v[156:159], a[60:63], v[124:127]
  s_waitcnt lgkmcnt(3)
  v_mfma_f32_16x16x32_bf16 v[128:131], v[160:163], a[56:59], v[128:131]
  ds_read_b128 v[152:155], v28 offset:49152
  v_mfma_f32_16x16x32_bf16 v[132:135], v[160:163], a[60:63], v[132:135]
  s_waitcnt lgkmcnt(3)
  v_mfma_f32_16x16x32_bf16 v[136:139], v[164:167], a[56:59], v[136:139]
  ds_read_b128 v[156:159], v28 offset:33792
  v_mfma_f32_16x16x32_bf16 v[140:143], v[164:167], a[60:63], v[140:143]
  s_waitcnt vmcnt(19) lgkmcnt(3)
  v_mfma_f32_16x16x32_bf16 v[120:123], v[144:147], a[64:67], v[120:123]
  ds_read_b128 v[160:163], v28 offset:41984
  s_waitcnt vmcnt(18)
  v_mfma_f32_16x16x32_bf16 v[124:127], v[144:147], a[68:71], v[124:127]
  s_waitcnt lgkmcnt(3)
  v_mfma_f32_16x16x32_bf16 v[128:131], v[148:151], a[64:67], v[128:131]
  ds_read_b128 v[164:167], v28 offset:50176
  v_mfma_f32_16x16x32_bf16 v[132:135], v[148:151], a[68:71], v[132:135]
  buffer_load_dword v26, v24, s[16:19], s53 offen sc1
  s_waitcnt lgkmcnt(3)
  v_mfma_f32_16x16x32_bf16 v[136:139], v[152:155], a[64:67], v[136:139]
  ds_read_b128 v[144:147], v28 offset:34816
  v_mfma_f32_16x16x32_bf16 v[140:143], v[152:155], a[68:71], v[140:143]
  s_waitcnt vmcnt(18) lgkmcnt(3)
  v_mfma_f32_16x16x32_bf16 v[120:123], v[156:159], a[72:75], v[120:123]
  ds_read_b128 v[148:151], v28 offset:43008
  s_waitcnt vmcnt(17)
  v_mfma_f32_16x16x32_bf16 v[124:127], v[156:159], a[76:79], v[124:127]
  s_waitcnt lgkmcnt(3)
  v_mfma_f32_16x16x32_bf16 v[128:131], v[160:163], a[72:75], v[128:131]
  ds_read_b128 v[152:155], v28 offset:51200
  v_mfma_f32_16x16x32_bf16 v[132:135], v[160:163], a[76:79], v[132:135]
  s_waitcnt lgkmcnt(3)
  v_mfma_f32_16x16x32_bf16 v[136:139], v[164:167], a[72:75], v[136:139]
  ds_read_b128 v[156:159], v28 offset:35840
  v_mfma_f32_16x16x32_bf16 v[140:143], v[164:167], a[76:79], v[140:143]
  s_waitcnt vmcnt(16) lgkmcnt(3)
  v_mfma_f32_16x16x32_bf16 v[120:123], v[144:147], a[80:83], v[120:123]
  ds_read_b128 v[160:163], v28 offset:44032
  s_waitcnt vmcnt(15)
  v_mfma_f32_16x16x32_bf16 v[124:127], v[144:147], a[84:87], v[124:127]
  s_waitcnt lgkmcnt(3)
  v_mfma_f32_16x16x32_bf16 v[128:131], v[148:151], a[80:83], v[128:131]
  ds_read_b128 v[164:167], v28 offset:52224
  v_mfma_f32_16x16x32_bf16 v[132:135], v[148:151], a[84:87], v[132:135]
  s_waitcnt lgkmcnt(3)
  v_mfma_f32_16x16x32_bf16 v[136:139], v[152:155], a[80:83], v[136:139]
  ds_read_b128 v[144:147], v28 offset:36864
  v_mfma_f32_16x16x32_bf16 v[140:143], v[152:155], a[84:87], v[140:143]
  s_waitcnt vmcnt(14) lgkmcnt(3)
  v_mfma_f32_16x16x32_bf16 v[120:123], v[156:159], a[88:91], v[120:123]
  ds_read_b128 v[148:151], v28 offset:45056
  s_waitcnt vmcnt(13)
  v_mfma_f32_16x16x32_bf16 v[124:127], v[156:159], a[92:95], v[124:127]
  s_waitcnt lgkmcnt(3)
  v_mfma_f32_16x16x32_bf16 v[128:131], v[160:163], a[88:91], v[128:131]
  ds_read_b128 v[152:155], v28 offset:53248
  v_mfma_f32_16x16x32_bf16 v[132:135], v[160:163], a[92:95], v[132:135]
  s_waitcnt lgkmcnt(3)
  v_mfma_f32_16x16x32_bf16 v[136:139], v[164:167], a[88:91], v[136:139]
  ds_read_b128 v[156:159], v28 offset:37888
  v_mfma_f32_16x16x32_bf16 v[140:143], v[164:167], a[92:95], v[140:143]
  s_mov_b32 s35, 0
  s_waitcnt vmcnt(0)
L_fc:
  v_cmp_ge_u32 vcc, v26, v22
  s_nop 3
  s_cmp_eq_u64 vcc, -1
  s_cbranch_scc1 L_fc_x
  s_sleep 3
  buffer_load_dword v26, v24, s[16:19], s53 offen sc1
  s_add_u32 s35, s35, 1
  s_cmp_ge_u32 s35, 0x100000
  s_waitcnt vmcnt(0)
  s_cbranch_scc0 L_fc
L_fc_x:
  buffer_load_dwordx4 v[64:67], v28, s[16:19], s56 offen sc1
  s_add_u32 s56, s56, 0x240000
  buffer_load_dwordx4 v[68:71], v28, s[16:19], s56 offen sc1
  s_add_u32 s56, s56, 0x240000
  buffer_load_dwordx4 v[72:75], v28, s[16:19], s56 offen sc1
  s_add_u32 s56, s56, 0x240000
  buffer_load_dwordx4 v[76:79], v28, s[16:19], s56 offen sc1
  s_add_u32 s56, s56, 0x240000
  buffer_load_dwordx4 v[80:83], v28, s[16:19], s56 offen sc1
  s_add_u32 s56, s56, 0x240000
  buffer_load_dwordx4 v[84:87], v28, s[16:19], s56 offen sc1
  s_add_u32 s56, s56, 0x240000
  buffer_load_dwordx4 v[88:91], v28, s[16:19], s56 offen sc1
  s_add_u32 s56, s56, 0x240000
  buffer_load_dwordx4 v[92:95], v28, s[16:19], s56 offen sc1
  s_add_u32 s56, s56, 0x240000
  buffer_load_dwordx4 v[188:191], v28, s[16:19], s56 offen sc1
  s_add_u32 s56, s56, 0x240000
  buffer_load_dwordx4 v[192:195], v28, s[16:19], s56 offen sc1
  s_add_u32 s56, s56, 0x240000
  buffer_load_dwordx4 v[196:199], v28, s[16:19], s56 offen sc1
  s_add_u32 s56, s56, 0x240000
  buffer_load_dwordx4 v[200:203], v28, s[16:19], s56 offen sc1
  s_add_u32 s56, s56, 0x240000
  s_waitcnt lgkmcnt(3)
  v_mfma_f32_16x16x32_bf16 v[120:123], v[144:147], a[96:99], v[120:123]
  ds_read_b128 v[160:163], v28 offset:46080
  v_mfma_f32_16x16x32_bf16 v[124:127], v[144:147], a[100:103], v[124:127]
  s_waitcnt lgkmcnt(3)
  v_mfma_f32_16x16x32_bf16 v[128:131], v[148:151], a[96:99], v[128:131]
  ds_read_b128 v[164:167], v28 offset:54272
  v_mfma_f32_16x16x32_bf16 v[132:135], v[148:151], a[100:103], v[132:135]
  s_waitcnt lgkmcnt(3)
  v_mfma_f32_16x16x32_bf16 v[136:139], v[152:155], a[96:99], v[136:139]
  ds_read_b128 v[144:147], v28 offset:38912
  v_mfma_f32_16x16x32_bf16 v[140:143], v[152:155], a[100:103], v[140:143]
  s_waitcnt lgkmcnt(3)
  v_mfma_f32_16x16x32_bf16 v[120:123], v[156:159], a[104:107], v[120:123]
  ds_read_b128 v[148:151], v28 offset:47104
  v_mfma_f32_16x16x32_bf16 v[124:127], v[156:159], a[108:111], v[124:127]
  s_waitcnt lgkmcnt(3)
  v_mfma_f32_16x16x32_bf16 v[128:131], v[160:163], a[104:107], v[128:131]
  ds_read_b128 v[152:155], v28 offset:55296
  v_mfma_f32_16x16x32_bf16 v[132:135], v[160:163], a[108:111], v[132:135]
  s_waitcnt lgkmcnt(3)
  v_mfma_f32_16x16x32_bf16 v[136:139], v[164:167], a[104:107], v[136:139]
  ds_read_b128 v[156:159], v28 offset:39936
  v_mfma_f32_16x16x32_bf16 v[140:143], v[164:167], a[108:111], v[140:143]
  s_waitcnt lgkmcnt(3)
  v_mfma_f32_16x16x32_bf16 v[120:123], v[144:147], a[112:115], v[120:123]
  ds_read_b128 v[160:163], v28 offset:48128
  v_mfma_f32_16x16x32_bf16 v[124:127], v[144:147], a[116:119], v[124:127]
  s_waitcnt lgkmcnt(3)
  v_mfma_f32_16x16x32_bf16 v[128:131], v[148:151], a[112:115], v[128:131]
  ds_read_b128 v[164:167], v28 offset:56320
  v_mfma_f32_16x16x32_bf16 v[132:135], v[148:151], a[116:119], v[132:135]
  s_waitcnt lgkmcnt(3)
  v_mfma_f32_16x16x32_bf16 v[136:139], v[152:155], a[112:115], v[136:139]
  ds_read_b128 v[144:147], v28 offset:57344
  v_mfma_f32_16x16x32_bf16 v[140:143], v[152:155], a[116:119], v[140:143]
  s_waitcnt lgkmcnt(3)
  v_mfma_f32_16x16x32_bf16 v[120:123], v[156:159], a[120:123], v[120:123]
  ds_read_b128 v[148:151], v3 offset:49152
  v_mfma_f32_16x16x32_bf16 v[124:127], v[156:159], a[124:127], v[124:127]
  s_waitcnt lgkmcnt(3)
  v_mfma_f32_16x16x32_bf16 v[128:131], v[160:163], a[120:123], v[128:131]
  ds_read_b128 v[152:155], v3 offset:57344
  v_mfma_f32_16x16x32_bf16 v[132:135], v[160:163], a[124:127], v[132:135]
  s_waitcnt lgkmcnt(3)
  v_mfma_f32_16x16x32_bf16 v[136:139], v[164:167], a[120:123], v[136:139]
  ds_read_b128 v[156:159], v28 offset:58368
  v_mfma_f32_16x16x32_bf16 v[140:143], v[164:167], a[124:127], v[140:143]
  s_waitcnt lgkmcnt(3)
  v_mfma_f32_16x16x32_bf16 v[120:123], v[144:147], a[128:131], v[120:123]
  ds_read_b128 v[160:163], v3 offset:50176
  v_mfma_f32_16x16x32_bf16 v[124:127], v[144:147], a[132:135], v[124:127]
  s_waitcnt lgkmcnt(3)
  v_mfma_f32_16x16x32_bf16 v[128:131], v[148:151], a[128:131], v[128:131]
  ds_read_b128 v[164:167], v3 offset:58368
  v_mfma_f32_16x16x32_bf16 v[132:135], v[148:151], a[132:135], v[132:135]
  s_waitcnt lgkmcnt(3)
  v_mfma_f32_16x16x32_bf16 v[136:139], v[152:155], a[128:131], v[136:139]
  v_mfma_f32_16x16x32_bf16 v[140:143], v[152:155], a[132:135], v[140:143]
  s_waitcnt lgkmcnt(2)
  v_mfma_f32_16x16x32_bf16 v[120:123], v[156:159], a[136:139], v[120:123]
  v_mfma_f32_16x16x32_bf16 v[124:127], v[156:159], a[140:143], v[124:127]
  s_waitcnt lgkmcnt(1)
  v_mfma_f32_16x16x32_bf16 v[128:131], v[160:163], a[136:139], v[128:131]
  v_mfma_f32_16x16x32_bf16 v[132:135], v[160:163], a[140:143], v[132:135]
  s_waitcnt lgkmcnt(0)
  v_mfma_f32_16x16x32_bf16 v[136:139], v[164:167], a[136:139], v[136:139]
  v_mfma_f32_16x16x32_bf16 v[140:143], v[164:167], a[140:143], v[140:143]
  s_nop 5
  v_permlane16_swap_b32 v120, v124
  v_permlane16_swap_b32 v121, v125
  v_permlane16_swap_b32 v122, v126
  v_permlane16_swap_b32 v123, v127
  v_permlane16_swap_b32 v128, v132
  v_permlane16_swap_b32 v129, v133
  v_permlane16_swap_b32 v130, v134
  v_permlane16_swap_b32 v131, v135
  v_mul_f32 v96, v96, v120
  v_mul_f32 v97, v97, v121
  v_mul_f32 v98, v98, v122
  v_mul_f32 v99, v99, v123
  v_mul_f32 v100, v100, v124
  v_mul_f32 v101, v101, v125
  v_mul_f32 v102, v102, v126
  v_mul_f32 v103, v103, v127
  v_mul_f32 v104, v104, v128
  v_mul_f32 v105, v105, v129
  v_mul_f32 v106, v106, v130
  v_mul_f32 v107, v107, v131
  v_mul_f32 v108, v108, v132
  v_mul_f32 v109, v109, v133
  v_mul_f32 v110, v110, v134
  v_mul_f32 v111, v111, v135
  v_permlane32_swap_b32 v96, v100
  v_permlane32_swap_b32 v97, v101
  v_permlane32_swap_b32 v98, v102
  v_permlane32_swap_b32 v99, v103
  v_permlane32_swap_b32 v104, v108
  v_permlane32_swap_b32 v105, v109
  v_permlane32_swap_b32 v106, v110
  v_permlane32_swap_b32 v107, v111
  v_pk_add_f32 v[96:97], v[96:97], v[208:209]
  v_pk_add_f32 v[98:99], v[98:99], v[210:211]
  v_pk_add_f32 v[100:101], v[100:101], v[212:213]
  v_pk_add_f32 v[102:103], v[102:103], v[214:215]
  v_cvt_pk_bf16_f32 v176, v96, v97
  v_cvt_pk_bf16_f32 v177, v98, v99
  v_cvt_pk_bf16_f32 v178, v100, v101
  v_cvt_pk_bf16_f32 v179, v102, v103
  v_pk_add_f32 v[104:105], v[104:105], v[216:217]
  v_pk_add_f32 v[106:107], v[106:107], v[218:219]
  v_pk_add_f32 v[108:109], v[108:109], v[220:221]
  v_pk_add_f32 v[110:111], v[110:111], v[222:223]
  v_cvt_pk_bf16_f32 v180, v104, v105
  v_cvt_pk_bf16_f32 v181, v106, v107
  v_cvt_pk_bf16_f32 v182, v108, v109
  v_cvt_pk_bf16_f32 v183, v110, v111
  buffer_store_dwordx4 v[176:179], v31, s[8:11], s60 offen sc1
  buffer_store_dwordx4 v[180:183], v31, s[8:11], s61 offen sc1
  s_waitcnt vmcnt(13)
  v_dot2_f32_bf16 v112, v64, s78, 0
  v_dot2_f32_bf16 v113, v64, s79, 0
  v_dot2_f32_bf16 v114, v65, s78, 0
  v_dot2_f32_bf16 v115, v65, s79, 0
  v_dot2_f32_bf16 v116, v66, s78, 0
  v_dot2_f32_bf16 v117, v66, s79, 0
  v_dot2_f32_bf16 v118, v67, s78, 0
  v_dot2_f32_bf16 v119, v67, s79, 0
  s_waitcnt vmcnt(12)
  v_dot2_f32_bf16 v112, v68, s78, v112
  v_dot2_f32_bf16 v113, v68, s79, v113
  v_dot2_f32_bf16 v114, v69, s78, v114
  v_dot2_f32_bf16 v115, v69, s79, v115
  v_dot2_f32_bf16 v116, v70, s78, v116
  v_dot2_f32_bf16 v117, v70, s79, v117
  v_dot2_f32_bf16 v118, v71, s78, v118
  v_dot2_f32_bf16 v119, v71, s79, v119
  s_waitcnt vmcnt(11)
  v_dot2_f32_bf16 v112, v72, s78, v112
  v_dot2_f32_bf16 v113, v72, s79, v113
  v_dot2_f32_bf16 v114, v73, s78, v114
  v_dot2_f32_bf16 v115, v73, s79, v115
  v_dot2_f32_bf16 v116, v74, s78, v116
  v_dot2_f32_bf16 v117, v74, s79, v117
  v_dot2_f32_bf16 v118, v75, s78, v118
  v_dot2_f32_bf16 v119, v75, s79, v119
  s_waitcnt vmcnt(10)
  v_dot2_f32_bf16 v112, v76, s78, v112
  v_dot2_f32_bf16 v113, v76, s79, v113
  v_dot2_f32_bf16 v114, v77, s78, v114
  v_dot2_f32_bf16 v115, v77, s79, v115
  v_dot2_f32_bf16 v116, v78, s78, v116
  v_dot2_f32_bf16 v117, v78, s79, v117
  v_dot2_f32_bf16 v118, v79, s78, v118
  v_dot2_f32_bf16 v119, v79, s79, v119
  s_waitcnt vmcnt(9)
  v_dot2_f32_bf16 v112, v80, s78, v112
  v_dot2_f32_bf16 v113, v80, s79, v113
  v_dot2_f32_bf16 v114, v81, s78, v114
  v_dot2_f32_bf16 v115, v81, s79, v115
  v_dot2_f32_bf16 v116, v82, s78, v116
  v_dot2_f32_bf16 v117, v82, s79, v117
  v_dot2_f32_bf16 v118, v83, s78, v118
  v_dot2_f32_bf16 v119, v83, s79, v119
  s_waitcnt vmcnt(8)
  v_dot2_f32_bf16 v112, v84, s78, v112
  v_dot2_f32_bf16 v113, v84, s79, v113
  v_dot2_f32_bf16 v114, v85, s78, v114
  v_dot2_f32_bf16 v115, v85, s79, v115
  v_dot2_f32_bf16 v116, v86, s78, v116
  v_dot2_f32_bf16 v117, v86, s79, v117
  v_dot2_f32_bf16 v118, v87, s78, v118
  v_dot2_f32_bf16 v119, v87, s79, v119
  s_waitcnt vmcnt(7)
  v_dot2_f32_bf16 v112, v88, s78, v112
  v_dot2_f32_bf16 v113, v88, s79, v113
  v_dot2_f32_bf16 v114, v89, s78, v114
  v_dot2_f32_bf16 v115, v89, s79, v115
  v_dot2_f32_bf16 v116, v90, s78, v116
  v_dot2_f32_bf16 v117, v90, s79, v117
  v_dot2_f32_bf16 v118, v91, s78, v118
  v_dot2_f32_bf16 v119, v91, s79, v119
  s_waitcnt vmcnt(6)
  v_dot2_f32_bf16 v112, v92, s78, v112
  v_dot2_f32_bf16 v113, v92, s79, v113
  v_dot2_f32_bf16 v114, v93, s78, v114
  v_dot2_f32_bf16 v115, v93, s79, v115
  v_dot2_f32_bf16 v116, v94, s78, v116
  v_dot2_f32_bf16 v117, v94, s79, v117
  v_dot2_f32_bf16 v118, v95, s78, v118
  v_dot2_f32_bf16 v119, v95, s79, v119
  s_waitcnt vmcnt(5)
  v_dot2_f32_bf16 v112, v188, s78, v112
  v_dot2_f32_bf16 v113, v188, s79, v113
  v_dot2_f32_bf16 v114, v189, s78, v114
  v_dot2_f32_bf16 v115, v189, s79, v115
  v_dot2_f32_bf16 v116, v190, s78, v116
  v_dot2_f32_bf16 v117, v190, s79, v117
  v_dot2_f32_bf16 v118, v191, s78, v118
  v_dot2_f32_bf16 v119, v191, s79, v119
  s_waitcnt vmcnt(4)
  v_dot2_f32_bf16 v112, v192, s78, v112
  v_dot2_f32_bf16 v113, v192, s79, v113
  v_dot2_f32_bf16 v114, v193, s78, v114
  v_dot2_f32_bf16 v115, v193, s79, v115
  v_dot2_f32_bf16 v116, v194, s78, v116
  v_dot2_f32_bf16 v117, v194, s79, v117
  v_dot2_f32_bf16 v118, v195, s78, v118
  v_dot2_f32_bf16 v119, v195, s79, v119
  s_waitcnt vmcnt(3)
  v_dot2_f32_bf16 v112, v196, s78, v112
  v_dot2_f32_bf16 v113, v196, s79, v113
  v_dot2_f32_bf16 v114, v197, s78, v114
  v_dot2_f32_bf16 v115, v197, s79, v115
  v_dot2_f32_bf16 v116, v198, s78, v116
  v_dot2_f32_bf16 v117, v198, s79, v117
  v_dot2_f32_bf16 v118, v199, s78, v118
  v_dot2_f32_bf16 v119, v199, s79, v119
  s_waitcnt vmcnt(2)
  v_dot2_f32_bf16 v112, v200, s78, v112
  v_dot2_f32_bf16 v113, v200, s79, v113
  v_dot2_f32_bf16 v114, v201, s78, v114
  v_dot2_f32_bf16 v115, v201, s79, v115
  v_dot2_f32_bf16 v116, v202, s78, v116
  v_dot2_f32_bf16 v117, v202, s79, v117
  v_dot2_f32_bf16 v118, v203, s78, v118
  v_dot2_f32_bf16 v119, v203, s79, v119
  v_accvgpr_read_b32 v232, a212
  v_accvgpr_read_b32 v233, a213
  v_accvgpr_read_b32 v234, a214
  v_accvgpr_read_b32 v235, a215
  v_lshlrev_b32 v224, 16, v232
  v_and_b32 v225, s51, v232
  v_lshlrev_b32 v226, 16, v233
  v_and_b32 v227, s51, v233
  v_lshlrev_b32 v228, 16, v234
  v_and_b32 v229, s51, v234
  v_lshlrev_b32 v230, 16, v235
  v_and_b32 v231, s51, v235
  v_fma_f32 v112, v112, s49, v224
  v_fma_f32 v113, v113, s49, v225
  v_fma_f32 v114, v114, s49, v226
  v_fma_f32 v115, v115, s49, v227
  v_fma_f32 v116, v116, s49, v228
  v_fma_f32 v117, v117, s49, v229
  v_fma_f32 v118, v118, s49, v230
  v_fma_f32 v119, v119, s49, v231
  v_mul_f32 v224, 0xbfb8aa3b, v112
  v_mul_f32 v225, 0xbfb8aa3b, v113
  v_mul_f32 v226, 0xbfb8aa3b, v114
  v_mul_f32 v227, 0xbfb8aa3b, v115
  v_mul_f32 v228, 0xbfb8aa3b, v116
  v_mul_f32 v229, 0xbfb8aa3b, v117
  v_mul_f32 v230, 0xbfb8aa3b, v118
  v_mul_f32 v231, 0xbfb8aa3b, v119
  v_exp_f32 v224, v224
  v_exp_f32 v225, v225
  v_exp_f32 v226, v226
  v_exp_f32 v227, v227
  v_exp_f32 v228, v228
  v_exp_f32 v229, v229
  v_exp_f32 v230, v230
  v_exp_f32 v231, v231
  v_accvgpr_read_b32 v232, a200
  v_accvgpr_read_b32 v233, a201
  v_accvgpr_read_b32 v234, a202
  v_accvgpr_read_b32 v235, a203
  v_add_f32 v224, 1.0, v224
  v_add_f32 v225, 1.0, v225
  v_add_f32 v226, 1.0, v226
  v_add_f32 v227, 1.0, v227
  v_add_f32 v228, 1.0, v228
  v_add_f32 v229, 1.0, v229
  v_add_f32 v230, 1.0, v230
  v_add_f32 v231, 1.0, v231
  v_rcp_f32 v224, v224
  v_rcp_f32 v225, v225
  v_rcp_f32 v226, v226
  v_rcp_f32 v227, v227
  v_rcp_f32 v228, v228
  v_rcp_f32 v229, v229
  v_rcp_f32 v230, v230
  v_rcp_f32 v231, v231
  v_mul_f32 v112, v112, v224
  v_mul_f32 v113, v113, v225
  v_mul_f32 v114, v114, v226
  v_mul_f32 v115, v115, v227
  v_mul_f32 v116, v116, v228
  v_mul_f32 v117, v117, v229
  v_mul_f32 v118, v118, v230
  v_mul_f32 v119, v119, v231
  v_lshlrev_b32 v224, 16, v232
  v_and_b32 v225, s51, v232
  v_lshlrev_b32 v226, 16, v233
  v_and_b32 v227, s51, v233
  v_lshlrev_b32 v228, 16, v234
  v_and_b32 v229, s51, v234
  v_lshlrev_b32 v230, 16, v235
  v_and_b32 v231, s51, v235
  v_permlane16_swap_b32 v136, v140
  v_permlane16_swap_b32 v137, v141
  v_permlane16_swap_b32 v138, v142
  v_permlane16_swap_b32 v139, v143
  v_mul_f32 v112, v112, v136
  v_mul_f32 v113, v113, v137
  v_mul_f32 v114, v114, v138
  v_mul_f32 v115, v115, v139
  v_mul_f32 v116, v116, v140
  v_mul_f32 v117, v117, v141
  v_mul_f32 v118, v118, v142
  v_mul_f32 v119, v119, v143
  v_permlane32_swap_b32 v112, v116
  v_permlane32_swap_b32 v113, v117
  v_permlane32_swap_b32 v114, v118
  v_permlane32_swap_b32 v115, v119
  v_pk_add_f32 v[112:113], v[112:113], v[224:225]
  v_pk_add_f32 v[114:115], v[114:115], v[226:227]
  v_pk_add_f32 v[116:117], v[116:117], v[228:229]
  v_pk_add_f32 v[118:119], v[118:119], v[230:231]
  v_cvt_pk_bf16_f32 v184, v112, v113
  v_cvt_pk_bf16_f32 v185, v114, v115
  v_cvt_pk_bf16_f32 v186, v116, v117
  v_cvt_pk_bf16_f32 v187, v118, v119
  buffer_store_dwordx4 v[184:187], v31, s[8:11], s62 offen sc1
L_end:
  s_endpgm
.p2align 6
L_attn:
  s_mul_i32 s41, s53, 288
  s_mul_i32 s55, s30, 3072
  s_mov_b32 s35, s33
  s_mul_i32 s46, s35, 0x80
  s_add_u32 s46, s46, s40
  s_add_u32 s35, s35, 1
  s_cmp_ge_u32 s35, 9
  s_cselect_b32 s35, 0, s35
  s_mul_i32 s47, s35, 0x80
  s_add_u32 s47, s47, s40
  s_mov_b32 s35, s33
  s_mul_i32 s63, s35, 0x36000
  s_add_u32 s63, s63, s41
  v_mov_b32 v39, 0x7ff00000
  v_add_u32 v8, 0, v1
  v_mul_u32_u24 v41, 1490, v8
  v_lshrrev_b32 v41, 16, v41
  v_mul_u32_u24 v42, 44, v41
  v_sub_u32 v42, v8, v42
  v_mul_u32_u24 v43, 57, v42
  v_lshrrev_b32 v43, 10, v43
  v_mul_u32_u24 v34, 864, v43
  v_lshl_add_u32 v34, v42, 4, v34
  v_add_u32 v34, 1152, v34
  v_mul_u32_u24 v36, 144, v42
  v_subrev_u32 v36, 5056, v36
  v_cmp_gt_u32 vcc, 36, v42
  s_nop 1
  v_cndmask_b32 v34, v36, v34, vcc
  v_mul_u32_u24 v35, 3456, v41
  s_mul_i32 s34, s30, 13824
  s_add_u32 s34, s34, 0x1000
  v_add3_u32 v34, v34, v35, s34
  v_cmp_gt_u32 vcc, 38, v42
  s_nop 1
  v_cndmask_b32 v34, v39, v34, vcc
  v_cmp_gt_u32 vcc, 4, v41
  s_nop 1
  v_cndmask_b32 v16, v39, v34, vcc
  v_add_u32 v8, 64, v1
  v_mul_u32_u24 v41, 1490, v8
  v_lshrrev_b32 v41, 16, v41
  v_mul_u32_u24 v42, 44, v41
  v_sub_u32 v42, v8, v42
  v_mul_u32_u24 v43, 57, v42
  v_lshrrev_b32 v43, 10, v43
  v_mul_u32_u24 v34, 864, v43
  v_lshl_add_u32 v34, v42, 4, v34
  v_add_u32 v34, 1152, v34
  v_mul_u32_u24 v36, 144, v42
  v_subrev_u32 v36, 5056, v36
  v_cmp_gt_u32 vcc, 36, v42
  s_nop 1
  v_cndmask_b32 v34, v36, v34, vcc
  v_mul_u32_u24 v35, 3456, v41
  s_mul_i32 s34, s30, 13824
  s_add_u32 s34, s34, 0xc00
  v_add3_u32 v34, v34, v35, s34
  v_cmp_gt_u32 vcc, 38, v42
  s_nop 1
  v_cndmask_b32 v34, v39, v34, vcc
  v_cmp_gt_u32 vcc, 4, v41
  s_nop 1
  v_cndmask_b32 v17, v39, v34, vcc
  v_add_u32 v8, 128, v1
  v_mul_u32_u24 v41, 1490, v8
  v_lshrrev_b32 v41, 16, v41
  v_mul_u32_u24 v42, 44, v41
  v_sub_u32 v42, v8, v42
  v_mul_u32_u24 v43, 57, v42
  v_lshrrev_b32 v43, 10, v43
  v_mul_u32_u24 v34, 864, v43
  v_lshl_add_u32 v34, v42, 4, v34
  v_add_u32 v34, 1152, v34
  v_mul_u32_u24 v36, 144, v42
  v_subrev_u32 v36, 5056, v36
  v_cmp_gt_u32 vcc, 36, v42
  s_nop 1
  v_cndmask_b32 v34, v36, v34, vcc
  v_mul_u32_u24 v35, 3456, v41
  s_mul_i32 s34, s30, 13824
  s_add_u32 s34, s34, 0x800
  v_add3_u32 v34, v34, v35, s34
  v_cmp_gt_u32 vcc, 38, v42
  s_nop 1
  v_cndmask_b32 v34, v39, v34, vcc
  v_cmp_gt_u32 vcc, 4, v41
  s_nop 1
  v_cndmask_b32 v18, v39, v34, vcc
  s_waitcnt lgkmcnt(0)
  s_mov_b32 s4, s64
  s_mov_b32 s5, s65
  s_mov_b32 s6, 0x240000
  s_mov_b32 s7, 0x00020000
  s_mov_b32 s8, s66
  s_mov_b32 s9, s67
  s_mov_b32 s10, 0x1e7000
  s_mov_b32 s11, 0x00020000
  s_sub_u32 s8, s8, 4096
  s_subb_u32 s9, s9, 0
  s_add_u32 s44, s63, 0x0
  s_add_u32 m0, s55, 0x2000
  s_nop 0
  buffer_load_dwordx4 v16, s[8:11], s44 offen lds
  buffer_load_dwordx4 v17, s[8:11], s44 offen offset:1024 lds
  buffer_load_dwordx4 v18, s[8:11], s44 offen offset:2048 lds
  s_add_u32 s45, s46, 0x0
  s_add_u32 m0, s3, 0x1c000
  s_nop 0
  buffer_load_dwordx4 v22, s[4:7], s45 offen lds
  buffer_load_dwordx4 v23, s[4:7], s45 offen offset:1024 lds
  buffer_load_dwordx4 v24, s[4:7], s45 offen offset:2048 lds
  buffer_load_dwordx4 v25, s[4:7], s45 offen offset:3072 lds
  s_add_u32 s44, s63, 0xd800
  s_add_u32 m0, s55, 0x5000
  s_nop 0
  buffer_load_dwordx4 v16, s[8:11], s44 offen lds
  buffer_load_dwordx4 v17, s[8:11], s44 offen offset:1024 lds
  buffer_load_dwordx4 v18, s[8:11], s44 offen offset:2048 lds
  s_mov_b32 s12, s68
  s_mov_b32 s13, s69
  s_mov_b32 s14, 0xa2000
  s_mov_b32 s15, 0x00020000
  s_mov_b32 s16, s82
  s_mov_b32 s17, s83
  s_mov_b32 s18, 0x4000000
  s_mov_b32 s19, 0x00020000
  s_mov_b32 s24, s80
  s_mov_b32 s25, s81
  s_mov_b32 s26, 0x100
  s_mov_b32 s27, 0x00020000
  s_mov_b32 s35, s33
  s_mul_i32 s46, s35, 0x80
  s_add_u32 s46, s46, s40
  s_add_u32 s35, s35, 1
  s_cmp_ge_u32 s35, 9
  s_cselect_b32 s35, 0, s35
  s_mul_i32 s47, s35, 0x80
  s_add_u32 s47, s47, s40
  s_add_u32 s35, s35, 1
  s_cmp_ge_u32 s35, 9
  s_cselect_b32 s35, 0, s35
  s_mul_i32 s20, s35, 0x80
  s_add_u32 s20, s20, s40
  s_add_u32 s35, s35, 1
  s_cmp_ge_u32 s35, 9
  s_cselect_b32 s35, 0, s35
  s_mul_i32 s21, s35, 0x80
  s_add_u32 s21, s21, s40
  s_add_u32 s35, s35, 1
  s_cmp_ge_u32 s35, 9
  s_cselect_b32 s35, 0, s35
  s_mul_i32 s22, s35, 0x80
  s_add_u32 s22, s22, s40
  s_add_u32 s35, s35, 1
  s_cmp_ge_u32 s35, 9
  s_cselect_b32 s35, 0, s35
  s_mul_i32 s23, s35, 0x80
  s_add_u32 s23, s23, s40
  s_add_u32 s35, s35, 1
  s_cmp_ge_u32 s35, 9
  s_cselect_b32 s35, 0, s35
  s_mul_i32 s60, s35, 0x80
  s_add_u32 s60, s60, s40
  s_add_u32 s35, s35, 1
  s_cmp_ge_u32 s35, 9
  s_cselect_b32 s35, 0, s35
  s_mul_i32 s61, s35, 0x80
  s_add_u32 s61, s61, s40
  s_add_u32 s35, s35, 1
  s_cmp_ge_u32 s35, 9
  s_cselect_b32 s35, 0, s35
  s_mul_i32 s62, s35, 0x80
  s_add_u32 s62, s62, s40
  s_mov_b32 s35, s33
  s_mul_i32 s63, s35, 0x36000
  s_add_u32 s63, s63, s41
  s_add_u32 s35, s35, 1
  s_cmp_ge_u32 s35, 9
  s_cselect_b32 s35, 0, s35
  s_mul_i32 s29, s35, 0x36000
  s_add_u32 s29, s29, s41
  s_add_u32 s35, s35, 1
  s_cmp_ge_u32 s35, 9
  s_cselect_b32 s35, 0, s35
  s_mul_i32 s70, s35, 0x36000
  s_add_u32 s70, s70, s41
  s_add_u32 s35, s35, 1
  s_cmp_ge_u32 s35, 9
  s_cselect_b32 s35, 0, s35
  s_mul_i32 s71, s35, 0x36000
  s_add_u32 s71, s71, s41
  s_add_u32 s35, s35, 1
  s_cmp_ge_u32 s35, 9
  s_cselect_b32 s35, 0, s35
  s_mul_i32 s72, s35, 0x36000
  s_add_u32 s72, s72, s41
  s_add_u32 s35, s35, 1
  s_cmp_ge_u32 s35, 9
  s_cselect_b32 s35, 0, s35
  s_mul_i32 s73, s35, 0x36000
  s_add_u32 s73, s73, s41
  s_add_u32 s35, s35, 1
  s_cmp_ge_u32 s35, 9
  s_cselect_b32 s35, 0, s35
  s_mul_i32 s74, s35, 0x36000
  s_add_u32 s74, s74, s41
  s_add_u32 s35, s35, 1
  s_cmp_ge_u32 s35, 9
  s_cselect_b32 s35, 0, s35
  s_mul_i32 s75, s35, 0x36000
  s_add_u32 s75, s75, s41
  s_add_u32 s35, s35, 1
  s_cmp_ge_u32 s35, 9
  s_cselect_b32 s35, 0, s35
  s_mul_i32 s76, s35, 0x36000
  s_add_u32 s76, s76, s41
  s_getpc_b64 s[82:83]
L_pc1:
  s_sub_u32 s82, s82, L_pc1-recurrent_scan__linear_attn_block__dense_activation_gelu__prompt_kernel
  s_subb_u32 s83, s83, 0
  s_lshr_b32 s34, s2, 3
  s_lshl_b32 s34, s34, 2
  s_add_u32 s34, s34, s30
  s_mul_i32 s34, s34, 7
  v_min_u32 v8, 6, v1
  v_add_u32 v8, s34, v8
  v_lshlrev_b32 v8, 7, v8
  v_min_u32 v8, L_codeend-recurrent_scan__linear_attn_block__dense_activation_gelu__prompt_kernel-4, v8
  global_load_dword v40, v8, s[82:83]
  s_add_u32 s45, s63, 0x1b000
  s_add_u32 m0, s55, 0x8000
  s_nop 0
  buffer_load_dwordx4 v16, s[8:11], s45 offen lds
  buffer_load_dwordx4 v17, s[8:11], s45 offen offset:1024 lds
  buffer_load_dwordx4 v18, s[8:11], s45 offen offset:2048 lds
  s_add_u32 s44, s63, 0x28800
  s_add_u32 m0, s55, 0xb000
  s_nop 0
  buffer_load_dwordx4 v16, s[8:11], s44 offen lds
  buffer_load_dwordx4 v17, s[8:11], s44 offen offset:1024 lds
  buffer_load_dwordx4 v18, s[8:11], s44 offen offset:2048 lds
  s_mov_b32 s50, 0x3f803f80
  s_mov_b32 s51, 0xffff0000
  v_and_b32 v8, 31, v1
  v_lshlrev_b32 v8, 7, v8
  s_lshl_b32 s34, s31, 13
  s_add_u32 s34, s34, 0x18000
  v_add_u32 v8, s34, v8
  v_bfe_u32 v41, v1, 1, 3
  v_lshrrev_b32 v42, 5, v1
  v_xor_b32 v41, v41, v42
  s_lshl_b32 s34, s32, 12
  v_xor_b32 v42, 0, v41
  v_lshl_add_u32 v9, v42, 4, v8
  v_add_u32 v26, s34, v9
  v_xor_b32 v42, 2, v41
  v_lshl_add_u32 v10, v42, 4, v8
  v_add_u32 v27, s34, v10
  v_xor_b32 v42, 4, v41
  v_lshl_add_u32 v11, v42, 4, v8
  v_add_u32 v28, s34, v11
  v_xor_b32 v42, 6, v41
  v_lshl_add_u32 v12, v42, 4, v8
  v_add_u32 v29, s34, v12
  v_bfe_u32 v37, v1, 2, 2
  v_mul_u32_u24 v8, 704, v37
  v_lshrrev_b32 v38, 5, v1
  v_mul_u32_u24 v41, 6144, v38
  v_add_u32 v8, v8, v41
  v_and_b32 v41, 3, v1
  v_bfe_u32 v42, v1, 4, 1
  v_lshl_add_u32 v43, v42, 2, v41
  s_mul_i32 s34, s32, 144
  v_lshl_add_u32 v2, v43, 3, v8
  v_add_u32 v2, s34, v2
  v_and_b32 v34, 1, v1
  v_bfe_u32 v35, v1, 1, 1
  v_mul_u32_u24 v36, 288, v34
  v_mul_u32_u24 v35, 72, v35
  s_add_u32 s34, s34, 64
  v_add3_u32 v36, v36, v35, s34
  s_lshl_b32 s34, s32, 4
  s_add_u32 s34, s34, 576
  v_lshl_add_u32 v34, v34, 3, s34
  v_cmp_eq_u32 s[58:59], 1, v42
  s_nop 1
  v_cndmask_b32 v36, v36, v34, s[58:59]
  v_add_u32 v4, v8, v36
  v_add_u32 v3, 0x10000, v2
  v_add_u32 v5, 0x10000, v4
  v_lshl_add_u32 v8, v38, 3, v37
  v_lshlrev_b32 v8, 8, v8
  v_lshl_add_u32 v8, v43, 3, v8
  s_lshl_b32 s34, s32, 1
  v_xor_b32 v41, s34, v37
  v_lshl_add_u32 v6, v41, 6, v8
  v_add_u32 v6, 0xe000, v6
  v_xor_b32 v7, 64, v6
  s_mov_b32 vcc_lo, 0x00020001
  s_mov_b32 vcc_hi, 0x00020001
  v_mov_b32 v8, 0x3f803f80
  v_cndmask_b32 v224, 0, v8, vcc
  v_cndmask_b32 v225, 0, v8, vcc
  v_cndmask_b32 v226, 0, v8, vcc
  v_cndmask_b32 v227, 0, v8, vcc
  v_accvgpr_write_b32 a156, v224
  v_accvgpr_write_b32 a157, v225
  v_accvgpr_write_b32 a158, v226
  v_accvgpr_write_b32 a159, v227
  s_waitcnt vmcnt(7)
  s_barrier
  ds_read_b128 a[0:3], v9 offset:16384
  ds_read_b128 a[4:7], v9 offset:20480
  ds_read_b64_tr_b16 v[44:45], v2 offset:8480
  ds_read_b64_tr_b16 v[46:47], v2 offset:11552
  ds_read_b64_tr_b16 v[48:49], v4 offset:8192
  ds_read_b64_tr_b16 v[50:51], v4 offset:11264
  ds_read_b64_tr_b16 v[52:53], v2 offset:8192
  ds_read_b64_tr_b16 v[54:55], v2 offset:11264
  s_waitcnt lgkmcnt(4)
  v_mfma_f32_16x16x32_bf16 a[132:135], a[156:159], v[44:47], 0
  s_add_u32 s45, s29, 0x0
  s_add_u32 m0, s55, 0xe000
  ds_read_b128 v[224:227], v26 offset:16384
  v_mfma_f32_32x32x16_bf16 v[96:111], a[0:3], v[44:47], 0
  ds_read_b128 v[228:231], v27 offset:16384
  ds_read_b64_tr_b16 v[56:57], v2 offset:8264
  buffer_load_dwordx4 v16, s[8:11], s45 offen lds
  v_mfma_f32_32x32x16_bf16 v[112:127], a[4:7], v[44:47], 0
  s_waitcnt lgkmcnt(5)
  ds_read_b128 v[232:235], v28 offset:16384
  ds_read_b64_tr_b16 v[58:59], v2 offset:11336
  buffer_load_dwordx4 v17, s[8:11], s45 offen offset:1024 lds
  v_lshrrev_b32 v8, 4, v1
  v_bfe_u32 v41, v1, 2, 2
  v_mfma_f32_16x16x32_bf16 a[144:147], a[156:159], v[48:51], 0
  ds_read_b128 v[236:239], v29 offset:16384
  buffer_load_dwordx4 v18, s[8:11], s45 offen offset:2048 lds
  v_mfma_f32_32x32x16_bf16 v[192:207], a[0:3], v[48:51], 0
  s_add_u32 s44, s47, 0x0
  ds_read_b64_tr_b16 v[60:61], v2 offset:8552
  v_xor_b32 v41, v41, v8
  v_lshrrev_b32 v42, 1, v41
  v_mul_u32_u24 v42, 144, v42
  v_and_b32 v41, 1, v41
  v_lshl_add_u32 v42, v41, 6, v42
  v_mfma_f32_32x32x16_bf16 v[208:223], a[4:7], v[48:51], 0
  s_waitcnt lgkmcnt(7)
  ds_read_b64_tr_b16 v[62:63], v2 offset:11624
  v_and_b32 v41, 3, v1
  v_lshl_add_u32 v42, v41, 4, v42
  v_mul_u32_u24 v8, 3456, v8
  s_mul_i32 s34, s30, 27648
  s_add_u32 s34, s34, 4096
  v_mfma_f32_16x16x32_bf16 a[128:131], a[156:159], v[52:55], 0
  s_add_u32 m0, s3, 0x20000
  v_add3_u32 v19, v8, v42, s34
  v_add_u32 v15, 12800, v19
  v_mfma_f32_32x32x16_bf16 v[64:79], a[0:3], v[52:55], 0
  ds_read_b64_tr_b16 v[44:45], v2 offset:20768
  buffer_load_dwordx4 v22, s[4:7], s44 offen lds
  s_lshl_b32 s54, s53, 4
  s_mul_i32 s56, s53, 98304
  s_add_u32 s56, s56, 0x2800000
  v_mfma_f32_32x32x16_bf16 v[80:95], a[4:7], v[52:55], 0
  s_waitcnt lgkmcnt(4)
  ds_read_b64_tr_b16 v[46:47], v2 offset:23840
  buffer_load_dwordx4 v23, s[4:7], s44 offen offset:1024 lds
  s_mul_i32 s42, s53, 165888
  v_mov_b32 v20, 0
  v_dot2_f32_bf16 v240, v224, s50, 0
  v_dot2_f32_bf16 v244, v224, v224, 0
  v_dot2_f32_bf16 v241, v225, s50, 0
  v_dot2_f32_bf16 v245, v225, v225, 0
  v_dot2_f32_bf16 v242, v226, s50, 0
  v_dot2_f32_bf16 v246, v226, v226, 0
  v_dot2_f32_bf16 v243, v227, s50, 0
  v_dot2_f32_bf16 v247, v227, v227, 0
  v_dot2_f32_bf16 v240, v228, s50, v240
  v_dot2_f32_bf16 v244, v228, v228, v244
  v_dot2_f32_bf16 v241, v229, s50, v241
  v_dot2_f32_bf16 v245, v229, v229, v245
  v_dot2_f32_bf16 v242, v230, s50, v242
  v_dot2_f32_bf16 v246, v230, v230, v246
  v_dot2_f32_bf16 v243, v231, s50, v243
  v_dot2_f32_bf16 v247, v231, v231, v247
  v_dot2_f32_bf16 v240, v232, s50, v240
  v_dot2_f32_bf16 v244, v232, v232, v244
  v_dot2_f32_bf16 v241, v233, s50, v241
  v_dot2_f32_bf16 v245, v233, v233, v245
  v_dot2_f32_bf16 v242, v234, s50, v242
  v_dot2_f32_bf16 v246, v234, v234, v246
  v_dot2_f32_bf16 v243, v235, s50, v243
  v_dot2_f32_bf16 v247, v235, v235, v247
  s_waitcnt lgkmcnt(4)
  v_dot2_f32_bf16 v240, v236, s50, v240
  v_dot2_f32_bf16 v244, v236, v236, v244
  v_dot2_f32_bf16 v241, v237, s50, v241
  v_dot2_f32_bf16 v245, v237, v237, v245
  v_dot2_f32_bf16 v242, v238, s50, v242
  v_dot2_f32_bf16 v246, v238, v238, v246
  v_dot2_f32_bf16 v243, v239, s50, v243
  v_dot2_f32_bf16 v247, v239, v239, v247
  v_mfma_f32_16x16x32_bf16 a[136:139], a[156:159], v[56:59], 0
  buffer_load_dwordx4 v24, s[4:7], s44 offen offset:2048 lds
  v_mfma_f32_32x32x16_bf16 v[128:143], a[0:3], v[56:59], 0
  ds_read_b128 a[8:11], v10 offset:16384
  ds_read_b64_tr_b16 v[48:49], v4 offset:20480
  buffer_load_dwordx4 v25, s[4:7], s44 offen offset:3072 lds
  s_cmp_ge_u32 s28, 9
  s_cselect_b32 s34, 9, 0
  v_mfma_f32_32x32x16_bf16 v[144:159], a[4:7], v[56:59], 0
  s_waitcnt lgkmcnt(4)
  s_add_u32 s45, s29, 0xd800
  s_add_u32 m0, s55, 0x11000
  ds_read_b128 a[12:15], v10 offset:20480
  ds_read_b64_tr_b16 v[50:51], v4 offset:23552
  s_sub_u32 s78, s28, s34
  s_lshl_b32 s34, s78, 7
  v_mfma_f32_16x16x32_bf16 a[140:143], a[156:159], v[60:63], 0
  buffer_load_dwordx4 v16, s[8:11], s45 offen lds
  v_mfma_f32_32x32x16_bf16 v[160:175], a[0:3], v[60:63], 0
  ds_read_b64_tr_b16 v[52:53], v2 offset:20480
  buffer_load_dwordx4 v17, s[8:11], s45 offen offset:1024 lds
  s_add_u32 s42, s42, s34
  s_mov_b32 s36, 0x2900000
  v_mfma_f32_32x32x16_bf16 v[176:191], a[4:7], v[60:63], 0
  s_waitcnt lgkmcnt(5)
  ds_read_b64_tr_b16 v[54:55], v2 offset:23552
  buffer_load_dwordx4 v18, s[8:11], s45 offen offset:2048 lds
  buffer_load_dword v40, v20, s[16:19], s36 offen
  s_add_u32 s36, s53, 12
  v_mfma_f32_16x16x32_bf16 a[132:135], a[156:159], v[44:47], a[132:135]
  s_waitcnt lgkmcnt(5)
  s_add_u32 s44, s29, 0x1b000
  s_lshl_b32 s48, s28, 7
  s_add_u32 s48, s48, 0x2c00000
  v_mfma_f32_32x32x16_bf16 v[96:111], a[8:11], v[44:47], v[96:111]
  s_waitcnt lgkmcnt(3)
  ds_read_b64_tr_b16 v[56:57], v2 offset:20552
  s_lshl_b32 s36, s36, 2
  v_mov_b32 v21, s36
  v_mov_b32 v8, 0x7ff00000
  v_cmp_eq_u32 vcc, 0, v0
  s_nop 1
  v_cndmask_b32 v21, v8, v21, vcc
  v_mfma_f32_32x32x16_bf16 v[112:127], a[12:15], v[44:47], v[112:127]
  s_waitcnt lgkmcnt(3)
  ds_read_b64_tr_b16 v[58:59], v2 offset:23624
  v_mov_b32 v8, 0
  buffer_store_dword v8, v21, s[16:19], s48 offen sc1
  v_bfe_u32 v42, v0, 3, 3
  v_mfma_f32_16x16x32_bf16 a[144:147], a[156:159], v[48:51], a[144:147]
  v_lshrrev_b32 v41, 6, v0
  v_lshl_add_u32 v42, v41, 4, v42
  v_mfma_f32_32x32x16_bf16 v[192:207], a[8:11], v[48:51], v[192:207]
  ds_read_b64_tr_b16 v[60:61], v2 offset:20840
  v_mul_u32_u24 v42, 1152, v42
  v_bfe_u32 v41, v0, 4, 1
  v_lshlrev_b32 v41, 2, v41
  v_and_b32 v8, 7, v0
  v_xor_b32 v8, v8, v41
  v_mfma_f32_32x32x16_bf16 v[208:223], a[12:15], v[48:51], v[208:223]
  s_waitcnt lgkmcnt(3)
  ds_read_b64_tr_b16 v[62:63], v2 offset:23912
  v_lshl_add_u32 v248, v8, 4, v42
  v_add_u32 v249, 0x2000, v248
  v_cmp_gt_u32 vcc, 64, v0
  s_nop 1
  v_cndmask_b32 v250, v39, v248, vcc
  v_cndmask_b32 v251, v39, v249, vcc
  v_mfma_f32_16x16x32_bf16 a[128:131], a[156:159], v[52:55], a[128:131]
  s_waitcnt vmcnt(12)
  s_barrier
  s_add_u32 m0, s55, 0x2000
  v_mfma_f32_32x32x16_bf16 v[64:79], a[8:11], v[52:55], v[64:79]
  ds_read_b64_tr_b16 v[44:45], v2 offset:33056
  buffer_load_dwordx4 v16, s[8:11], s44 offen lds
  v_and_b32 v42, 1, v1
  v_lshlrev_b32 v34, 4, v42
  v_bfe_u32 v42, v1, 1, 1
  v_mfma_f32_32x32x16_bf16 v[80:95], a[12:15], v[52:55], v[80:95]
  s_waitcnt lgkmcnt(3)
  ds_read_b64_tr_b16 v[46:47], v2 offset:36128
  buffer_load_dwordx4 v17, s[8:11], s44 offen offset:1024 lds
  v_lshl_add_u32 v34, v42, 3, v34
  s_lshl_b32 s34, s32, 5
  s_add_u32 s34, s34, 0x16000
  v_mfma_f32_16x16x32_bf16 a[136:139], a[156:159], v[56:59], a[136:139]
  buffer_load_dwordx4 v18, s[8:11], s44 offen offset:2048 lds
  v_mfma_f32_32x32x16_bf16 v[128:143], a[8:11], v[56:59], v[128:143]
  s_add_u32 s45, s29, 0x28800
  ds_read_b128 a[16:19], v11 offset:16384
  ds_read_b64_tr_b16 v[48:49], v4 offset:32768
  v_add_u32 v34, s34, v34
  v_lshrrev_b32 v8, 5, v1
  v_mul_u32_u24 v8, 18, v8
  v_bfe_u32 v41, v1, 4, 1
  v_mfma_f32_32x32x16_bf16 v[144:159], a[12:15], v[56:59], v[144:159]
  s_waitcnt lgkmcnt(4)
  ds_read_b128 a[20:23], v11 offset:20480
  ds_read_b64_tr_b16 v[50:51], v4 offset:35840
  v_lshl_add_u32 v8, v41, 2, v8
  v_bfe_u32 v42, v1, 2, 2
  v_add_u32 v8, v8, v42
  v_bfe_u32 v42, v8, 1, 1
  v_mfma_f32_16x16x32_bf16 a[140:143], a[156:159], v[60:63], a[140:143]
  v_xor_b32 v42, s31, v42
  v_lshl_add_u32 v252, v42, 6, v34
  v_mfma_f32_32x32x16_bf16 v[160:175], a[8:11], v[60:63], v[160:175]
  ds_read_b64_tr_b16 v[52:53], v2 offset:32768
  v_lshl_add_u32 v252, v8, 7, v252
  v_mul_u32_u24 v8, 72, v41
  v_bfe_u32 v42, v1, 3, 1
  v_mul_u32_u24 v42, 18, v42
  v_add3_u32 v8, v8, v42, 16
  v_mfma_f32_32x32x16_bf16 v[176:191], a[12:15], v[60:63], v[176:191]
  s_waitcnt lgkmcnt(5)
  ds_read_b64_tr_b16 v[54:55], v2 offset:35840
  v_bfe_u32 v42, v1, 2, 1
  v_add_u32 v8, v8, v42
  v_bfe_u32 v42, v8, 1, 1
  v_xor_b32 v42, s31, v42
  v_lshl_add_u32 v255, v42, 6, v34
  v_mfma_f32_16x16x32_bf16 a[132:135], a[156:159], v[44:47], a[132:135]
  s_waitcnt lgkmcnt(5)
  v_lshl_add_u32 v255, v8, 7, v255
  v_cmp_gt_u32 vcc, 32, v1
  v_mfma_f32_32x32x16_bf16 v[96:111], a[16:19], v[44:47], v[96:111]
  s_waitcnt lgkmcnt(3)
  ds_read_b64_tr_b16 v[56:57], v2 offset:32840
  v_lshlrev_b32 v253, 4, v1
  v_cndmask_b32 v254, v39, v253, vcc
  s_lshl_b32 s34, s78, 2
  s_add_u32 s34, s34, s30
  s_mul_i32 s34, s34, 18432
  v_mfma_f32_32x32x16_bf16 v[112:127], a[20:23], v[44:47], v[112:127]
  s_waitcnt lgkmcnt(3)
  ds_read_b64_tr_b16 v[58:59], v2 offset:35912
  s_mul_i32 s36, s53, 4608
  s_add_u32 s34, s34, s36
  s_add_u32 s64, s34, 0x2400000
  s_add_u32 s65, s64, 4096
  s_mul_i32 s34, s30, 896
  v_mfma_f32_16x16x32_bf16 a[144:147], a[156:159], v[48:51], a[144:147]
  s_add_u32 s34, s34, 4608
  v_lshl_add_u32 v8, v1, 2, s34
  v_mfma_f32_32x32x16_bf16 v[192:207], a[16:19], v[48:51], v[192:207]
  ds_read_b64_tr_b16 v[60:61], v2 offset:33128
  v_cmp_gt_u32 vcc, 16, v1
  s_nop 1
  v_cndmask_b32 v13, v39, v8, vcc
  v_cmp_gt_u32 vcc, 32, v1
  s_nop 1
  v_cndmask_b32 v14, v39, v8, vcc
  v_mfma_f32_32x32x16_bf16 v[208:223], a[20:23], v[48:51], v[208:223]
  s_waitcnt lgkmcnt(3)
  ds_read_b64_tr_b16 v[62:63], v2 offset:36200
  v_mfma_f32_16x16x32_bf16 a[128:131], a[156:159], v[52:55], a[128:131]
  v_mfma_f32_32x32x16_bf16 v[64:79], a[16:19], v[52:55], v[64:79]
  ds_read_b64_tr_b16 v[44:45], v2 offset:45344
  v_mfma_f32_32x32x16_bf16 v[80:95], a[20:23], v[52:55], v[80:95]
  s_waitcnt lgkmcnt(3)
  ds_read_b64_tr_b16 v[46:47], v2 offset:48416
  v_mfma_f32_16x16x32_bf16 a[136:139], a[156:159], v[56:59], a[136:139]
  v_mfma_f32_32x32x16_bf16 v[128:143], a[16:19], v[56:59], v[128:143]
  ds_read_b128 a[24:27], v12 offset:16384
  ds_read_b64_tr_b16 v[48:49], v4 offset:45056
  v_mfma_f32_32x32x16_bf16 v[144:159], a[20:23], v[56:59], v[144:159]
  s_waitcnt lgkmcnt(4)
  ds_read_b128 a[28:31], v12 offset:20480
  ds_read_b64_tr_b16 v[50:51], v4 offset:48128
  v_mfma_f32_16x16x32_bf16 a[140:143], a[156:159], v[60:63], a[140:143]
  v_mfma_f32_32x32x16_bf16 v[160:175], a[16:19], v[60:63], v[160:175]
  ds_read_b64_tr_b16 v[52:53], v2 offset:45056
  v_mfma_f32_32x32x16_bf16 v[176:191], a[20:23], v[60:63], v[176:191]
  s_waitcnt lgkmcnt(5)
  ds_read_b64_tr_b16 v[54:55], v2 offset:48128
  v_mfma_f32_16x16x32_bf16 a[132:135], a[156:159], v[44:47], a[132:135]
  s_waitcnt lgkmcnt(5)
  v_mfma_f32_32x32x16_bf16 v[96:111], a[24:27], v[44:47], v[96:111]
  s_waitcnt lgkmcnt(3)
  ds_read_b64_tr_b16 v[56:57], v2 offset:45128
  v_mfma_f32_32x32x16_bf16 v[112:127], a[28:31], v[44:47], v[112:127]
  s_waitcnt lgkmcnt(3)
  ds_read_b64_tr_b16 v[58:59], v2 offset:48200
  v_mfma_f32_16x16x32_bf16 a[144:147], a[156:159], v[48:51], a[144:147]
  v_mfma_f32_32x32x16_bf16 v[192:207], a[24:27], v[48:51], v[192:207]
  ds_read_b64_tr_b16 v[60:61], v2 offset:45416
  v_mfma_f32_32x32x16_bf16 v[208:223], a[28:31], v[48:51], v[208:223]
  s_waitcnt lgkmcnt(3)
  ds_read_b64_tr_b16 v[62:63], v2 offset:48488
  v_mfma_f32_16x16x32_bf16 a[128:131], a[156:159], v[52:55], a[128:131]
  s_waitcnt vmcnt(5)
  s_barrier
  s_add_u32 m0, s55, 0x5000
  v_mfma_f32_32x32x16_bf16 v[64:79], a[24:27], v[52:55], v[64:79]
  ds_read_b64_tr_b16 v[44:45], v2 offset:57632
  buffer_load_dwordx4 v16, s[8:11], s45 offen lds
  v_mfma_f32_32x32x16_bf16 v[80:95], a[28:31], v[52:55], v[80:95]
  s_waitcnt lgkmcnt(3)
  ds_read_b64_tr_b16 v[46:47], v2 offset:60704
  buffer_load_dwordx4 v17, s[8:11], s45 offen offset:1024 lds
  v_mfma_f32_16x16x32_bf16 a[136:139], a[156:159], v[56:59], a[136:139]
  buffer_load_dwordx4 v18, s[8:11], s45 offen offset:2048 lds
  v_mfma_f32_32x32x16_bf16 v[128:143], a[24:27], v[56:59], v[128:143]
  s_add_u32 s44, s70, 0x0
  s_add_u32 m0, s55, 0x8000
  ds_read_b128 a[32:35], v9 offset:32768
  ds_read_b64_tr_b16 v[48:49], v4 offset:57344
  v_mfma_f32_32x32x16_bf16 v[144:159], a[28:31], v[56:59], v[144:159]
  s_waitcnt lgkmcnt(4)
  ds_read_b128 a[36:39], v9 offset:36864
  ds_read_b64_tr_b16 v[50:51], v4 offset:60416
  buffer_load_dwordx4 v16, s[8:11], s44 offen lds
  v_mfma_f32_16x16x32_bf16 a[140:143], a[156:159], v[60:63], a[140:143]
  buffer_load_dwordx4 v17, s[8:11], s44 offen offset:1024 lds
  v_mfma_f32_32x32x16_bf16 v[160:175], a[24:27], v[60:63], v[160:175]
  ds_read_b64_tr_b16 v[52:53], v2 offset:57344
  buffer_load_dwordx4 v18, s[8:11], s44 offen offset:2048 lds
  v_mfma_f32_32x32x16_bf16 v[176:191], a[28:31], v[60:63], v[176:191]
  s_waitcnt lgkmcnt(5)
  s_add_u32 s45, s20, 0x0
  s_add_u32 m0, s3, 0x24000
  ds_read_b64_tr_b16 v[54:55], v2 offset:60416
  v_mfma_f32_16x16x32_bf16 a[132:135], a[156:159], v[44:47], a[132:135]
  s_waitcnt lgkmcnt(5)
  ds_read_b128 v[224:227], v26 offset:32768
  buffer_load_dwordx4 v22, s[4:7], s45 offen lds
  v_mfma_f32_32x32x16_bf16 v[96:111], a[32:35], v[44:47], v[96:111]
  s_waitcnt lgkmcnt(4)
  ds_read_b128 v[228:231], v27 offset:32768
  ds_read_b64_tr_b16 v[56:57], v2 offset:57416
  v_mfma_f32_32x32x16_bf16 v[112:127], a[36:39], v[44:47], v[112:127]
  s_waitcnt lgkmcnt(5)
  ds_read_b128 v[232:235], v28 offset:32768
  ds_read_b64_tr_b16 v[58:59], v2 offset:60488
  buffer_load_dwordx4 v23, s[4:7], s45 offen offset:1024 lds
  v_mfma_f32_16x16x32_bf16 a[144:147], a[156:159], v[48:51], a[144:147]
  ds_read_b128 v[236:239], v29 offset:32768
  v_mfma_f32_32x32x16_bf16 v[192:207], a[32:35], v[48:51], v[192:207]
  ds_read_b64_tr_b16 v[60:61], v2 offset:57704
  buffer_load_dwordx4 v24, s[4:7], s45 offen offset:2048 lds
  v_mfma_f32_32x32x16_bf16 v[208:223], a[36:39], v[48:51], v[208:223]
  s_waitcnt lgkmcnt(7)
  ds_read_b64_tr_b16 v[62:63], v2 offset:60776
  v_mfma_f32_16x16x32_bf16 a[128:131], a[156:159], v[52:55], a[128:131]
  buffer_load_dwordx4 v25, s[4:7], s45 offen offset:3072 lds
  v_mfma_f32_32x32x16_bf16 v[64:79], a[32:35], v[52:55], v[64:79]
  s_add_u32 s44, s70, 0xd800
  ds_read_b64_tr_b16 v[44:45], v3 offset:4384
  v_mfma_f32_32x32x16_bf16 v[80:95], a[36:39], v[52:55], v[80:95]
  s_waitcnt lgkmcnt(4)
  ds_read_b64_tr_b16 v[46:47], v3 offset:7456
  v_dot2_f32_bf16 v240, v224, s50, v240
  v_dot2_f32_bf16 v244, v224, v224, v244
  v_dot2_f32_bf16 v241, v225, s50, v241
  v_dot2_f32_bf16 v245, v225, v225, v245
  v_dot2_f32_bf16 v242, v226, s50, v242
  v_dot2_f32_bf16 v246, v226, v226, v246
  v_dot2_f32_bf16 v243, v227, s50, v243
  v_dot2_f32_bf16 v247, v227, v227, v247
  v_dot2_f32_bf16 v240, v228, s50, v240
  v_dot2_f32_bf16 v244, v228, v228, v244
  v_dot2_f32_bf16 v241, v229, s50, v241
  v_dot2_f32_bf16 v245, v229, v229, v245
  v_dot2_f32_bf16 v242, v230, s50, v242
  v_dot2_f32_bf16 v246, v230, v230, v246
  v_dot2_f32_bf16 v243, v231, s50, v243
  v_dot2_f32_bf16 v247, v231, v231, v247
  v_dot2_f32_bf16 v240, v232, s50, v240
  v_dot2_f32_bf16 v244, v232, v232, v244
  v_dot2_f32_bf16 v241, v233, s50, v241
  v_dot2_f32_bf16 v245, v233, v233, v245
  v_dot2_f32_bf16 v242, v234, s50, v242
  v_dot2_f32_bf16 v246, v234, v234, v246
  v_dot2_f32_bf16 v243, v235, s50, v243
  v_dot2_f32_bf16 v247, v235, v235, v247
  s_waitcnt lgkmcnt(4)
  v_dot2_f32_bf16 v240, v236, s50, v240
  v_dot2_f32_bf16 v244, v236, v236, v244
  v_dot2_f32_bf16 v241, v237, s50, v241
  v_dot2_f32_bf16 v245, v237, v237, v245
  v_dot2_f32_bf16 v242, v238, s50, v242
  v_dot2_f32_bf16 v246, v238, v238, v246
  v_dot2_f32_bf16 v243, v239, s50, v243
  v_dot2_f32_bf16 v247, v239, v239, v247
  v_mfma_f32_16x16x32_bf16 a[136:139], a[156:159], v[56:59], a[136:139]
  v_mfma_f32_32x32x16_bf16 v[128:143], a[32:35], v[56:59], v[128:143]
  ds_read_b128 a[40:43], v10 offset:32768
  ds_read_b64_tr_b16 v[48:49], v5 offset:4096
  v_mfma_f32_32x32x16_bf16 v[144:159], a[36:39], v[56:59], v[144:159]
  s_waitcnt lgkmcnt(4)
  ds_read_b128 a[44:47], v10 offset:36864
  ds_read_b64_tr_b16 v[50:51], v5 offset:7168
  v_mfma_f32_16x16x32_bf16 a[140:143], a[156:159], v[60:63], a[140:143]
  v_mfma_f32_32x32x16_bf16 v[160:175], a[32:35], v[60:63], v[160:175]
  ds_read_b64_tr_b16 v[52:53], v3 offset:4096
  v_mfma_f32_32x32x16_bf16 v[176:191], a[36:39], v[60:63], v[176:191]
  s_waitcnt lgkmcnt(5)
  ds_read_b64_tr_b16 v[54:55], v3 offset:7168
  v_mfma_f32_16x16x32_bf16 a[132:135], a[156:159], v[44:47], a[132:135]
  s_waitcnt lgkmcnt(5)
  v_mfma_f32_32x32x16_bf16 v[96:111], a[40:43], v[44:47], v[96:111]
  s_waitcnt lgkmcnt(3)
  ds_read_b64_tr_b16 v[56:57], v3 offset:4168
  v_mfma_f32_32x32x16_bf16 v[112:127], a[44:47], v[44:47], v[112:127]
  s_waitcnt lgkmcnt(3)
  ds_read_b64_tr_b16 v[58:59], v3 offset:7240
  v_mfma_f32_16x16x32_bf16 a[144:147], a[156:159], v[48:51], a[144:147]
  v_mfma_f32_32x32x16_bf16 v[192:207], a[40:43], v[48:51], v[192:207]
  ds_read_b64_tr_b16 v[60:61], v3 offset:4456
  v_mfma_f32_32x32x16_bf16 v[208:223], a[44:47], v[48:51], v[208:223]
  s_waitcnt lgkmcnt(3)
  ds_read_b64_tr_b16 v[62:63], v3 offset:7528
  v_mfma_f32_16x16x32_bf16 a[128:131], a[156:159], v[52:55], a[128:131]
  s_waitcnt vmcnt(7)
  s_barrier
  s_add_u32 m0, s55, 0xb000
  v_mfma_f32_32x32x16_bf16 v[64:79], a[40:43], v[52:55], v[64:79]
  ds_read_b64_tr_b16 v[44:45], v2 offset:8480
  buffer_load_dwordx4 v16, s[8:11], s44 offen lds
  v_mfma_f32_32x32x16_bf16 v[80:95], a[44:47], v[52:55], v[80:95]
  s_waitcnt lgkmcnt(3)
  ds_read_b64_tr_b16 v[46:47], v2 offset:11552
  v_mfma_f32_16x16x32_bf16 a[136:139], a[156:159], v[56:59], a[136:139]
  buffer_load_dwordx4 v17, s[8:11], s44 offen offset:1024 lds
  v_mfma_f32_32x32x16_bf16 v[128:143], a[40:43], v[56:59], v[128:143]
  ds_read_b128 a[48:51], v11 offset:32768
  ds_read_b64_tr_b16 v[48:49], v4 offset:8192
  v_mfma_f32_32x32x16_bf16 v[144:159], a[44:47], v[56:59], v[144:159]
  s_waitcnt lgkmcnt(4)
  ds_read_b128 a[52:55], v11 offset:36864
  ds_read_b64_tr_b16 v[50:51], v4 offset:11264
  buffer_load_dwordx4 v18, s[8:11], s44 offen offset:2048 lds
  v_mfma_f32_16x16x32_bf16 a[140:143], a[156:159], v[60:63], a[140:143]
  s_add_u32 s45, s70, 0x1b000
  s_add_u32 m0, s55, 0xe000
  v_mfma_f32_32x32x16_bf16 v[160:175], a[40:43], v[60:63], v[160:175]
  ds_read_b64_tr_b16 v[52:53], v2 offset:8192
  buffer_load_dwordx4 v16, s[8:11], s45 offen lds
  v_mfma_f32_32x32x16_bf16 v[176:191], a[44:47], v[60:63], v[176:191]
  s_waitcnt lgkmcnt(5)
  ds_read_b64_tr_b16 v[54:55], v2 offset:11264
  v_mfma_f32_16x16x32_bf16 a[132:135], a[156:159], v[44:47], a[132:135]
  s_waitcnt lgkmcnt(5)
  v_mfma_f32_32x32x16_bf16 v[96:111], a[48:51], v[44:47], v[96:111]
  s_waitcnt lgkmcnt(3)
  ds_read_b64_tr_b16 v[56:57], v2 offset:8264
  buffer_load_dwordx4 v17, s[8:11], s45 offen offset:1024 lds
  v_mfma_f32_32x32x16_bf16 v[112:127], a[52:55], v[44:47], v[112:127]
  s_waitcnt lgkmcnt(3)
  ds_read_b64_tr_b16 v[58:59], v2 offset:11336
  v_mfma_f32_16x16x32_bf16 a[144:147], a[156:159], v[48:51], a[144:147]
  v_mfma_f32_32x32x16_bf16 v[192:207], a[48:51], v[48:51], v[192:207]
  ds_read_b64_tr_b16 v[60:61], v2 offset:8552
  buffer_load_dwordx4 v18, s[8:11], s45 offen offset:2048 lds
  v_mfma_f32_32x32x16_bf16 v[208:223], a[52:55], v[48:51], v[208:223]
  s_waitcnt lgkmcnt(3)
  s_add_u32 s44, s70, 0x28800
  ds_read_b64_tr_b16 v[62:63], v2 offset:11624
  v_mfma_f32_16x16x32_bf16 a[128:131], a[156:159], v[52:55], a[128:131]
  v_mfma_f32_32x32x16_bf16 v[64:79], a[48:51], v[52:55], v[64:79]
  ds_read_b64_tr_b16 v[44:45], v2 offset:20768
  v_mfma_f32_32x32x16_bf16 v[80:95], a[52:55], v[52:55], v[80:95]
  s_waitcnt lgkmcnt(3)
  ds_read_b64_tr_b16 v[46:47], v2 offset:23840
  v_mfma_f32_16x16x32_bf16 a[136:139], a[156:159], v[56:59], a[136:139]
  v_mfma_f32_32x32x16_bf16 v[128:143], a[48:51], v[56:59], v[128:143]
  ds_read_b128 a[56:59], v12 offset:32768
  ds_read_b64_tr_b16 v[48:49], v4 offset:20480
  v_mfma_f32_32x32x16_bf16 v[144:159], a[52:55], v[56:59], v[144:159]
  s_waitcnt lgkmcnt(4)
  ds_read_b128 a[60:63], v12 offset:36864
  ds_read_b64_tr_b16 v[50:51], v4 offset:23552
  v_mfma_f32_16x16x32_bf16 a[140:143], a[156:159], v[60:63], a[140:143]
  v_mfma_f32_32x32x16_bf16 v[160:175], a[48:51], v[60:63], v[160:175]
  ds_read_b64_tr_b16 v[52:53], v2 offset:20480
  v_mfma_f32_32x32x16_bf16 v[176:191], a[52:55], v[60:63], v[176:191]
  s_waitcnt lgkmcnt(5)
  ds_read_b64_tr_b16 v[54:55], v2 offset:23552
  v_mfma_f32_16x16x32_bf16 a[132:135], a[156:159], v[44:47], a[132:135]
  s_waitcnt lgkmcnt(5)
  v_mfma_f32_32x32x16_bf16 v[96:111], a[56:59], v[44:47], v[96:111]
  s_waitcnt lgkmcnt(3)
  ds_read_b64_tr_b16 v[56:57], v2 offset:20552
  v_mfma_f32_32x32x16_bf16 v[112:127], a[60:63], v[44:47], v[112:127]
  s_waitcnt lgkmcnt(3)
  ds_read_b64_tr_b16 v[58:59], v2 offset:23624
  v_mfma_f32_16x16x32_bf16 a[144:147], a[156:159], v[48:51], a[144:147]
  v_mfma_f32_32x32x16_bf16 v[192:207], a[56:59], v[48:51], v[192:207]
  ds_read_b64_tr_b16 v[60:61], v2 offset:20840
  v_mfma_f32_32x32x16_bf16 v[208:223], a[60:63], v[48:51], v[208:223]
  s_waitcnt lgkmcnt(3)
  ds_read_b64_tr_b16 v[62:63], v2 offset:23912
  v_mfma_f32_16x16x32_bf16 a[128:131], a[156:159], v[52:55], a[128:131]
  s_waitcnt vmcnt(3)
  s_barrier
  v_mfma_f32_32x32x16_bf16 v[64:79], a[56:59], v[52:55], v[64:79]
  s_add_u32 m0, s55, 0x11000
  ds_read_b64_tr_b16 v[44:45], v2 offset:33056
  v_mfma_f32_32x32x16_bf16 v[80:95], a[60:63], v[52:55], v[80:95]
  s_waitcnt lgkmcnt(3)
  ds_read_b64_tr_b16 v[46:47], v2 offset:36128
  buffer_load_dwordx4 v16, s[8:11], s44 offen lds
  v_mfma_f32_16x16x32_bf16 a[136:139], a[156:159], v[56:59], a[136:139]
  v_mfma_f32_32x32x16_bf16 v[128:143], a[56:59], v[56:59], v[128:143]
  ds_read_b128 a[0:3], v9 offset:49152
  ds_read_b64_tr_b16 v[48:49], v4 offset:32768
  buffer_load_dwordx4 v17, s[8:11], s44 offen offset:1024 lds
  v_mfma_f32_32x32x16_bf16 v[144:159], a[60:63], v[56:59], v[144:159]
  s_waitcnt lgkmcnt(4)
  ds_read_b128 a[4:7], v9 offset:53248
  ds_read_b64_tr_b16 v[50:51], v4 offset:35840
  v_mfma_f32_16x16x32_bf16 a[140:143], a[156:159], v[60:63], a[140:143]
  v_mfma_f32_32x32x16_bf16 v[160:175], a[56:59], v[60:63], v[160:175]
  ds_read_b64_tr_b16 v[52:53], v2 offset:32768
  buffer_load_dwordx4 v18, s[8:11], s44 offen offset:2048 lds
  v_mfma_f32_32x32x16_bf16 v[176:191], a[60:63], v[60:63], v[176:191]
  s_waitcnt lgkmcnt(5)
  s_add_u32 s45, s71, 0x0
  s_add_u32 m0, s55, 0x2000
  ds_read_b64_tr_b16 v[54:55], v2 offset:35840
  v_mfma_f32_16x16x32_bf16 a[132:135], a[156:159], v[44:47], a[132:135]
  s_waitcnt lgkmcnt(5)
  ds_read_b128 v[224:227], v26 offset:49152
  v_mfma_f32_32x32x16_bf16 v[96:111], a[0:3], v[44:47], v[96:111]
  s_waitcnt lgkmcnt(4)
  ds_read_b128 v[228:231], v27 offset:49152
  ds_read_b64_tr_b16 v[56:57], v2 offset:32840
  buffer_load_dwordx4 v16, s[8:11], s45 offen lds
  v_mfma_f32_32x32x16_bf16 v[112:127], a[4:7], v[44:47], v[112:127]
  s_waitcnt lgkmcnt(5)
  ds_read_b128 v[232:235], v28 offset:49152
  ds_read_b64_tr_b16 v[58:59], v2 offset:35912
  v_mfma_f32_16x16x32_bf16 a[144:147], a[156:159], v[48:51], a[144:147]
  ds_read_b128 v[236:239], v29 offset:49152
  v_mfma_f32_32x32x16_bf16 v[192:207], a[0:3], v[48:51], v[192:207]
  ds_read_b64_tr_b16 v[60:61], v2 offset:33128
  buffer_load_dwordx4 v17, s[8:11], s45 offen offset:1024 lds
  v_mfma_f32_32x32x16_bf16 v[208:223], a[4:7], v[48:51], v[208:223]
  s_waitcnt lgkmcnt(7)
  ds_read_b64_tr_b16 v[62:63], v2 offset:36200
  v_mfma_f32_16x16x32_bf16 a[128:131], a[156:159], v[52:55], a[128:131]
  v_mfma_f32_32x32x16_bf16 v[64:79], a[0:3], v[52:55], v[64:79]
  ds_read_b64_tr_b16 v[44:45], v2 offset:45344
  buffer_load_dwordx4 v18, s[8:11], s45 offen offset:2048 lds
  v_mfma_f32_32x32x16_bf16 v[80:95], a[4:7], v[52:55], v[80:95]
  s_waitcnt lgkmcnt(4)
  s_add_u32 s44, s21, 0x0
  s_add_u32 m0, s3, 0x1c000
  ds_read_b64_tr_b16 v[46:47], v2 offset:48416
  v_dot2_f32_bf16 v240, v224, s50, v240
  v_dot2_f32_bf16 v244, v224, v224, v244
  v_dot2_f32_bf16 v241, v225, s50, v241
  v_dot2_f32_bf16 v245, v225, v225, v245
  v_dot2_f32_bf16 v242, v226, s50, v242
  v_dot2_f32_bf16 v246, v226, v226, v246
  v_dot2_f32_bf16 v243, v227, s50, v243
  v_dot2_f32_bf16 v247, v227, v227, v247
  v_dot2_f32_bf16 v240, v228, s50, v240
  v_dot2_f32_bf16 v244, v228, v228, v244
  v_dot2_f32_bf16 v241, v229, s50, v241
  v_dot2_f32_bf16 v245, v229, v229, v245
  v_dot2_f32_bf16 v242, v230, s50, v242
  v_dot2_f32_bf16 v246, v230, v230, v246
  v_dot2_f32_bf16 v243, v231, s50, v243
  v_dot2_f32_bf16 v247, v231, v231, v247
  v_dot2_f32_bf16 v240, v232, s50, v240
  v_dot2_f32_bf16 v244, v232, v232, v244
  v_dot2_f32_bf16 v241, v233, s50, v241
  v_dot2_f32_bf16 v245, v233, v233, v245
  v_dot2_f32_bf16 v242, v234, s50, v242
  v_dot2_f32_bf16 v246, v234, v234, v246
  v_dot2_f32_bf16 v243, v235, s50, v243
  v_dot2_f32_bf16 v247, v235, v235, v247
  s_waitcnt lgkmcnt(4)
  v_dot2_f32_bf16 v240, v236, s50, v240
  v_dot2_f32_bf16 v244, v236, v236, v244
  v_dot2_f32_bf16 v241, v237, s50, v241
  v_dot2_f32_bf16 v245, v237, v237, v245
  v_dot2_f32_bf16 v242, v238, s50, v242
  v_dot2_f32_bf16 v246, v238, v238, v246
  v_dot2_f32_bf16 v243, v239, s50, v243
  v_dot2_f32_bf16 v247, v239, v239, v247
  v_mfma_f32_16x16x32_bf16 a[136:139], a[156:159], v[56:59], a[136:139]
  v_mfma_f32_32x32x16_bf16 v[128:143], a[0:3], v[56:59], v[128:143]
  ds_read_b128 a[8:11], v10 offset:49152
  ds_read_b64_tr_b16 v[48:49], v4 offset:45056
  buffer_load_dwordx4 v22, s[4:7], s44 offen lds
  v_mfma_f32_32x32x16_bf16 v[144:159], a[4:7], v[56:59], v[144:159]
  s_waitcnt lgkmcnt(4)
  ds_read_b128 a[12:15], v10 offset:53248
  ds_read_b64_tr_b16 v[50:51], v4 offset:48128
  v_mfma_f32_16x16x32_bf16 a[140:143], a[156:159], v[60:63], a[140:143]
  v_mfma_f32_32x32x16_bf16 v[160:175], a[0:3], v[60:63], v[160:175]
  ds_read_b64_tr_b16 v[52:53], v2 offset:45056
  buffer_load_dwordx4 v23, s[4:7], s44 offen offset:1024 lds
  v_mfma_f32_32x32x16_bf16 v[176:191], a[4:7], v[60:63], v[176:191]
  s_waitcnt lgkmcnt(5)
  ds_read_b64_tr_b16 v[54:55], v2 offset:48128
  v_mfma_f32_16x16x32_bf16 a[132:135], a[156:159], v[44:47], a[132:135]
  s_waitcnt lgkmcnt(5)
  v_mfma_f32_32x32x16_bf16 v[96:111], a[8:11], v[44:47], v[96:111]
  s_waitcnt lgkmcnt(3)
  ds_read_b64_tr_b16 v[56:57], v2 offset:45128
  buffer_load_dwordx4 v24, s[4:7], s44 offen offset:2048 lds
  v_mfma_f32_32x32x16_bf16 v[112:127], a[12:15], v[44:47], v[112:127]
  s_waitcnt lgkmcnt(3)
  ds_read_b64_tr_b16 v[58:59], v2 offset:48200
  v_mfma_f32_16x16x32_bf16 a[144:147], a[156:159], v[48:51], a[144:147]
  v_mfma_f32_32x32x16_bf16 v[192:207], a[8:11], v[48:51], v[192:207]
  ds_read_b64_tr_b16 v[60:61], v2 offset:45416
  buffer_load_dwordx4 v25, s[4:7], s44 offen offset:3072 lds
  v_mfma_f32_32x32x16_bf16 v[208:223], a[12:15], v[48:51], v[208:223]
  s_waitcnt lgkmcnt(3)
  s_add_u32 s45, s71, 0xd800
  ds_read_b64_tr_b16 v[62:63], v2 offset:48488
  v_mfma_f32_16x16x32_bf16 a[128:131], a[156:159], v[52:55], a[128:131]
  s_waitcnt vmcnt(7)
  s_barrier
  v_mfma_f32_32x32x16_bf16 v[64:79], a[8:11], v[52:55], v[64:79]
  s_add_u32 m0, s55, 0x5000
  ds_read_b64_tr_b16 v[44:45], v2 offset:57632
  v_mfma_f32_32x32x16_bf16 v[80:95], a[12:15], v[52:55], v[80:95]
  s_waitcnt lgkmcnt(3)
  ds_read_b64_tr_b16 v[46:47], v2 offset:60704
  buffer_load_dwordx4 v16, s[8:11], s45 offen lds
  v_mfma_f32_16x16x32_bf16 a[136:139], a[156:159], v[56:59], a[136:139]
  v_mfma_f32_32x32x16_bf16 v[128:143], a[8:11], v[56:59], v[128:143]
  ds_read_b128 a[16:19], v11 offset:49152
  ds_read_b64_tr_b16 v[48:49], v4 offset:57344
  buffer_load_dwordx4 v17, s[8:11], s45 offen offset:1024 lds
  v_mfma_f32_32x32x16_bf16 v[144:159], a[12:15], v[56:59], v[144:159]
  s_waitcnt lgkmcnt(4)
  ds_read_b128 a[20:23], v11 offset:53248
  ds_read_b64_tr_b16 v[50:51], v4 offset:60416
  v_mfma_f32_16x16x32_bf16 a[140:143], a[156:159], v[60:63], a[140:143]
  v_mfma_f32_32x32x16_bf16 v[160:175], a[8:11], v[60:63], v[160:175]
  ds_read_b64_tr_b16 v[52:53], v2 offset:57344
  buffer_load_dwordx4 v18, s[8:11], s45 offen offset:2048 lds
  v_mfma_f32_32x32x16_bf16 v[176:191], a[12:15], v[60:63], v[176:191]
  s_waitcnt lgkmcnt(5)
  s_add_u32 s44, s42, 0x0
  s_add_u32 m0, s43, 0x16000
  ds_read_b64_tr_b16 v[54:55], v2 offset:60416
  v_mfma_f32_16x16x32_bf16 a[132:135], a[156:159], v[44:47], a[132:135]
  s_waitcnt lgkmcnt(5)
  v_mfma_f32_32x32x16_bf16 v[96:111], a[16:19], v[44:47], v[96:111]
  s_waitcnt lgkmcnt(3)
  ds_read_b64_tr_b16 v[56:57], v2 offset:57416
  buffer_load_dwordx4 v248, s[12:15], s44 offen lds
  v_mfma_f32_32x32x16_bf16 v[112:127], a[20:23], v[44:47], v[112:127]
  s_waitcnt lgkmcnt(3)
  ds_read_b64_tr_b16 v[58:59], v2 offset:60488
  v_mfma_f32_16x16x32_bf16 a[144:147], a[156:159], v[48:51], a[144:147]
  v_mfma_f32_32x32x16_bf16 v[192:207], a[16:19], v[48:51], v[192:207]
  ds_read_b64_tr_b16 v[60:61], v2 offset:57704
  buffer_load_dwordx4 v249, s[12:15], s44 offen offset:1024 lds
  v_mfma_f32_32x32x16_bf16 v[208:223], a[20:23], v[48:51], v[208:223]
  s_waitcnt lgkmcnt(3)
  s_add_u32 s45, s42, 0x12000
  s_add_u32 m0, s43, 0x18000
  ds_read_b64_tr_b16 v[62:63], v2 offset:60776
  v_mfma_f32_16x16x32_bf16 a[128:131], a[156:159], v[52:55], a[128:131]
  v_mfma_f32_32x32x16_bf16 v[64:79], a[16:19], v[52:55], v[64:79]
  ds_read_b64_tr_b16 v[44:45], v3 offset:4384
  buffer_load_dwordx4 v248, s[12:15], s45 offen lds
  buffer_load_dwordx4 v249, s[12:15], s45 offen offset:1024 lds
  v_mfma_f32_32x32x16_bf16 v[80:95], a[20:23], v[52:55], v[80:95]
  s_waitcnt lgkmcnt(3)
  s_add_u32 s44, s42, 0x24000
  s_add_u32 m0, s43, 0x1a000
  ds_read_b64_tr_b16 v[46:47], v3 offset:7456
  v_mfma_f32_16x16x32_bf16 a[136:139], a[156:159], v[56:59], a[136:139]
  buffer_load_dwordx4 v250, s[12:15], s44 offen lds
  buffer_load_dwordx4 v251, s[12:15], s44 offen offset:1024 lds
  v_mfma_f32_32x32x16_bf16 v[128:143], a[16:19], v[56:59], v[128:143]
  s_add_u32 s45, s71, 0x1b000
  s_add_u32 m0, s55, 0x8000
  ds_read_b128 a[24:27], v12 offset:49152
  ds_read_b64_tr_b16 v[48:49], v5 offset:4096
  v_mfma_f32_32x32x16_bf16 v[144:159], a[20:23], v[56:59], v[144:159]
  s_waitcnt lgkmcnt(4)
  ds_read_b128 a[28:31], v12 offset:53248
  ds_read_b64_tr_b16 v[50:51], v5 offset:7168
  buffer_load_dwordx4 v16, s[8:11], s45 offen lds
  v_mfma_f32_16x16x32_bf16 a[140:143], a[156:159], v[60:63], a[140:143]
  v_mfma_f32_32x32x16_bf16 v[160:175], a[16:19], v[60:63], v[160:175]
  ds_read_b64_tr_b16 v[52:53], v3 offset:4096
  buffer_load_dwordx4 v17, s[8:11], s45 offen offset:1024 lds
  v_mfma_f32_32x32x16_bf16 v[176:191], a[20:23], v[60:63], v[176:191]
  s_waitcnt lgkmcnt(5)
  ds_read_b64_tr_b16 v[54:55], v3 offset:7168
  v_mfma_f32_16x16x32_bf16 a[132:135], a[156:159], v[44:47], a[132:135]
  s_waitcnt lgkmcnt(5)
  v_mfma_f32_32x32x16_bf16 v[96:111], a[24:27], v[44:47], v[96:111]
  s_waitcnt lgkmcnt(3)
  ds_read_b64_tr_b16 v[56:57], v3 offset:4168
  buffer_load_dwordx4 v18, s[8:11], s45 offen offset:2048 lds
  v_mfma_f32_32x32x16_bf16 v[112:127], a[28:31], v[44:47], v[112:127]
  s_waitcnt lgkmcnt(3)
  s_add_u32 s44, s71, 0x28800
  ds_read_b64_tr_b16 v[58:59], v3 offset:7240
  v_mfma_f32_16x16x32_bf16 a[144:147], a[156:159], v[48:51], a[144:147]
  v_mfma_f32_32x32x16_bf16 v[192:207], a[24:27], v[48:51], v[192:207]
  ds_read_b64_tr_b16 v[60:61], v3 offset:4456
  v_mfma_f32_32x32x16_bf16 v[208:223], a[28:31], v[48:51], v[208:223]
  s_waitcnt lgkmcnt(3)
  ds_read_b64_tr_b16 v[62:63], v3 offset:7528
  v_mfma_f32_16x16x32_bf16 a[128:131], a[156:159], v[52:55], a[128:131]
  s_waitcnt vmcnt(3)
  s_barrier
  v_mfma_f32_32x32x16_bf16 v[64:79], a[24:27], v[52:55], v[64:79]
  s_add_u32 m0, s55, 0xb000
  ds_read_b64_tr_b16 v[44:45], v2 offset:8480
  v_mfma_f32_32x32x16_bf16 v[80:95], a[28:31], v[52:55], v[80:95]
  s_waitcnt lgkmcnt(3)
  ds_read_b64_tr_b16 v[46:47], v2 offset:11552
  buffer_load_dwordx4 v16, s[8:11], s44 offen lds
  v_mfma_f32_16x16x32_bf16 a[136:139], a[156:159], v[56:59], a[136:139]
  v_mfma_f32_32x32x16_bf16 v[128:143], a[24:27], v[56:59], v[128:143]
  ds_read_b128 a[32:35], v9 offset:16384
  ds_read_b64_tr_b16 v[48:49], v4 offset:8192
  buffer_load_dwordx4 v17, s[8:11], s44 offen offset:1024 lds
  v_mfma_f32_32x32x16_bf16 v[144:159], a[28:31], v[56:59], v[144:159]
  s_waitcnt lgkmcnt(4)
  ds_read_b128 a[36:39], v9 offset:20480
  ds_read_b64_tr_b16 v[50:51], v4 offset:11264
  v_mfma_f32_16x16x32_bf16 a[140:143], a[156:159], v[60:63], a[140:143]
  v_mfma_f32_32x32x16_bf16 v[160:175], a[24:27], v[60:63], v[160:175]
  ds_read_b64_tr_b16 v[52:53], v2 offset:8192
  buffer_load_dwordx4 v18, s[8:11], s44 offen offset:2048 lds
  v_mfma_f32_32x32x16_bf16 v[176:191], a[28:31], v[60:63], v[176:191]
  s_waitcnt lgkmcnt(5)
  s_add_u32 s45, s72, 0x0
  s_add_u32 m0, s55, 0xe000
  ds_read_b64_tr_b16 v[54:55], v2 offset:11264
  v_mfma_f32_16x16x32_bf16 a[132:135], a[156:159], v[44:47], a[132:135]
  s_waitcnt lgkmcnt(5)
  ds_read_b128 v[224:227], v26 offset:16384
  v_mfma_f32_32x32x16_bf16 v[96:111], a[32:35], v[44:47], v[96:111]
  s_waitcnt lgkmcnt(4)
  ds_read_b128 v[228:231], v27 offset:16384
  ds_read_b64_tr_b16 v[56:57], v2 offset:8264
  buffer_load_dwordx4 v16, s[8:11], s45 offen lds
  v_mfma_f32_32x32x16_bf16 v[112:127], a[36:39], v[44:47], v[112:127]
  s_waitcnt lgkmcnt(5)
  ds_read_b128 v[232:235], v28 offset:16384
  ds_read_b64_tr_b16 v[58:59], v2 offset:11336
  v_mfma_f32_16x16x32_bf16 a[144:147], a[156:159], v[48:51], a[144:147]
  ds_read_b128 v[236:239], v29 offset:16384
  v_mfma_f32_32x32x16_bf16 v[192:207], a[32:35], v[48:51], v[192:207]
  ds_read_b64_tr_b16 v[60:61], v2 offset:8552
  buffer_load_dwordx4 v17, s[8:11], s45 offen offset:1024 lds
  v_mfma_f32_32x32x16_bf16 v[208:223], a[36:39], v[48:51], v[208:223]
  s_waitcnt lgkmcnt(7)
  ds_read_b64_tr_b16 v[62:63], v2 offset:11624
  v_mfma_f32_16x16x32_bf16 a[128:131], a[156:159], v[52:55], a[128:131]
  v_mfma_f32_32x32x16_bf16 v[64:79], a[32:35], v[52:55], v[64:79]
  ds_read_b64_tr_b16 v[44:45], v2 offset:20768
  buffer_load_dwordx4 v18, s[8:11], s45 offen offset:2048 lds
  v_mfma_f32_32x32x16_bf16 v[80:95], a[36:39], v[52:55], v[80:95]
  s_waitcnt lgkmcnt(4)
  s_add_u32 s44, s22, 0x0
  s_add_u32 m0, s3, 0x20000
  ds_read_b64_tr_b16 v[46:47], v2 offset:23840
  v_dot2_f32_bf16 v240, v224, s50, v240
  v_dot2_f32_bf16 v244, v224, v224, v244
  v_dot2_f32_bf16 v241, v225, s50, v241
  v_dot2_f32_bf16 v245, v225, v225, v245
  v_dot2_f32_bf16 v242, v226, s50, v242
  v_dot2_f32_bf16 v246, v226, v226, v246
  v_dot2_f32_bf16 v243, v227, s50, v243
  v_dot2_f32_bf16 v247, v227, v227, v247
  v_dot2_f32_bf16 v240, v228, s50, v240
  v_dot2_f32_bf16 v244, v228, v228, v244
  v_dot2_f32_bf16 v241, v229, s50, v241
  v_dot2_f32_bf16 v245, v229, v229, v245
  v_dot2_f32_bf16 v242, v230, s50, v242
  v_dot2_f32_bf16 v246, v230, v230, v246
  v_dot2_f32_bf16 v243, v231, s50, v243
  v_dot2_f32_bf16 v247, v231, v231, v247
  v_dot2_f32_bf16 v240, v232, s50, v240
  v_dot2_f32_bf16 v244, v232, v232, v244
  v_dot2_f32_bf16 v241, v233, s50, v241
  v_dot2_f32_bf16 v245, v233, v233, v245
  v_dot2_f32_bf16 v242, v234, s50, v242
  v_dot2_f32_bf16 v246, v234, v234, v246
  v_dot2_f32_bf16 v243, v235, s50, v243
  v_dot2_f32_bf16 v247, v235, v235, v247
  s_waitcnt lgkmcnt(4)
  v_dot2_f32_bf16 v240, v236, s50, v240
  v_dot2_f32_bf16 v244, v236, v236, v244
  v_dot2_f32_bf16 v241, v237, s50, v241
  v_dot2_f32_bf16 v245, v237, v237, v245
  v_dot2_f32_bf16 v242, v238, s50, v242
  v_dot2_f32_bf16 v246, v238, v238, v246
  v_dot2_f32_bf16 v243, v239, s50, v243
  v_dot2_f32_bf16 v247, v239, v239, v247
  v_mfma_f32_16x16x32_bf16 a[136:139], a[156:159], v[56:59], a[136:139]
  v_mfma_f32_32x32x16_bf16 v[128:143], a[32:35], v[56:59], v[128:143]
  ds_read_b128 a[40:43], v10 offset:16384
  ds_read_b64_tr_b16 v[48:49], v4 offset:20480
  buffer_load_dwordx4 v22, s[4:7], s44 offen lds
  v_mfma_f32_32x32x16_bf16 v[144:159], a[36:39], v[56:59], v[144:159]
  s_waitcnt lgkmcnt(4)
  ds_read_b128 a[44:47], v10 offset:20480
  ds_read_b64_tr_b16 v[50:51], v4 offset:23552
  v_mfma_f32_16x16x32_bf16 a[140:143], a[156:159], v[60:63], a[140:143]
  v_mfma_f32_32x32x16_bf16 v[160:175], a[32:35], v[60:63], v[160:175]
  ds_read_b64_tr_b16 v[52:53], v2 offset:20480
  buffer_load_dwordx4 v23, s[4:7], s44 offen offset:1024 lds
  v_mfma_f32_32x32x16_bf16 v[176:191], a[36:39], v[60:63], v[176:191]
  s_waitcnt lgkmcnt(5)
  ds_read_b64_tr_b16 v[54:55], v2 offset:23552
  v_mfma_f32_16x16x32_bf16 a[132:135], a[156:159], v[44:47], a[132:135]
  s_waitcnt lgkmcnt(5)
  v_mfma_f32_32x32x16_bf16 v[96:111], a[40:43], v[44:47], v[96:111]
  s_waitcnt lgkmcnt(3)
  ds_read_b64_tr_b16 v[56:57], v2 offset:20552
  buffer_load_dwordx4 v24, s[4:7], s44 offen offset:2048 lds
  v_mfma_f32_32x32x16_bf16 v[112:127], a[44:47], v[44:47], v[112:127]
  s_waitcnt lgkmcnt(3)
  ds_read_b64_tr_b16 v[58:59], v2 offset:23624
  v_mfma_f32_16x16x32_bf16 a[144:147], a[156:159], v[48:51], a[144:147]
  v_mfma_f32_32x32x16_bf16 v[192:207], a[40:43], v[48:51], v[192:207]
  ds_read_b64_tr_b16 v[60:61], v2 offset:20840
  buffer_load_dwordx4 v25, s[4:7], s44 offen offset:3072 lds
  v_mfma_f32_32x32x16_bf16 v[208:223], a[44:47], v[48:51], v[208:223]
  s_waitcnt lgkmcnt(3)
  s_add_u32 s45, s72, 0xd800
  ds_read_b64_tr_b16 a[168:169], v252 offset:0
  ds_read_b64_tr_b16 v[62:63], v2 offset:23912
  v_mfma_f32_16x16x32_bf16 a[128:131], a[156:159], v[52:55], a[128:131]
  s_waitcnt vmcnt(7)
  s_barrier
  ds_read_b64_tr_b16 a[170:171], v252 offset:1024
  v_mfma_f32_32x32x16_bf16 v[64:79], a[40:43], v[52:55], v[64:79]
  s_add_u32 m0, s55, 0x11000
  ds_read_b64_tr_b16 a[172:173], v252 offset:4608
  ds_read_b64_tr_b16 v[44:45], v2 offset:33056
  v_mfma_f32_32x32x16_bf16 v[80:95], a[44:47], v[52:55], v[80:95]
  s_waitcnt lgkmcnt(6)
  ds_read_b64_tr_b16 a[174:175], v252 offset:5632
  ds_read_b64_tr_b16 v[46:47], v2 offset:36128
  buffer_load_dwordx4 v16, s[8:11], s45 offen lds
  v_mfma_f32_16x16x32_bf16 a[136:139], a[156:159], v[56:59], a[136:139]
  ds_read_b64_tr_b16 a[176:177], v252 offset:9216
  v_mfma_f32_32x32x16_bf16 v[128:143], a[40:43], v[56:59], v[128:143]
  ds_read_b128 a[48:51], v11 offset:16384
  ds_read_b64_tr_b16 a[178:179], v252 offset:10240
  ds_read_b64_tr_b16 v[48:49], v4 offset:32768
  buffer_load_dwordx4 v17, s[8:11], s45 offen offset:1024 lds
  v_mfma_f32_32x32x16_bf16 v[144:159], a[44:47], v[56:59], v[144:159]
  s_waitcnt lgkmcnt(9)
  ds_read_b128 a[52:55], v11 offset:20480
  ds_read_b64_tr_b16 a[180:181], v252 offset:13824
  ds_read_b64_tr_b16 v[50:51], v4 offset:35840
  v_mfma_f32_16x16x32_bf16 a[140:143], a[156:159], v[60:63], a[140:143]
  ds_read_b64_tr_b16 a[182:183], v252 offset:14848
  v_mfma_f32_32x32x16_bf16 v[160:175], a[40:43], v[60:63], v[160:175]
  ds_read_b64_tr_b16 a[184:185], v255 offset:0
  ds_read_b64_tr_b16 v[52:53], v2 offset:32768
  buffer_load_dwordx4 v18, s[8:11], s45 offen offset:2048 lds
  v_mfma_f32_32x32x16_bf16 v[176:191], a[44:47], v[60:63], v[176:191]
  s_waitcnt lgkmcnt(10)
  s_add_u32 s44, s72, 0x1b000
  s_add_u32 m0, s55, 0x2000
  ds_read_b64_tr_b16 a[186:187], v255 offset:4608
  ds_read_b64_tr_b16 v[54:55], v2 offset:35840
  v_mfma_f32_16x16x32_bf16 a[132:135], a[156:159], v[44:47], a[132:135]
  s_waitcnt lgkmcnt(10)
  v_mfma_f32_32x32x16_bf16 v[96:111], a[48:51], v[44:47], v[96:111]
  s_waitcnt lgkmcnt(7)
  ds_read_b64_tr_b16 v[56:57], v2 offset:32840
  buffer_load_dwordx4 v16, s[8:11], s44 offen lds
  v_mfma_f32_32x32x16_bf16 v[112:127], a[52:55], v[44:47], v[112:127]
  s_waitcnt lgkmcnt(6)
  ds_read_b64_tr_b16 v[58:59], v2 offset:35912
  v_mfma_f32_16x16x32_bf16 a[144:147], a[156:159], v[48:51], a[144:147]
  v_mfma_f32_32x32x16_bf16 v[192:207], a[48:51], v[48:51], v[192:207]
  ds_read_b64_tr_b16 v[60:61], v2 offset:33128
  buffer_load_dwordx4 v17, s[8:11], s44 offen offset:1024 lds
  buffer_store_dwordx4 a[168:171], v253, s[16:19], s64 offen sc1
  v_mfma_f32_32x32x16_bf16 v[208:223], a[52:55], v[48:51], v[208:223]
  s_waitcnt lgkmcnt(3)
  ds_read_b64_tr_b16 v[62:63], v2 offset:36200
  v_mfma_f32_16x16x32_bf16 a[128:131], a[156:159], v[52:55], a[128:131]
  v_mfma_f32_32x32x16_bf16 v[64:79], a[48:51], v[52:55], v[64:79]
  ds_read_b64_tr_b16 v[44:45], v2 offset:45344
  buffer_load_dwordx4 v18, s[8:11], s44 offen offset:2048 lds
  v_mfma_f32_32x32x16_bf16 v[80:95], a[52:55], v[52:55], v[80:95]
  s_waitcnt lgkmcnt(3)
  s_add_u32 s45, s72, 0x28800
  ds_read_b64_tr_b16 v[46:47], v2 offset:48416
  v_mfma_f32_16x16x32_bf16 a[136:139], a[156:159], v[56:59], a[136:139]
  v_mfma_f32_32x32x16_bf16 v[128:143], a[48:51], v[56:59], v[128:143]
  ds_read_b128 a[56:59], v12 offset:16384
  ds_read_b64_tr_b16 v[48:49], v4 offset:45056
  buffer_store_dwordx4 a[172:175], v253, s[16:19], s64 offen offset:1024 sc1
  v_mfma_f32_32x32x16_bf16 v[144:159], a[52:55], v[56:59], v[144:159]
  s_waitcnt lgkmcnt(4)
  ds_read_b128 a[60:63], v12 offset:20480
  ds_read_b64_tr_b16 v[50:51], v4 offset:48128
  v_mfma_f32_16x16x32_bf16 a[140:143], a[156:159], v[60:63], a[140:143]
  v_mfma_f32_32x32x16_bf16 v[160:175], a[48:51], v[60:63], v[160:175]
  ds_read_b64_tr_b16 v[52:53], v2 offset:45056
  v_mfma_f32_32x32x16_bf16 v[176:191], a[52:55], v[60:63], v[176:191]
  s_waitcnt lgkmcnt(5)
  ds_read_b64_tr_b16 v[54:55], v2 offset:48128
  v_mfma_f32_16x16x32_bf16 a[132:135], a[156:159], v[44:47], a[132:135]
  s_waitcnt lgkmcnt(5)
  v_mfma_f32_32x32x16_bf16 v[96:111], a[56:59], v[44:47], v[96:111]
  s_waitcnt lgkmcnt(3)
  ds_read_b64_tr_b16 v[56:57], v2 offset:45128
  buffer_store_dwordx4 a[176:179], v253, s[16:19], s64 offen offset:2048 sc1
  v_mfma_f32_32x32x16_bf16 v[112:127], a[60:63], v[44:47], v[112:127]
  s_waitcnt lgkmcnt(3)
  ds_read_b64_tr_b16 v[58:59], v2 offset:48200
  v_mfma_f32_16x16x32_bf16 a[144:147], a[156:159], v[48:51], a[144:147]
  v_mfma_f32_32x32x16_bf16 v[192:207], a[56:59], v[48:51], v[192:207]
  ds_read_b64_tr_b16 v[60:61], v2 offset:45416
  v_mfma_f32_32x32x16_bf16 v[208:223], a[60:63], v[48:51], v[208:223]
  s_waitcnt lgkmcnt(3)
  ds_read_b64_tr_b16 v[62:63], v2 offset:48488
  v_mfma_f32_16x16x32_bf16 a[128:131], a[156:159], v[52:55], a[128:131]
  s_waitcnt vmcnt(6)
  s_barrier
  v_mfma_f32_32x32x16_bf16 v[64:79], a[56:59], v[52:55], v[64:79]
  s_add_u32 m0, s55, 0x5000
  ds_read_b64_tr_b16 v[44:45], v2 offset:57632
  buffer_store_dwordx4 a[180:183], v253, s[16:19], s64 offen offset:3072 sc1
  v_mfma_f32_32x32x16_bf16 v[80:95], a[60:63], v[52:55], v[80:95]
  s_waitcnt lgkmcnt(3)
  ds_read_b64_tr_b16 v[46:47], v2 offset:60704
  buffer_load_dwordx4 v16, s[8:11], s45 offen lds
  v_mfma_f32_16x16x32_bf16 a[136:139], a[156:159], v[56:59], a[136:139]
  v_mfma_f32_32x32x16_bf16 v[128:143], a[56:59], v[56:59], v[128:143]
  ds_read_b128 a[0:3], v9 offset:32768
  ds_read_b64_tr_b16 v[48:49], v4 offset:57344
  buffer_load_dwordx4 v17, s[8:11], s45 offen offset:1024 lds
  v_mfma_f32_32x32x16_bf16 v[144:159], a[60:63], v[56:59], v[144:159]
  s_waitcnt lgkmcnt(4)
  ds_read_b128 a[4:7], v9 offset:36864
  ds_read_b64_tr_b16 v[50:51], v4 offset:60416
  v_mfma_f32_16x16x32_bf16 a[140:143], a[156:159], v[60:63], a[140:143]
  v_mfma_f32_32x32x16_bf16 v[160:175], a[56:59], v[60:63], v[160:175]
  ds_read_b64_tr_b16 v[52:53], v2 offset:57344
  buffer_load_dwordx4 v18, s[8:11], s45 offen offset:2048 lds
  buffer_store_dwordx4 a[184:187], v254, s[16:19], s65 offen sc1
  v_mfma_f32_32x32x16_bf16 v[176:191], a[60:63], v[60:63], v[176:191]
  s_waitcnt lgkmcnt(5)
  s_add_u32 s44, s73, 0x0
  s_add_u32 m0, s55, 0x8000
  ds_read_b64_tr_b16 v[54:55], v2 offset:60416
  v_mfma_f32_16x16x32_bf16 a[132:135], a[156:159], v[44:47], a[132:135]
  s_waitcnt lgkmcnt(5)
  ds_read_b128 v[224:227], v26 offset:32768
  v_mfma_f32_32x32x16_bf16 v[96:111], a[0:3], v[44:47], v[96:111]
  s_waitcnt lgkmcnt(4)
  ds_read_b128 v[228:231], v27 offset:32768
  ds_read_b64_tr_b16 v[56:57], v2 offset:57416
  buffer_load_dwordx4 v16, s[8:11], s44 offen lds
  v_mfma_f32_32x32x16_bf16 v[112:127], a[4:7], v[44:47], v[112:127]
  s_waitcnt lgkmcnt(5)
  ds_read_b128 v[232:235], v28 offset:32768
  ds_read_b64_tr_b16 v[58:59], v2 offset:60488
  v_mfma_f32_16x16x32_bf16 a[144:147], a[156:159], v[48:51], a[144:147]
  ds_read_b128 v[236:239], v29 offset:32768
  v_mfma_f32_32x32x16_bf16 v[192:207], a[0:3], v[48:51], v[192:207]
  ds_read_b64_tr_b16 v[60:61], v2 offset:57704
  buffer_load_dwordx4 v17, s[8:11], s44 offen offset:1024 lds
  v_mfma_f32_32x32x16_bf16 v[208:223], a[4:7], v[48:51], v[208:223]
  s_waitcnt lgkmcnt(7)
  ds_read_b64_tr_b16 v[62:63], v2 offset:60776
  v_mfma_f32_16x16x32_bf16 a[128:131], a[156:159], v[52:55], a[128:131]
  v_mfma_f32_32x32x16_bf16 v[64:79], a[0:3], v[52:55], v[64:79]
  ds_read_b64_tr_b16 v[44:45], v3 offset:4384
  buffer_load_dwordx4 v18, s[8:11], s44 offen offset:2048 lds
  v_mfma_f32_32x32x16_bf16 v[80:95], a[4:7], v[52:55], v[80:95]
  s_waitcnt lgkmcnt(4)
  s_add_u32 s45, s23, 0x0
  s_add_u32 m0, s3, 0x24000
  ds_read_b64_tr_b16 v[46:47], v3 offset:7456
  v_dot2_f32_bf16 v240, v224, s50, v240
  v_dot2_f32_bf16 v244, v224, v224, v244
  v_dot2_f32_bf16 v241, v225, s50, v241
  v_dot2_f32_bf16 v245, v225, v225, v245
  v_dot2_f32_bf16 v242, v226, s50, v242
  v_dot2_f32_bf16 v246, v226, v226, v246
  v_dot2_f32_bf16 v243, v227, s50, v243
  v_dot2_f32_bf16 v247, v227, v227, v247
  v_dot2_f32_bf16 v240, v228, s50, v240
  v_dot2_f32_bf16 v244, v228, v228, v244
  v_dot2_f32_bf16 v241, v229, s50, v241
  v_dot2_f32_bf16 v245, v229, v229, v245
  v_dot2_f32_bf16 v242, v230, s50, v242
  v_dot2_f32_bf16 v246, v230, v230, v246
  v_dot2_f32_bf16 v243, v231, s50, v243
  v_dot2_f32_bf16 v247, v231, v231, v247
  v_dot2_f32_bf16 v240, v232, s50, v240
  v_dot2_f32_bf16 v244, v232, v232, v244
  v_dot2_f32_bf16 v241, v233, s50, v241
  v_dot2_f32_bf16 v245, v233, v233, v245
  v_dot2_f32_bf16 v242, v234, s50, v242
  v_dot2_f32_bf16 v246, v234, v234, v246
  v_dot2_f32_bf16 v243, v235, s50, v243
  v_dot2_f32_bf16 v247, v235, v235, v247
  s_waitcnt lgkmcnt(4)
  v_dot2_f32_bf16 v240, v236, s50, v240
  v_dot2_f32_bf16 v244, v236, v236, v244
  v_dot2_f32_bf16 v241, v237, s50, v241
  v_dot2_f32_bf16 v245, v237, v237, v245
  v_dot2_f32_bf16 v242, v238, s50, v242
  v_dot2_f32_bf16 v246, v238, v238, v246
  v_dot2_f32_bf16 v243, v239, s50, v243
  v_dot2_f32_bf16 v247, v239, v239, v247
  v_mfma_f32_16x16x32_bf16 a[136:139], a[156:159], v[56:59], a[136:139]
  v_mfma_f32_32x32x16_bf16 v[128:143], a[0:3], v[56:59], v[128:143]
  ds_read_b128 a[8:11], v10 offset:32768
  ds_read_b64_tr_b16 v[48:49], v5 offset:4096
  buffer_load_dwordx4 v22, s[4:7], s45 offen lds
  v_mfma_f32_32x32x16_bf16 v[144:159], a[4:7], v[56:59], v[144:159]
  s_waitcnt lgkmcnt(4)
  ds_read_b128 a[12:15], v10 offset:36864
  ds_read_b64_tr_b16 v[50:51], v5 offset:7168
  v_mfma_f32_16x16x32_bf16 a[140:143], a[156:159], v[60:63], a[140:143]
  v_mfma_f32_32x32x16_bf16 v[160:175], a[0:3], v[60:63], v[160:175]
  ds_read_b64_tr_b16 v[52:53], v3 offset:4096
  buffer_load_dwordx4 v23, s[4:7], s45 offen offset:1024 lds
  v_mfma_f32_32x32x16_bf16 v[176:191], a[4:7], v[60:63], v[176:191]
  s_waitcnt lgkmcnt(5)
  ds_read_b64_tr_b16 v[54:55], v3 offset:7168
  v_mfma_f32_16x16x32_bf16 a[132:135], a[156:159], v[44:47], a[132:135]
  s_waitcnt lgkmcnt(5)
  v_mfma_f32_32x32x16_bf16 v[96:111], a[8:11], v[44:47], v[96:111]
  s_waitcnt lgkmcnt(3)
  ds_read_b64_tr_b16 v[56:57], v3 offset:4168
  buffer_load_dwordx4 v24, s[4:7], s45 offen offset:2048 lds
  v_mfma_f32_32x32x16_bf16 v[112:127], a[12:15], v[44:47], v[112:127]
  s_waitcnt lgkmcnt(3)
  ds_read_b64_tr_b16 v[58:59], v3 offset:7240
  v_mfma_f32_16x16x32_bf16 a[144:147], a[156:159], v[48:51], a[144:147]
  v_mfma_f32_32x32x16_bf16 v[192:207], a[8:11], v[48:51], v[192:207]
  ds_read_b64_tr_b16 v[60:61], v3 offset:4456
  buffer_load_dwordx4 v25, s[4:7], s45 offen offset:3072 lds
  v_mfma_f32_32x32x16_bf16 v[208:223], a[12:15], v[48:51], v[208:223]
  s_waitcnt lgkmcnt(3)
  s_add_u32 s44, s73, 0xd800
  s_add_u32 m0, s55, 0x14000
  ds_read_b64_tr_b16 v[62:63], v3 offset:7528
  v_mfma_f32_16x16x32_bf16 a[128:131], a[156:159], v[52:55], a[128:131]
  s_waitcnt vmcnt(8)
  s_barrier
  v_mfma_f32_32x32x16_bf16 v[64:79], a[8:11], v[52:55], v[64:79]
  ds_read_b64_tr_b16 v[44:45], v2 offset:8480
  buffer_load_dwordx4 v16, s[8:11], s44 offen lds
  v_mfma_f32_32x32x16_bf16 v[80:95], a[12:15], v[52:55], v[80:95]
  s_waitcnt lgkmcnt(3)
  ds_read_b64_tr_b16 v[46:47], v2 offset:11552
  v_mfma_f32_16x16x32_bf16 a[136:139], a[156:159], v[56:59], a[136:139]
  v_mfma_f32_32x32x16_bf16 v[128:143], a[8:11], v[56:59], v[128:143]
  ds_read_b128 a[16:19], v11 offset:32768
  ds_read_b64_tr_b16 v[48:49], v4 offset:8192
  buffer_load_dwordx4 v17, s[8:11], s44 offen offset:1024 lds
  v_mfma_f32_32x32x16_bf16 v[144:159], a[12:15], v[56:59], v[144:159]
  s_waitcnt lgkmcnt(4)
  ds_read_b128 a[20:23], v11 offset:36864
  ds_read_b64_tr_b16 v[50:51], v4 offset:11264
  v_mfma_f32_16x16x32_bf16 a[140:143], a[156:159], v[60:63], a[140:143]
  v_mfma_f32_32x32x16_bf16 v[160:175], a[8:11], v[60:63], v[160:175]
  ds_read_b64_tr_b16 v[52:53], v2 offset:8192
  buffer_load_dwordx4 v18, s[8:11], s44 offen offset:2048 lds
  v_mfma_f32_32x32x16_bf16 v[176:191], a[12:15], v[60:63], v[176:191]
  s_waitcnt lgkmcnt(5)
  s_add_u32 s45, s73, 0x1b000
  s_add_u32 m0, s55, 0xb000
  ds_read_b64_tr_b16 v[54:55], v2 offset:11264
  v_mfma_f32_16x16x32_bf16 a[132:135], a[156:159], v[44:47], a[132:135]
  s_waitcnt lgkmcnt(5)
  v_mfma_f32_32x32x16_bf16 v[96:111], a[16:19], v[44:47], v[96:111]
  s_waitcnt lgkmcnt(3)
  ds_read_b64_tr_b16 v[56:57], v2 offset:8264
  buffer_load_dwordx4 v16, s[8:11], s45 offen lds
  v_mfma_f32_32x32x16_bf16 v[112:127], a[20:23], v[44:47], v[112:127]
  s_waitcnt lgkmcnt(3)
  ds_read_b64_tr_b16 v[58:59], v2 offset:11336
  v_mfma_f32_16x16x32_bf16 a[144:147], a[156:159], v[48:51], a[144:147]
  v_mfma_f32_32x32x16_bf16 v[192:207], a[16:19], v[48:51], v[192:207]
  ds_read_b64_tr_b16 v[60:61], v2 offset:8552
  buffer_load_dwordx4 v17, s[8:11], s45 offen offset:1024 lds
  v_mfma_f32_32x32x16_bf16 v[208:223], a[20:23], v[48:51], v[208:223]
  s_waitcnt lgkmcnt(3)
  ds_read_b64_tr_b16 v[62:63], v2 offset:11624
  v_mfma_f32_16x16x32_bf16 a[128:131], a[156:159], v[52:55], a[128:131]
  v_mfma_f32_32x32x16_bf16 v[64:79], a[16:19], v[52:55], v[64:79]
  ds_read_b64_tr_b16 v[44:45], v2 offset:20768
  buffer_load_dwordx4 v18, s[8:11], s45 offen offset:2048 lds
  v_mfma_f32_32x32x16_bf16 v[80:95], a[20:23], v[52:55], v[80:95]
  s_waitcnt lgkmcnt(3)
  s_add_u32 s44, s73, 0x28800
  s_add_u32 m0, s55, 0xe000
  ds_read_b64_tr_b16 v[46:47], v2 offset:23840
  v_mfma_f32_16x16x32_bf16 a[136:139], a[156:159], v[56:59], a[136:139]
  v_mfma_f32_32x32x16_bf16 v[128:143], a[16:19], v[56:59], v[128:143]
  ds_read_b128 a[24:27], v12 offset:32768
  ds_read_b64_tr_b16 v[48:49], v4 offset:20480
  buffer_load_dwordx4 v16, s[8:11], s44 offen lds
  v_mfma_f32_32x32x16_bf16 v[144:159], a[20:23], v[56:59], v[144:159]
  s_waitcnt lgkmcnt(4)
  ds_read_b128 a[28:31], v12 offset:36864
  ds_read_b64_tr_b16 v[50:51], v4 offset:23552
  v_mfma_f32_16x16x32_bf16 a[140:143], a[156:159], v[60:63], a[140:143]
  v_mfma_f32_32x32x16_bf16 v[160:175], a[16:19], v[60:63], v[160:175]
  ds_read_b64_tr_b16 v[52:53], v2 offset:20480
  buffer_load_dwordx4 v17, s[8:11], s44 offen offset:1024 lds
  v_mfma_f32_32x32x16_bf16 v[176:191], a[20:23], v[60:63], v[176:191]
  s_waitcnt lgkmcnt(5)
  ds_read_b64_tr_b16 v[54:55], v2 offset:23552
  v_mfma_f32_16x16x32_bf16 a[132:135], a[156:159], v[44:47], a[132:135]
  s_waitcnt lgkmcnt(5)
  v_mfma_f32_32x32x16_bf16 v[96:111], a[24:27], v[44:47], v[96:111]
  s_waitcnt lgkmcnt(3)
  ds_read_b64_tr_b16 v[56:57], v2 offset:20552
  buffer_load_dwordx4 v18, s[8:11], s44 offen offset:2048 lds
  v_mfma_f32_32x32x16_bf16 v[112:127], a[28:31], v[44:47], v[112:127]
  s_waitcnt lgkmcnt(3)
  s_add_u32 s45, s74, 0x0
  ds_read_b64_tr_b16 v[58:59], v2 offset:23624
  v_mfma_f32_16x16x32_bf16 a[144:147], a[156:159], v[48:51], a[144:147]
  v_mfma_f32_32x32x16_bf16 v[192:207], a[24:27], v[48:51], v[192:207]
  ds_read_b64_tr_b16 v[60:61], v2 offset:20840
  v_mfma_f32_32x32x16_bf16 v[208:223], a[28:31], v[48:51], v[208:223]
  s_waitcnt lgkmcnt(3)
  s_waitcnt vmcnt(16)
  ds_read_b64_tr_b16 v[62:63], v2 offset:23912
  v_mfma_f32_16x16x32_bf16 a[128:131], a[156:159], v[52:55], a[128:131]
  s_waitcnt vmcnt(6)
  s_barrier
  v_mfma_f32_32x32x16_bf16 v[64:79], a[24:27], v[52:55], v[64:79]
  s_add_u32 m0, s55, 0x11000
  ds_read_b64_tr_b16 v[44:45], v2 offset:33056
  s_lshl_b32 s34, s28, 2
  v_lshlrev_b32 v248, 12, v0
  v_mov_b32 v249, 1
  buffer_atomic_add v249, v248, s[24:27], s34 offen offset:0
  buffer_atomic_add v249, v248, s[24:27], 0 offen offset:64
  v_mfma_f32_32x32x16_bf16 v[80:95], a[28:31], v[52:55], v[80:95]
  s_waitcnt lgkmcnt(3)
  ds_read_b64_tr_b16 v[46:47], v2 offset:36128
  buffer_load_dwordx4 v16, s[8:11], s45 offen lds
  v_mfma_f32_16x16x32_bf16 a[136:139], a[156:159], v[56:59], a[136:139]
  v_mfma_f32_32x32x16_bf16 v[128:143], a[24:27], v[56:59], v[128:143]
  ds_read_b128 a[32:35], v9 offset:49152
  ds_read_b64_tr_b16 v[48:49], v4 offset:32768
  buffer_load_dwordx4 v17, s[8:11], s45 offen offset:1024 lds
  v_mfma_f32_32x32x16_bf16 v[144:159], a[28:31], v[56:59], v[144:159]
  s_waitcnt lgkmcnt(4)
  ds_read_b128 a[36:39], v9 offset:53248
  ds_read_b64_tr_b16 v[50:51], v4 offset:35840
  v_mfma_f32_16x16x32_bf16 a[140:143], a[156:159], v[60:63], a[140:143]
  v_mfma_f32_32x32x16_bf16 v[160:175], a[24:27], v[60:63], v[160:175]
  ds_read_b64_tr_b16 v[52:53], v2 offset:32768
  buffer_load_dwordx4 v18, s[8:11], s45 offen offset:2048 lds
  v_mfma_f32_32x32x16_bf16 v[176:191], a[28:31], v[60:63], v[176:191]
  s_waitcnt lgkmcnt(5)
  s_add_u32 s44, s60, 0x0
  s_add_u32 m0, s3, 0x1c000
  ds_read_b64_tr_b16 v[54:55], v2 offset:35840
  v_mfma_f32_16x16x32_bf16 a[132:135], a[156:159], v[44:47], a[132:135]
  s_waitcnt lgkmcnt(5)
  ds_read_b128 v[224:227], v26 offset:49152
  v_mfma_f32_32x32x16_bf16 v[96:111], a[32:35], v[44:47], v[96:111]
  s_waitcnt lgkmcnt(4)
  ds_read_b128 v[228:231], v27 offset:49152
  ds_read_b64_tr_b16 v[56:57], v2 offset:32840
  buffer_load_dwordx4 v22, s[4:7], s44 offen lds
  v_mfma_f32_32x32x16_bf16 v[112:127], a[36:39], v[44:47], v[112:127]
  s_waitcnt lgkmcnt(5)
  ds_read_b128 v[232:235], v28 offset:49152
  ds_read_b64_tr_b16 v[58:59], v2 offset:35912
  v_mfma_f32_16x16x32_bf16 a[144:147], a[156:159], v[48:51], a[144:147]
  ds_read_b128 v[236:239], v29 offset:49152
  v_mfma_f32_32x32x16_bf16 v[192:207], a[32:35], v[48:51], v[192:207]
  ds_read_b64_tr_b16 v[60:61], v2 offset:33128
  buffer_load_dwordx4 v23, s[4:7], s44 offen offset:1024 lds
  v_mfma_f32_32x32x16_bf16 v[208:223], a[36:39], v[48:51], v[208:223]
  s_waitcnt lgkmcnt(7)
  ds_read_b64_tr_b16 v[62:63], v2 offset:36200
  v_mfma_f32_16x16x32_bf16 a[128:131], a[156:159], v[52:55], a[128:131]
  v_mfma_f32_32x32x16_bf16 v[64:79], a[32:35], v[52:55], v[64:79]
  ds_read_b64_tr_b16 v[44:45], v3 offset:16672
  buffer_load_dwordx4 v24, s[4:7], s44 offen offset:2048 lds
  v_mfma_f32_32x32x16_bf16 v[80:95], a[36:39], v[52:55], v[80:95]
  s_waitcnt lgkmcnt(4)
  ds_read_b64_tr_b16 v[46:47], v3 offset:19744
  v_dot2_f32_bf16 v240, v224, s50, v240
  v_dot2_f32_bf16 v244, v224, v224, v244
  v_dot2_f32_bf16 v241, v225, s50, v241
  v_dot2_f32_bf16 v245, v225, v225, v245
  v_dot2_f32_bf16 v242, v226, s50, v242
  v_dot2_f32_bf16 v246, v226, v226, v246
  v_dot2_f32_bf16 v243, v227, s50, v243
  v_dot2_f32_bf16 v247, v227, v227, v247
  v_dot2_f32_bf16 v240, v228, s50, v240
  v_dot2_f32_bf16 v244, v228, v228, v244
  v_dot2_f32_bf16 v241, v229, s50, v241
  v_dot2_f32_bf16 v245, v229, v229, v245
  v_dot2_f32_bf16 v242, v230, s50, v242
  v_dot2_f32_bf16 v246, v230, v230, v246
  v_dot2_f32_bf16 v243, v231, s50, v243
  v_dot2_f32_bf16 v247, v231, v231, v247
  v_dot2_f32_bf16 v240, v232, s50, v240
  v_dot2_f32_bf16 v244, v232, v232, v244
  v_dot2_f32_bf16 v241, v233, s50, v241
  v_dot2_f32_bf16 v245, v233, v233, v245
  v_dot2_f32_bf16 v242, v234, s50, v242
  v_dot2_f32_bf16 v246, v234, v234, v246
  v_dot2_f32_bf16 v243, v235, s50, v243
  v_dot2_f32_bf16 v247, v235, v235, v247
  s_waitcnt lgkmcnt(4)
  v_dot2_f32_bf16 v240, v236, s50, v240
  v_dot2_f32_bf16 v244, v236, v236, v244
  v_dot2_f32_bf16 v241, v237, s50, v241
  v_dot2_f32_bf16 v245, v237, v237, v245
  v_dot2_f32_bf16 v242, v238, s50, v242
  v_dot2_f32_bf16 v246, v238, v238, v246
  v_dot2_f32_bf16 v243, v239, s50, v243
  v_dot2_f32_bf16 v247, v239, v239, v247
  v_mfma_f32_16x16x32_bf16 a[136:139], a[156:159], v[56:59], a[136:139]
  v_mfma_f32_32x32x16_bf16 v[128:143], a[32:35], v[56:59], v[128:143]
  ds_read_b128 a[40:43], v10 offset:49152
  ds_read_b64_tr_b16 v[48:49], v5 offset:16384
  buffer_load_dwordx4 v25, s[4:7], s44 offen offset:3072 lds
  v_mfma_f32_32x32x16_bf16 v[144:159], a[36:39], v[56:59], v[144:159]
  s_waitcnt lgkmcnt(4)
  s_add_u32 s45, s74, 0xd800
  s_add_u32 m0, s55, 0x2000
  ds_read_b128 a[44:47], v10 offset:53248
  ds_read_b64_tr_b16 v[50:51], v5 offset:19456
  v_mfma_f32_16x16x32_bf16 a[140:143], a[156:159], v[60:63], a[140:143]
  v_mfma_f32_32x32x16_bf16 v[160:175], a[32:35], v[60:63], v[160:175]
  ds_read_b64_tr_b16 v[52:53], v3 offset:16384
  buffer_load_dwordx4 v16, s[8:11], s45 offen lds
  v_mfma_f32_32x32x16_bf16 v[176:191], a[36:39], v[60:63], v[176:191]
  s_waitcnt lgkmcnt(5)
  ds_read_b64_tr_b16 v[54:55], v3 offset:19456
  v_mfma_f32_16x16x32_bf16 a[132:135], a[156:159], v[44:47], a[132:135]
  s_waitcnt lgkmcnt(5)
  v_mfma_f32_32x32x16_bf16 v[96:111], a[40:43], v[44:47], v[96:111]
  s_waitcnt lgkmcnt(3)
  ds_read_b64_tr_b16 v[56:57], v3 offset:16456
  buffer_load_dwordx4 v17, s[8:11], s45 offen offset:1024 lds
  v_mfma_f32_32x32x16_bf16 v[112:127], a[44:47], v[44:47], v[112:127]
  s_waitcnt lgkmcnt(3)
  ds_read_b64_tr_b16 v[58:59], v3 offset:19528
  v_mfma_f32_16x16x32_bf16 a[144:147], a[156:159], v[48:51], a[144:147]
  v_mfma_f32_32x32x16_bf16 v[192:207], a[40:43], v[48:51], v[192:207]
  ds_read_b64_tr_b16 v[60:61], v3 offset:16744
  buffer_load_dwordx4 v18, s[8:11], s45 offen offset:2048 lds
  v_mfma_f32_32x32x16_bf16 v[208:223], a[44:47], v[48:51], v[208:223]
  s_waitcnt lgkmcnt(3)
  s_add_u32 s44, s74, 0x1b000
  ds_read_b64_tr_b16 v[62:63], v3 offset:19816
  v_mfma_f32_16x16x32_bf16 a[128:131], a[156:159], v[52:55], a[128:131]
  s_waitcnt vmcnt(12)
  s_barrier
  v_mfma_f32_32x32x16_bf16 v[64:79], a[40:43], v[52:55], v[64:79]
  s_add_u32 m0, s55, 0x5000
  ds_read_b64_tr_b16 v[44:45], v2 offset:45344
  v_mfma_f32_32x32x16_bf16 v[80:95], a[44:47], v[52:55], v[80:95]
  s_waitcnt lgkmcnt(3)
  ds_read_b64_tr_b16 v[46:47], v2 offset:48416
  buffer_load_dwordx4 v16, s[8:11], s44 offen lds
  v_mfma_f32_16x16x32_bf16 a[136:139], a[156:159], v[56:59], a[136:139]
  v_mfma_f32_32x32x16_bf16 v[128:143], a[40:43], v[56:59], v[128:143]
  ds_read_b128 a[48:51], v11 offset:49152
  ds_read_b64_tr_b16 v[48:49], v4 offset:45056
  buffer_load_dwordx4 v17, s[8:11], s44 offen offset:1024 lds
  v_mfma_f32_32x32x16_bf16 v[144:159], a[44:47], v[56:59], v[144:159]
  s_waitcnt lgkmcnt(4)
  ds_read_b128 a[52:55], v11 offset:53248
  ds_read_b64_tr_b16 v[50:51], v4 offset:48128
  v_mfma_f32_16x16x32_bf16 a[140:143], a[156:159], v[60:63], a[140:143]
  v_mfma_f32_32x32x16_bf16 v[160:175], a[40:43], v[60:63], v[160:175]
  ds_read_b64_tr_b16 v[52:53], v2 offset:45056
  buffer_load_dwordx4 v18, s[8:11], s44 offen offset:2048 lds
  v_mfma_f32_32x32x16_bf16 v[176:191], a[44:47], v[60:63], v[176:191]
  s_waitcnt lgkmcnt(5)
  s_add_u32 s45, s74, 0x28800
  s_add_u32 m0, s55, 0x8000
  ds_read_b64_tr_b16 v[54:55], v2 offset:48128
  v_mfma_f32_16x16x32_bf16 a[132:135], a[156:159], v[44:47], a[132:135]
  s_waitcnt lgkmcnt(5)
  v_mfma_f32_32x32x16_bf16 v[96:111], a[48:51], v[44:47], v[96:111]
  s_waitcnt lgkmcnt(3)
  ds_read_b64_tr_b16 v[56:57], v2 offset:45128
  buffer_load_dwordx4 v16, s[8:11], s45 offen lds
  v_mfma_f32_32x32x16_bf16 v[112:127], a[52:55], v[44:47], v[112:127]
  s_waitcnt lgkmcnt(3)
  ds_read_b64_tr_b16 v[58:59], v2 offset:48200
  v_mfma_f32_16x16x32_bf16 a[144:147], a[156:159], v[48:51], a[144:147]
  v_mfma_f32_32x32x16_bf16 v[192:207], a[48:51], v[48:51], v[192:207]
  ds_read_b64_tr_b16 v[60:61], v2 offset:45416
  buffer_load_dwordx4 v17, s[8:11], s45 offen offset:1024 lds
  v_mfma_f32_32x32x16_bf16 v[208:223], a[52:55], v[48:51], v[208:223]
  s_waitcnt lgkmcnt(3)
  ds_read_b64_tr_b16 v[62:63], v2 offset:48488
  v_mfma_f32_16x16x32_bf16 a[128:131], a[156:159], v[52:55], a[128:131]
  v_mfma_f32_32x32x16_bf16 v[64:79], a[48:51], v[52:55], v[64:79]
  ds_read_b64_tr_b16 v[44:45], v2 offset:57632
  buffer_load_dwordx4 v18, s[8:11], s45 offen offset:2048 lds
  v_mfma_f32_32x32x16_bf16 v[80:95], a[52:55], v[52:55], v[80:95]
  s_waitcnt lgkmcnt(3)
  s_add_u32 s44, s75, 0x0
  ds_read_b64_tr_b16 v[46:47], v2 offset:60704
  v_mfma_f32_16x16x32_bf16 a[136:139], a[156:159], v[56:59], a[136:139]
  v_mfma_f32_32x32x16_bf16 v[128:143], a[48:51], v[56:59], v[128:143]
  ds_read_b128 a[56:59], v12 offset:49152
  ds_read_b64_tr_b16 v[48:49], v4 offset:57344
  v_mfma_f32_32x32x16_bf16 v[144:159], a[52:55], v[56:59], v[144:159]
  s_waitcnt lgkmcnt(4)
  ds_read_b128 a[60:63], v12 offset:53248
  ds_read_b64_tr_b16 v[50:51], v4 offset:60416
  v_mfma_f32_16x16x32_bf16 a[140:143], a[156:159], v[60:63], a[140:143]
  v_mfma_f32_32x32x16_bf16 v[160:175], a[48:51], v[60:63], v[160:175]
  ds_read_b64_tr_b16 v[52:53], v2 offset:57344
  v_mfma_f32_32x32x16_bf16 v[176:191], a[52:55], v[60:63], v[176:191]
  s_waitcnt lgkmcnt(5)
  ds_read_b64_tr_b16 v[54:55], v2 offset:60416
  v_mfma_f32_16x16x32_bf16 a[132:135], a[156:159], v[44:47], a[132:135]
  s_waitcnt lgkmcnt(5)
  v_mfma_f32_32x32x16_bf16 v[96:111], a[56:59], v[44:47], v[96:111]
  s_waitcnt lgkmcnt(3)
  ds_read_b64_tr_b16 v[56:57], v2 offset:57416
  v_mfma_f32_32x32x16_bf16 v[112:127], a[60:63], v[44:47], v[112:127]
  s_waitcnt lgkmcnt(3)
  ds_read_b64_tr_b16 v[58:59], v2 offset:60488
  v_mfma_f32_16x16x32_bf16 a[144:147], a[156:159], v[48:51], a[144:147]
  v_mfma_f32_32x32x16_bf16 v[192:207], a[56:59], v[48:51], v[192:207]
  ds_read_b64_tr_b16 v[60:61], v2 offset:57704
  v_mfma_f32_32x32x16_bf16 v[208:223], a[60:63], v[48:51], v[208:223]
  s_waitcnt lgkmcnt(3)
  ds_read_b64_tr_b16 v[62:63], v2 offset:60776
  v_mfma_f32_16x16x32_bf16 a[128:131], a[156:159], v[52:55], a[128:131]
  s_waitcnt vmcnt(6)
  s_barrier
  v_mfma_f32_32x32x16_bf16 v[64:79], a[56:59], v[52:55], v[64:79]
  s_add_u32 m0, s55, 0x14000
  ds_read_b64_tr_b16 v[44:45], v3 offset:4384
  v_mfma_f32_32x32x16_bf16 v[80:95], a[60:63], v[52:55], v[80:95]
  s_waitcnt lgkmcnt(3)
  ds_read_b64_tr_b16 v[46:47], v3 offset:7456
  buffer_load_dwordx4 v16, s[8:11], s44 offen lds
  v_mfma_f32_16x16x32_bf16 a[136:139], a[156:159], v[56:59], a[136:139]
  v_mfma_f32_32x32x16_bf16 v[128:143], a[56:59], v[56:59], v[128:143]
  ds_read_b128 a[0:3], v9 offset:16384
  ds_read_b64_tr_b16 v[48:49], v5 offset:4096
  buffer_load_dwordx4 v17, s[8:11], s44 offen offset:1024 lds
  v_mfma_f32_32x32x16_bf16 v[144:159], a[60:63], v[56:59], v[144:159]
  s_waitcnt lgkmcnt(4)
  ds_read_b128 a[4:7], v9 offset:20480
  ds_read_b64_tr_b16 v[50:51], v5 offset:7168
  v_mfma_f32_16x16x32_bf16 a[140:143], a[156:159], v[60:63], a[140:143]
  v_mfma_f32_32x32x16_bf16 v[160:175], a[56:59], v[60:63], v[160:175]
  ds_read_b64_tr_b16 v[52:53], v3 offset:4096
  buffer_load_dwordx4 v18, s[8:11], s44 offen offset:2048 lds
  v_mfma_f32_32x32x16_bf16 v[176:191], a[60:63], v[60:63], v[176:191]
  s_waitcnt lgkmcnt(5)
  s_add_u32 s45, s61, 0x0
  s_add_u32 m0, s3, 0x20000
  ds_read_b64_tr_b16 v[54:55], v3 offset:7168
  v_mfma_f32_16x16x32_bf16 a[132:135], a[156:159], v[44:47], a[132:135]
  s_waitcnt lgkmcnt(5)
  ds_read_b128 v[224:227], v26 offset:16384
  v_mfma_f32_32x32x16_bf16 v[96:111], a[0:3], v[44:47], v[96:111]
  s_waitcnt lgkmcnt(4)
  ds_read_b128 v[228:231], v27 offset:16384
  ds_read_b64_tr_b16 v[56:57], v3 offset:4168
  buffer_load_dwordx4 v22, s[4:7], s45 offen lds
  v_mfma_f32_32x32x16_bf16 v[112:127], a[4:7], v[44:47], v[112:127]
  s_waitcnt lgkmcnt(5)
  ds_read_b128 v[232:235], v28 offset:16384
  ds_read_b64_tr_b16 v[58:59], v3 offset:7240
  v_mfma_f32_16x16x32_bf16 a[144:147], a[156:159], v[48:51], a[144:147]
  ds_read_b128 v[236:239], v29 offset:16384
  v_mfma_f32_32x32x16_bf16 v[192:207], a[0:3], v[48:51], v[192:207]
  ds_read_b64_tr_b16 v[60:61], v3 offset:4456
  buffer_load_dwordx4 v23, s[4:7], s45 offen offset:1024 lds
  v_mfma_f32_32x32x16_bf16 v[208:223], a[4:7], v[48:51], v[208:223]
  s_waitcnt lgkmcnt(7)
  ds_read_b64_tr_b16 v[62:63], v3 offset:7528
  v_mfma_f32_16x16x32_bf16 a[128:131], a[156:159], v[52:55], a[128:131]
  v_mfma_f32_32x32x16_bf16 v[64:79], a[0:3], v[52:55], v[64:79]
  ds_read_b64_tr_b16 v[44:45], v2 offset:8480
  buffer_load_dwordx4 v24, s[4:7], s45 offen offset:2048 lds
  v_mfma_f32_32x32x16_bf16 v[80:95], a[4:7], v[52:55], v[80:95]
  s_waitcnt lgkmcnt(4)
  ds_read_b64_tr_b16 v[46:47], v2 offset:11552
  v_dot2_f32_bf16 v240, v224, s50, v240
  v_dot2_f32_bf16 v244, v224, v224, v244
  v_dot2_f32_bf16 v241, v225, s50, v241
  v_dot2_f32_bf16 v245, v225, v225, v245
  v_dot2_f32_bf16 v242, v226, s50, v242
  v_dot2_f32_bf16 v246, v226, v226, v246
  v_dot2_f32_bf16 v243, v227, s50, v243
  v_dot2_f32_bf16 v247, v227, v227, v247
  v_dot2_f32_bf16 v240, v228, s50, v240
  v_dot2_f32_bf16 v244, v228, v228, v244
  v_dot2_f32_bf16 v241, v229, s50, v241
  v_dot2_f32_bf16 v245, v229, v229, v245
  v_dot2_f32_bf16 v242, v230, s50, v242
  v_dot2_f32_bf16 v246, v230, v230, v246
  v_dot2_f32_bf16 v243, v231, s50, v243
  v_dot2_f32_bf16 v247, v231, v231, v247
  v_dot2_f32_bf16 v240, v232, s50, v240
  v_dot2_f32_bf16 v244, v232, v232, v244
  v_dot2_f32_bf16 v241, v233, s50, v241
  v_dot2_f32_bf16 v245, v233, v233, v245
  v_dot2_f32_bf16 v242, v234, s50, v242
  v_dot2_f32_bf16 v246, v234, v234, v246
  v_dot2_f32_bf16 v243, v235, s50, v243
  v_dot2_f32_bf16 v247, v235, v235, v247
  s_waitcnt lgkmcnt(4)
  v_dot2_f32_bf16 v240, v236, s50, v240
  v_dot2_f32_bf16 v244, v236, v236, v244
  v_dot2_f32_bf16 v241, v237, s50, v241
  v_dot2_f32_bf16 v245, v237, v237, v245
  v_dot2_f32_bf16 v242, v238, s50, v242
  v_dot2_f32_bf16 v246, v238, v238, v246
  v_dot2_f32_bf16 v243, v239, s50, v243
  v_dot2_f32_bf16 v247, v239, v239, v247
  v_mfma_f32_16x16x32_bf16 a[136:139], a[156:159], v[56:59], a[136:139]
  v_mfma_f32_32x32x16_bf16 v[128:143], a[0:3], v[56:59], v[128:143]
  ds_read_b128 a[8:11], v10 offset:16384
  ds_read_b64_tr_b16 v[48:49], v4 offset:8192
  buffer_load_dwordx4 v25, s[4:7], s45 offen offset:3072 lds
  v_mfma_f32_32x32x16_bf16 v[144:159], a[4:7], v[56:59], v[144:159]
  s_waitcnt lgkmcnt(4)
  s_add_u32 s44, s75, 0xd800
  s_add_u32 m0, s55, 0xb000
  ds_read_b128 a[12:15], v10 offset:20480
  ds_read_b64_tr_b16 v[50:51], v4 offset:11264
  v_mfma_f32_16x16x32_bf16 a[140:143], a[156:159], v[60:63], a[140:143]
  v_mfma_f32_32x32x16_bf16 v[160:175], a[0:3], v[60:63], v[160:175]
  ds_read_b64_tr_b16 v[52:53], v2 offset:8192
  buffer_load_dwordx4 v16, s[8:11], s44 offen lds
  v_mfma_f32_32x32x16_bf16 v[176:191], a[4:7], v[60:63], v[176:191]
  s_waitcnt lgkmcnt(5)
  ds_read_b64_tr_b16 v[54:55], v2 offset:11264
  v_mfma_f32_16x16x32_bf16 a[132:135], a[156:159], v[44:47], a[132:135]
  s_waitcnt lgkmcnt(5)
  v_mfma_f32_32x32x16_bf16 v[96:111], a[8:11], v[44:47], v[96:111]
  s_waitcnt lgkmcnt(3)
  ds_read_b64_tr_b16 v[56:57], v2 offset:8264
  buffer_load_dwordx4 v17, s[8:11], s44 offen offset:1024 lds
  v_mfma_f32_32x32x16_bf16 v[112:127], a[12:15], v[44:47], v[112:127]
  s_waitcnt lgkmcnt(3)
  ds_read_b64_tr_b16 v[58:59], v2 offset:11336
  v_mfma_f32_16x16x32_bf16 a[144:147], a[156:159], v[48:51], a[144:147]
  v_mfma_f32_32x32x16_bf16 v[192:207], a[8:11], v[48:51], v[192:207]
  ds_read_b64_tr_b16 v[60:61], v2 offset:8552
  buffer_load_dwordx4 v18, s[8:11], s44 offen offset:2048 lds
  v_mfma_f32_32x32x16_bf16 v[208:223], a[12:15], v[48:51], v[208:223]
  s_waitcnt lgkmcnt(3)
  s_add_u32 s45, s75, 0x1b000
  ds_read_b64_tr_b16 v[62:63], v2 offset:11624
  v_mfma_f32_16x16x32_bf16 a[128:131], a[156:159], v[52:55], a[128:131]
  s_waitcnt vmcnt(10)
  s_barrier
  v_mfma_f32_32x32x16_bf16 v[64:79], a[8:11], v[52:55], v[64:79]
  s_add_u32 m0, s55, 0xe000
  ds_read_b64_tr_b16 v[44:45], v2 offset:20768
  v_mfma_f32_32x32x16_bf16 v[80:95], a[12:15], v[52:55], v[80:95]
  s_waitcnt lgkmcnt(3)
  ds_read_b64_tr_b16 v[46:47], v2 offset:23840
  buffer_load_dwordx4 v16, s[8:11], s45 offen lds
  v_mfma_f32_16x16x32_bf16 a[136:139], a[156:159], v[56:59], a[136:139]
  v_mfma_f32_32x32x16_bf16 v[128:143], a[8:11], v[56:59], v[128:143]
  ds_read_b128 a[16:19], v11 offset:16384
  ds_read_b64_tr_b16 v[48:49], v4 offset:20480
  buffer_load_dwordx4 v17, s[8:11], s45 offen offset:1024 lds
  v_mfma_f32_32x32x16_bf16 v[144:159], a[12:15], v[56:59], v[144:159]
  s_waitcnt lgkmcnt(4)
  ds_read_b128 a[20:23], v11 offset:20480
  ds_read_b64_tr_b16 v[50:51], v4 offset:23552
  v_mfma_f32_16x16x32_bf16 a[140:143], a[156:159], v[60:63], a[140:143]
  v_mfma_f32_32x32x16_bf16 v[160:175], a[8:11], v[60:63], v[160:175]
  ds_read_b64_tr_b16 v[52:53], v2 offset:20480
  buffer_load_dwordx4 v18, s[8:11], s45 offen offset:2048 lds
  v_mfma_f32_32x32x16_bf16 v[176:191], a[12:15], v[60:63], v[176:191]
  s_waitcnt lgkmcnt(5)
  s_add_u32 s44, s75, 0x28800
  s_add_u32 m0, s55, 0x11000
  ds_read_b64_tr_b16 v[54:55], v2 offset:23552
  v_mfma_f32_16x16x32_bf16 a[132:135], a[156:159], v[44:47], a[132:135]
  s_waitcnt lgkmcnt(5)
  v_mfma_f32_32x32x16_bf16 v[96:111], a[16:19], v[44:47], v[96:111]
  s_waitcnt lgkmcnt(3)
  ds_read_b64_tr_b16 v[56:57], v2 offset:20552
  buffer_load_dwordx4 v16, s[8:11], s44 offen lds
  v_mfma_f32_32x32x16_bf16 v[112:127], a[20:23], v[44:47], v[112:127]
  s_waitcnt lgkmcnt(3)
  ds_read_b64_tr_b16 v[58:59], v2 offset:23624
  v_mfma_f32_16x16x32_bf16 a[144:147], a[156:159], v[48:51], a[144:147]
  v_mfma_f32_32x32x16_bf16 v[192:207], a[16:19], v[48:51], v[192:207]
  ds_read_b64_tr_b16 v[60:61], v2 offset:20840
  buffer_load_dwordx4 v17, s[8:11], s44 offen offset:1024 lds
  v_mfma_f32_32x32x16_bf16 v[208:223], a[20:23], v[48:51], v[208:223]
  s_waitcnt lgkmcnt(3)
  ds_read_b64_tr_b16 v[62:63], v2 offset:23912
  v_mfma_f32_16x16x32_bf16 a[128:131], a[156:159], v[52:55], a[128:131]
  v_mfma_f32_32x32x16_bf16 v[64:79], a[16:19], v[52:55], v[64:79]
  ds_read_b64_tr_b16 v[44:45], v2 offset:33056
  buffer_load_dwordx4 v18, s[8:11], s44 offen offset:2048 lds
  v_mfma_f32_32x32x16_bf16 v[80:95], a[20:23], v[52:55], v[80:95]
  s_waitcnt lgkmcnt(3)
  s_add_u32 s45, s76, 0x0
  ds_read_b64_tr_b16 v[46:47], v2 offset:36128
  v_mfma_f32_16x16x32_bf16 a[136:139], a[156:159], v[56:59], a[136:139]
  v_mfma_f32_32x32x16_bf16 v[128:143], a[16:19], v[56:59], v[128:143]
  ds_read_b128 a[24:27], v12 offset:16384
  ds_read_b64_tr_b16 v[48:49], v4 offset:32768
  v_mfma_f32_32x32x16_bf16 v[144:159], a[20:23], v[56:59], v[144:159]
  s_waitcnt lgkmcnt(4)
  ds_read_b128 a[28:31], v12 offset:20480
  ds_read_b64_tr_b16 v[50:51], v4 offset:35840
  v_mfma_f32_16x16x32_bf16 a[140:143], a[156:159], v[60:63], a[140:143]
  v_mfma_f32_32x32x16_bf16 v[160:175], a[16:19], v[60:63], v[160:175]
  ds_read_b64_tr_b16 v[52:53], v2 offset:32768
  v_mfma_f32_32x32x16_bf16 v[176:191], a[20:23], v[60:63], v[176:191]
  s_waitcnt lgkmcnt(5)
  ds_read_b64_tr_b16 v[54:55], v2 offset:35840
  v_mfma_f32_16x16x32_bf16 a[132:135], a[156:159], v[44:47], a[132:135]
  s_waitcnt lgkmcnt(5)
  v_mfma_f32_32x32x16_bf16 v[96:111], a[24:27], v[44:47], v[96:111]
  s_waitcnt lgkmcnt(3)
  ds_read_b64_tr_b16 v[56:57], v2 offset:32840
  v_mfma_f32_32x32x16_bf16 v[112:127], a[28:31], v[44:47], v[112:127]
  s_waitcnt lgkmcnt(3)
  ds_read_b64_tr_b16 v[58:59], v2 offset:35912
  v_mfma_f32_16x16x32_bf16 a[144:147], a[156:159], v[48:51], a[144:147]
  v_mfma_f32_32x32x16_bf16 v[192:207], a[24:27], v[48:51], v[192:207]
  ds_read_b64_tr_b16 v[60:61], v2 offset:33128
  v_mfma_f32_32x32x16_bf16 v[208:223], a[28:31], v[48:51], v[208:223]
  s_waitcnt lgkmcnt(3)
  ds_read_b64_tr_b16 v[62:63], v2 offset:36200
  v_mfma_f32_16x16x32_bf16 a[128:131], a[156:159], v[52:55], a[128:131]
  s_waitcnt vmcnt(6)
  s_barrier
  v_mfma_f32_32x32x16_bf16 v[64:79], a[24:27], v[52:55], v[64:79]
  s_add_u32 m0, s55, 0x2000
  ds_read_b64_tr_b16 v[44:45], v3 offset:16672
  v_mfma_f32_32x32x16_bf16 v[80:95], a[28:31], v[52:55], v[80:95]
  s_waitcnt lgkmcnt(3)
  ds_read_b64_tr_b16 v[46:47], v3 offset:19744
  buffer_load_dwordx4 v16, s[8:11], s45 offen lds
  v_mfma_f32_16x16x32_bf16 a[136:139], a[156:159], v[56:59], a[136:139]
  v_mfma_f32_32x32x16_bf16 v[128:143], a[24:27], v[56:59], v[128:143]
  ds_read_b128 a[32:35], v9 offset:32768
  ds_read_b64_tr_b16 v[48:49], v5 offset:16384
  buffer_load_dwordx4 v17, s[8:11], s45 offen offset:1024 lds
  v_mfma_f32_32x32x16_bf16 v[144:159], a[28:31], v[56:59], v[144:159]
  s_waitcnt lgkmcnt(4)
  ds_read_b128 a[36:39], v9 offset:36864
  ds_read_b64_tr_b16 v[50:51], v5 offset:19456
  v_mfma_f32_16x16x32_bf16 a[140:143], a[156:159], v[60:63], a[140:143]
  v_mfma_f32_32x32x16_bf16 v[160:175], a[24:27], v[60:63], v[160:175]
  ds_read_b64_tr_b16 v[52:53], v3 offset:16384
  buffer_load_dwordx4 v18, s[8:11], s45 offen offset:2048 lds
  v_mfma_f32_32x32x16_bf16 v[176:191], a[28:31], v[60:63], v[176:191]
  s_waitcnt lgkmcnt(5)
  s_add_u32 s44, s62, 0x0
  s_add_u32 m0, s3, 0x24000
  ds_read_b64_tr_b16 v[54:55], v3 offset:19456
  v_mfma_f32_16x16x32_bf16 a[132:135], a[156:159], v[44:47], a[132:135]
  s_waitcnt lgkmcnt(5)
  ds_read_b128 v[224:227], v26 offset:32768
  v_mfma_f32_32x32x16_bf16 v[96:111], a[32:35], v[44:47], v[96:111]
  s_waitcnt lgkmcnt(4)
  ds_read_b128 v[228:231], v27 offset:32768
  ds_read_b64_tr_b16 v[56:57], v3 offset:16456
  buffer_load_dwordx4 v22, s[4:7], s44 offen lds
  v_mfma_f32_32x32x16_bf16 v[112:127], a[36:39], v[44:47], v[112:127]
  s_waitcnt lgkmcnt(5)
  ds_read_b128 v[232:235], v28 offset:32768
  ds_read_b64_tr_b16 v[58:59], v3 offset:19528
  v_mfma_f32_16x16x32_bf16 a[144:147], a[156:159], v[48:51], a[144:147]
  ds_read_b128 v[236:239], v29 offset:32768
  v_mfma_f32_32x32x16_bf16 v[192:207], a[32:35], v[48:51], v[192:207]
  ds_read_b64_tr_b16 v[60:61], v3 offset:16744
  buffer_load_dwordx4 v23, s[4:7], s44 offen offset:1024 lds
  v_mfma_f32_32x32x16_bf16 v[208:223], a[36:39], v[48:51], v[208:223]
  s_waitcnt lgkmcnt(7)
  ds_read_b64_tr_b16 v[62:63], v3 offset:19816
  v_mfma_f32_16x16x32_bf16 a[128:131], a[156:159], v[52:55], a[128:131]
  v_mfma_f32_32x32x16_bf16 v[64:79], a[32:35], v[52:55], v[64:79]
  ds_read_b64_tr_b16 v[44:45], v2 offset:45344
  buffer_load_dwordx4 v24, s[4:7], s44 offen offset:2048 lds
  v_mfma_f32_32x32x16_bf16 v[80:95], a[36:39], v[52:55], v[80:95]
  s_waitcnt lgkmcnt(4)
  ds_read_b64_tr_b16 v[46:47], v2 offset:48416
  v_dot2_f32_bf16 v240, v224, s50, v240
  v_dot2_f32_bf16 v244, v224, v224, v244
  v_dot2_f32_bf16 v241, v225, s50, v241
  v_dot2_f32_bf16 v245, v225, v225, v245
  v_dot2_f32_bf16 v242, v226, s50, v242
  v_dot2_f32_bf16 v246, v226, v226, v246
  v_dot2_f32_bf16 v243, v227, s50, v243
  v_dot2_f32_bf16 v247, v227, v227, v247
  v_dot2_f32_bf16 v240, v228, s50, v240
  v_dot2_f32_bf16 v244, v228, v228, v244
  v_dot2_f32_bf16 v241, v229, s50, v241
  v_dot2_f32_bf16 v245, v229, v229, v245
  v_dot2_f32_bf16 v242, v230, s50, v242
  v_dot2_f32_bf16 v246, v230, v230, v246
  v_dot2_f32_bf16 v243, v231, s50, v243
  v_dot2_f32_bf16 v247, v231, v231, v247
  v_dot2_f32_bf16 v240, v232, s50, v240
  v_dot2_f32_bf16 v244, v232, v232, v244
  v_dot2_f32_bf16 v241, v233, s50, v241
  v_dot2_f32_bf16 v245, v233, v233, v245
  v_dot2_f32_bf16 v242, v234, s50, v242
  v_dot2_f32_bf16 v246, v234, v234, v246
  v_dot2_f32_bf16 v243, v235, s50, v243
  v_dot2_f32_bf16 v247, v235, v235, v247
  s_waitcnt lgkmcnt(4)
  v_dot2_f32_bf16 v240, v236, s50, v240
  v_dot2_f32_bf16 v244, v236, v236, v244
  v_dot2_f32_bf16 v241, v237, s50, v241
  v_dot2_f32_bf16 v245, v237, v237, v245
  v_dot2_f32_bf16 v242, v238, s50, v242
  v_dot2_f32_bf16 v246, v238, v238, v246
  v_dot2_f32_bf16 v243, v239, s50, v243
  v_dot2_f32_bf16 v247, v239, v239, v247
  v_mfma_f32_16x16x32_bf16 a[136:139], a[156:159], v[56:59], a[136:139]
  v_mfma_f32_32x32x16_bf16 v[128:143], a[32:35], v[56:59], v[128:143]
  ds_read_b128 a[40:43], v10 offset:32768
  ds_read_b64_tr_b16 v[48:49], v4 offset:45056
  buffer_load_dwordx4 v25, s[4:7], s44 offen offset:3072 lds
  v_mfma_f32_32x32x16_bf16 v[144:159], a[36:39], v[56:59], v[144:159]
  s_waitcnt lgkmcnt(4)
  s_add_u32 s45, s76, 0xd800
  s_add_u32 m0, s55, 0x5000
  ds_read_b128 a[44:47], v10 offset:36864
  ds_read_b64_tr_b16 v[50:51], v4 offset:48128
  v_mfma_f32_16x16x32_bf16 a[140:143], a[156:159], v[60:63], a[140:143]
  v_mfma_f32_32x32x16_bf16 v[160:175], a[32:35], v[60:63], v[160:175]
  ds_read_b64_tr_b16 v[52:53], v2 offset:45056
  buffer_load_dwordx4 v16, s[8:11], s45 offen lds
  v_mfma_f32_32x32x16_bf16 v[176:191], a[36:39], v[60:63], v[176:191]
  s_waitcnt lgkmcnt(5)
  ds_read_b64_tr_b16 v[54:55], v2 offset:48128
  v_mfma_f32_16x16x32_bf16 a[132:135], a[156:159], v[44:47], a[132:135]
  s_waitcnt lgkmcnt(5)
  v_mfma_f32_32x32x16_bf16 v[96:111], a[40:43], v[44:47], v[96:111]
  s_waitcnt lgkmcnt(3)
  ds_read_b64_tr_b16 v[56:57], v2 offset:45128
  buffer_load_dwordx4 v17, s[8:11], s45 offen offset:1024 lds
  v_mfma_f32_32x32x16_bf16 v[112:127], a[44:47], v[44:47], v[112:127]
  s_waitcnt lgkmcnt(3)
  ds_read_b64_tr_b16 v[58:59], v2 offset:48200
  v_mfma_f32_16x16x32_bf16 a[144:147], a[156:159], v[48:51], a[144:147]
  v_mfma_f32_32x32x16_bf16 v[192:207], a[40:43], v[48:51], v[192:207]
  ds_read_b64_tr_b16 v[60:61], v2 offset:45416
  buffer_load_dwordx4 v18, s[8:11], s45 offen offset:2048 lds
  v_mfma_f32_32x32x16_bf16 v[208:223], a[44:47], v[48:51], v[208:223]
  s_waitcnt lgkmcnt(3)
  s_add_u32 s44, s76, 0x1b000
  ds_read_b64_tr_b16 v[62:63], v2 offset:48488
  v_mfma_f32_16x16x32_bf16 a[128:131], a[156:159], v[52:55], a[128:131]
  s_waitcnt vmcnt(10)
  s_barrier
  v_mfma_f32_32x32x16_bf16 v[64:79], a[40:43], v[52:55], v[64:79]
  s_add_u32 m0, s55, 0x8000
  ds_read_b64_tr_b16 v[44:45], v2 offset:57632
  v_mfma_f32_32x32x16_bf16 v[80:95], a[44:47], v[52:55], v[80:95]
  s_waitcnt lgkmcnt(3)
  ds_read_b64_tr_b16 v[46:47], v2 offset:60704
  buffer_load_dwordx4 v16, s[8:11], s44 offen lds
  v_mfma_f32_16x16x32_bf16 a[136:139], a[156:159], v[56:59], a[136:139]
  v_mfma_f32_32x32x16_bf16 v[128:143], a[40:43], v[56:59], v[128:143]
  ds_read_b128 a[48:51], v11 offset:32768
  ds_read_b64_tr_b16 v[48:49], v4 offset:57344
  buffer_load_dwordx4 v17, s[8:11], s44 offen offset:1024 lds
  v_mfma_f32_32x32x16_bf16 v[144:159], a[44:47], v[56:59], v[144:159]
  s_waitcnt lgkmcnt(4)
  ds_read_b128 a[52:55], v11 offset:36864
  ds_read_b64_tr_b16 v[50:51], v4 offset:60416
  v_mfma_f32_16x16x32_bf16 a[140:143], a[156:159], v[60:63], a[140:143]
  v_mfma_f32_32x32x16_bf16 v[160:175], a[40:43], v[60:63], v[160:175]
  ds_read_b64_tr_b16 v[52:53], v2 offset:57344
  buffer_load_dwordx4 v18, s[8:11], s44 offen offset:2048 lds
  v_mfma_f32_32x32x16_bf16 v[176:191], a[44:47], v[60:63], v[176:191]
  s_waitcnt lgkmcnt(5)
  s_add_u32 s45, s76, 0x28800
  s_add_u32 m0, s55, 0x14000
  ds_read_b64_tr_b16 v[54:55], v2 offset:60416
  v_mfma_f32_16x16x32_bf16 a[132:135], a[156:159], v[44:47], a[132:135]
  s_waitcnt lgkmcnt(5)
  v_mfma_f32_32x32x16_bf16 v[96:111], a[48:51], v[44:47], v[96:111]
  s_waitcnt lgkmcnt(3)
  ds_read_b64_tr_b16 v[56:57], v2 offset:57416
  buffer_load_dwordx4 v16, s[8:11], s45 offen lds
  v_mfma_f32_32x32x16_bf16 v[112:127], a[52:55], v[44:47], v[112:127]
  s_waitcnt lgkmcnt(3)
  ds_read_b64_tr_b16 v[58:59], v2 offset:60488
  v_mfma_f32_16x16x32_bf16 a[144:147], a[156:159], v[48:51], a[144:147]
  v_mfma_f32_32x32x16_bf16 v[192:207], a[48:51], v[48:51], v[192:207]
  ds_read_b64_tr_b16 v[60:61], v2 offset:57704
  buffer_load_dwordx4 v17, s[8:11], s45 offen offset:1024 lds
  v_mfma_f32_32x32x16_bf16 v[208:223], a[52:55], v[48:51], v[208:223]
  s_waitcnt lgkmcnt(3)
  ds_read_b64_tr_b16 v[62:63], v2 offset:60776
  v_mfma_f32_16x16x32_bf16 a[128:131], a[156:159], v[52:55], a[128:131]
  v_mfma_f32_32x32x16_bf16 v[64:79], a[48:51], v[52:55], v[64:79]
  ds_read_b64_tr_b16 v[44:45], v3 offset:4384
  buffer_load_dwordx4 v18, s[8:11], s45 offen offset:2048 lds
  v_mfma_f32_32x32x16_bf16 v[80:95], a[52:55], v[52:55], v[80:95]
  s_waitcnt lgkmcnt(3)
  s_add_u32 s44, s63, 0x0
  s_add_u32 m0, s43, 0x18000
  ds_read_b64_tr_b16 v[46:47], v3 offset:7456
  v_mfma_f32_16x16x32_bf16 a[136:139], a[156:159], v[56:59], a[136:139]
  v_mfma_f32_32x32x16_bf16 v[128:143], a[48:51], v[56:59], v[128:143]
  ds_read_b128 a[56:59], v12 offset:32768
  ds_read_b64_tr_b16 v[48:49], v5 offset:4096
  buffer_load_dwordx4 v19, s[8:11], s44 offen lds
  v_mfma_f32_32x32x16_bf16 v[144:159], a[52:55], v[56:59], v[144:159]
  s_waitcnt lgkmcnt(4)
  ds_read_b128 a[60:63], v12 offset:36864
  ds_read_b64_tr_b16 v[50:51], v5 offset:7168
  v_mfma_f32_16x16x32_bf16 a[140:143], a[156:159], v[60:63], a[140:143]
  v_mfma_f32_32x32x16_bf16 v[160:175], a[48:51], v[60:63], v[160:175]
  ds_read_b64_tr_b16 v[52:53], v3 offset:4096
  buffer_load_dwordx4 v15, s[8:11], s44 offen offset:1024 lds
  v_mfma_f32_32x32x16_bf16 v[176:191], a[52:55], v[60:63], v[176:191]
  s_waitcnt lgkmcnt(5)
  s_add_u32 s45, s46, 0x0
  s_add_u32 m0, s3, 0x1c000
  ds_read_b64_tr_b16 v[54:55], v3 offset:7168
  v_mfma_f32_16x16x32_bf16 a[132:135], a[156:159], v[44:47], a[132:135]
  s_waitcnt lgkmcnt(5)
  v_mfma_f32_32x32x16_bf16 v[96:111], a[56:59], v[44:47], v[96:111]
  s_waitcnt lgkmcnt(3)
  ds_read_b64_tr_b16 v[56:57], v3 offset:4168
  buffer_load_dwordx4 v22, s[4:7], s45 offen lds
  v_mfma_f32_32x32x16_bf16 v[112:127], a[60:63], v[44:47], v[112:127]
  s_waitcnt lgkmcnt(3)
  ds_read_b64_tr_b16 v[58:59], v3 offset:7240
  v_mfma_f32_16x16x32_bf16 a[144:147], a[156:159], v[48:51], a[144:147]
  v_mfma_f32_32x32x16_bf16 v[192:207], a[56:59], v[48:51], v[192:207]
  ds_read_b64_tr_b16 v[60:61], v3 offset:4456
  buffer_load_dwordx4 v23, s[4:7], s45 offen offset:1024 lds
  v_mfma_f32_32x32x16_bf16 v[208:223], a[60:63], v[48:51], v[208:223]
  s_waitcnt lgkmcnt(3)
  ds_read_b64_tr_b16 v[62:63], v3 offset:7528
  v_mfma_f32_16x16x32_bf16 a[128:131], a[156:159], v[52:55], a[128:131]
  s_waitcnt vmcnt(10)
  s_barrier
  v_mfma_f32_32x32x16_bf16 v[64:79], a[56:59], v[52:55], v[64:79]
  ds_read_b64_tr_b16 v[44:45], v2 offset:8480
  buffer_load_dwordx4 v24, s[4:7], s45 offen offset:2048 lds
  v_mfma_f32_32x32x16_bf16 v[80:95], a[60:63], v[52:55], v[80:95]
  s_waitcnt lgkmcnt(3)
  ds_read_b64_tr_b16 v[46:47], v2 offset:11552
  v_mfma_f32_16x16x32_bf16 a[136:139], a[156:159], v[56:59], a[136:139]
  v_mfma_f32_32x32x16_bf16 v[128:143], a[56:59], v[56:59], v[128:143]
  ds_read_b128 a[0:3], v9 offset:49152
  ds_read_b64_tr_b16 v[48:49], v4 offset:8192
  buffer_load_dwordx4 v25, s[4:7], s45 offen offset:3072 lds
  v_mfma_f32_32x32x16_bf16 v[144:159], a[60:63], v[56:59], v[144:159]
  s_waitcnt lgkmcnt(4)
  s_add_u32 s44, s63, 0x1b000
  s_add_u32 m0, s43, 0x1a000
  ds_read_b128 a[4:7], v9 offset:53248
  ds_read_b64_tr_b16 v[50:51], v4 offset:11264
  v_mfma_f32_16x16x32_bf16 a[140:143], a[156:159], v[60:63], a[140:143]
  v_mfma_f32_32x32x16_bf16 v[160:175], a[56:59], v[60:63], v[160:175]
  ds_read_b64_tr_b16 v[52:53], v2 offset:8192
  buffer_load_dwordx4 v19, s[8:11], s44 offen lds
  v_mfma_f32_32x32x16_bf16 v[176:191], a[60:63], v[60:63], v[176:191]
  s_waitcnt lgkmcnt(5)
  ds_read_b64_tr_b16 v[54:55], v2 offset:11264
  v_mfma_f32_16x16x32_bf16 a[132:135], a[156:159], v[44:47], a[132:135]
  s_waitcnt lgkmcnt(5)
  ds_read_b128 v[224:227], v26 offset:49152
  v_mfma_f32_32x32x16_bf16 v[96:111], a[0:3], v[44:47], v[96:111]
  s_waitcnt lgkmcnt(4)
  ds_read_b128 v[228:231], v27 offset:49152
  ds_read_b64_tr_b16 v[56:57], v2 offset:8264
  buffer_load_dwordx4 v15, s[8:11], s44 offen offset:1024 lds
  v_mfma_f32_32x32x16_bf16 v[112:127], a[4:7], v[44:47], v[112:127]
  s_waitcnt lgkmcnt(5)
  s_add_u32 s45, s29, 0x0
  s_add_u32 m0, s43, 0xe000
  ds_read_b128 v[232:235], v28 offset:49152
  ds_read_b64_tr_b16 v[58:59], v2 offset:11336
  v_mfma_f32_16x16x32_bf16 a[144:147], a[156:159], v[48:51], a[144:147]
  ds_read_b128 v[236:239], v29 offset:49152
  v_mfma_f32_32x32x16_bf16 v[192:207], a[0:3], v[48:51], v[192:207]
  ds_read_b64_tr_b16 v[60:61], v2 offset:8552
  buffer_load_dwordx4 v19, s[8:11], s45 offen lds
  v_mfma_f32_32x32x16_bf16 v[208:223], a[4:7], v[48:51], v[208:223]
  s_waitcnt lgkmcnt(7)
  ds_read_b64_tr_b16 v[62:63], v2 offset:11624
  v_mfma_f32_16x16x32_bf16 a[128:131], a[156:159], v[52:55], a[128:131]
  v_mfma_f32_32x32x16_bf16 v[64:79], a[0:3], v[52:55], v[64:79]
  ds_read_b64_tr_b16 v[44:45], v2 offset:20768
  buffer_load_dwordx4 v15, s[8:11], s45 offen offset:1024 lds
  v_mfma_f32_32x32x16_bf16 v[80:95], a[4:7], v[52:55], v[80:95]
  s_waitcnt lgkmcnt(4)
  s_add_u32 s44, s47, 0x0
  s_add_u32 m0, s3, 0x20000
  ds_read_b64_tr_b16 v[46:47], v2 offset:23840
  v_dot2_f32_bf16 v240, v224, s50, v240
  v_dot2_f32_bf16 v244, v224, v224, v244
  v_dot2_f32_bf16 v241, v225, s50, v241
  v_dot2_f32_bf16 v245, v225, v225, v245
  v_dot2_f32_bf16 v242, v226, s50, v242
  v_dot2_f32_bf16 v246, v226, v226, v246
  v_dot2_f32_bf16 v243, v227, s50, v243
  v_dot2_f32_bf16 v247, v227, v227, v247
  v_dot2_f32_bf16 v240, v228, s50, v240
  v_dot2_f32_bf16 v244, v228, v228, v244
  v_dot2_f32_bf16 v241, v229, s50, v241
  v_dot2_f32_bf16 v245, v229, v229, v245
  v_dot2_f32_bf16 v242, v230, s50, v242
  v_dot2_f32_bf16 v246, v230, v230, v246
  v_dot2_f32_bf16 v243, v231, s50, v243
  v_dot2_f32_bf16 v247, v231, v231, v247
  v_dot2_f32_bf16 v240, v232, s50, v240
  v_dot2_f32_bf16 v244, v232, v232, v244
  v_dot2_f32_bf16 v241, v233, s50, v241
  v_dot2_f32_bf16 v245, v233, v233, v245
  v_dot2_f32_bf16 v242, v234, s50, v242
  v_dot2_f32_bf16 v246, v234, v234, v246
  v_dot2_f32_bf16 v243, v235, s50, v243
  v_dot2_f32_bf16 v247, v235, v235, v247
  s_waitcnt lgkmcnt(4)
  v_dot2_f32_bf16 v240, v236, s50, v240
  v_dot2_f32_bf16 v244, v236, v236, v244
  v_dot2_f32_bf16 v241, v237, s50, v241
  v_dot2_f32_bf16 v245, v237, v237, v245
  v_dot2_f32_bf16 v242, v238, s50, v242
  v_dot2_f32_bf16 v246, v238, v238, v246
  v_dot2_f32_bf16 v243, v239, s50, v243
  v_dot2_f32_bf16 v247, v239, v239, v247
  v_mfma_f32_16x16x32_bf16 a[136:139], a[156:159], v[56:59], a[136:139]
  v_add_f32 v240, v240, v241
  v_add_f32 v244, v244, v245
  v_mfma_f32_32x32x16_bf16 v[128:143], a[0:3], v[56:59], v[128:143]
  ds_read_b128 a[8:11], v10 offset:49152
  ds_read_b64_tr_b16 v[48:49], v4 offset:20480
  buffer_load_dwordx4 v22, s[4:7], s44 offen lds
  v_add_f32 v242, v242, v243
  v_add_f32 v246, v246, v247
  v_mfma_f32_32x32x16_bf16 v[144:159], a[4:7], v[56:59], v[144:159]
  s_waitcnt lgkmcnt(4)
  ds_read_b128 a[12:15], v10 offset:53248
  ds_read_b64_tr_b16 v[50:51], v4 offset:23552
  v_add_f32 v240, v240, v242
  v_add_f32 v244, v244, v246
  v_mov_b32 v241, v240
  v_mov_b32 v245, v244
  v_mfma_f32_16x16x32_bf16 a[140:143], a[156:159], v[60:63], a[140:143]
  v_permlane32_swap_b32 v240, v241
  v_permlane32_swap_b32 v244, v245
  v_mfma_f32_32x32x16_bf16 v[160:175], a[0:3], v[60:63], v[160:175]
  ds_read_b64_tr_b16 v[52:53], v2 offset:20480
  buffer_load_dwordx4 v23, s[4:7], s44 offen offset:1024 lds
  v_add_f32 v240, v240, v241
  v_add_f32 v244, v244, v245
  v_mul_f32 v240, 0xbae38e39, v240
  v_mfma_f32_32x32x16_bf16 v[176:191], a[4:7], v[60:63], v[176:191]
  s_waitcnt lgkmcnt(5)
  ds_read_b64_tr_b16 v[54:55], v2 offset:23552
  v_mul_f32 v244, 0x3ae38e39, v244
  v_fma_f32 v244, -v240, v240, v244
  v_max_f32 v244, 0, v244
  v_add_f32 v244, 0x3727c5ac, v244
  v_mfma_f32_16x16x32_bf16 a[132:135], a[156:159], v[44:47], a[132:135]
  s_waitcnt lgkmcnt(5)
  v_rsq_f32 v252, v244
  v_cvt_pk_bf16_f32 v36, v240, v240
  v_and_b32 v36, s51, v36
  v_mfma_f32_32x32x16_bf16 v[96:111], a[8:11], v[44:47], v[96:111]
  s_waitcnt lgkmcnt(3)
  ds_read_b64_tr_b16 v[56:57], v2 offset:20552
  buffer_load_dwordx4 v24, s[4:7], s44 offen offset:2048 lds
  v_mul_f32 v244, v244, v252
  v_sub_f32 v37, v240, v36
  v_cvt_pk_bf16_f32 v248, v36, v37
  v_cvt_pk_bf16_f32 v249, v36, v244
  v_mfma_f32_32x32x16_bf16 v[112:127], a[12:15], v[44:47], v[112:127]
  s_waitcnt lgkmcnt(3)
  ds_read_b64_tr_b16 v[58:59], v2 offset:23624
  v_and_b32 v36, s51, v249
  v_sub_f32 v37, v244, v36
  v_cvt_pk_bf16_f32 v250, v37, 0
  v_mov_b32 v251, 0
  v_lshlrev_b32 v36, 4, v0
  v_mfma_f32_16x16x32_bf16 a[144:147], a[156:159], v[48:51], a[144:147]
  v_and_b32 v37, 31, v1
  s_lshl_b32 s34, s30, 7
  v_lshl_add_u32 v37, v37, 2, s34
  v_mfma_f32_32x32x16_bf16 v[192:207], a[8:11], v[48:51], v[192:207]
  ds_read_b64_tr_b16 v[60:61], v2 offset:20840
  buffer_load_dwordx4 v25, s[4:7], s44 offen offset:3072 lds
  v_mfma_f32_32x32x16_bf16 v[208:223], a[12:15], v[48:51], v[208:223]
  s_waitcnt lgkmcnt(3)
  ds_read_b64_tr_b16 v[62:63], v2 offset:23912
  ds_write_b128 v36, v[248:251] offset:0
  ds_write_b32 v37, v252 offset:4096
  v_mfma_f32_16x16x32_bf16 a[128:131], a[156:159], v[52:55], a[128:131]
  s_waitcnt vmcnt(14)
  s_barrier
  s_lshl_b32 s34, s32, 10
  v_subrev_u32 v36, s34, v36
  v_lshrrev_b32 v37, 5, v1
  s_lshl_b32 s34, s31, 8
  v_lshl_add_u32 v37, v37, 4, s34
  v_mov_b32 v32, 0
  v_mov_b32 v33, 0
  v_mfma_f32_32x32x16_bf16 v[64:79], a[8:11], v[52:55], v[64:79]
  s_add_u32 s45, s29, 0x1b000
  s_add_u32 m0, s43, 0x10000
  ds_read_b64_tr_b16 v[44:45], v2 offset:33056
  v_mfma_f32_32x32x16_bf16 v[80:95], a[12:15], v[52:55], v[80:95]
  s_waitcnt lgkmcnt(5)
  ds_read_b64_tr_b16 v[46:47], v2 offset:36128
  buffer_load_dwordx4 v19, s[8:11], s45 offen lds
  v_mfma_f32_16x16x32_bf16 a[136:139], a[156:159], v[56:59], a[136:139]
  v_mfma_f32_32x32x16_bf16 v[128:143], a[8:11], v[56:59], v[128:143]
  ds_read_b128 a[16:19], v11 offset:49152
  ds_read_b64_tr_b16 v[48:49], v4 offset:32768
  buffer_load_dwordx4 v15, s[8:11], s45 offen offset:1024 lds
  v_mfma_f32_32x32x16_bf16 v[144:159], a[12:15], v[56:59], v[144:159]
  s_waitcnt lgkmcnt(6)
  s_add_u32 s44, s70, 0x0
  s_add_u32 m0, s43, 0x12000
  ds_read_b128 a[20:23], v11 offset:53248
  ds_read_b64_tr_b16 v[50:51], v4 offset:35840
  v_mfma_f32_16x16x32_bf16 a[140:143], a[156:159], v[60:63], a[140:143]
  v_mfma_f32_32x32x16_bf16 v[160:175], a[8:11], v[60:63], v[160:175]
  ds_read_b64_tr_b16 v[52:53], v2 offset:32768
  buffer_load_dwordx4 v19, s[8:11], s44 offen lds
  v_mfma_f32_32x32x16_bf16 v[176:191], a[12:15], v[60:63], v[176:191]
  s_waitcnt lgkmcnt(5)
  ds_read_b64_tr_b16 v[54:55], v2 offset:35840
  v_mfma_f32_16x16x32_bf16 a[132:135], a[156:159], v[44:47], a[132:135]
  s_waitcnt lgkmcnt(5)
  v_mfma_f32_32x32x16_bf16 v[96:111], a[16:19], v[44:47], v[96:111]
  s_waitcnt lgkmcnt(3)
  ds_read_b64_tr_b16 v[56:57], v2 offset:32840
  buffer_load_dwordx4 v15, s[8:11], s44 offen offset:1024 lds
  v_mfma_f32_32x32x16_bf16 v[112:127], a[20:23], v[44:47], v[112:127]
  s_waitcnt lgkmcnt(3)
  s_add_u32 s45, s20, 0x0
  ds_read_b64_tr_b16 v[58:59], v2 offset:35912
  v_mfma_f32_16x16x32_bf16 a[144:147], a[156:159], v[48:51], a[144:147]
  v_mfma_f32_32x32x16_bf16 v[192:207], a[16:19], v[48:51], v[192:207]
  ds_read_b64_tr_b16 v[60:61], v2 offset:33128
  v_mfma_f32_32x32x16_bf16 v[208:223], a[20:23], v[48:51], v[208:223]
  s_waitcnt lgkmcnt(3)
  ds_read_b64_tr_b16 v[62:63], v2 offset:36200
  v_mfma_f32_16x16x32_bf16 a[128:131], a[156:159], v[52:55], a[128:131]
  v_mfma_f32_32x32x16_bf16 v[64:79], a[16:19], v[52:55], v[64:79]
  ds_read_b64_tr_b16 v[44:45], v3 offset:16672
  v_mfma_f32_32x32x16_bf16 v[80:95], a[20:23], v[52:55], v[80:95]
  s_waitcnt lgkmcnt(3)
  ds_read_b64_tr_b16 v[46:47], v3 offset:19744
  v_mfma_f32_16x16x32_bf16 a[136:139], a[156:159], v[56:59], a[136:139]
  v_mfma_f32_32x32x16_bf16 v[128:143], a[16:19], v[56:59], v[128:143]
  ds_read_b128 a[24:27], v12 offset:49152
  ds_read_b64_tr_b16 v[48:49], v5 offset:16384
  v_mfma_f32_32x32x16_bf16 v[144:159], a[20:23], v[56:59], v[144:159]
  s_waitcnt lgkmcnt(4)
  ds_read_b128 a[28:31], v12 offset:53248
  ds_read_b64_tr_b16 v[50:51], v5 offset:19456
  v_mfma_f32_16x16x32_bf16 a[140:143], a[156:159], v[60:63], a[140:143]
  v_mfma_f32_32x32x16_bf16 v[160:175], a[16:19], v[60:63], v[160:175]
  ds_read_b64_tr_b16 v[52:53], v3 offset:16384
  v_mfma_f32_32x32x16_bf16 v[176:191], a[20:23], v[60:63], v[176:191]
  s_waitcnt lgkmcnt(5)
  ds_read_b64_tr_b16 v[54:55], v3 offset:19456
  v_mfma_f32_16x16x32_bf16 a[132:135], a[156:159], v[44:47], a[132:135]
  s_waitcnt lgkmcnt(5)
  v_mfma_f32_32x32x16_bf16 v[96:111], a[24:27], v[44:47], v[96:111]
  s_waitcnt lgkmcnt(3)
  ds_read_b64_tr_b16 v[56:57], v3 offset:16456
  v_mfma_f32_32x32x16_bf16 v[112:127], a[28:31], v[44:47], v[112:127]
  s_waitcnt lgkmcnt(3)
  ds_read_b64_tr_b16 v[58:59], v3 offset:19528
  v_mfma_f32_16x16x32_bf16 a[144:147], a[156:159], v[48:51], a[144:147]
  s_nop 3
  ds_write2_b32 v13, a132, a133 offset0:32 offset1:48
  v_mfma_f32_32x32x16_bf16 v[192:207], a[24:27], v[48:51], v[192:207]
  ds_read_b64_tr_b16 v[60:61], v3 offset:16744
  ds_read_b32 v34, v14 offset:128
  v_mfma_f32_32x32x16_bf16 v[208:223], a[28:31], v[48:51], v[208:223]
  s_waitcnt lgkmcnt(5)
  ds_read_b64_tr_b16 v[62:63], v3 offset:19816
  v_mfma_f32_16x16x32_bf16 a[128:131], a[156:159], v[52:55], a[128:131]
  s_barrier
  ds_write2_b32 v13, a144, a145 offset0:128 offset1:144
  v_mfma_f32_32x32x16_bf16 v[64:79], a[24:27], v[52:55], v[64:79]
  s_add_u32 m0, s3, 0x24000
  ds_read_b128 a[160:163], v36 offset:0
  ds_read_b128 a[164:167], v36 offset:1024
  ds_read_b32 v35, v14 offset:512
  ds_read_b128 v[224:227], v37 offset:4096
  ds_read_b128 v[228:231], v37 offset:4128
  ds_read_b128 v[232:235], v37 offset:4160
  v_mfma_f32_32x32x16_bf16 v[80:95], a[28:31], v[52:55], v[80:95]
  s_waitcnt lgkmcnt(11)
  buffer_load_dwordx4 v22, s[4:7], s45 offen lds
  ds_read_b128 v[236:239], v37 offset:4192
  ds_read_b128 v[240:243], v37 offset:4224
  ds_read_b128 v[244:247], v37 offset:4256
  ds_read_b128 v[248:251], v37 offset:4288
  v_mfma_f32_16x16x32_bf16 a[136:139], a[156:159], v[56:59], a[136:139]
  s_waitcnt lgkmcnt(14)
  ds_read_b128 v[252:255], v37 offset:4320
  s_waitcnt lgkmcnt(14)
  ds_write2_b32 v13, a128, a129 offset0:0 offset1:16
  v_mfma_f32_32x32x16_bf16 v[128:143], a[24:27], v[56:59], v[128:143]
  buffer_load_dwordx4 v23, s[4:7], s45 offen offset:1024 lds
  s_waitcnt lgkmcnt(14)
  ds_read_b32 v38, v14 offset:0
  v_mfma_f32_32x32x16_bf16 v[144:159], a[28:31], v[56:59], v[144:159]
  s_waitcnt lgkmcnt(14)
  v_mfma_f32_16x16x32_bf16 a[140:143], a[156:159], v[60:63], a[140:143]
  s_nop 0
  ds_write2_b32 v13, a136, a137 offset0:64 offset1:80
  v_mfma_f32_32x32x16_bf16 v[160:175], a[24:27], v[60:63], v[160:175]
  buffer_load_dwordx4 v24, s[4:7], s45 offen offset:2048 lds
  s_waitcnt lgkmcnt(14)
  ds_read_b32 v41, v14 offset:256
  v_mfma_f32_32x32x16_bf16 v[176:191], a[28:31], v[60:63], v[176:191]
  s_waitcnt lgkmcnt(14)
  v_cvt_pk_bf16_f32 v30, v34, v34
  v_and_b32 v31, s51, v30
  v_sub_f32 v34, v34, v31
  v_cvt_pk_bf16_f32 v31, v34, 0
  s_nop 1
  v_mfma_f32_32x32x16_bf16 v[96:111], a[160:163], v[30:33], v[96:111]
  s_waitcnt lgkmcnt(13)
  buffer_load_dwordx4 v25, s[4:7], s45 offen offset:3072 lds
  ds_write2_b32 v13, a140, a141 offset0:96 offset1:112
  v_mfma_f32_32x32x16_bf16 v[112:127], a[164:167], v[30:33], v[112:127]
  s_waitcnt vmcnt(16)
  s_barrier
  ds_read_b32 v42, v14 offset:384
  s_waitcnt lgkmcnt(14)
  v_cvt_pk_bf16_f32 v30, v35, v35
  v_and_b32 v31, s51, v30
  v_sub_f32 v35, v35, v31
  v_cvt_pk_bf16_f32 v31, v35, 0
  s_nop 1
  v_mfma_f32_32x32x16_bf16 v[192:207], a[160:163], v[30:33], v[192:207]
  s_add_u32 s44, s70, 0x1b000
  s_add_u32 m0, s43, 0x14000
  ds_read_b64_tr_b16 v[44:45], v6 offset:40960
  v_mfma_f32_32x32x16_bf16 v[208:223], a[164:167], v[30:33], v[208:223]
  s_waitcnt lgkmcnt(14)
  ds_read_b64_tr_b16 v[46:47], v6 offset:41984
  buffer_load_dwordx4 v19, s[8:11], s44 offen lds
  s_waitcnt lgkmcnt(6)
  v_cvt_pk_bf16_f32 v30, v38, v38
  v_and_b32 v31, s51, v30
  v_sub_f32 v38, v38, v31
  v_cvt_pk_bf16_f32 v31, v38, 0
  s_nop 1
  v_mfma_f32_32x32x16_bf16 v[64:79], a[160:163], v[30:33], v[64:79]
  v_mfma_f32_32x32x16_bf16 v[80:95], a[164:167], v[30:33], v[80:95]
  ds_read_b128 a[32:35], v9 offset:16384
  ds_read_b64_tr_b16 v[48:49], v7 offset:40960
  buffer_load_dwordx4 v15, s[8:11], s44 offen offset:1024 lds
  s_waitcnt lgkmcnt(6)
  v_cvt_pk_bf16_f32 v30, v41, v41
  v_and_b32 v31, s51, v30
  v_sub_f32 v41, v41, v31
  v_cvt_pk_bf16_f32 v31, v41, 0
  s_nop 1
  v_mfma_f32_32x32x16_bf16 v[128:143], a[160:163], v[30:33], v[128:143]
  s_add_u32 s45, s71, 0x0
  s_add_u32 m0, s43, 0x16000
  ds_read_b128 a[36:39], v9 offset:20480
  ds_read_b64_tr_b16 v[50:51], v7 offset:41984
  v_mfma_f32_32x32x16_bf16 v[144:159], a[164:167], v[30:33], v[144:159]
  buffer_load_dwordx4 v19, s[8:11], s45 offen lds
  s_waitcnt lgkmcnt(6)
  v_cvt_pk_bf16_f32 v30, v42, v42
  v_and_b32 v31, s51, v30
  v_sub_f32 v42, v42, v31
  v_cvt_pk_bf16_f32 v31, v42, 0
  s_nop 1
  v_mfma_f32_32x32x16_bf16 v[160:175], a[160:163], v[30:33], v[160:175]
  ds_read_b64_tr_b16 v[52:53], v6 offset:45056
  v_mfma_f32_32x32x16_bf16 v[176:191], a[164:167], v[30:33], v[176:191]
  s_waitcnt lgkmcnt(5)
  ds_read_b64_tr_b16 v[54:55], v6 offset:46080
  buffer_load_dwordx4 v15, s[8:11], s45 offen offset:1024 lds
  v_mov_b32 v43, 0x3f803f80
  v_mul_f32 v34, v96, v224
  v_mul_f32 v40, v98, v226
  v_mul_f32 v35, v97, v225
  v_mul_f32 v41, v99, v227
  v_mfma_f32_16x16x32_bf16 a[148:151], a[156:159], v[44:47], 0
  s_waitcnt lgkmcnt(5)
  s_add_u32 s44, s21, 0x0
  v_cvt_pk_bf16_f32 v96, v34, v35
  v_cvt_pk_bf16_f32 v97, v40, v41
  v_mul_f32 v34, v100, v228
  v_mul_f32 v40, v102, v230
  v_mul_f32 v35, v101, v229
  v_mul_f32 v41, v103, v231
  v_mfma_f32_32x32x16_bf16 a[64:79], a[32:35], v[44:47], 0
  s_waitcnt lgkmcnt(3)
  ds_read_b128 a[40:43], v10 offset:16384
  ds_read_b64_tr_b16 v[56:57], v7 offset:45056
  v_cvt_pk_bf16_f32 v98, v34, v35
  v_cvt_pk_bf16_f32 v99, v40, v41
  v_mul_f32 v34, v104, v232
  v_mul_f32 v40, v106, v234
  v_mul_f32 v35, v105, v233
  v_mfma_f32_32x32x16_bf16 a[80:95], a[36:39], v[44:47], 0
  s_waitcnt lgkmcnt(4)
  ds_read_b128 a[44:47], v10 offset:20480
  ds_read_b64_tr_b16 v[58:59], v7 offset:46080
  v_mul_f32 v41, v107, v235
  v_cvt_pk_bf16_f32 v100, v34, v35
  v_cvt_pk_bf16_f32 v101, v40, v41
  v_mul_f32 v34, v108, v236
  v_mul_f32 v40, v110, v238
  v_mul_f32 v35, v109, v237
  v_mfma_f32_16x16x32_bf16 a[152:155], a[156:159], v[48:51], 0
  s_waitcnt vmcnt(18) lgkmcnt(3)
  s_barrier
  v_mul_f32 v41, v111, v239
  v_cvt_pk_bf16_f32 v102, v34, v35
  v_cvt_pk_bf16_f32 v103, v40, v41
  v_mul_f32 v34, v112, v240
  v_mul_f32 v40, v114, v242
  v_mul_f32 v35, v113, v241
  v_mfma_f32_32x32x16_bf16 a[96:111], a[32:35], v[48:51], 0
  ds_read_b64_tr_b16 v[60:61], v6 offset:49152
  v_mul_f32 v41, v115, v243
  v_cvt_pk_bf16_f32 v104, v34, v35
  v_cvt_pk_bf16_f32 v105, v40, v41
  v_mul_f32 v34, v116, v244
  v_mul_f32 v40, v118, v246
  v_mfma_f32_32x32x16_bf16 a[112:127], a[36:39], v[48:51], 0
  ds_read_b64_tr_b16 v[62:63], v6 offset:50176
  v_mul_f32 v35, v117, v245
  v_mul_f32 v41, v119, v247
  v_cvt_pk_bf16_f32 v106, v34, v35
  v_cvt_pk_bf16_f32 v107, v40, v41
  v_mul_f32 v34, v120, v248
  v_mul_f32 v40, v122, v250
  v_mfma_f32_16x16x32_bf16 a[148:151], a[156:159], v[52:55], a[148:151]
  v_mul_f32 v35, v121, v249
  v_mul_f32 v41, v123, v251
  v_cvt_pk_bf16_f32 v108, v34, v35
  v_cvt_pk_bf16_f32 v109, v40, v41
  v_mul_f32 v34, v124, v252
  v_mul_f32 v40, v126, v254
  v_mfma_f32_32x32x16_bf16 a[64:79], a[40:43], v[52:55], a[64:79]
  s_waitcnt lgkmcnt(3)
  ds_read_b128 a[48:51], v11 offset:16384
  ds_read_b64_tr_b16 v[44:45], v7 offset:49152
  v_mul_f32 v35, v125, v253
  v_mul_f32 v41, v127, v255
  v_cvt_pk_bf16_f32 v110, v34, v35
  v_cvt_pk_bf16_f32 v111, v40, v41
  v_mul_f32 v34, v192, v224
  v_mfma_f32_32x32x16_bf16 a[80:95], a[44:47], v[52:55], a[80:95]
  s_waitcnt lgkmcnt(4)
  ds_read_b128 a[52:55], v11 offset:20480
  ds_read_b64_tr_b16 v[46:47], v7 offset:50176
  v_mul_f32 v40, v194, v226
  v_mul_f32 v35, v193, v225
  v_mul_f32 v41, v195, v227
  v_cvt_pk_bf16_f32 v112, v34, v35
  v_cvt_pk_bf16_f32 v113, v40, v41
  v_mul_f32 v38, 0x3fb8aa3b, v34
  v_mfma_f32_16x16x32_bf16 a[152:155], a[156:159], v[56:59], a[152:155]
  v_mul_f32 v42, 0x3fb8aa3b, v40
  v_mul_f32 v39, 0x3fb8aa3b, v35
  v_mul_f32 v8, 0x3fb8aa3b, v41
  v_exp_f32_e64 v38, v38 clamp
  v_mfma_f32_32x32x16_bf16 a[96:111], a[40:43], v[56:59], a[96:111]
  ds_read_b64_tr_b16 v[48:49], v6 offset:53248
  v_exp_f32_e64 v42, v42 clamp
  v_exp_f32_e64 v39, v39 clamp
  v_exp_f32_e64 v8, v8 clamp
  v_mfma_f32_32x32x16_bf16 a[112:127], a[44:47], v[56:59], a[112:127]
  s_waitcnt lgkmcnt(5)
  ds_read_b64_tr_b16 v[50:51], v6 offset:54272
  v_max_f32 v34, 0, v34
  v_max_f32 v40, 0, v40
  v_max_f32 v35, 0, v35
  v_max_f32 v41, 0, v41
  v_add_f32 v34, v34, v38
  v_add_f32 v40, v40, v42
  v_mfma_f32_16x16x32_bf16 a[148:151], a[156:159], v[60:63], a[148:151]
  s_waitcnt lgkmcnt(5)
  v_add_f32 v35, v35, v39
  v_add_f32 v41, v41, v8
  v_add_f32 v34, 0x358637bd, v34
  v_add_f32 v40, 0x358637bd, v40
  v_add_f32 v35, 0x358637bd, v35
  v_add_f32 v41, 0x358637bd, v41
  v_mfma_f32_32x32x16_bf16 a[64:79], a[48:51], v[60:63], a[64:79]
  s_waitcnt lgkmcnt(3)
  ds_read_b128 a[56:59], v12 offset:16384
  ds_read_b64_tr_b16 v[52:53], v7 offset:53248
  v_cvt_pk_bf16_f32 v192, v34, v35
  v_cvt_pk_bf16_f32 v193, v40, v41
  v_mul_f32 v34, v196, v228
  v_mul_f32 v40, v198, v230
  v_mul_f32 v35, v197, v229
  v_mfma_f32_32x32x16_bf16 a[80:95], a[52:55], v[60:63], a[80:95]
  s_waitcnt lgkmcnt(4)
  ds_read_b128 a[60:63], v12 offset:20480
  ds_read_b64_tr_b16 v[54:55], v7 offset:54272
  v_mul_f32 v41, v199, v231
  v_cvt_pk_bf16_f32 v114, v34, v35
  v_cvt_pk_bf16_f32 v115, v40, v41
  v_mul_f32 v38, 0x3fb8aa3b, v34
  v_mul_f32 v42, 0x3fb8aa3b, v40
  v_mul_f32 v39, 0x3fb8aa3b, v35
  v_mfma_f32_16x16x32_bf16 a[152:155], a[156:159], v[44:47], a[152:155]
  s_waitcnt vmcnt(12) lgkmcnt(3)
  s_barrier
  v_mul_f32 v8, 0x3fb8aa3b, v41
  v_exp_f32_e64 v38, v38 clamp
  v_exp_f32_e64 v42, v42 clamp
  v_mfma_f32_32x32x16_bf16 a[96:111], a[48:51], v[44:47], a[96:111]
  ds_read_b64_tr_b16 v[56:57], v6 offset:0
  v_exp_f32_e64 v39, v39 clamp
  v_exp_f32_e64 v8, v8 clamp
  v_max_f32 v34, 0, v34
  v_max_f32 v40, 0, v40
  v_mfma_f32_32x32x16_bf16 a[112:127], a[52:55], v[44:47], a[112:127]
  ds_read_b64_tr_b16 v[58:59], v6 offset:1024
  v_max_f32 v35, 0, v35
  v_max_f32 v41, 0, v41
  v_add_f32 v34, v34, v38
  v_add_f32 v40, v40, v42
  v_add_f32 v35, v35, v39
  v_add_f32 v41, v41, v8
  v_mfma_f32_16x16x32_bf16 a[148:151], a[156:159], v[48:51], a[148:151]
  v_add_f32 v34, 0x358637bd, v34
  v_add_f32 v40, 0x358637bd, v40
  v_add_f32 v35, 0x358637bd, v35
  v_add_f32 v41, 0x358637bd, v41
  v_cvt_pk_bf16_f32 v194, v34, v35
  v_cvt_pk_bf16_f32 v195, v40, v41
  v_mfma_f32_32x32x16_bf16 a[64:79], a[56:59], v[48:51], a[64:79]
  s_waitcnt lgkmcnt(3)
  ds_read_b128 a[0:3], v9 offset:32768
  ds_read_b64_tr_b16 v[60:61], v7 offset:0
  v_mul_f32 v34, v200, v232
  v_mul_f32 v40, v202, v234
  v_mul_f32 v35, v201, v233
  v_mul_f32 v41, v203, v235
  v_cvt_pk_bf16_f32 v116, v34, v35
  v_mfma_f32_32x32x16_bf16 a[80:95], a[60:63], v[48:51], a[80:95]
  s_waitcnt lgkmcnt(4)
  ds_read_b128 a[4:7], v9 offset:36864
  ds_read_b64_tr_b16 v[62:63], v7 offset:1024
  v_cvt_pk_bf16_f32 v117, v40, v41
  v_mul_f32 v38, 0x3fb8aa3b, v34
  v_mul_f32 v42, 0x3fb8aa3b, v40
  v_mul_f32 v39, 0x3fb8aa3b, v35
  v_mul_f32 v8, 0x3fb8aa3b, v41
  v_mfma_f32_16x16x32_bf16 a[152:155], a[156:159], v[52:55], a[152:155]
  v_exp_f32_e64 v38, v38 clamp
  v_exp_f32_e64 v42, v42 clamp
  v_exp_f32_e64 v39, v39 clamp
  v_mfma_f32_32x32x16_bf16 a[96:111], a[56:59], v[52:55], a[96:111]
  ds_read_b64_tr_b16 v[44:45], v6 offset:4096
  v_exp_f32_e64 v8, v8 clamp
  v_max_f32 v34, 0, v34
  v_max_f32 v40, 0, v40
  v_max_f32 v35, 0, v35
  v_max_f32 v41, 0, v41
  v_mfma_f32_32x32x16_bf16 a[112:127], a[60:63], v[52:55], a[112:127]
  s_waitcnt lgkmcnt(5)
  ds_read_b64_tr_b16 v[46:47], v6 offset:5120
  v_add_f32 v34, v34, v38
  v_add_f32 v40, v40, v42
  v_add_f32 v35, v35, v39
  v_add_f32 v41, v41, v8
  v_add_f32 v34, 0x358637bd, v34
  v_add_f32 v40, 0x358637bd, v40
  v_mfma_f32_16x16x32_bf16 a[148:151], a[156:159], v[56:59], a[148:151]
  s_waitcnt lgkmcnt(5)
  v_add_f32 v35, 0x358637bd, v35
  v_add_f32 v41, 0x358637bd, v41
  v_cvt_pk_bf16_f32 v196, v34, v35
  v_cvt_pk_bf16_f32 v197, v40, v41
  v_mul_f32 v34, v204, v236
  v_mul_f32 v40, v206, v238
  v_mfma_f32_32x32x16_bf16 a[64:79], a[0:3], v[56:59], a[64:79]
  s_waitcnt lgkmcnt(3)
  ds_read_b128 a[8:11], v10 offset:32768
  ds_read_b64_tr_b16 v[48:49], v7 offset:4096
  v_mul_f32 v35, v205, v237
  v_mul_f32 v41, v207, v239
  v_cvt_pk_bf16_f32 v118, v34, v35
  v_cvt_pk_bf16_f32 v119, v40, v41
  v_mul_f32 v38, 0x3fb8aa3b, v34
  v_mfma_f32_32x32x16_bf16 a[80:95], a[4:7], v[56:59], a[80:95]
  s_waitcnt lgkmcnt(4)
  ds_read_b128 a[12:15], v10 offset:36864
  ds_read_b64_tr_b16 v[50:51], v7 offset:5120
  v_mul_f32 v42, 0x3fb8aa3b, v40
  v_mul_f32 v39, 0x3fb8aa3b, v35
  v_mul_f32 v8, 0x3fb8aa3b, v41
  v_exp_f32_e64 v38, v38 clamp
  v_mfma_f32_16x16x32_bf16 a[152:155], a[156:159], v[60:63], a[152:155]
  s_waitcnt vmcnt(10) lgkmcnt(3)
  s_barrier
  v_exp_f32_e64 v42, v42 clamp
  v_exp_f32_e64 v39, v39 clamp
  v_exp_f32_e64 v8, v8 clamp
  v_max_f32 v34, 0, v34
  v_mfma_f32_32x32x16_bf16 a[96:111], a[0:3], v[60:63], a[96:111]
  s_add_u32 m0, s3, 0x1c000
  ds_read_b64_tr_b16 v[52:53], v6 offset:8192
  v_max_f32 v40, 0, v40
  v_max_f32 v35, 0, v35
  v_max_f32 v41, 0, v41
  v_add_f32 v34, v34, v38
  v_add_f32 v40, v40, v42
  v_mfma_f32_32x32x16_bf16 a[112:127], a[4:7], v[60:63], a[112:127]
  ds_read_b64_tr_b16 v[54:55], v6 offset:9216
  buffer_load_dwordx4 v22, s[4:7], s44 offen lds
  v_add_f32 v35, v35, v39
  v_add_f32 v41, v41, v8
  v_add_f32 v34, 0x358637bd, v34
  v_add_f32 v40, 0x358637bd, v40
  v_add_f32 v35, 0x358637bd, v35
  v_add_f32 v41, 0x358637bd, v41
  v_mfma_f32_16x16x32_bf16 a[148:151], a[156:159], v[44:47], a[148:151]
  v_cvt_pk_bf16_f32 v198, v34, v35
  v_cvt_pk_bf16_f32 v199, v40, v41
  v_mul_f32 v34, v208, v240
  v_mul_f32 v40, v210, v242
  v_mul_f32 v35, v209, v241
  v_mul_f32 v41, v211, v243
  v_mfma_f32_32x32x16_bf16 a[64:79], a[8:11], v[44:47], a[64:79]
  s_waitcnt lgkmcnt(3)
  ds_read_b128 a[16:19], v11 offset:32768
  ds_read_b64_tr_b16 v[56:57], v7 offset:8192
  buffer_load_dwordx4 v23, s[4:7], s44 offen offset:1024 lds
  v_cvt_pk_bf16_f32 v120, v34, v35
  v_cvt_pk_bf16_f32 v121, v40, v41
  v_mul_f32 v38, 0x3fb8aa3b, v34
  v_mul_f32 v42, 0x3fb8aa3b, v40
  v_mul_f32 v39, 0x3fb8aa3b, v35
  v_mfma_f32_32x32x16_bf16 a[80:95], a[12:15], v[44:47], a[80:95]
  s_waitcnt lgkmcnt(4)
  ds_read_b128 a[20:23], v11 offset:36864
  ds_read_b64_tr_b16 v[58:59], v7 offset:9216
  v_mul_f32 v8, 0x3fb8aa3b, v41
  v_exp_f32_e64 v38, v38 clamp
  v_exp_f32_e64 v42, v42 clamp
  v_mfma_f32_16x16x32_bf16 a[152:155], a[156:159], v[48:51], a[152:155]
  v_exp_f32_e64 v39, v39 clamp
  v_exp_f32_e64 v8, v8 clamp
  v_max_f32 v34, 0, v34
  v_max_f32 v40, 0, v40
  v_max_f32 v35, 0, v35
  v_mfma_f32_32x32x16_bf16 a[96:111], a[8:11], v[48:51], a[96:111]
  ds_read_b64_tr_b16 v[60:61], v6 offset:12288
  buffer_load_dwordx4 v24, s[4:7], s44 offen offset:2048 lds
  v_max_f32 v41, 0, v41
  v_add_f32 v34, v34, v38
  v_add_f32 v40, v40, v42
  v_add_f32 v35, v35, v39
  v_add_f32 v41, v41, v8
  v_mfma_f32_32x32x16_bf16 a[112:127], a[12:15], v[48:51], a[112:127]
  s_waitcnt lgkmcnt(5)
  ds_read_b64_tr_b16 v[62:63], v6 offset:13312
  v_add_f32 v34, 0x358637bd, v34
  v_add_f32 v40, 0x358637bd, v40
  v_add_f32 v35, 0x358637bd, v35
  v_add_f32 v41, 0x358637bd, v41
  v_cvt_pk_bf16_f32 v200, v34, v35
  v_cvt_pk_bf16_f32 v201, v40, v41
  v_mfma_f32_16x16x32_bf16 a[148:151], a[156:159], v[52:55], a[148:151]
  s_waitcnt lgkmcnt(5)
  v_mul_f32 v34, v212, v244
  v_mul_f32 v40, v214, v246
  v_mul_f32 v35, v213, v245
  v_mul_f32 v41, v215, v247
  v_cvt_pk_bf16_f32 v122, v34, v35
  v_cvt_pk_bf16_f32 v123, v40, v41
  v_mfma_f32_32x32x16_bf16 a[64:79], a[16:19], v[52:55], a[64:79]
  s_waitcnt lgkmcnt(3)
  ds_read_b128 a[24:27], v12 offset:32768
  ds_read_b64_tr_b16 v[44:45], v7 offset:12288
  buffer_load_dwordx4 v25, s[4:7], s44 offen offset:3072 lds
  v_mul_f32 v38, 0x3fb8aa3b, v34
  v_mul_f32 v42, 0x3fb8aa3b, v40
  v_mul_f32 v39, 0x3fb8aa3b, v35
  v_mul_f32 v8, 0x3fb8aa3b, v41
  v_mfma_f32_32x32x16_bf16 a[80:95], a[20:23], v[52:55], a[80:95]
  s_waitcnt lgkmcnt(4)
  ds_read_b128 a[28:31], v12 offset:36864
  ds_read_b64_tr_b16 v[46:47], v7 offset:13312
  v_exp_f32_e64 v38, v38 clamp
  v_exp_f32_e64 v42, v42 clamp
  v_exp_f32_e64 v39, v39 clamp
  v_mfma_f32_16x16x32_bf16 a[152:155], a[156:159], v[56:59], a[152:155]
  s_waitcnt vmcnt(8) lgkmcnt(3)
  s_barrier
  v_exp_f32_e64 v8, v8 clamp
  v_max_f32 v34, 0, v34
  v_max_f32 v40, 0, v40
  v_max_f32 v35, 0, v35
  v_max_f32 v41, 0, v41
  v_add_f32 v34, v34, v38
  v_mfma_f32_32x32x16_bf16 a[96:111], a[16:19], v[56:59], a[96:111]
  s_add_u32 s45, s71, 0x1b000
  ds_read_b64_tr_b16 v[48:49], v6 offset:16384
  v_add_f32 v40, v40, v42
  v_add_f32 v35, v35, v39
  v_add_f32 v41, v41, v8
  v_add_f32 v34, 0x358637bd, v34
  v_add_f32 v40, 0x358637bd, v40
  v_mfma_f32_32x32x16_bf16 a[112:127], a[20:23], v[56:59], a[112:127]
  ds_read_b64_tr_b16 v[50:51], v6 offset:17408
  v_add_f32 v35, 0x358637bd, v35
  v_add_f32 v41, 0x358637bd, v41
  v_cvt_pk_bf16_f32 v202, v34, v35
  v_cvt_pk_bf16_f32 v203, v40, v41
  v_mul_f32 v34, v216, v248
  v_mul_f32 v40, v218, v250
  v_mfma_f32_16x16x32_bf16 a[148:151], a[156:159], v[60:63], a[148:151]
  s_add_u32 m0, s43, 0x18000
  v_mul_f32 v35, v217, v249
  v_mul_f32 v41, v219, v251
  v_cvt_pk_bf16_f32 v124, v34, v35
  v_cvt_pk_bf16_f32 v125, v40, v41
  v_mul_f32 v38, 0x3fb8aa3b, v34
  v_mul_f32 v42, 0x3fb8aa3b, v40
  v_mfma_f32_32x32x16_bf16 a[64:79], a[24:27], v[60:63], a[64:79]
  s_waitcnt lgkmcnt(3)
  ds_read_b128 a[32:35], v9 offset:49152
  ds_read_b64_tr_b16 v[52:53], v7 offset:16384
  buffer_load_dwordx4 v19, s[8:11], s45 offen lds
  v_mul_f32 v39, 0x3fb8aa3b, v35
  v_mul_f32 v8, 0x3fb8aa3b, v41
  v_exp_f32_e64 v38, v38 clamp
  v_mfma_f32_32x32x16_bf16 a[80:95], a[28:31], v[60:63], a[80:95]
  s_waitcnt lgkmcnt(4)
  ds_read_b128 a[36:39], v9 offset:53248
  ds_read_b64_tr_b16 v[54:55], v7 offset:17408
  v_exp_f32_e64 v42, v42 clamp
  v_exp_f32_e64 v39, v39 clamp
  v_exp_f32_e64 v8, v8 clamp
  v_max_f32 v34, 0, v34
  v_mfma_f32_16x16x32_bf16 a[152:155], a[156:159], v[44:47], a[152:155]
  v_max_f32 v40, 0, v40
  v_max_f32 v35, 0, v35
  v_max_f32 v41, 0, v41
  v_add_f32 v34, v34, v38
  v_add_f32 v40, v40, v42
  v_add_f32 v35, v35, v39
  v_mfma_f32_32x32x16_bf16 a[96:111], a[24:27], v[44:47], a[96:111]
  ds_read_b64_tr_b16 v[56:57], v6 offset:20480
  buffer_load_dwordx4 v15, s[8:11], s45 offen offset:1024 lds
  v_add_f32 v41, v41, v8
  v_add_f32 v34, 0x358637bd, v34
  v_add_f32 v40, 0x358637bd, v40
  v_add_f32 v35, 0x358637bd, v35
  v_add_f32 v41, 0x358637bd, v41
  v_mfma_f32_32x32x16_bf16 a[112:127], a[28:31], v[44:47], a[112:127]
  s_waitcnt lgkmcnt(5)
  ds_read_b64_tr_b16 v[58:59], v6 offset:21504
  v_cvt_pk_bf16_f32 v204, v34, v35
  v_cvt_pk_bf16_f32 v205, v40, v41
  v_mul_f32 v34, v220, v252
  v_mul_f32 v40, v222, v254
  v_mul_f32 v35, v221, v253
  v_mul_f32 v41, v223, v255
  v_mfma_f32_16x16x32_bf16 a[148:151], a[156:159], v[48:51], a[148:151]
  s_waitcnt lgkmcnt(5)
  s_add_u32 s44, s72, 0x0
  v_cvt_pk_bf16_f32 v126, v34, v35
  v_cvt_pk_bf16_f32 v127, v40, v41
  v_mul_f32 v38, 0x3fb8aa3b, v34
  v_mul_f32 v42, 0x3fb8aa3b, v40
  v_mul_f32 v39, 0x3fb8aa3b, v35
  v_mul_f32 v8, 0x3fb8aa3b, v41
  v_mfma_f32_32x32x16_bf16 a[64:79], a[32:35], v[48:51], a[64:79]
  s_waitcnt lgkmcnt(3)
  s_add_u32 m0, s43, 0x1a000
  ds_read_b128 a[40:43], v10 offset:49152
  ds_read_b64_tr_b16 v[60:61], v7 offset:20480
  v_exp_f32_e64 v38, v38 clamp
  v_exp_f32_e64 v42, v42 clamp
  v_mfma_f32_32x32x16_bf16 a[80:95], a[36:39], v[48:51], a[80:95]
  s_waitcnt lgkmcnt(4)
  ds_read_b128 a[44:47], v10 offset:53248
  ds_read_b64_tr_b16 v[62:63], v7 offset:21504
  buffer_load_dwordx4 v19, s[8:11], s44 offen lds
  v_exp_f32_e64 v39, v39 clamp
  v_exp_f32_e64 v8, v8 clamp
  v_max_f32 v34, 0, v34
  v_max_f32 v40, 0, v40
  v_max_f32 v35, 0, v35
  v_mfma_f32_16x16x32_bf16 a[152:155], a[156:159], v[52:55], a[152:155]
  s_waitcnt vmcnt(9) lgkmcnt(3)
  s_barrier
  v_max_f32 v41, 0, v41
  v_add_f32 v34, v34, v38
  v_add_f32 v40, v40, v42
  v_add_f32 v35, v35, v39
  v_add_f32 v41, v41, v8
  v_add_f32 v34, 0x358637bd, v34
  v_mfma_f32_32x32x16_bf16 a[96:111], a[32:35], v[52:55], a[96:111]
  ds_read_b64_tr_b16 v[44:45], v6 offset:24576
  buffer_load_dwordx4 v15, s[8:11], s44 offen offset:1024 lds
  v_add_f32 v40, 0x358637bd, v40
  v_add_f32 v35, 0x358637bd, v35
  v_add_f32 v41, 0x358637bd, v41
  v_cvt_pk_bf16_f32 v206, v34, v35
  v_cvt_pk_bf16_f32 v207, v40, v41
  v_mfma_f32_32x32x16_bf16 a[112:127], a[36:39], v[52:55], a[112:127]
  ds_read_b64_tr_b16 v[46:47], v6 offset:25600
  v_cndmask_b32 v112, v112, v43, s[58:59]
  v_cndmask_b32 v113, v113, v43, s[58:59]
  v_cndmask_b32 v114, v114, v43, s[58:59]
  v_cndmask_b32 v115, v115, v43, s[58:59]
  v_cndmask_b32 v116, v116, v43, s[58:59]
  v_cndmask_b32 v117, v117, v43, s[58:59]
  v_mfma_f32_16x16x32_bf16 a[148:151], a[156:159], v[56:59], a[148:151]
  s_add_u32 s45, s22, 0x0
  v_cndmask_b32 v118, v118, v43, s[58:59]
  v_cndmask_b32 v119, v119, v43, s[58:59]
  v_cndmask_b32 v120, v120, v43, s[58:59]
  v_cndmask_b32 v121, v121, v43, s[58:59]
  v_cndmask_b32 v122, v122, v43, s[58:59]
  v_cndmask_b32 v123, v123, v43, s[58:59]
  v_mfma_f32_32x32x16_bf16 a[64:79], a[40:43], v[56:59], a[64:79]
  s_waitcnt lgkmcnt(3)
  s_add_u32 m0, s3, 0x20000
  ds_read_b128 a[48:51], v11 offset:49152
  ds_read_b64_tr_b16 v[48:49], v7 offset:24576
  v_cndmask_b32 v124, v124, v43, s[58:59]
  v_cndmask_b32 v125, v125, v43, s[58:59]
  v_cndmask_b32 v126, v126, v43, s[58:59]
  v_cndmask_b32 v127, v127, v43, s[58:59]
  v_mul_f32 v34, v64, v224
  v_mfma_f32_32x32x16_bf16 a[80:95], a[44:47], v[56:59], a[80:95]
  s_waitcnt lgkmcnt(4)
  ds_read_b128 a[52:55], v11 offset:53248
  ds_read_b64_tr_b16 v[50:51], v7 offset:25600
  buffer_load_dwordx4 v22, s[4:7], s45 offen lds
  v_mul_f32 v40, v66, v226
  v_mul_f32 v35, v65, v225
  v_mul_f32 v41, v67, v227
  v_mul_f32 v38, 0x3fb8aa3b, v34
  v_mul_f32 v42, 0x3fb8aa3b, v40
  v_mul_f32 v39, 0x3fb8aa3b, v35
  v_mfma_f32_16x16x32_bf16 a[152:155], a[156:159], v[60:63], a[152:155]
  v_mul_f32 v8, 0x3fb8aa3b, v41
  v_exp_f32_e64 v38, v38 clamp
  v_exp_f32_e64 v42, v42 clamp
  v_mfma_f32_32x32x16_bf16 a[96:111], a[40:43], v[60:63], a[96:111]
  ds_read_b64_tr_b16 v[52:53], v6 offset:28672
  buffer_load_dwordx4 v23, s[4:7], s45 offen offset:1024 lds
  v_exp_f32_e64 v39, v39 clamp
  v_exp_f32_e64 v8, v8 clamp
  v_max_f32 v34, 0, v34
  v_max_f32 v40, 0, v40
  v_mfma_f32_32x32x16_bf16 a[112:127], a[44:47], v[60:63], a[112:127]
  s_waitcnt lgkmcnt(5)
  ds_read_b64_tr_b16 v[54:55], v6 offset:29696
  v_max_f32 v35, 0, v35
  v_max_f32 v41, 0, v41
  v_add_f32 v34, v34, v38
  v_add_f32 v40, v40, v42
  v_add_f32 v35, v35, v39
  v_add_f32 v41, v41, v8
  v_mfma_f32_16x16x32_bf16 a[148:151], a[156:159], v[44:47], a[148:151]
  s_waitcnt lgkmcnt(5)
  v_add_f32 v34, 0x358637bd, v34
  v_add_f32 v40, 0x358637bd, v40
  v_add_f32 v35, 0x358637bd, v35
  v_add_f32 v41, 0x358637bd, v41
  v_cvt_pk_bf16_f32 v64, v34, v35
  v_cvt_pk_bf16_f32 v65, v40, v41
  v_mfma_f32_32x32x16_bf16 a[64:79], a[48:51], v[44:47], a[64:79]
  s_waitcnt lgkmcnt(3)
  ds_read_b128 a[56:59], v12 offset:49152
  ds_read_b64_tr_b16 v[56:57], v7 offset:28672
  buffer_load_dwordx4 v24, s[4:7], s45 offen offset:2048 lds
  v_mul_f32 v34, v68, v228
  v_mul_f32 v40, v70, v230
  v_mul_f32 v35, v69, v229
  v_mul_f32 v41, v71, v231
  v_mul_f32 v38, 0x3fb8aa3b, v34
  v_mfma_f32_32x32x16_bf16 a[80:95], a[52:55], v[44:47], a[80:95]
  s_waitcnt lgkmcnt(4)
  ds_read_b128 a[60:63], v12 offset:53248
  ds_read_b64_tr_b16 v[58:59], v7 offset:29696
  v_mul_f32 v42, 0x3fb8aa3b, v40
  v_mul_f32 v39, 0x3fb8aa3b, v35
  v_mul_f32 v8, 0x3fb8aa3b, v41
  v_exp_f32_e64 v38, v38 clamp
  v_mfma_f32_16x16x32_bf16 a[152:155], a[156:159], v[48:51], a[152:155]
  s_waitcnt vmcnt(7) lgkmcnt(3)
  s_barrier
  v_exp_f32_e64 v42, v42 clamp
  v_exp_f32_e64 v39, v39 clamp
  v_exp_f32_e64 v8, v8 clamp
  v_max_f32 v34, 0, v34
  v_mfma_f32_32x32x16_bf16 a[96:111], a[48:51], v[48:51], a[96:111]
  ds_read_b64_tr_b16 v[60:61], v6 offset:32768
  buffer_load_dwordx4 v25, s[4:7], s45 offen offset:3072 lds
  v_max_f32 v40, 0, v40
  v_max_f32 v35, 0, v35
  v_max_f32 v41, 0, v41
  v_add_f32 v34, v34, v38
  v_add_f32 v40, v40, v42
  v_mfma_f32_32x32x16_bf16 a[112:127], a[52:55], v[48:51], a[112:127]
  ds_read_b64_tr_b16 v[62:63], v6 offset:33792
  v_add_f32 v35, v35, v39
  v_add_f32 v41, v41, v8
  v_add_f32 v34, 0x358637bd, v34
  v_add_f32 v40, 0x358637bd, v40
  v_add_f32 v35, 0x358637bd, v35
  v_add_f32 v41, 0x358637bd, v41
  v_mfma_f32_16x16x32_bf16 a[148:151], a[156:159], v[52:55], a[148:151]
  s_add_u32 s44, s72, 0x1b000
  v_cvt_pk_bf16_f32 v66, v34, v35
  v_cvt_pk_bf16_f32 v67, v40, v41
  v_mul_f32 v34, v72, v232
  v_mul_f32 v40, v74, v234
  v_mul_f32 v35, v73, v233
  v_mul_f32 v41, v75, v235
  v_mfma_f32_32x32x16_bf16 a[64:79], a[56:59], v[52:55], a[64:79]
  s_waitcnt lgkmcnt(3)
  s_add_u32 m0, s43, 0xe000
  ds_read_b128 a[0:3], v9 offset:16384
  ds_read_b64_tr_b16 v[44:45], v7 offset:32768
  v_mul_f32 v38, 0x3fb8aa3b, v34
  v_mul_f32 v42, 0x3fb8aa3b, v40
  v_mul_f32 v39, 0x3fb8aa3b, v35
  v_mul_f32 v8, 0x3fb8aa3b, v41
  v_mfma_f32_32x32x16_bf16 a[80:95], a[60:63], v[52:55], a[80:95]
  s_waitcnt lgkmcnt(4)
  ds_read_b128 a[4:7], v9 offset:20480
  ds_read_b64_tr_b16 v[46:47], v7 offset:33792
  buffer_load_dwordx4 v19, s[8:11], s44 offen lds
  v_exp_f32_e64 v38, v38 clamp
  v_exp_f32_e64 v42, v42 clamp
  v_exp_f32_e64 v39, v39 clamp
  v_mfma_f32_16x16x32_bf16 a[152:155], a[156:159], v[56:59], a[152:155]
  v_exp_f32_e64 v8, v8 clamp
  v_max_f32 v34, 0, v34
  v_max_f32 v40, 0, v40
  v_max_f32 v35, 0, v35
  v_max_f32 v41, 0, v41
  v_add_f32 v34, v34, v38
  v_mfma_f32_32x32x16_bf16 a[96:111], a[56:59], v[56:59], a[96:111]
  ds_read_b64_tr_b16 v[48:49], v6 offset:36864
  buffer_load_dwordx4 v15, s[8:11], s44 offen offset:1024 lds
  v_add_f32 v40, v40, v42
  v_add_f32 v35, v35, v39
  v_add_f32 v41, v41, v8
  v_add_f32 v34, 0x358637bd, v34
  v_add_f32 v40, 0x358637bd, v40
  v_mfma_f32_32x32x16_bf16 a[112:127], a[60:63], v[56:59], a[112:127]
  s_waitcnt lgkmcnt(5)
  ds_read_b64_tr_b16 v[50:51], v6 offset:37888
  v_add_f32 v35, 0x358637bd, v35
  v_add_f32 v41, 0x358637bd, v41
  v_cvt_pk_bf16_f32 v68, v34, v35
  v_cvt_pk_bf16_f32 v69, v40, v41
  v_mul_f32 v34, v76, v236
  v_mul_f32 v40, v78, v238
  v_mfma_f32_16x16x32_bf16 a[148:151], a[156:159], v[60:63], a[148:151]
  s_waitcnt lgkmcnt(5)
  s_add_u32 s45, s73, 0x0
  v_mul_f32 v35, v77, v237
  v_mul_f32 v41, v79, v239
  v_mul_f32 v38, 0x3fb8aa3b, v34
  v_mul_f32 v42, 0x3fb8aa3b, v40
  v_mul_f32 v39, 0x3fb8aa3b, v35
  v_mul_f32 v8, 0x3fb8aa3b, v41
  v_mfma_f32_32x32x16_bf16 a[64:79], a[0:3], v[60:63], a[64:79]
  s_waitcnt lgkmcnt(3)
  s_add_u32 m0, s43, 0x10000
  ds_read_b128 a[8:11], v10 offset:16384
  ds_read_b64_tr_b16 v[52:53], v7 offset:36864
  v_exp_f32_e64 v38, v38 clamp
  v_exp_f32_e64 v42, v42 clamp
  v_mfma_f32_32x32x16_bf16 a[80:95], a[4:7], v[60:63], a[80:95]
  s_waitcnt lgkmcnt(4)
  ds_read_b128 a[12:15], v10 offset:20480
  ds_read_b64_tr_b16 v[54:55], v7 offset:37888
  buffer_load_dwordx4 v19, s[8:11], s45 offen lds
  v_exp_f32_e64 v39, v39 clamp
  v_exp_f32_e64 v8, v8 clamp
  v_max_f32 v34, 0, v34
  v_max_f32 v40, 0, v40
  v_max_f32 v35, 0, v35
  v_mfma_f32_16x16x32_bf16 a[152:155], a[156:159], v[44:47], a[152:155]
  s_waitcnt vmcnt(9) lgkmcnt(3)
  s_barrier
  v_max_f32 v41, 0, v41
  v_add_f32 v34, v34, v38
  v_add_f32 v40, v40, v42
  v_add_f32 v35, v35, v39
  v_add_f32 v41, v41, v8
  v_add_f32 v34, 0x358637bd, v34
  v_mfma_f32_32x32x16_bf16 a[96:111], a[0:3], v[44:47], a[96:111]
  ds_read_b64_tr_b16 v[56:57], v6 offset:40960
  buffer_load_dwordx4 v15, s[8:11], s45 offen offset:1024 lds
  v_add_f32 v40, 0x358637bd, v40
  v_add_f32 v35, 0x358637bd, v35
  v_add_f32 v41, 0x358637bd, v41
  v_cvt_pk_bf16_f32 v70, v34, v35
  v_cvt_pk_bf16_f32 v71, v40, v41
  v_mfma_f32_32x32x16_bf16 a[112:127], a[4:7], v[44:47], a[112:127]
  ds_read_b64_tr_b16 v[58:59], v6 offset:41984
  v_mul_f32 v34, v80, v240
  v_mul_f32 v40, v82, v242
  v_mul_f32 v35, v81, v241
  v_mul_f32 v41, v83, v243
  v_mul_f32 v38, 0x3fb8aa3b, v34
  v_mul_f32 v42, 0x3fb8aa3b, v40
  v_mfma_f32_16x16x32_bf16 a[148:151], a[156:159], v[48:51], a[148:151]
  s_add_u32 s44, s23, 0x0
  v_mul_f32 v39, 0x3fb8aa3b, v35
  v_mul_f32 v8, 0x3fb8aa3b, v41
  v_exp_f32_e64 v38, v38 clamp
  v_exp_f32_e64 v42, v42 clamp
  v_mfma_f32_32x32x16_bf16 a[64:79], a[8:11], v[48:51], a[64:79]
  s_waitcnt lgkmcnt(3)
  s_add_u32 m0, s3, 0x24000
  ds_read_b128 a[16:19], v11 offset:16384
  ds_read_b64_tr_b16 v[60:61], v7 offset:40960
  v_exp_f32_e64 v39, v39 clamp
  v_exp_f32_e64 v8, v8 clamp
  v_max_f32 v34, 0, v34
  v_mfma_f32_32x32x16_bf16 a[80:95], a[12:15], v[48:51], a[80:95]
  s_waitcnt lgkmcnt(4)
  ds_read_b128 a[20:23], v11 offset:20480
  ds_read_b64_tr_b16 v[62:63], v7 offset:41984
  buffer_load_dwordx4 v22, s[4:7], s44 offen lds
  v_max_f32 v40, 0, v40
  v_max_f32 v35, 0, v35
  v_max_f32 v41, 0, v41
  v_add_f32 v34, v34, v38
  v_add_f32 v40, v40, v42
  v_add_f32 v35, v35, v39
  v_mfma_f32_16x16x32_bf16 a[152:155], a[156:159], v[52:55], a[152:155]
  v_add_f32 v41, v41, v8
  v_add_f32 v34, 0x358637bd, v34
  v_add_f32 v40, 0x358637bd, v40
  v_add_f32 v35, 0x358637bd, v35
  v_add_f32 v41, 0x358637bd, v41
  v_cvt_pk_bf16_f32 v72, v34, v35
  v_mfma_f32_32x32x16_bf16 a[96:111], a[8:11], v[52:55], a[96:111]
  ds_read_b64_tr_b16 v[44:45], v6 offset:45056
  buffer_load_dwordx4 v23, s[4:7], s44 offen offset:1024 lds
  v_cvt_pk_bf16_f32 v73, v40, v41
  v_mul_f32 v34, v84, v244
  v_mul_f32 v40, v86, v246
  v_mul_f32 v35, v85, v245
  v_mul_f32 v41, v87, v247
  v_mfma_f32_32x32x16_bf16 a[112:127], a[12:15], v[52:55], a[112:127]
  s_waitcnt lgkmcnt(5)
  ds_read_b64_tr_b16 v[46:47], v6 offset:46080
  v_mul_f32 v38, 0x3fb8aa3b, v34
  v_mul_f32 v42, 0x3fb8aa3b, v40
  v_mul_f32 v39, 0x3fb8aa3b, v35
  v_mul_f32 v8, 0x3fb8aa3b, v41
  v_exp_f32_e64 v38, v38 clamp
  v_mfma_f32_16x16x32_bf16 a[148:151], a[156:159], v[56:59], a[148:151]
  s_waitcnt lgkmcnt(5)
  v_exp_f32_e64 v42, v42 clamp
  v_exp_f32_e64 v39, v39 clamp
  v_exp_f32_e64 v8, v8 clamp
  v_mfma_f32_32x32x16_bf16 a[64:79], a[16:19], v[56:59], a[64:79]
  s_waitcnt lgkmcnt(3)
  ds_read_b128 a[24:27], v12 offset:16384
  ds_read_b64_tr_b16 v[48:49], v7 offset:45056
  buffer_load_dwordx4 v24, s[4:7], s44 offen offset:2048 lds
  v_max_f32 v34, 0, v34
  v_max_f32 v40, 0, v40
  v_max_f32 v35, 0, v35
  v_max_f32 v41, 0, v41
  v_add_f32 v34, v34, v38
  v_mfma_f32_32x32x16_bf16 a[80:95], a[20:23], v[56:59], a[80:95]
  s_waitcnt lgkmcnt(4)
  ds_read_b128 a[28:31], v12 offset:20480
  ds_read_b64_tr_b16 v[50:51], v7 offset:46080
  v_add_f32 v40, v40, v42
  v_add_f32 v35, v35, v39
  v_add_f32 v41, v41, v8
  v_add_f32 v34, 0x358637bd, v34
  v_add_f32 v40, 0x358637bd, v40
  v_add_f32 v35, 0x358637bd, v35
  v_mfma_f32_16x16x32_bf16 a[152:155], a[156:159], v[60:63], a[152:155]
  s_waitcnt lgkmcnt(3)
  s_barrier
  v_add_f32 v41, 0x358637bd, v41
  v_cvt_pk_bf16_f32 v74, v34, v35
  v_cvt_pk_bf16_f32 v75, v40, v41
  v_mul_f32 v34, v88, v248
  v_mul_f32 v40, v90, v250
  v_mul_f32 v35, v89, v249
  v_mfma_f32_32x32x16_bf16 a[96:111], a[16:19], v[60:63], a[96:111]
  buffer_load_dwordx4 v25, s[4:7], s44 offen offset:3072 lds
  v_mul_f32 v41, v91, v251
  v_mul_f32 v38, 0x3fb8aa3b, v34
  v_mul_f32 v42, 0x3fb8aa3b, v40
  v_mul_f32 v39, 0x3fb8aa3b, v35
  v_mul_f32 v8, 0x3fb8aa3b, v41
  v_mfma_f32_32x32x16_bf16 a[112:127], a[20:23], v[60:63], a[112:127]
  v_exp_f32_e64 v38, v38 clamp
  v_exp_f32_e64 v42, v42 clamp
  v_exp_f32_e64 v39, v39 clamp
  v_mfma_f32_16x16x32_bf16 a[148:151], a[156:159], v[44:47], a[148:151]
  s_add_u32 s45, s73, 0x1b000
  v_exp_f32_e64 v8, v8 clamp
  v_max_f32 v34, 0, v34
  v_max_f32 v40, 0, v40
  v_max_f32 v35, 0, v35
  v_max_f32 v41, 0, v41
  v_mfma_f32_32x32x16_bf16 a[64:79], a[24:27], v[44:47], a[64:79]
  s_waitcnt lgkmcnt(1)
  s_add_u32 m0, s43, 0x12000
  v_add_f32 v34, v34, v38
  v_add_f32 v40, v40, v42
  v_add_f32 v35, v35, v39
  v_add_f32 v41, v41, v8
  v_add_f32 v34, 0x358637bd, v34
  v_add_f32 v40, 0x358637bd, v40
  v_mfma_f32_32x32x16_bf16 a[80:95], a[28:31], v[44:47], a[80:95]
  s_waitcnt lgkmcnt(0)
  buffer_load_dwordx4 v19, s[8:11], s45 offen lds
  v_add_f32 v35, 0x358637bd, v35
  v_add_f32 v41, 0x358637bd, v41
  v_cvt_pk_bf16_f32 v76, v34, v35
  v_cvt_pk_bf16_f32 v77, v40, v41
  v_mul_f32 v34, v92, v252
  v_mfma_f32_16x16x32_bf16 a[152:155], a[156:159], v[48:51], a[152:155]
  v_mul_f32 v40, v94, v254
  v_mul_f32 v35, v93, v253
  v_mul_f32 v41, v95, v255
  v_mul_f32 v38, 0x3fb8aa3b, v34
  v_mul_f32 v42, 0x3fb8aa3b, v40
  v_mul_f32 v39, 0x3fb8aa3b, v35
  v_mfma_f32_32x32x16_bf16 a[96:111], a[24:27], v[48:51], a[96:111]
  buffer_load_dwordx4 v15, s[8:11], s45 offen offset:1024 lds
  v_mul_f32 v8, 0x3fb8aa3b, v41
  v_exp_f32_e64 v38, v38 clamp
  v_exp_f32_e64 v42, v42 clamp
  v_mfma_f32_32x32x16_bf16 a[112:127], a[28:31], v[48:51], a[112:127]
  s_add_u32 s44, s74, 0x0
  v_exp_f32_e64 v39, v39 clamp
  v_exp_f32_e64 v8, v8 clamp
  v_max_f32 v34, 0, v34
  v_max_f32 v40, 0, v40
  v_mfma_f32_32x32x16_bf16 a[200:215], v[192:195], v[96:99], 0
  s_add_u32 m0, s43, 0x14000
  v_max_f32 v35, 0, v35
  v_max_f32 v41, 0, v41
  v_add_f32 v34, v34, v38
  v_add_f32 v40, v40, v42
  v_add_f32 v35, v35, v39
  v_add_f32 v41, v41, v8
  v_mfma_f32_32x32x16_bf16 a[200:215], v[196:199], v[100:103], a[200:215]
  buffer_load_dwordx4 v19, s[8:11], s44 offen lds
  v_add_f32 v34, 0x358637bd, v34
  v_add_f32 v40, 0x358637bd, v40
  v_add_f32 v35, 0x358637bd, v35
  v_add_f32 v41, 0x358637bd, v41
  v_cvt_pk_bf16_f32 v78, v34, v35
  v_mfma_f32_32x32x16_bf16 a[200:215], v[200:203], v[104:107], a[200:215]
  v_cvt_pk_bf16_f32 v79, v40, v41
  v_mfma_f32_32x32x16_bf16 a[200:215], v[204:207], v[108:111], a[200:215]
  s_waitcnt vmcnt(11)
  s_barrier
  v_mul_f32 v34, v128, v224
  v_mul_f32 v40, v130, v226
  v_mul_f32 v35, v129, v225
  v_mul_f32 v41, v131, v227
  v_mfma_f32_32x32x16_bf16 a[168:183], v[64:67], v[96:99], 0
  buffer_load_dwordx4 v15, s[8:11], s44 offen offset:1024 lds
  v_mul_f32 v38, 0x3fb8aa3b, v34
  v_mul_f32 v42, 0x3fb8aa3b, v40
  v_mul_f32 v39, 0x3fb8aa3b, v35
  v_mul_f32 v8, 0x3fb8aa3b, v41
  v_mfma_f32_32x32x16_bf16 a[168:183], v[68:71], v[100:103], a[168:183]
  s_add_u32 s45, s60, 0x0
  v_exp_f32_e64 v38, v38 clamp
  v_exp_f32_e64 v42, v42 clamp
  v_exp_f32_e64 v39, v39 clamp
  v_mfma_f32_32x32x16_bf16 a[168:183], v[72:75], v[104:107], a[168:183]
  s_add_u32 m0, s3, 0x1c000
  v_exp_f32_e64 v8, v8 clamp
  v_max_f32 v34, 0, v34
  v_max_f32 v40, 0, v40
  v_max_f32 v35, 0, v35
  v_max_f32 v41, 0, v41
  v_mfma_f32_32x32x16_bf16 a[168:183], v[76:79], v[108:111], a[168:183]
  buffer_load_dwordx4 v22, s[4:7], s45 offen lds
  v_add_f32 v34, v34, v38
  v_add_f32 v40, v40, v42
  v_add_f32 v35, v35, v39
  v_add_f32 v41, v41, v8
  v_mfma_f32_32x32x16_bf16 a[184:199], v[64:67], v[112:115], 0
  ds_read_b64_tr_b16 v[52:53], v6 offset:49152
  v_add_f32 v34, 0x358637bd, v34
  v_add_f32 v40, 0x358637bd, v40
  v_add_f32 v35, 0x358637bd, v35
  v_add_f32 v41, 0x358637bd, v41
  v_cvt_pk_bf16_f32 v128, v34, v35
  v_mfma_f32_32x32x16_bf16 a[184:199], v[68:71], v[116:119], a[184:199]
  ds_read_b64_tr_b16 v[54:55], v6 offset:50176
  buffer_load_dwordx4 v23, s[4:7], s45 offen offset:1024 lds
  v_cvt_pk_bf16_f32 v129, v40, v41
  v_mul_f32 v34, v132, v228
  v_mul_f32 v40, v134, v230
  v_mul_f32 v35, v133, v229
  v_mul_f32 v41, v135, v231
  v_mfma_f32_32x32x16_bf16 a[184:199], v[72:75], v[120:123], a[184:199]
  v_mul_f32 v38, 0x3fb8aa3b, v34
  v_mul_f32 v42, 0x3fb8aa3b, v40
  v_mul_f32 v39, 0x3fb8aa3b, v35
  v_mul_f32 v8, 0x3fb8aa3b, v41
  v_exp_f32_e64 v38, v38 clamp
  v_mfma_f32_32x32x16_bf16 a[184:199], v[76:79], v[124:127], a[184:199]
  ds_read_b128 a[32:35], v9 offset:32768
  ds_read_b64_tr_b16 v[56:57], v7 offset:49152
  buffer_load_dwordx4 v24, s[4:7], s45 offen offset:2048 lds
  v_exp_f32_e64 v42, v42 clamp
  v_mfma_f32_32x32x16_bf16 v[80:95], v[192:195], v[112:115], 0
  ds_read_b128 a[36:39], v9 offset:36864
  ds_read_b64_tr_b16 v[58:59], v7 offset:50176
  v_exp_f32_e64 v39, v39 clamp
  v_exp_f32_e64 v8, v8 clamp
  v_max_f32 v34, 0, v34
  v_max_f32 v40, 0, v40
  v_mfma_f32_32x32x16_bf16 v[80:95], v[196:199], v[116:119], v[80:95]
  buffer_load_dwordx4 v25, s[4:7], s45 offen offset:3072 lds
  v_max_f32 v35, 0, v35
  v_max_f32 v41, 0, v41
  v_add_f32 v34, v34, v38
  v_add_f32 v40, v40, v42
  v_add_f32 v35, v35, v39
  v_mfma_f32_32x32x16_bf16 v[80:95], v[200:203], v[120:123], v[80:95]
  s_add_u32 s44, s74, 0x1b000
  ds_read_b64_tr_b16 v[60:61], v6 offset:53248
  v_add_f32 v41, v41, v8
  v_add_f32 v34, 0x358637bd, v34
  v_add_f32 v40, 0x358637bd, v40
  v_add_f32 v35, 0x358637bd, v35
  v_add_f32 v41, 0x358637bd, v41
  v_mfma_f32_32x32x16_bf16 v[80:95], v[204:207], v[124:127], v[80:95]
  s_waitcnt vmcnt(14) lgkmcnt(2)
  s_barrier
  ds_read_b64_tr_b16 v[62:63], v6 offset:54272
  v_cvt_pk_bf16_f32 v130, v34, v35
  v_cvt_pk_bf16_f32 v131, v40, v41
  v_mul_f32 v34, v136, v232
  v_mul_f32 v40, v138, v234
  v_mul_f32 v35, v137, v233
  v_mfma_f32_16x16x32_bf16 a[148:151], a[156:159], v[52:55], a[148:151]
  s_add_u32 m0, s43, 0x16000
  v_mul_f32 v41, v139, v235
  v_mul_f32 v38, 0x3fb8aa3b, v34
  v_mul_f32 v42, 0x3fb8aa3b, v40
  v_mul_f32 v39, 0x3fb8aa3b, v35
  v_mul_f32 v8, 0x3fb8aa3b, v41
  v_mfma_f32_32x32x16_bf16 a[64:79], a[32:35], v[52:55], a[64:79]
  ds_read_b128 a[40:43], v10 offset:32768
  ds_read_b64_tr_b16 v[44:45], v7 offset:53248
  buffer_load_dwordx4 v19, s[8:11], s44 offen lds
  v_exp_f32_e64 v38, v38 clamp
  v_exp_f32_e64 v42, v42 clamp
  v_mfma_f32_32x32x16_bf16 a[80:95], a[36:39], v[52:55], a[80:95]
  s_waitcnt lgkmcnt(4)
  ds_read_b128 a[44:47], v10 offset:36864
  ds_read_b64_tr_b16 v[46:47], v7 offset:54272
  v_exp_f32_e64 v39, v39 clamp
  v_exp_f32_e64 v8, v8 clamp
  v_max_f32 v34, 0, v34
  v_max_f32 v40, 0, v40
  v_mfma_f32_16x16x32_bf16 a[152:155], a[156:159], v[56:59], a[152:155]
  v_max_f32 v35, 0, v35
  v_max_f32 v41, 0, v41
  v_add_f32 v34, v34, v38
  v_add_f32 v40, v40, v42
  v_mfma_f32_32x32x16_bf16 a[96:111], a[32:35], v[56:59], a[96:111]
  ds_read_b64_tr_b16 v[48:49], v6 offset:0
  buffer_load_dwordx4 v15, s[8:11], s44 offen offset:1024 lds
  v_add_f32 v35, v35, v39
  v_add_f32 v41, v41, v8
  v_add_f32 v34, 0x358637bd, v34
  v_add_f32 v40, 0x358637bd, v40
  v_add_f32 v35, 0x358637bd, v35
  v_mfma_f32_32x32x16_bf16 a[112:127], a[36:39], v[56:59], a[112:127]
  s_waitcnt lgkmcnt(5)
  ds_read_b64_tr_b16 v[50:51], v6 offset:1024
  v_add_f32 v41, 0x358637bd, v41
  v_cvt_pk_bf16_f32 v132, v34, v35
  v_cvt_pk_bf16_f32 v133, v40, v41
  v_mul_f32 v34, v140, v236
  v_mul_f32 v40, v142, v238
  v_mfma_f32_16x16x32_bf16 a[148:151], a[156:159], v[60:63], a[148:151]
  s_waitcnt lgkmcnt(5)
  s_add_u32 s45, s75, 0x0
  v_mul_f32 v35, v141, v237
  v_mul_f32 v41, v143, v239
  v_mul_f32 v38, 0x3fb8aa3b, v34
  v_mul_f32 v42, 0x3fb8aa3b, v40
  v_mul_f32 v39, 0x3fb8aa3b, v35
  v_mfma_f32_32x32x16_bf16 a[64:79], a[40:43], v[60:63], a[64:79]
  s_waitcnt lgkmcnt(3)
  s_add_u32 m0, s43, 0x18000
  ds_read_b128 a[48:51], v11 offset:32768
  ds_read_b64_tr_b16 v[52:53], v7 offset:0
  v_mul_f32 v8, 0x3fb8aa3b, v41
  v_exp_f32_e64 v38, v38 clamp
  v_exp_f32_e64 v42, v42 clamp
  v_mfma_f32_32x32x16_bf16 a[80:95], a[44:47], v[60:63], a[80:95]
  s_waitcnt lgkmcnt(4)
  ds_read_b128 a[52:55], v11 offset:36864
  ds_read_b64_tr_b16 v[54:55], v7 offset:1024
  buffer_load_dwordx4 v19, s[8:11], s45 offen lds
  v_exp_f32_e64 v39, v39 clamp
  v_exp_f32_e64 v8, v8 clamp
  v_max_f32 v34, 0, v34
  v_mfma_f32_16x16x32_bf16 a[152:155], a[156:159], v[44:47], a[152:155]
  v_max_f32 v40, 0, v40
  v_max_f32 v35, 0, v35
  v_max_f32 v41, 0, v41
  v_add_f32 v34, v34, v38
  v_add_f32 v40, v40, v42
  v_mfma_f32_32x32x16_bf16 a[96:111], a[40:43], v[44:47], a[96:111]
  ds_read_b64_tr_b16 v[56:57], v6 offset:4096
  buffer_load_dwordx4 v15, s[8:11], s45 offen offset:1024 lds
  v_add_f32 v35, v35, v39
  v_add_f32 v41, v41, v8
  v_add_f32 v34, 0x358637bd, v34
  v_add_f32 v40, 0x358637bd, v40
  v_add_f32 v35, 0x358637bd, v35
  v_mfma_f32_32x32x16_bf16 a[112:127], a[44:47], v[44:47], a[112:127]
  s_waitcnt vmcnt(12) lgkmcnt(2)
  s_barrier
  ds_read_b64_tr_b16 v[58:59], v6 offset:5120
  v_add_f32 v41, 0x358637bd, v41
  v_cvt_pk_bf16_f32 v134, v34, v35
  v_cvt_pk_bf16_f32 v135, v40, v41
  v_mul_f32 v34, v144, v240
  v_mul_f32 v40, v146, v242
  v_mfma_f32_16x16x32_bf16 a[148:151], a[156:159], v[48:51], a[148:151]
  s_add_u32 s44, s61, 0x0
  v_mul_f32 v35, v145, v241
  v_mul_f32 v41, v147, v243
  v_mul_f32 v38, 0x3fb8aa3b, v34
  v_mul_f32 v42, 0x3fb8aa3b, v40
  v_mfma_f32_32x32x16_bf16 a[64:79], a[48:51], v[48:51], a[64:79]
  ds_read_b128 a[56:59], v12 offset:32768
  ds_read_b64_tr_b16 v[60:61], v7 offset:4096
  v_mul_f32 v39, 0x3fb8aa3b, v35
  v_mul_f32 v8, 0x3fb8aa3b, v41
  v_exp_f32_e64 v38, v38 clamp
  v_mfma_f32_32x32x16_bf16 a[80:95], a[52:55], v[48:51], a[80:95]
  s_waitcnt lgkmcnt(4)
  ds_read_b128 a[60:63], v12 offset:36864
  ds_read_b64_tr_b16 v[62:63], v7 offset:5120
  v_exp_f32_e64 v42, v42 clamp
  v_exp_f32_e64 v39, v39 clamp
  v_exp_f32_e64 v8, v8 clamp
  v_mfma_f32_16x16x32_bf16 a[152:155], a[156:159], v[52:55], a[152:155]
  v_max_f32 v34, 0, v34
  v_max_f32 v40, 0, v40
  v_max_f32 v35, 0, v35
  v_max_f32 v41, 0, v41
  v_add_f32 v34, v34, v38
  v_mfma_f32_32x32x16_bf16 a[96:111], a[48:51], v[52:55], a[96:111]
  ds_read_b64_tr_b16 v[44:45], v6 offset:8192
  v_add_f32 v40, v40, v42
  v_add_f32 v35, v35, v39
  v_add_f32 v41, v41, v8
  v_add_f32 v34, 0x358637bd, v34
  v_add_f32 v40, 0x358637bd, v40
  v_mfma_f32_32x32x16_bf16 a[112:127], a[52:55], v[52:55], a[112:127]
  s_waitcnt lgkmcnt(5)
  ds_read_b64_tr_b16 v[46:47], v6 offset:9216
  v_add_f32 v35, 0x358637bd, v35
  v_add_f32 v41, 0x358637bd, v41
  v_cvt_pk_bf16_f32 v136, v34, v35
  v_cvt_pk_bf16_f32 v137, v40, v41
  v_mul_f32 v34, v148, v244
  v_mfma_f32_16x16x32_bf16 a[148:151], a[156:159], v[56:59], a[148:151]
  s_waitcnt lgkmcnt(5)
  v_mul_f32 v40, v150, v246
  v_mul_f32 v35, v149, v245
  v_mul_f32 v41, v151, v247
  v_mul_f32 v38, 0x3fb8aa3b, v34
  v_mul_f32 v42, 0x3fb8aa3b, v40
  v_mfma_f32_32x32x16_bf16 a[64:79], a[56:59], v[56:59], a[64:79]
  s_waitcnt lgkmcnt(3)
  ds_read_b128 a[0:3], v9 offset:49152
  ds_read_b64_tr_b16 v[48:49], v7 offset:8192
  v_mul_f32 v39, 0x3fb8aa3b, v35
  v_mul_f32 v8, 0x3fb8aa3b, v41
  v_exp_f32_e64 v38, v38 clamp
  v_mfma_f32_32x32x16_bf16 a[80:95], a[60:63], v[56:59], a[80:95]
  s_waitcnt lgkmcnt(4)
  ds_read_b128 a[4:7], v9 offset:53248
  ds_read_b64_tr_b16 v[50:51], v7 offset:9216
  v_exp_f32_e64 v42, v42 clamp
  v_exp_f32_e64 v39, v39 clamp
  v_mfma_f32_16x16x32_bf16 a[152:155], a[156:159], v[60:63], a[152:155]
  v_exp_f32_e64 v8, v8 clamp
  v_max_f32 v34, 0, v34
  v_max_f32 v40, 0, v40
  v_max_f32 v35, 0, v35
  v_max_f32 v41, 0, v41
  v_mfma_f32_32x32x16_bf16 a[96:111], a[56:59], v[60:63], a[96:111]
  ds_read_b64_tr_b16 v[52:53], v6 offset:12288
  v_add_f32 v34, v34, v38
  v_add_f32 v40, v40, v42
  v_add_f32 v35, v35, v39
  v_add_f32 v41, v41, v8
  v_add_f32 v34, 0x358637bd, v34
  v_mfma_f32_32x32x16_bf16 a[112:127], a[60:63], v[60:63], a[112:127]
  s_waitcnt vmcnt(10) lgkmcnt(2)
  s_barrier
  ds_read_b64_tr_b16 v[54:55], v6 offset:13312
  v_add_f32 v40, 0x358637bd, v40
  v_add_f32 v35, 0x358637bd, v35
  v_add_f32 v41, 0x358637bd, v41
  v_cvt_pk_bf16_f32 v138, v34, v35
  v_cvt_pk_bf16_f32 v139, v40, v41
  v_mfma_f32_16x16x32_bf16 a[148:151], a[156:159], v[44:47], a[148:151]
  s_add_u32 m0, s3, 0x20000
  v_mul_f32 v34, v152, v248
  v_mul_f32 v40, v154, v250
  v_mul_f32 v35, v153, v249
  v_mul_f32 v41, v155, v251
  v_mul_f32 v38, 0x3fb8aa3b, v34
  v_mfma_f32_32x32x16_bf16 a[64:79], a[0:3], v[44:47], a[64:79]
  ds_read_b128 a[8:11], v10 offset:49152
  ds_read_b64_tr_b16 v[56:57], v7 offset:12288
  buffer_load_dwordx4 v22, s[4:7], s44 offen lds
  v_mul_f32 v42, 0x3fb8aa3b, v40
  v_mul_f32 v39, 0x3fb8aa3b, v35
  v_mul_f32 v8, 0x3fb8aa3b, v41
  v_exp_f32_e64 v38, v38 clamp
  v_mfma_f32_32x32x16_bf16 a[80:95], a[4:7], v[44:47], a[80:95]
  s_waitcnt lgkmcnt(4)
  ds_read_b128 a[12:15], v10 offset:53248
  ds_read_b64_tr_b16 v[58:59], v7 offset:13312
  v_exp_f32_e64 v42, v42 clamp
  v_exp_f32_e64 v39, v39 clamp
  v_mfma_f32_16x16x32_bf16 a[152:155], a[156:159], v[48:51], a[152:155]
  v_exp_f32_e64 v8, v8 clamp
  v_max_f32 v34, 0, v34
  v_max_f32 v40, 0, v40
  v_max_f32 v35, 0, v35
  v_max_f32 v41, 0, v41
  v_mfma_f32_32x32x16_bf16 a[96:111], a[0:3], v[48:51], a[96:111]
  ds_read_b64_tr_b16 v[60:61], v6 offset:16384
  buffer_load_dwordx4 v23, s[4:7], s44 offen offset:1024 lds
  v_add_f32 v34, v34, v38
  v_add_f32 v40, v40, v42
  v_add_f32 v35, v35, v39
  v_add_f32 v41, v41, v8
  v_add_f32 v34, 0x358637bd, v34
  v_mfma_f32_32x32x16_bf16 a[112:127], a[4:7], v[48:51], a[112:127]
  s_waitcnt lgkmcnt(5)
  ds_read_b64_tr_b16 v[62:63], v6 offset:17408
  v_add_f32 v40, 0x358637bd, v40
  v_add_f32 v35, 0x358637bd, v35
  v_add_f32 v41, 0x358637bd, v41
  v_cvt_pk_bf16_f32 v140, v34, v35
  v_cvt_pk_bf16_f32 v141, v40, v41
  v_mfma_f32_16x16x32_bf16 a[148:151], a[156:159], v[52:55], a[148:151]
  s_waitcnt lgkmcnt(5)
  v_mul_f32 v34, v156, v252
  v_mul_f32 v40, v158, v254
  v_mul_f32 v35, v157, v253
  v_mul_f32 v41, v159, v255
  v_mfma_f32_32x32x16_bf16 a[64:79], a[8:11], v[52:55], a[64:79]
  s_waitcnt lgkmcnt(3)
  ds_read_b128 a[16:19], v11 offset:49152
  ds_read_b64_tr_b16 v[44:45], v7 offset:16384
  buffer_load_dwordx4 v24, s[4:7], s44 offen offset:2048 lds
  v_mul_f32 v38, 0x3fb8aa3b, v34
  v_mul_f32 v42, 0x3fb8aa3b, v40
  v_mul_f32 v39, 0x3fb8aa3b, v35
  v_mul_f32 v8, 0x3fb8aa3b, v41
  v_mfma_f32_32x32x16_bf16 a[80:95], a[12:15], v[52:55], a[80:95]
  s_waitcnt lgkmcnt(4)
  ds_read_b128 a[20:23], v11 offset:53248
  ds_read_b64_tr_b16 v[46:47], v7 offset:17408
  v_exp_f32_e64 v38, v38 clamp
  v_exp_f32_e64 v42, v42 clamp
  v_exp_f32_e64 v39, v39 clamp
  v_mfma_f32_16x16x32_bf16 a[152:155], a[156:159], v[56:59], a[152:155]
  v_exp_f32_e64 v8, v8 clamp
  v_max_f32 v34, 0, v34
  v_max_f32 v40, 0, v40
  v_max_f32 v35, 0, v35
  v_mfma_f32_32x32x16_bf16 a[96:111], a[8:11], v[56:59], a[96:111]
  ds_read_b64_tr_b16 v[48:49], v6 offset:20480
  buffer_load_dwordx4 v25, s[4:7], s44 offen offset:3072 lds
  v_max_f32 v41, 0, v41
  v_add_f32 v34, v34, v38
  v_add_f32 v40, v40, v42
  v_add_f32 v35, v35, v39
  v_add_f32 v41, v41, v8
  v_mfma_f32_32x32x16_bf16 a[112:127], a[12:15], v[56:59], a[112:127]
  s_waitcnt lgkmcnt(2)
  s_barrier
  ds_read_b64_tr_b16 v[50:51], v6 offset:21504
  v_add_f32 v34, 0x358637bd, v34
  v_add_f32 v40, 0x358637bd, v40
  v_add_f32 v35, 0x358637bd, v35
  v_add_f32 v41, 0x358637bd, v41
  v_cvt_pk_bf16_f32 v142, v34, v35
  v_mfma_f32_16x16x32_bf16 a[148:151], a[156:159], v[60:63], a[148:151]
  s_add_u32 s45, s75, 0x1b000
  v_cvt_pk_bf16_f32 v143, v40, v41
  v_mul_f32 v34, v160, v224
  v_mul_f32 v40, v162, v226
  v_mul_f32 v35, v161, v225
  v_mul_f32 v41, v163, v227
  v_mfma_f32_32x32x16_bf16 a[64:79], a[16:19], v[60:63], a[64:79]
  s_add_u32 m0, s43, 0x1a000
  ds_read_b128 a[24:27], v12 offset:49152
  ds_read_b64_tr_b16 v[52:53], v7 offset:20480
  v_cvt_pk_bf16_f32 v160, v34, v35
  v_cvt_pk_bf16_f32 v161, v40, v41
  v_mul_f32 v34, v164, v228
  v_mul_f32 v40, v166, v230
  v_mfma_f32_32x32x16_bf16 a[80:95], a[20:23], v[60:63], a[80:95]
  s_waitcnt lgkmcnt(4)
  ds_read_b128 a[28:31], v12 offset:53248
  ds_read_b64_tr_b16 v[54:55], v7 offset:21504
  buffer_load_dwordx4 v19, s[8:11], s45 offen lds
  v_mul_f32 v35, v165, v229
  v_mul_f32 v41, v167, v231
  v_cvt_pk_bf16_f32 v162, v34, v35
  v_cvt_pk_bf16_f32 v163, v40, v41
  v_mul_f32 v34, v168, v232
  v_mfma_f32_16x16x32_bf16 a[152:155], a[156:159], v[44:47], a[152:155]
  v_mul_f32 v40, v170, v234
  v_mul_f32 v35, v169, v233
  v_mul_f32 v41, v171, v235
  v_cvt_pk_bf16_f32 v164, v34, v35
  v_cvt_pk_bf16_f32 v165, v40, v41
  v_mfma_f32_32x32x16_bf16 a[96:111], a[16:19], v[44:47], a[96:111]
  buffer_load_dwordx4 v15, s[8:11], s45 offen offset:1024 lds
  v_mul_f32 v34, v172, v236
  v_mul_f32 v40, v174, v238
  v_mul_f32 v35, v173, v237
  v_mul_f32 v41, v175, v239
  v_cvt_pk_bf16_f32 v166, v34, v35
  v_mfma_f32_32x32x16_bf16 a[112:127], a[20:23], v[44:47], a[112:127]
  s_waitcnt lgkmcnt(4)
  v_cvt_pk_bf16_f32 v167, v40, v41
  v_mul_f32 v34, v176, v240
  v_mul_f32 v40, v178, v242
  v_mul_f32 v35, v177, v241
  v_mul_f32 v41, v179, v243
  v_cvt_pk_bf16_f32 v168, v34, v35
  v_mfma_f32_16x16x32_bf16 a[148:151], a[156:159], v[48:51], a[148:151]
  s_waitcnt lgkmcnt(3)
  s_add_u32 s44, s76, 0x0
  v_cvt_pk_bf16_f32 v169, v40, v41
  v_mul_f32 v34, v180, v244
  v_mul_f32 v40, v182, v246
  v_mul_f32 v35, v181, v245
  v_mfma_f32_32x32x16_bf16 a[64:79], a[24:27], v[48:51], a[64:79]
  s_waitcnt lgkmcnt(1)
  s_add_u32 m0, s43, 0xe000
  v_mul_f32 v41, v183, v247
  v_cvt_pk_bf16_f32 v170, v34, v35
  v_cvt_pk_bf16_f32 v171, v40, v41
  v_mul_f32 v34, v184, v248
  v_mul_f32 v40, v186, v250
  v_mul_f32 v35, v185, v249
  v_mfma_f32_32x32x16_bf16 a[80:95], a[28:31], v[48:51], a[80:95]
  s_waitcnt lgkmcnt(0)
  buffer_load_dwordx4 v19, s[8:11], s44 offen lds
  v_mul_f32 v41, v187, v251
  v_cvt_pk_bf16_f32 v172, v34, v35
  v_cvt_pk_bf16_f32 v173, v40, v41
  v_mul_f32 v34, v188, v252
  v_mfma_f32_16x16x32_bf16 a[152:155], a[156:159], v[52:55], a[152:155]
  v_mul_f32 v40, v190, v254
  v_mul_f32 v35, v189, v253
  v_mul_f32 v41, v191, v255
  v_cvt_pk_bf16_f32 v174, v34, v35
  v_mfma_f32_32x32x16_bf16 a[96:111], a[24:27], v[52:55], a[96:111]
  buffer_load_dwordx4 v15, s[8:11], s44 offen offset:1024 lds
  v_cvt_pk_bf16_f32 v175, v40, v41
  v_mfma_f32_32x32x16_bf16 a[112:127], a[28:31], v[52:55], a[112:127]
  s_waitcnt vmcnt(12)
  s_barrier
  v_and_b32 v34, 31, v1
  v_lshrrev_b32 v35, 5, v1
  v_mfma_f32_32x32x16_bf16 a[216:231], v[128:131], v[160:163], 0
  s_add_u32 s45, s62, 0x0
  s_mul_i32 s34, s31, 23680
  s_mul_i32 s35, s32, 11840
  s_add_u32 s34, s34, s35
  s_mul_i32 s36, s30, 5920
  s_mul_i32 s37, s31, 16896
  s_mul_i32 s38, s32, 8520
  s_add_u32 s37, s37, s38
  s_mul_i32 s57, s30, 1536
  s_add_u32 s56, s57, s56
  s_mul_i32 s57, s28, 6144
  s_add_u32 s57, s57, s56
  v_mul_u32_u24 v144, 160, v34
  v_mfma_f32_32x32x16_bf16 a[216:231], v[132:135], v[164:167], a[216:231]
  s_add_u32 m0, s3, 0x24000
  v_lshl_add_u32 v144, v35, 4, v144
  v_add_u32 v144, s34, v144
  v_mov_b32 v43, 0x7ff00000
  v_add_u32 v146, 3200, v144
  v_subrev_u32 v38, 12, v34
  v_cmp_gt_u32 vcc, 5, v38
  v_add_u32 v145, 4480, v144
  v_subrev_u32 v38, 4, v34
  v_cndmask_b32 v146, v43, v146, vcc
  v_cmp_gt_u32 vcc, 4, v38
  s_nop 1
  v_cndmask_b32 v145, v43, v145, vcc
  v_cmp_eq_u32 vcc, 16, v34
  s_nop 1
  v_cndmask_b32 v145, v145, v146, vcc
  v_mfma_f32_32x32x16_bf16 a[216:231], v[136:139], v[168:171], a[216:231]
  buffer_load_dwordx4 v22, s[4:7], s45 offen lds
  v_cmp_gt_u32 vcc, 32, v1
  s_nop 1
  v_cndmask_b32 v147, v43, v144, vcc
  v_cndmask_b32 v148, v43, v145, vcc
  v_cndmask_b32 v149, v43, v146, vcc
  v_add_u32 v39, 0, v1
  v_mul_u32_u24 v40, 57, v39
  v_lshrrev_b32 v40, 9, v40
  v_mul_u32_u24 v38, 9, v40
  v_sub_u32 v38, v39, v38
  v_mul_u32_u24 v150, 160, v40
  v_lshl_add_u32 v150, v38, 3, v150
  v_add_u32 v150, s36, v150
  v_add_u32 v151, 2952, v150
  v_mfma_f32_32x32x16_bf16 a[216:231], v[140:143], v[172:175], a[216:231]
  v_mul_u32_u24 v26, 176, v40
  v_lshl_add_u32 v26, v38, 2, v26
  v_add_u32 v26, s37, v26
  v_add_u32 v39, 64, v1
  v_mul_u32_u24 v40, 57, v39
  v_lshrrev_b32 v40, 9, v40
  v_mul_u32_u24 v38, 9, v40
  v_sub_u32 v38, v39, v38
  v_mul_u32_u24 v152, 160, v40
  v_lshl_add_u32 v152, v38, 3, v152
  v_add_u32 v152, s36, v152
  v_add_u32 v153, 2952, v152
  v_mul_u32_u24 v27, 176, v40
  v_lshl_add_u32 v27, v38, 2, v27
  v_mfma_f32_32x32x16_bf16 a[232:247], v[128:131], v[112:115], 0
  ds_read_b64_tr_b16 v[56:57], v6 offset:24576
  buffer_load_dwordx4 v23, s[4:7], s45 offen offset:1024 lds
  v_add_u32 v27, s37, v27
  v_add_u32 v39, 128, v1
  v_mul_u32_u24 v40, 57, v39
  v_lshrrev_b32 v40, 9, v40
  v_mul_u32_u24 v38, 9, v40
  v_sub_u32 v38, v39, v38
  v_mul_u32_u24 v154, 160, v40
  v_lshl_add_u32 v154, v38, 3, v154
  v_add_u32 v154, s36, v154
  v_add_u32 v155, 2952, v154
  v_mul_u32_u24 v28, 176, v40
  v_lshl_add_u32 v28, v38, 2, v28
  v_add_u32 v28, s37, v28
  v_mfma_f32_32x32x16_bf16 a[232:247], v[132:135], v[116:119], a[232:247]
  ds_read_b64_tr_b16 v[58:59], v6 offset:25600
  v_add_u32 v41, 2880, v154
  v_cmp_eq_u32 vcc, 18, v40
  s_nop 1
  v_cndmask_b32 v154, v154, v41, vcc
  v_add_u32 v41, 704, v28
  v_cndmask_b32 v29, v43, v41, vcc
  v_cmp_gt_u32 vcc, 19, v40
  v_lshlrev_b32 v20, 4, v1
  v_lshlrev_b32 v21, 3, v1
  v_cndmask_b32 v28, v43, v28, vcc
  v_cndmask_b32 v154, v1, v154, vcc
  v_cndmask_b32 v155, v1, v155, vcc
  v_and_b32 v154, -8, v154
  v_and_b32 v155, -8, v155
  v_mfma_f32_32x32x16_bf16 a[232:247], v[136:139], v[120:123], a[232:247]
  buffer_load_dwordx4 v24, s[4:7], s45 offen offset:2048 lds
  v_mfma_f32_32x32x16_bf16 a[232:247], v[140:143], v[124:127], a[232:247]
  ds_read_b128 a[32:35], v9 offset:16384
  ds_read_b64_tr_b16 v[60:61], v7 offset:24576
  ds_write_b128 v144, a[168:171] offset:8192
  ds_write_b128 v145, a[184:187] offset:8192
  ds_write_b128 v144, a[172:175] offset:8224
  v_mfma_f32_32x32x16_bf16 v[208:223], v[192:195], v[160:163], 0
  ds_read_b128 a[36:39], v9 offset:20480
  ds_read_b64_tr_b16 v[62:63], v7 offset:25600
  buffer_load_dwordx4 v25, s[4:7], s45 offen offset:3072 lds
  ds_write_b128 v145, a[188:191] offset:8224
  ds_write_b128 v144, a[176:179] offset:8256
  ds_write_b128 v145, a[192:195] offset:8256
  v_mfma_f32_32x32x16_bf16 v[208:223], v[196:199], v[164:167], v[208:223]
  s_add_u32 s44, s76, 0x1b000
  ds_write_b128 v144, a[180:183] offset:8288
  ds_write_b128 v145, a[196:199] offset:8288
  ds_write_b128 v147, a[200:203] offset:8320
  v_mfma_f32_32x32x16_bf16 v[208:223], v[200:203], v[168:171], v[208:223]
  s_add_u32 m0, s43, 0x10000
  s_waitcnt lgkmcnt(14)
  ds_read_b64_tr_b16 v[44:45], v6 offset:28672
  s_waitcnt lgkmcnt(14)
  ds_write_b128 v148, v[80:83] offset:8320
  s_waitcnt lgkmcnt(14)
  ds_write_b128 v149, v[84:87] offset:14240
  s_waitcnt lgkmcnt(14)
  ds_write_b128 v144, a[216:219] offset:14112
  v_mfma_f32_32x32x16_bf16 v[208:223], v[204:207], v[172:175], v[208:223]
  s_waitcnt lgkmcnt(4)
  s_barrier
  ds_read_b64_tr_b16 v[46:47], v6 offset:29696
  ds_write_b128 v144, a[220:223] offset:14144
  ds_write_b128 v144, a[224:227] offset:14176
  ds_write_b128 v144, a[228:231] offset:14208
  v_mfma_f32_16x16x32_bf16 a[148:151], a[156:159], v[56:59], a[148:151]
  ds_write_b128 v146, a[232:235] offset:14112
  ds_write_b128 v146, a[236:239] offset:14144
  ds_write_b128 v146, a[240:243] offset:14176
  v_mfma_f32_32x32x16_bf16 a[64:79], a[32:35], v[56:59], a[64:79]
  ds_read_b128 a[40:43], v10 offset:16384
  ds_read_b64_tr_b16 v[48:49], v7 offset:28672
  buffer_load_dwordx4 v19, s[8:11], s44 offen lds
  ds_write_b128 v146, a[244:247] offset:14208
  ds_write_b128 v147, v[212:215] offset:14240
  v_mfma_f32_32x32x16_bf16 a[80:95], a[36:39], v[56:59], a[80:95]
  s_waitcnt lgkmcnt(14)
  ds_read_b128 a[44:47], v10 offset:20480
  s_waitcnt lgkmcnt(14)
  ds_read_b64_tr_b16 v[50:51], v7 offset:29696
  v_mfma_f32_16x16x32_bf16 a[152:155], a[156:159], v[60:63], a[152:155]
  v_mfma_f32_32x32x16_bf16 a[96:111], a[32:35], v[60:63], a[96:111]
  s_waitcnt vmcnt(15) lgkmcnt(1)
  s_barrier
  ds_read_b64_tr_b16 v[52:53], v6 offset:32768
  ds_read_b64 v[64:65], v150 offset:8192
  v_mfma_f32_32x32x16_bf16 a[112:127], a[36:39], v[60:63], a[112:127]
  ds_read_b64_tr_b16 v[54:55], v6 offset:33792
  buffer_load_dwordx4 v15, s[8:11], s44 offen offset:1024 lds
  ds_read_b64 v[96:97], v150 offset:31872
  ds_read_b64 v[66:67], v152 offset:8192
  ds_read_b64 v[98:99], v152 offset:31872
  ds_read_b64 v[68:69], v154 offset:8192
  ds_read_b64 v[100:101], v154 offset:31872
  ds_read_b64 v[70:71], v151 offset:8192
  ds_read_b64 v[102:103], v151 offset:31872
  ds_read_b64 v[72:73], v153 offset:8192
  ds_read_b64 v[104:105], v153 offset:31872
  ds_read_b64 v[74:75], v155 offset:8192
  ds_read_b64 v[106:107], v155 offset:31872
  v_mfma_f32_16x16x32_bf16 a[148:151], a[156:159], v[44:47], a[148:151]
  v_mfma_f32_32x32x16_bf16 a[64:79], a[40:43], v[44:47], a[64:79]
  s_waitcnt lgkmcnt(14)
  ds_read_b128 a[48:51], v11 offset:16384
  s_waitcnt lgkmcnt(14)
  ds_read_b64_tr_b16 v[56:57], v7 offset:32768
  s_waitcnt lgkmcnt(12)
  v_add_f32 v64, v64, v96
  v_add_f32 v65, v65, v97
  s_waitcnt lgkmcnt(10)
  v_add_f32 v66, v66, v98
  v_add_f32 v67, v67, v99
  v_mfma_f32_32x32x16_bf16 a[80:95], a[44:47], v[44:47], a[80:95]
  ds_read_b128 a[52:55], v11 offset:20480
  ds_read_b64_tr_b16 v[58:59], v7 offset:33792
  s_waitcnt lgkmcnt(10)
  v_add_f32 v68, v68, v100
  v_add_f32 v69, v69, v101
  s_waitcnt lgkmcnt(8)
  v_add_f32 v70, v70, v102
  v_add_f32 v71, v71, v103
  s_waitcnt lgkmcnt(6)
  v_add_f32 v72, v72, v104
  v_add_f32 v73, v73, v105
  s_waitcnt lgkmcnt(4)
  v_add_f32 v74, v74, v106
  v_add_f32 v75, v75, v107
  v_cvt_pk_bf16_f32 v64, v64, v65
  v_cvt_pk_bf16_f32 v65, v66, v67
  v_cvt_pk_bf16_f32 v66, v68, v69
  v_cvt_pk_bf16_f32 v67, v70, v71
  v_cvt_pk_bf16_f32 v68, v72, v73
  v_cvt_pk_bf16_f32 v69, v74, v75
  v_mfma_f32_16x16x32_bf16 a[152:155], a[156:159], v[48:51], a[152:155]
  buffer_store_dwordx4 v[64:67], v20, s[16:19], s57 offen sc1
  buffer_store_dwordx2 v[68:69], v21, s[16:19], s57 offen offset:1024 sc1
  v_mfma_f32_32x32x16_bf16 a[96:111], a[40:43], v[48:51], a[96:111]
  ds_read_b64_tr_b16 v[60:61], v6 offset:36864
  v_mfma_f32_32x32x16_bf16 a[112:127], a[44:47], v[48:51], a[112:127]
  s_waitcnt vmcnt(12) lgkmcnt(2)
  s_barrier
  ds_read_b64_tr_b16 v[62:63], v6 offset:37888
  v_mfma_f32_16x16x32_bf16 a[148:151], a[156:159], v[52:55], a[148:151]
  v_mfma_f32_32x32x16_bf16 a[64:79], a[48:51], v[52:55], a[64:79]
  ds_read_b128 a[56:59], v12 offset:16384
  ds_read_b64_tr_b16 v[44:45], v7 offset:36864
  v_mfma_f32_32x32x16_bf16 a[80:95], a[52:55], v[52:55], a[80:95]
  s_waitcnt lgkmcnt(4)
  ds_read_b128 a[60:63], v12 offset:20480
  ds_read_b64_tr_b16 v[46:47], v7 offset:37888
  v_mfma_f32_16x16x32_bf16 a[152:155], a[156:159], v[56:59], a[152:155]
  v_mfma_f32_32x32x16_bf16 a[96:111], a[48:51], v[56:59], a[96:111]
  ds_read_b64_tr_b16 v[48:49], v6 offset:40960
  v_mfma_f32_32x32x16_bf16 a[112:127], a[52:55], v[56:59], a[112:127]
  s_waitcnt lgkmcnt(5)
  ds_read_b64_tr_b16 v[50:51], v6 offset:41984
  v_mfma_f32_16x16x32_bf16 a[148:151], a[156:159], v[60:63], a[148:151]
  s_waitcnt lgkmcnt(5)
  v_mfma_f32_32x32x16_bf16 a[64:79], a[56:59], v[60:63], a[64:79]
  s_waitcnt lgkmcnt(3)
  ds_read_b128 a[0:3], v9 offset:32768
  ds_read_b64_tr_b16 v[52:53], v7 offset:40960
  v_mfma_f32_32x32x16_bf16 a[80:95], a[60:63], v[60:63], a[80:95]
  s_waitcnt lgkmcnt(4)
  ds_read_b128 a[4:7], v9 offset:36864
  ds_read_b64_tr_b16 v[54:55], v7 offset:41984
  v_mfma_f32_16x16x32_bf16 a[152:155], a[156:159], v[44:47], a[152:155]
  v_mfma_f32_32x32x16_bf16 a[96:111], a[56:59], v[44:47], a[96:111]
  ds_read_b64_tr_b16 v[56:57], v6 offset:45056
  v_mfma_f32_32x32x16_bf16 a[112:127], a[60:63], v[44:47], a[112:127]
  s_waitcnt vmcnt(10) lgkmcnt(2)
  s_barrier
  ds_read_b64_tr_b16 v[58:59], v6 offset:46080
  v_mfma_f32_16x16x32_bf16 a[148:151], a[156:159], v[48:51], a[148:151]
  v_mfma_f32_32x32x16_bf16 a[64:79], a[0:3], v[48:51], a[64:79]
  ds_read_b128 a[8:11], v10 offset:32768
  ds_read_b64_tr_b16 v[60:61], v7 offset:45056
  v_mfma_f32_32x32x16_bf16 a[80:95], a[4:7], v[48:51], a[80:95]
  s_waitcnt lgkmcnt(4)
  ds_read_b128 a[12:15], v10 offset:36864
  ds_read_b64_tr_b16 v[62:63], v7 offset:46080
  v_mfma_f32_16x16x32_bf16 a[152:155], a[156:159], v[52:55], a[152:155]
  v_mfma_f32_32x32x16_bf16 a[96:111], a[0:3], v[52:55], a[96:111]
  ds_read_b64_tr_b16 v[44:45], v6 offset:49152
  v_mfma_f32_32x32x16_bf16 a[112:127], a[4:7], v[52:55], a[112:127]
  s_waitcnt lgkmcnt(5)
  ds_read_b64_tr_b16 v[46:47], v6 offset:50176
  v_mfma_f32_16x16x32_bf16 a[148:151], a[156:159], v[56:59], a[148:151]
  s_waitcnt lgkmcnt(5)
  v_mfma_f32_32x32x16_bf16 a[64:79], a[8:11], v[56:59], a[64:79]
  s_waitcnt lgkmcnt(3)
  ds_read_b128 a[16:19], v11 offset:32768
  ds_read_b64_tr_b16 v[48:49], v7 offset:49152
  v_mfma_f32_32x32x16_bf16 a[80:95], a[12:15], v[56:59], a[80:95]
  s_waitcnt lgkmcnt(4)
  ds_read_b128 a[20:23], v11 offset:36864
  ds_read_b64_tr_b16 v[50:51], v7 offset:50176
  v_mfma_f32_16x16x32_bf16 a[152:155], a[156:159], v[60:63], a[152:155]
  v_mfma_f32_32x32x16_bf16 a[96:111], a[8:11], v[60:63], a[96:111]
  ds_read_b64_tr_b16 v[52:53], v6 offset:53248
  v_mfma_f32_32x32x16_bf16 a[112:127], a[12:15], v[60:63], a[112:127]
  s_waitcnt vmcnt(4) lgkmcnt(2)
  s_barrier
  ds_read_b64_tr_b16 v[54:55], v6 offset:54272
  v_mfma_f32_16x16x32_bf16 a[148:151], a[156:159], v[44:47], a[148:151]
  v_mfma_f32_32x32x16_bf16 a[64:79], a[16:19], v[44:47], a[64:79]
  ds_read_b128 a[24:27], v12 offset:32768
  ds_read_b64_tr_b16 v[56:57], v7 offset:53248
  v_mfma_f32_32x32x16_bf16 a[80:95], a[20:23], v[44:47], a[80:95]
  s_waitcnt lgkmcnt(4)
  ds_read_b128 a[28:31], v12 offset:36864
  ds_read_b64_tr_b16 v[58:59], v7 offset:54272
  v_mfma_f32_16x16x32_bf16 a[152:155], a[156:159], v[48:51], a[152:155]
  v_mfma_f32_32x32x16_bf16 a[96:111], a[16:19], v[48:51], a[96:111]
  ds_read_b64_tr_b16 v[60:61], v6 offset:0
  v_mfma_f32_32x32x16_bf16 a[112:127], a[20:23], v[48:51], a[112:127]
  s_waitcnt lgkmcnt(5)
  ds_read_b64_tr_b16 v[62:63], v6 offset:1024
  v_mfma_f32_16x16x32_bf16 a[148:151], a[156:159], v[52:55], a[148:151]
  s_waitcnt lgkmcnt(5)
  v_mfma_f32_32x32x16_bf16 a[64:79], a[24:27], v[52:55], a[64:79]
  s_waitcnt lgkmcnt(3)
  ds_read_b128 a[32:35], v9 offset:49152
  ds_read_b64_tr_b16 v[44:45], v7 offset:0
  v_mfma_f32_32x32x16_bf16 a[80:95], a[28:31], v[52:55], a[80:95]
  s_waitcnt lgkmcnt(4)
  ds_read_b128 a[36:39], v9 offset:53248
  ds_read_b64_tr_b16 v[46:47], v7 offset:1024
  v_mfma_f32_16x16x32_bf16 a[152:155], a[156:159], v[56:59], a[152:155]
  v_mfma_f32_32x32x16_bf16 a[96:111], a[24:27], v[56:59], a[96:111]
  s_waitcnt vmcnt(0)
  ds_read_b64_tr_b16 v[48:49], v6 offset:4096
  v_lshlrev_b32 v156, 12, v0
  v_mov_b32 v157, 1
  v_mfma_f32_32x32x16_bf16 a[112:127], a[28:31], v[56:59], a[112:127]
  s_waitcnt lgkmcnt(2)
  s_barrier
  ds_read_b64_tr_b16 v[50:51], v6 offset:5120
  buffer_atomic_add v157, v156, s[24:27], s54 offen offset:128
  v_mfma_f32_16x16x32_bf16 a[148:151], a[156:159], v[60:63], a[148:151]
  v_lshlrev_b32 v158, 4, v0
  v_mov_b32 v176, 0
  v_mov_b32 v177, 0
  v_mov_b32 v178, 0
  v_mov_b32 v179, 0
  v_mfma_f32_32x32x16_bf16 a[64:79], a[32:35], v[60:63], a[64:79]
  ds_read_b128 a[40:43], v10 offset:49152
  ds_read_b64_tr_b16 v[52:53], v7 offset:4096
  ds_write_b128 v158, v[176:179] offset:8192
  ds_write_b128 v158, v[176:179] offset:12288
  ds_write_b128 v158, v[176:179] offset:16384
  ds_write_b128 v158, v[176:179] offset:20480
  ds_write_b128 v158, v[176:179] offset:24576
  ds_write_b128 v158, v[176:179] offset:28672
  ds_write_b128 v158, v[176:179] offset:32768
  ds_write_b128 v158, v[176:179] offset:36864
  ds_write_b128 v158, v[176:179] offset:40960
  v_and_b32 v8, 31, v1
  v_lshrrev_b32 v41, 5, v1
  s_mul_i32 s34, s30, 10880
  s_add_u32 s34, s34, 0x1c000
  v_mul_u32_u24 v180, 136, v8
  v_lshl_add_u32 v180, v41, 3, v180
  v_add_u32 v180, s34, v180
  v_add_u32 v181, 6528, v180
  v_cndmask_b32 v181, v43, v181, s[58:59]
  v_bfe_u32 v42, v1, 2, 2
  v_lshl_add_u32 v42, v41, 3, v42
  v_mul_u32_u24 v182, 136, v42
  v_and_b32 v42, 3, v1
  v_lshl_add_u32 v182, v42, 3, v182
  v_bfe_u32 v42, v1, 4, 1
  v_mfma_f32_32x32x16_bf16 a[80:95], a[36:39], v[60:63], a[80:95]
  s_waitcnt lgkmcnt(13)
  ds_read_b128 a[44:47], v10 offset:53248
  ds_read_b64_tr_b16 v[54:55], v7 offset:5120
  v_lshl_add_u32 v182, v42, 5, v182
  v_add_u32 v182, s34, v182
  s_mul_i32 s34, s32, 16896
  v_mul_u32_u24 v183, 176, v8
  v_mfma_f32_16x16x32_bf16 a[152:155], a[156:159], v[44:47], a[152:155]
  v_lshl_add_u32 v183, v41, 4, v183
  v_add_u32 v183, s34, v183
  v_mfma_f32_32x32x16_bf16 a[96:111], a[32:35], v[44:47], a[96:111]
  s_waitcnt lgkmcnt(14)
  ds_read_b64_tr_b16 v[56:57], v6 offset:8192
  v_bfe_u32 v42, v1, 4, 1
  v_mul_u32_u24 v42, 18432, v42
  v_and_b32 v184, 15, v1
  v_lshl_add_u32 v184, v184, 4, v42
  s_mul_i32 s34, s32, 1792
  v_mfma_f32_32x32x16_bf16 a[112:127], a[36:39], v[44:47], a[112:127]
  s_waitcnt lgkmcnt(14)
  ds_read_b64_tr_b16 v[58:59], v6 offset:9216
  s_sub_u32 s34, 4096, s34
  v_add_u32 v186, s34, v184
  v_cmp_gt_u32 vcc, 32, v1
  v_lshl_add_u32 v184, v41, 8, v184
  s_nop 0
  v_cndmask_b32 v186, v43, v186, vcc
  v_mfma_f32_16x16x32_bf16 a[148:151], a[156:159], v[48:51], a[148:151]
  s_waitcnt lgkmcnt(14)
  s_mul_i32 s36, s53, 4608
  s_mul_i32 s34, s31, 73728
  v_mfma_f32_32x32x16_bf16 a[64:79], a[40:43], v[48:51], a[64:79]
  s_waitcnt lgkmcnt(3)
  ds_read_b128 a[48:51], v11 offset:49152
  ds_read_b64_tr_b16 v[60:61], v7 offset:8192
  s_add_u32 s34, s34, s36
  s_lshl_b32 s36, s32, 11
  s_add_u32 s34, s34, s36
  s_add_u32 s34, s34, s40
  v_mfma_f32_32x32x16_bf16 a[80:95], a[44:47], v[48:51], a[80:95]
  s_waitcnt lgkmcnt(4)
  ds_read_b128 a[52:55], v11 offset:53248
  ds_read_b64_tr_b16 v[62:63], v7 offset:9216
  s_add_u32 s66, s34, 0x2000000
  s_add_u32 s67, s66, 36864
  s_add_u32 s29, s53, 12
  s_mov_b32 s36, s29
  v_mfma_f32_16x16x32_bf16 a[152:155], a[156:159], v[52:55], a[152:155]
  s_lshl_b32 s48, s28, 7
  s_add_u32 s48, s48, 0x2c00000
  v_mfma_f32_32x32x16_bf16 a[96:111], a[40:43], v[52:55], a[96:111]
  ds_read_b64_tr_b16 v[44:45], v6 offset:12288
  s_lshl_b32 s36, s36, 2
  v_mov_b32 v185, s36
  v_mov_b32 v187, 0x7ff00000
  v_cmp_eq_u32 vcc, 0, v0
  s_nop 1
  v_cndmask_b32 v185, v187, v185, vcc
  v_mfma_f32_32x32x16_bf16 a[112:127], a[44:47], v[52:55], a[112:127]
  s_waitcnt lgkmcnt(2)
  s_barrier
  ds_read_b64_tr_b16 v[46:47], v6 offset:13312
  v_mfma_f32_16x16x32_bf16 a[148:151], a[156:159], v[56:59], a[148:151]
  v_mfma_f32_32x32x16_bf16 a[64:79], a[48:51], v[56:59], a[64:79]
  ds_read_b128 a[56:59], v12 offset:49152
  ds_read_b64_tr_b16 v[48:49], v7 offset:12288
  v_mfma_f32_32x32x16_bf16 a[80:95], a[52:55], v[56:59], a[80:95]
  s_waitcnt lgkmcnt(4)
  ds_read_b128 a[60:63], v12 offset:53248
  ds_read_b64_tr_b16 v[50:51], v7 offset:13312
  v_mfma_f32_16x16x32_bf16 a[152:155], a[156:159], v[60:63], a[152:155]
  v_mfma_f32_32x32x16_bf16 a[96:111], a[48:51], v[60:63], a[96:111]
  v_mfma_f32_32x32x16_bf16 a[112:127], a[52:55], v[60:63], a[112:127]
  s_waitcnt lgkmcnt(4)
  v_mfma_f32_16x16x32_bf16 a[148:151], a[156:159], v[44:47], a[148:151]
  s_waitcnt lgkmcnt(3)
  v_mfma_f32_32x32x16_bf16 a[64:79], a[56:59], v[44:47], a[64:79]
  s_waitcnt lgkmcnt(1)
  v_mfma_f32_32x32x16_bf16 a[80:95], a[60:63], v[44:47], a[80:95]
  s_waitcnt lgkmcnt(0)
  v_mfma_f32_16x16x32_bf16 a[152:155], a[156:159], v[48:51], a[152:155]
  v_mfma_f32_32x32x16_bf16 a[96:111], a[56:59], v[48:51], a[96:111]
  v_mfma_f32_32x32x16_bf16 a[112:127], a[60:63], v[48:51], a[112:127]
  s_barrier
  s_nop 2
  ds_write2_b32 v13, a148, a149 offset0:160 offset1:176
  s_nop 4
  ds_write2_b32 v13, a152, a153 offset0:192 offset1:208
  ds_read_b32 v34, v14 offset:640
  ds_read_b32 v35, v14 offset:768
  s_waitcnt lgkmcnt(0)
  s_barrier
  v_cvt_pk_bf16_f32 v30, v34, v34
  v_and_b32 v31, s51, v30
  v_sub_f32 v34, v34, v31
  v_cvt_pk_bf16_f32 v31, v34, 0
  s_nop 1
  v_mfma_f32_32x32x16_bf16 a[64:79], a[160:163], v[30:33], a[64:79]
  v_mfma_f32_32x32x16_bf16 a[80:95], a[164:167], v[30:33], a[80:95]
  v_cvt_pk_bf16_f32 v30, v35, v35
  v_and_b32 v31, s51, v30
  v_sub_f32 v35, v35, v31
  v_cvt_pk_bf16_f32 v31, v35, 0
  s_nop 1
  v_mfma_f32_32x32x16_bf16 a[96:111], a[160:163], v[30:33], a[96:111]
  v_mfma_f32_32x32x16_bf16 a[112:127], a[164:167], v[30:33], a[112:127]
  ds_write_b64 v181, v[192:193] offset:0
  ds_write_b64 v181, v[194:195] offset:16
  ds_write_b64 v181, v[196:197] offset:32
  ds_write_b64 v181, v[198:199] offset:48
  ds_write_b64 v181, v[200:201] offset:64
  ds_write_b64 v181, v[202:203] offset:80
  ds_write_b64 v181, v[204:205] offset:96
  ds_write_b64 v181, v[206:207] offset:112
  s_mov_b32 s60, 0x3fb8aa3b
  s_mov_b32 s62, 0x358637bd
  s_mov_b32 s61, 0x3fb8aa3b
  s_mov_b32 s63, 0x358637bd
  v_accvgpr_read_b32 v34, a64
  v_accvgpr_read_b32 v38, a66
  v_accvgpr_read_b32 v35, a65
  v_accvgpr_read_b32 v39, a67
  v_pk_mul_f32 v[34:35], v[34:35], v[224:225]
  v_pk_mul_f32 v[38:39], v[38:39], v[226:227]
  v_pk_mul_f32 v[36:37], v[34:35], s[60:61]
  v_pk_mul_f32 v[40:41], v[38:39], s[60:61]
  v_exp_f32_e64 v36, v36 clamp
  v_exp_f32_e64 v40, v40 clamp
  v_exp_f32_e64 v37, v37 clamp
  v_exp_f32_e64 v41, v41 clamp
  v_max_f32 v34, 0, v34
  v_max_f32 v38, 0, v38
  v_max_f32 v35, 0, v35
  v_max_f32 v39, 0, v39
  v_pk_add_f32 v[34:35], v[34:35], v[36:37]
  v_pk_add_f32 v[38:39], v[38:39], v[40:41]
  v_pk_add_f32 v[34:35], v[34:35], s[62:63]
  v_pk_add_f32 v[38:39], v[38:39], s[62:63]
  v_cvt_pk_bf16_f32 v112, v34, v35
  v_cvt_pk_bf16_f32 v113, v38, v39
  v_accvgpr_read_b32 v34, a68
  v_accvgpr_read_b32 v38, a70
  v_accvgpr_read_b32 v35, a69
  v_accvgpr_read_b32 v39, a71
  v_pk_mul_f32 v[34:35], v[34:35], v[228:229]
  v_pk_mul_f32 v[38:39], v[38:39], v[230:231]
  v_pk_mul_f32 v[36:37], v[34:35], s[60:61]
  v_pk_mul_f32 v[40:41], v[38:39], s[60:61]
  v_exp_f32_e64 v36, v36 clamp
  v_exp_f32_e64 v40, v40 clamp
  v_exp_f32_e64 v37, v37 clamp
  v_exp_f32_e64 v41, v41 clamp
  v_max_f32 v34, 0, v34
  v_max_f32 v38, 0, v38
  v_max_f32 v35, 0, v35
  v_max_f32 v39, 0, v39
  v_pk_add_f32 v[34:35], v[34:35], v[36:37]
  v_pk_add_f32 v[38:39], v[38:39], v[40:41]
  v_pk_add_f32 v[34:35], v[34:35], s[62:63]
  v_pk_add_f32 v[38:39], v[38:39], s[62:63]
  v_cvt_pk_bf16_f32 v114, v34, v35
  v_cvt_pk_bf16_f32 v115, v38, v39
  ds_write_b64 v180, v[112:113] offset:0
  ds_write_b64 v180, v[114:115] offset:16
  v_accvgpr_read_b32 v34, a72
  v_accvgpr_read_b32 v38, a74
  v_accvgpr_read_b32 v35, a73
  v_accvgpr_read_b32 v39, a75
  v_pk_mul_f32 v[34:35], v[34:35], v[232:233]
  v_pk_mul_f32 v[38:39], v[38:39], v[234:235]
  v_pk_mul_f32 v[36:37], v[34:35], s[60:61]
  v_pk_mul_f32 v[40:41], v[38:39], s[60:61]
  v_exp_f32_e64 v36, v36 clamp
  v_exp_f32_e64 v40, v40 clamp
  v_exp_f32_e64 v37, v37 clamp
  v_exp_f32_e64 v41, v41 clamp
  v_max_f32 v34, 0, v34
  v_max_f32 v38, 0, v38
  v_max_f32 v35, 0, v35
  v_max_f32 v39, 0, v39
  v_pk_add_f32 v[34:35], v[34:35], v[36:37]
  v_pk_add_f32 v[38:39], v[38:39], v[40:41]
  v_pk_add_f32 v[34:35], v[34:35], s[62:63]
  v_pk_add_f32 v[38:39], v[38:39], s[62:63]
  v_cvt_pk_bf16_f32 v116, v34, v35
  v_cvt_pk_bf16_f32 v117, v38, v39
  v_accvgpr_read_b32 v34, a76
  v_accvgpr_read_b32 v38, a78
  v_accvgpr_read_b32 v35, a77
  v_accvgpr_read_b32 v39, a79
  v_pk_mul_f32 v[34:35], v[34:35], v[236:237]
  v_pk_mul_f32 v[38:39], v[38:39], v[238:239]
  v_pk_mul_f32 v[36:37], v[34:35], s[60:61]
  v_pk_mul_f32 v[40:41], v[38:39], s[60:61]
  v_exp_f32_e64 v36, v36 clamp
  v_exp_f32_e64 v40, v40 clamp
  v_exp_f32_e64 v37, v37 clamp
  v_exp_f32_e64 v41, v41 clamp
  v_max_f32 v34, 0, v34
  v_max_f32 v38, 0, v38
  v_max_f32 v35, 0, v35
  v_max_f32 v39, 0, v39
  v_pk_add_f32 v[34:35], v[34:35], v[36:37]
  v_pk_add_f32 v[38:39], v[38:39], v[40:41]
  v_pk_add_f32 v[34:35], v[34:35], s[62:63]
  v_pk_add_f32 v[38:39], v[38:39], s[62:63]
  v_cvt_pk_bf16_f32 v118, v34, v35
  v_cvt_pk_bf16_f32 v119, v38, v39
  ds_write_b64 v180, v[116:117] offset:32
  ds_write_b64 v180, v[118:119] offset:48
  v_accvgpr_read_b32 v34, a80
  v_accvgpr_read_b32 v38, a82
  v_accvgpr_read_b32 v35, a81
  v_accvgpr_read_b32 v39, a83
  v_pk_mul_f32 v[34:35], v[34:35], v[240:241]
  v_pk_mul_f32 v[38:39], v[38:39], v[242:243]
  v_pk_mul_f32 v[36:37], v[34:35], s[60:61]
  v_pk_mul_f32 v[40:41], v[38:39], s[60:61]
  v_exp_f32_e64 v36, v36 clamp
  v_exp_f32_e64 v40, v40 clamp
  v_exp_f32_e64 v37, v37 clamp
  v_exp_f32_e64 v41, v41 clamp
  v_max_f32 v34, 0, v34
  v_max_f32 v38, 0, v38
  v_max_f32 v35, 0, v35
  v_max_f32 v39, 0, v39
  v_pk_add_f32 v[34:35], v[34:35], v[36:37]
  v_pk_add_f32 v[38:39], v[38:39], v[40:41]
  v_pk_add_f32 v[34:35], v[34:35], s[62:63]
  v_pk_add_f32 v[38:39], v[38:39], s[62:63]
  v_cvt_pk_bf16_f32 v120, v34, v35
  v_cvt_pk_bf16_f32 v121, v38, v39
  v_accvgpr_read_b32 v34, a84
  v_accvgpr_read_b32 v38, a86
  v_accvgpr_read_b32 v35, a85
  v_accvgpr_read_b32 v39, a87
  v_pk_mul_f32 v[34:35], v[34:35], v[244:245]
  v_pk_mul_f32 v[38:39], v[38:39], v[246:247]
  v_pk_mul_f32 v[36:37], v[34:35], s[60:61]
  v_pk_mul_f32 v[40:41], v[38:39], s[60:61]
  v_exp_f32_e64 v36, v36 clamp
  v_exp_f32_e64 v40, v40 clamp
  v_exp_f32_e64 v37, v37 clamp
  v_exp_f32_e64 v41, v41 clamp
  v_max_f32 v34, 0, v34
  v_max_f32 v38, 0, v38
  v_max_f32 v35, 0, v35
  v_max_f32 v39, 0, v39
  v_pk_add_f32 v[34:35], v[34:35], v[36:37]
  v_pk_add_f32 v[38:39], v[38:39], v[40:41]
  v_pk_add_f32 v[34:35], v[34:35], s[62:63]
  v_pk_add_f32 v[38:39], v[38:39], s[62:63]
  v_cvt_pk_bf16_f32 v122, v34, v35
  v_cvt_pk_bf16_f32 v123, v38, v39
  ds_write_b64 v180, v[120:121] offset:64
  ds_write_b64 v180, v[122:123] offset:80
  v_accvgpr_read_b32 v34, a88
  v_accvgpr_read_b32 v38, a90
  v_accvgpr_read_b32 v35, a89
  v_accvgpr_read_b32 v39, a91
  v_pk_mul_f32 v[34:35], v[34:35], v[248:249]
  v_pk_mul_f32 v[38:39], v[38:39], v[250:251]
  v_pk_mul_f32 v[36:37], v[34:35], s[60:61]
  v_pk_mul_f32 v[40:41], v[38:39], s[60:61]
  v_exp_f32_e64 v36, v36 clamp
  v_exp_f32_e64 v40, v40 clamp
  v_exp_f32_e64 v37, v37 clamp
  v_exp_f32_e64 v41, v41 clamp
  v_max_f32 v34, 0, v34
  v_max_f32 v38, 0, v38
  v_max_f32 v35, 0, v35
  v_max_f32 v39, 0, v39
  v_pk_add_f32 v[34:35], v[34:35], v[36:37]
  v_pk_add_f32 v[38:39], v[38:39], v[40:41]
  v_pk_add_f32 v[34:35], v[34:35], s[62:63]
  v_pk_add_f32 v[38:39], v[38:39], s[62:63]
  v_cvt_pk_bf16_f32 v124, v34, v35
  v_cvt_pk_bf16_f32 v125, v38, v39
  v_accvgpr_read_b32 v34, a92
  v_accvgpr_read_b32 v38, a94
  v_accvgpr_read_b32 v35, a93
  v_accvgpr_read_b32 v39, a95
  v_pk_mul_f32 v[34:35], v[34:35], v[252:253]
  v_pk_mul_f32 v[38:39], v[38:39], v[254:255]
  v_pk_mul_f32 v[36:37], v[34:35], s[60:61]
  v_pk_mul_f32 v[40:41], v[38:39], s[60:61]
  v_exp_f32_e64 v36, v36 clamp
  v_exp_f32_e64 v40, v40 clamp
  v_exp_f32_e64 v37, v37 clamp
  v_exp_f32_e64 v41, v41 clamp
  v_max_f32 v34, 0, v34
  v_max_f32 v38, 0, v38
  v_max_f32 v35, 0, v35
  v_max_f32 v39, 0, v39
  v_pk_add_f32 v[34:35], v[34:35], v[36:37]
  v_pk_add_f32 v[38:39], v[38:39], v[40:41]
  v_pk_add_f32 v[34:35], v[34:35], s[62:63]
  v_pk_add_f32 v[38:39], v[38:39], s[62:63]
  v_cvt_pk_bf16_f32 v126, v34, v35
  v_cvt_pk_bf16_f32 v127, v38, v39
  ds_write_b64 v180, v[124:125] offset:96
  s_waitcnt lgkmcnt(14)
  ds_write_b64 v180, v[126:127] offset:112
  s_waitcnt lgkmcnt(0)
  v_mov_b32 v41, 0
  s_mov_b32 s35, 0
  s_cmp_lg_u32 s30, 0
  s_cbranch_scc1 L_pd_x
L_pd:
  buffer_load_dword v8, v41, s[24:27], s54 offen offset:128 sc1
  s_add_u32 s35, s35, 1
  s_cmp_ge_u32 s35, 0x200000
  s_waitcnt vmcnt(0)
  s_cbranch_scc1 L_pd_x
  v_readfirstlane_b32 s34, v8
  s_nop 3
  s_nop 4
  s_cmp_ge_u32 s34, 16
  s_cbranch_scc1 L_pd_x
  s_sleep 4
  s_branch L_pd
L_pd_x:
  s_barrier
  s_mov_b32 s34, s28
  s_nop 2
  s_mul_i32 s44, s34, 6144
  s_add_u32 s44, s44, s56
  buffer_load_dwordx4 v[64:67], v20, s[16:19], s44 offen sc1
  buffer_load_dwordx2 v[68:69], v21, s[16:19], s44 offen offset:1024 sc1
  s_add_u32 s34, s34, 1
  s_and_b32 s34, s34, 15
  s_mul_i32 s45, s34, 6144
  s_add_u32 s45, s45, s56
  buffer_load_dwordx4 v[70:73], v20, s[16:19], s45 offen sc1
  buffer_load_dwordx2 v[74:75], v21, s[16:19], s45 offen offset:1024 sc1
  s_add_u32 s34, s34, 1
  s_and_b32 s34, s34, 15
  s_mul_i32 s44, s34, 6144
  s_add_u32 s44, s44, s56
  buffer_load_dwordx4 v[76:79], v20, s[16:19], s44 offen sc1
  buffer_load_dwordx2 v[80:81], v21, s[16:19], s44 offen offset:1024 sc1
  s_add_u32 s34, s34, 1
  s_and_b32 s34, s34, 15
  s_mul_i32 s45, s34, 6144
  s_add_u32 s45, s45, s56
  buffer_load_dwordx4 v[82:85], v20, s[16:19], s45 offen sc1
  buffer_load_dwordx2 v[86:87], v21, s[16:19], s45 offen offset:1024 sc1
  s_add_u32 s34, s34, 1
  s_and_b32 s34, s34, 15
  s_mul_i32 s44, s34, 6144
  s_add_u32 s44, s44, s56
  buffer_load_dwordx4 v[88:91], v20, s[16:19], s44 offen sc1
  buffer_load_dwordx2 v[92:93], v21, s[16:19], s44 offen offset:1024 sc1
  s_add_u32 s34, s34, 1
  s_and_b32 s34, s34, 15
  s_mul_i32 s45, s34, 6144
  s_add_u32 s45, s45, s56
  buffer_load_dwordx4 v[94:97], v20, s[16:19], s45 offen sc1
  buffer_load_dwordx2 v[98:99], v21, s[16:19], s45 offen offset:1024 sc1
  s_add_u32 s34, s34, 1
  s_and_b32 s34, s34, 15
  v_accvgpr_read_b32 v34, a96
  v_accvgpr_read_b32 v38, a98
  v_accvgpr_read_b32 v35, a97
  v_accvgpr_read_b32 v39, a99
  v_pk_mul_f32 v[34:35], v[34:35], v[224:225]
  v_pk_mul_f32 v[38:39], v[38:39], v[226:227]
  v_pk_mul_f32 v[36:37], v[34:35], s[60:61]
  v_pk_mul_f32 v[40:41], v[38:39], s[60:61]
  v_exp_f32_e64 v36, v36 clamp
  v_exp_f32_e64 v40, v40 clamp
  v_exp_f32_e64 v37, v37 clamp
  v_exp_f32_e64 v41, v41 clamp
  v_max_f32 v34, 0, v34
  v_max_f32 v38, 0, v38
  v_max_f32 v35, 0, v35
  v_max_f32 v39, 0, v39
  v_pk_add_f32 v[34:35], v[34:35], v[36:37]
  v_pk_add_f32 v[38:39], v[38:39], v[40:41]
  v_pk_add_f32 v[34:35], v[34:35], s[62:63]
  v_pk_add_f32 v[38:39], v[38:39], s[62:63]
  v_cvt_pk_bf16_f32 v128, v34, v35
  v_cvt_pk_bf16_f32 v129, v38, v39
  v_accvgpr_read_b32 v34, a100
  v_accvgpr_read_b32 v38, a102
  v_accvgpr_read_b32 v35, a101
  v_accvgpr_read_b32 v39, a103
  v_pk_mul_f32 v[34:35], v[34:35], v[228:229]
  v_pk_mul_f32 v[38:39], v[38:39], v[230:231]
  v_pk_mul_f32 v[36:37], v[34:35], s[60:61]
  v_pk_mul_f32 v[40:41], v[38:39], s[60:61]
  v_exp_f32_e64 v36, v36 clamp
  v_exp_f32_e64 v40, v40 clamp
  v_exp_f32_e64 v37, v37 clamp
  v_exp_f32_e64 v41, v41 clamp
  v_max_f32 v34, 0, v34
  v_max_f32 v38, 0, v38
  v_max_f32 v35, 0, v35
  v_max_f32 v39, 0, v39
  v_pk_add_f32 v[34:35], v[34:35], v[36:37]
  v_pk_add_f32 v[38:39], v[38:39], v[40:41]
  v_pk_add_f32 v[34:35], v[34:35], s[62:63]
  v_pk_add_f32 v[38:39], v[38:39], s[62:63]
  v_cvt_pk_bf16_f32 v130, v34, v35
  v_cvt_pk_bf16_f32 v131, v38, v39
  ds_write_b64 v180, v[128:129] offset:4352
  ds_write_b64 v180, v[130:131] offset:4368
  s_mul_i32 s44, s34, 6144
  s_add_u32 s44, s44, s56
  buffer_load_dwordx4 v[100:103], v20, s[16:19], s44 offen sc1
  buffer_load_dwordx2 v[104:105], v21, s[16:19], s44 offen offset:1024 sc1
  s_add_u32 s34, s34, 1
  s_and_b32 s34, s34, 15
  s_mul_i32 s45, s34, 6144
  s_add_u32 s45, s45, s56
  buffer_load_dwordx4 v[106:109], v20, s[16:19], s45 offen sc1
  buffer_load_dwordx2 v[110:111], v21, s[16:19], s45 offen offset:1024 sc1
  s_add_u32 s34, s34, 1
  s_and_b32 s34, s34, 15
  s_mul_i32 s44, s34, 6144
  s_add_u32 s44, s44, s56
  buffer_load_dwordx4 v[144:147], v20, s[16:19], s44 offen sc1
  buffer_load_dwordx2 v[148:149], v21, s[16:19], s44 offen offset:1024 sc1
  s_add_u32 s34, s34, 1
  s_and_b32 s34, s34, 15
  s_mul_i32 s45, s34, 6144
  s_add_u32 s45, s45, s56
  buffer_load_dwordx4 v[150:153], v20, s[16:19], s45 offen sc1
  buffer_load_dwordx2 v[154:155], v21, s[16:19], s45 offen offset:1024 sc1
  s_add_u32 s34, s34, 1
  s_and_b32 s34, s34, 15
  s_mul_i32 s44, s34, 6144
  s_add_u32 s44, s44, s56
  buffer_load_dwordx4 v[156:159], v20, s[16:19], s44 offen sc1
  buffer_load_dwordx2 v[160:161], v21, s[16:19], s44 offen offset:1024 sc1
  s_add_u32 s34, s34, 1
  s_and_b32 s34, s34, 15
  s_mul_i32 s45, s34, 6144
  s_add_u32 s45, s45, s56
  buffer_load_dwordx4 v[162:165], v20, s[16:19], s45 offen sc1
  buffer_load_dwordx2 v[166:167], v21, s[16:19], s45 offen offset:1024 sc1
  s_add_u32 s34, s34, 1
  s_and_b32 s34, s34, 15
  v_accvgpr_read_b32 v34, a104
  v_accvgpr_read_b32 v38, a106
  v_accvgpr_read_b32 v35, a105
  v_accvgpr_read_b32 v39, a107
  v_pk_mul_f32 v[34:35], v[34:35], v[232:233]
  v_pk_mul_f32 v[38:39], v[38:39], v[234:235]
  v_pk_mul_f32 v[36:37], v[34:35], s[60:61]
  v_pk_mul_f32 v[40:41], v[38:39], s[60:61]
  v_exp_f32_e64 v36, v36 clamp
  v_exp_f32_e64 v40, v40 clamp
  v_exp_f32_e64 v37, v37 clamp
  v_exp_f32_e64 v41, v41 clamp
  v_max_f32 v34, 0, v34
  v_max_f32 v38, 0, v38
  v_max_f32 v35, 0, v35
  v_max_f32 v39, 0, v39
  v_pk_add_f32 v[34:35], v[34:35], v[36:37]
  v_pk_add_f32 v[38:39], v[38:39], v[40:41]
  v_pk_add_f32 v[34:35], v[34:35], s[62:63]
  v_pk_add_f32 v[38:39], v[38:39], s[62:63]
  v_cvt_pk_bf16_f32 v132, v34, v35
  v_cvt_pk_bf16_f32 v133, v38, v39
  v_accvgpr_read_b32 v34, a108
  v_accvgpr_read_b32 v38, a110
  v_accvgpr_read_b32 v35, a109
  v_accvgpr_read_b32 v39, a111
  v_pk_mul_f32 v[34:35], v[34:35], v[236:237]
  v_pk_mul_f32 v[38:39], v[38:39], v[238:239]
  v_pk_mul_f32 v[36:37], v[34:35], s[60:61]
  v_pk_mul_f32 v[40:41], v[38:39], s[60:61]
  v_exp_f32_e64 v36, v36 clamp
  v_exp_f32_e64 v40, v40 clamp
  v_exp_f32_e64 v37, v37 clamp
  v_exp_f32_e64 v41, v41 clamp
  v_max_f32 v34, 0, v34
  v_max_f32 v38, 0, v38
  v_max_f32 v35, 0, v35
  v_max_f32 v39, 0, v39
  v_pk_add_f32 v[34:35], v[34:35], v[36:37]
  v_pk_add_f32 v[38:39], v[38:39], v[40:41]
  v_pk_add_f32 v[34:35], v[34:35], s[62:63]
  v_pk_add_f32 v[38:39], v[38:39], s[62:63]
  v_cvt_pk_bf16_f32 v134, v34, v35
  v_cvt_pk_bf16_f32 v135, v38, v39
  ds_write_b64 v180, v[132:133] offset:4384
  ds_write_b64 v180, v[134:135] offset:4400
  s_mul_i32 s44, s34, 6144
  s_add_u32 s44, s44, s56
  buffer_load_dwordx4 v[188:191], v20, s[16:19], s44 offen sc1
  buffer_load_dwordx2 v[192:193], v21, s[16:19], s44 offen offset:1024 sc1
  s_add_u32 s34, s34, 1
  s_and_b32 s34, s34, 15
  s_mul_i32 s45, s34, 6144
  s_add_u32 s45, s45, s56
  buffer_load_dwordx4 v[194:197], v20, s[16:19], s45 offen sc1
  buffer_load_dwordx2 v[198:199], v21, s[16:19], s45 offen offset:1024 sc1
  s_add_u32 s34, s34, 1
  s_and_b32 s34, s34, 15
  s_mul_i32 s44, s34, 6144
  s_add_u32 s44, s44, s56
  buffer_load_dwordx4 v[200:203], v20, s[16:19], s44 offen sc1
  buffer_load_dwordx2 v[204:205], v21, s[16:19], s44 offen offset:1024 sc1
  s_add_u32 s34, s34, 1
  s_and_b32 s34, s34, 15
  s_mul_i32 s45, s34, 6144
  s_add_u32 s45, s45, s56
  buffer_load_dwordx4 v[206:209], v20, s[16:19], s45 offen sc1
  buffer_load_dwordx2 v[210:211], v21, s[16:19], s45 offen offset:1024 sc1
  s_add_u32 s34, s34, 1
  s_and_b32 s34, s34, 15
  v_accvgpr_read_b32 v34, a112
  v_accvgpr_read_b32 v38, a114
  v_accvgpr_read_b32 v35, a113
  v_accvgpr_read_b32 v39, a115
  v_pk_mul_f32 v[34:35], v[34:35], v[240:241]
  v_pk_mul_f32 v[38:39], v[38:39], v[242:243]
  v_pk_mul_f32 v[36:37], v[34:35], s[60:61]
  v_pk_mul_f32 v[40:41], v[38:39], s[60:61]
  v_exp_f32_e64 v36, v36 clamp
  v_exp_f32_e64 v40, v40 clamp
  v_exp_f32_e64 v37, v37 clamp
  v_exp_f32_e64 v41, v41 clamp
  v_max_f32 v34, 0, v34
  v_max_f32 v38, 0, v38
  v_max_f32 v35, 0, v35
  v_max_f32 v39, 0, v39
  v_pk_add_f32 v[34:35], v[34:35], v[36:37]
  v_pk_add_f32 v[38:39], v[38:39], v[40:41]
  v_pk_add_f32 v[34:35], v[34:35], s[62:63]
  v_pk_add_f32 v[38:39], v[38:39], s[62:63]
  v_cvt_pk_bf16_f32 v136, v34, v35
  v_cvt_pk_bf16_f32 v137, v38, v39
  v_accvgpr_read_b32 v34, a116
  v_accvgpr_read_b32 v38, a118
  v_accvgpr_read_b32 v35, a117
  v_accvgpr_read_b32 v39, a119
  v_pk_mul_f32 v[34:35], v[34:35], v[244:245]
  v_pk_mul_f32 v[38:39], v[38:39], v[246:247]
  v_pk_mul_f32 v[36:37], v[34:35], s[60:61]
  v_pk_mul_f32 v[40:41], v[38:39], s[60:61]
  v_exp_f32_e64 v36, v36 clamp
  v_exp_f32_e64 v40, v40 clamp
  v_exp_f32_e64 v37, v37 clamp
  v_exp_f32_e64 v41, v41 clamp
  v_max_f32 v34, 0, v34
  v_max_f32 v38, 0, v38
  v_max_f32 v35, 0, v35
  v_max_f32 v39, 0, v39
  v_pk_add_f32 v[34:35], v[34:35], v[36:37]
  v_pk_add_f32 v[38:39], v[38:39], v[40:41]
  v_pk_add_f32 v[34:35], v[34:35], s[62:63]
  v_pk_add_f32 v[38:39], v[38:39], s[62:63]
  v_cvt_pk_bf16_f32 v138, v34, v35
  v_cvt_pk_bf16_f32 v139, v38, v39
  ds_write_b64 v180, v[136:137] offset:4416
  ds_write_b64 v180, v[138:139] offset:4432
  v_accvgpr_read_b32 v34, a120
  v_accvgpr_read_b32 v38, a122
  v_accvgpr_read_b32 v35, a121
  v_accvgpr_read_b32 v39, a123
  v_pk_mul_f32 v[34:35], v[34:35], v[248:249]
  v_pk_mul_f32 v[38:39], v[38:39], v[250:251]
  v_pk_mul_f32 v[36:37], v[34:35], s[60:61]
  v_pk_mul_f32 v[40:41], v[38:39], s[60:61]
  v_exp_f32_e64 v36, v36 clamp
  v_exp_f32_e64 v40, v40 clamp
  v_exp_f32_e64 v37, v37 clamp
  v_exp_f32_e64 v41, v41 clamp
  v_max_f32 v34, 0, v34
  v_max_f32 v38, 0, v38
  v_max_f32 v35, 0, v35
  v_max_f32 v39, 0, v39
  v_pk_add_f32 v[34:35], v[34:35], v[36:37]
  v_pk_add_f32 v[38:39], v[38:39], v[40:41]
  v_pk_add_f32 v[34:35], v[34:35], s[62:63]
  v_pk_add_f32 v[38:39], v[38:39], s[62:63]
  v_cvt_pk_bf16_f32 v140, v34, v35
  v_cvt_pk_bf16_f32 v141, v38, v39
  v_accvgpr_read_b32 v34, a124
  v_accvgpr_read_b32 v38, a126
  v_accvgpr_read_b32 v35, a125
  v_accvgpr_read_b32 v39, a127
  v_pk_mul_f32 v[34:35], v[34:35], v[252:253]
  v_pk_mul_f32 v[38:39], v[38:39], v[254:255]
  v_pk_mul_f32 v[36:37], v[34:35], s[60:61]
  v_pk_mul_f32 v[40:41], v[38:39], s[60:61]
  v_exp_f32_e64 v36, v36 clamp
  v_exp_f32_e64 v40, v40 clamp
  v_exp_f32_e64 v37, v37 clamp
  v_exp_f32_e64 v41, v41 clamp
  v_max_f32 v34, 0, v34
  v_max_f32 v38, 0, v38
  v_max_f32 v35, 0, v35
  v_max_f32 v39, 0, v39
  v_pk_add_f32 v[34:35], v[34:35], v[36:37]
  v_pk_add_f32 v[38:39], v[38:39], v[40:41]
  v_pk_add_f32 v[34:35], v[34:35], s[62:63]
  v_pk_add_f32 v[38:39], v[38:39], s[62:63]
  v_cvt_pk_bf16_f32 v142, v34, v35
  v_cvt_pk_bf16_f32 v143, v38, v39
  ds_write_b64 v180, v[140:141] offset:4448
  ds_write_b64 v180, v[142:143] offset:4464
  ds_read_b64_tr_b16 a[24:25], v182 offset:0
  ds_read_b64_tr_b16 a[26:27], v182 offset:544
  ds_read_b64_tr_b16 a[28:29], v182 offset:64
  ds_read_b64_tr_b16 a[30:31], v182 offset:608
  ds_read_b64_tr_b16 a[32:33], v182 offset:2176
  ds_read_b64_tr_b16 a[34:35], v182 offset:2720
  ds_read_b64_tr_b16 a[36:37], v182 offset:2240
  s_waitcnt lgkmcnt(14)
  ds_read_b64_tr_b16 a[38:39], v182 offset:2784
  s_waitcnt lgkmcnt(14)
  ds_read_b64_tr_b16 a[40:41], v182 offset:4352
  s_waitcnt lgkmcnt(14)
  ds_read_b64_tr_b16 a[42:43], v182 offset:4896
  s_waitcnt lgkmcnt(14)
  ds_read_b64_tr_b16 a[44:45], v182 offset:4416
  s_waitcnt lgkmcnt(14)
  ds_read_b64_tr_b16 a[46:47], v182 offset:4960
  s_waitcnt lgkmcnt(14)
  ds_read_b64_tr_b16 a[48:49], v182 offset:6528
  s_waitcnt lgkmcnt(14)
  ds_read_b64_tr_b16 a[50:51], v182 offset:7072
  s_waitcnt lgkmcnt(14)
  ds_read_b64_tr_b16 a[52:53], v182 offset:6592
  s_waitcnt lgkmcnt(14)
  ds_read_b64_tr_b16 a[54:55], v182 offset:7136
  s_waitcnt lgkmcnt(14)
  ds_read_b64_tr_b16 a[56:57], v182 offset:8704
  s_waitcnt lgkmcnt(14)
  ds_read_b64_tr_b16 a[58:59], v182 offset:9248
  s_waitcnt lgkmcnt(14)
  ds_read_b64_tr_b16 a[60:61], v182 offset:8768
  s_waitcnt lgkmcnt(14)
  ds_read_b64_tr_b16 a[62:63], v182 offset:9312
  s_mov_b32 s36, 0x00003f80
  s_mov_b32 s37, 0x3f800000
  s_waitcnt vmcnt(31)
  v_dot2_f32_bf16 v212, v64, s36, 0
  v_dot2_f32_bf16 v213, v64, s37, 0
  v_dot2_f32_bf16 v214, v65, s36, 0
  v_dot2_f32_bf16 v215, v65, s37, 0
  v_dot2_f32_bf16 v216, v66, s36, 0
  v_dot2_f32_bf16 v217, v66, s37, 0
  v_dot2_f32_bf16 v218, v67, s36, 0
  v_dot2_f32_bf16 v219, v67, s37, 0
  s_waitcnt vmcnt(30)
  v_dot2_f32_bf16 v220, v68, s36, 0
  v_dot2_f32_bf16 v221, v68, s37, 0
  v_dot2_f32_bf16 v222, v69, s36, 0
  v_dot2_f32_bf16 v223, v69, s37, 0
  s_waitcnt vmcnt(29)
  v_dot2_f32_bf16 v212, v70, s36, v212
  v_dot2_f32_bf16 v213, v70, s37, v213
  v_dot2_f32_bf16 v214, v71, s36, v214
  v_dot2_f32_bf16 v215, v71, s37, v215
  v_dot2_f32_bf16 v216, v72, s36, v216
  v_dot2_f32_bf16 v217, v72, s37, v217
  v_dot2_f32_bf16 v218, v73, s36, v218
  v_dot2_f32_bf16 v219, v73, s37, v219
  s_waitcnt vmcnt(28)
  v_dot2_f32_bf16 v220, v74, s36, v220
  v_dot2_f32_bf16 v221, v74, s37, v221
  v_dot2_f32_bf16 v222, v75, s36, v222
  v_dot2_f32_bf16 v223, v75, s37, v223
  s_waitcnt vmcnt(27)
  v_dot2_f32_bf16 v212, v76, s36, v212
  v_dot2_f32_bf16 v213, v76, s37, v213
  v_dot2_f32_bf16 v214, v77, s36, v214
  v_dot2_f32_bf16 v215, v77, s37, v215
  v_dot2_f32_bf16 v216, v78, s36, v216
  v_dot2_f32_bf16 v217, v78, s37, v217
  v_dot2_f32_bf16 v218, v79, s36, v218
  v_dot2_f32_bf16 v219, v79, s37, v219
  s_waitcnt vmcnt(26)
  v_dot2_f32_bf16 v220, v80, s36, v220
  v_dot2_f32_bf16 v221, v80, s37, v221
  v_dot2_f32_bf16 v222, v81, s36, v222
  v_dot2_f32_bf16 v223, v81, s37, v223
  s_waitcnt vmcnt(25)
  v_dot2_f32_bf16 v212, v82, s36, v212
  v_dot2_f32_bf16 v213, v82, s37, v213
  v_dot2_f32_bf16 v214, v83, s36, v214
  v_dot2_f32_bf16 v215, v83, s37, v215
  v_dot2_f32_bf16 v216, v84, s36, v216
  v_dot2_f32_bf16 v217, v84, s37, v217
  v_dot2_f32_bf16 v218, v85, s36, v218
  v_dot2_f32_bf16 v219, v85, s37, v219
  s_waitcnt vmcnt(24)
  v_dot2_f32_bf16 v220, v86, s36, v220
  v_dot2_f32_bf16 v221, v86, s37, v221
  v_dot2_f32_bf16 v222, v87, s36, v222
  v_dot2_f32_bf16 v223, v87, s37, v223
  s_waitcnt vmcnt(23)
  v_dot2_f32_bf16 v212, v88, s36, v212
  v_dot2_f32_bf16 v213, v88, s37, v213
  v_dot2_f32_bf16 v214, v89, s36, v214
  v_dot2_f32_bf16 v215, v89, s37, v215
  v_dot2_f32_bf16 v216, v90, s36, v216
  v_dot2_f32_bf16 v217, v90, s37, v217
  v_dot2_f32_bf16 v218, v91, s36, v218
  v_dot2_f32_bf16 v219, v91, s37, v219
  s_waitcnt vmcnt(22)
  v_dot2_f32_bf16 v220, v92, s36, v220
  v_dot2_f32_bf16 v221, v92, s37, v221
  v_dot2_f32_bf16 v222, v93, s36, v222
  v_dot2_f32_bf16 v223, v93, s37, v223
  s_waitcnt vmcnt(21)
  v_dot2_f32_bf16 v212, v94, s36, v212
  v_dot2_f32_bf16 v213, v94, s37, v213
  v_dot2_f32_bf16 v214, v95, s36, v214
  v_dot2_f32_bf16 v215, v95, s37, v215
  v_dot2_f32_bf16 v216, v96, s36, v216
  v_dot2_f32_bf16 v217, v96, s37, v217
  v_dot2_f32_bf16 v218, v97, s36, v218
  v_dot2_f32_bf16 v219, v97, s37, v219
  s_waitcnt vmcnt(20)
  v_dot2_f32_bf16 v220, v98, s36, v220
  v_dot2_f32_bf16 v221, v98, s37, v221
  v_dot2_f32_bf16 v222, v99, s36, v222
  v_dot2_f32_bf16 v223, v99, s37, v223
  s_waitcnt vmcnt(19)
  v_dot2_f32_bf16 v212, v100, s36, v212
  v_dot2_f32_bf16 v213, v100, s37, v213
  v_dot2_f32_bf16 v214, v101, s36, v214
  v_dot2_f32_bf16 v215, v101, s37, v215
  v_dot2_f32_bf16 v216, v102, s36, v216
  v_dot2_f32_bf16 v217, v102, s37, v217
  v_dot2_f32_bf16 v218, v103, s36, v218
  v_dot2_f32_bf16 v219, v103, s37, v219
  s_waitcnt vmcnt(18)
  v_dot2_f32_bf16 v220, v104, s36, v220
  v_dot2_f32_bf16 v221, v104, s37, v221
  v_dot2_f32_bf16 v222, v105, s36, v222
  v_dot2_f32_bf16 v223, v105, s37, v223
  s_waitcnt vmcnt(17)
  v_dot2_f32_bf16 v212, v106, s36, v212
  v_dot2_f32_bf16 v213, v106, s37, v213
  v_dot2_f32_bf16 v214, v107, s36, v214
  v_dot2_f32_bf16 v215, v107, s37, v215
  v_dot2_f32_bf16 v216, v108, s36, v216
  v_dot2_f32_bf16 v217, v108, s37, v217
  v_dot2_f32_bf16 v218, v109, s36, v218
  v_dot2_f32_bf16 v219, v109, s37, v219
  s_waitcnt vmcnt(16)
  v_dot2_f32_bf16 v220, v110, s36, v220
  v_dot2_f32_bf16 v221, v110, s37, v221
  v_dot2_f32_bf16 v222, v111, s36, v222
  v_dot2_f32_bf16 v223, v111, s37, v223
  s_waitcnt vmcnt(15)
  v_dot2_f32_bf16 v212, v144, s36, v212
  v_dot2_f32_bf16 v213, v144, s37, v213
  v_dot2_f32_bf16 v214, v145, s36, v214
  v_dot2_f32_bf16 v215, v145, s37, v215
  v_dot2_f32_bf16 v216, v146, s36, v216
  v_dot2_f32_bf16 v217, v146, s37, v217
  v_dot2_f32_bf16 v218, v147, s36, v218
  v_dot2_f32_bf16 v219, v147, s37, v219
  s_waitcnt vmcnt(14)
  v_dot2_f32_bf16 v220, v148, s36, v220
  v_dot2_f32_bf16 v221, v148, s37, v221
  v_dot2_f32_bf16 v222, v149, s36, v222
  v_dot2_f32_bf16 v223, v149, s37, v223
  s_waitcnt vmcnt(13)
  v_dot2_f32_bf16 v212, v150, s36, v212
  v_dot2_f32_bf16 v213, v150, s37, v213
  v_dot2_f32_bf16 v214, v151, s36, v214
  v_dot2_f32_bf16 v215, v151, s37, v215
  v_dot2_f32_bf16 v216, v152, s36, v216
  v_dot2_f32_bf16 v217, v152, s37, v217
  v_dot2_f32_bf16 v218, v153, s36, v218
  v_dot2_f32_bf16 v219, v153, s37, v219
  s_waitcnt vmcnt(12)
  v_dot2_f32_bf16 v220, v154, s36, v220
  v_dot2_f32_bf16 v221, v154, s37, v221
  v_dot2_f32_bf16 v222, v155, s36, v222
  v_dot2_f32_bf16 v223, v155, s37, v223
  s_waitcnt vmcnt(11)
  v_dot2_f32_bf16 v212, v156, s36, v212
  v_dot2_f32_bf16 v213, v156, s37, v213
  v_dot2_f32_bf16 v214, v157, s36, v214
  v_dot2_f32_bf16 v215, v157, s37, v215
  v_dot2_f32_bf16 v216, v158, s36, v216
  v_dot2_f32_bf16 v217, v158, s37, v217
  v_dot2_f32_bf16 v218, v159, s36, v218
  v_dot2_f32_bf16 v219, v159, s37, v219
  s_waitcnt vmcnt(10)
  v_dot2_f32_bf16 v220, v160, s36, v220
  v_dot2_f32_bf16 v221, v160, s37, v221
  v_dot2_f32_bf16 v222, v161, s36, v222
  v_dot2_f32_bf16 v223, v161, s37, v223
  s_waitcnt vmcnt(9)
  v_dot2_f32_bf16 v212, v162, s36, v212
  v_dot2_f32_bf16 v213, v162, s37, v213
  v_dot2_f32_bf16 v214, v163, s36, v214
  v_dot2_f32_bf16 v215, v163, s37, v215
  v_dot2_f32_bf16 v216, v164, s36, v216
  v_dot2_f32_bf16 v217, v164, s37, v217
  v_dot2_f32_bf16 v218, v165, s36, v218
  v_dot2_f32_bf16 v219, v165, s37, v219
  s_waitcnt vmcnt(8)
  v_dot2_f32_bf16 v220, v166, s36, v220
  v_dot2_f32_bf16 v221, v166, s37, v221
  v_dot2_f32_bf16 v222, v167, s36, v222
  v_dot2_f32_bf16 v223, v167, s37, v223
  s_waitcnt vmcnt(7)
  v_dot2_f32_bf16 v212, v188, s36, v212
  v_dot2_f32_bf16 v213, v188, s37, v213
  v_dot2_f32_bf16 v214, v189, s36, v214
  v_dot2_f32_bf16 v215, v189, s37, v215
  v_dot2_f32_bf16 v216, v190, s36, v216
  v_dot2_f32_bf16 v217, v190, s37, v217
  v_dot2_f32_bf16 v218, v191, s36, v218
  v_dot2_f32_bf16 v219, v191, s37, v219
  s_waitcnt vmcnt(6)
  v_dot2_f32_bf16 v220, v192, s36, v220
  v_dot2_f32_bf16 v221, v192, s37, v221
  v_dot2_f32_bf16 v222, v193, s36, v222
  v_dot2_f32_bf16 v223, v193, s37, v223
  s_waitcnt vmcnt(5)
  v_dot2_f32_bf16 v212, v194, s36, v212
  v_dot2_f32_bf16 v213, v194, s37, v213
  v_dot2_f32_bf16 v214, v195, s36, v214
  v_dot2_f32_bf16 v215, v195, s37, v215
  v_dot2_f32_bf16 v216, v196, s36, v216
  v_dot2_f32_bf16 v217, v196, s37, v217
  v_dot2_f32_bf16 v218, v197, s36, v218
  v_dot2_f32_bf16 v219, v197, s37, v219
  s_waitcnt vmcnt(4)
  v_dot2_f32_bf16 v220, v198, s36, v220
  v_dot2_f32_bf16 v221, v198, s37, v221
  v_dot2_f32_bf16 v222, v199, s36, v222
  v_dot2_f32_bf16 v223, v199, s37, v223
  s_waitcnt vmcnt(3)
  v_dot2_f32_bf16 v212, v200, s36, v212
  v_dot2_f32_bf16 v213, v200, s37, v213
  v_dot2_f32_bf16 v214, v201, s36, v214
  v_dot2_f32_bf16 v215, v201, s37, v215
  v_dot2_f32_bf16 v216, v202, s36, v216
  v_dot2_f32_bf16 v217, v202, s37, v217
  v_dot2_f32_bf16 v218, v203, s36, v218
  v_dot2_f32_bf16 v219, v203, s37, v219
  s_waitcnt vmcnt(2)
  v_dot2_f32_bf16 v220, v204, s36, v220
  v_dot2_f32_bf16 v221, v204, s37, v221
  v_dot2_f32_bf16 v222, v205, s36, v222
  v_dot2_f32_bf16 v223, v205, s37, v223
  s_waitcnt vmcnt(1)
  v_dot2_f32_bf16 v212, v206, s36, v212
  v_dot2_f32_bf16 v213, v206, s37, v213
  v_dot2_f32_bf16 v214, v207, s36, v214
  v_dot2_f32_bf16 v215, v207, s37, v215
  v_dot2_f32_bf16 v216, v208, s36, v216
  v_dot2_f32_bf16 v217, v208, s37, v217
  v_dot2_f32_bf16 v218, v209, s36, v218
  v_dot2_f32_bf16 v219, v209, s37, v219
  s_waitcnt vmcnt(0)
  v_dot2_f32_bf16 v220, v210, s36, v220
  v_dot2_f32_bf16 v221, v210, s37, v221
  v_dot2_f32_bf16 v222, v211, s36, v222
  v_dot2_f32_bf16 v223, v211, s37, v223
  v_cvt_pk_bf16_f32 v212, v212, v213
  v_cvt_pk_bf16_f32 v214, v214, v215
  v_cvt_pk_bf16_f32 v216, v216, v217
  v_cvt_pk_bf16_f32 v218, v218, v219
  v_cvt_pk_bf16_f32 v220, v220, v221
  v_cvt_pk_bf16_f32 v222, v222, v223
  s_waitcnt lgkmcnt(14)
  ds_write_b32 v26, v212 offset:8192
  s_waitcnt lgkmcnt(14)
  ds_write_b32 v27, v214 offset:8192
  s_waitcnt lgkmcnt(14)
  ds_write_b32 v28, v216 offset:8192
  s_waitcnt lgkmcnt(14)
  ds_write_b32 v29, v216 offset:8192
  s_waitcnt lgkmcnt(14)
  ds_write_b32 v26, v218 offset:12452
  s_waitcnt lgkmcnt(14)
  ds_write_b32 v27, v220 offset:12452
  s_waitcnt lgkmcnt(14)
  ds_write_b32 v28, v222 offset:12452
  s_waitcnt lgkmcnt(14)
  ds_write_b32 v29, v222 offset:12452
  s_waitcnt lgkmcnt(0)
  s_barrier
  ds_read_b128 v[116:119], v183 offset:8192
  ds_read_b128 v[120:123], v183 offset:8224
  ds_read_b128 v[124:127], v183 offset:8256
  ds_read_b128 v[128:131], v183 offset:13856
  ds_read_b128 v[132:135], v183 offset:13888
  ds_read_b128 v[136:139], v183 offset:13920
  ds_read_b128 v[140:143], v183 offset:19520
  ds_read_b128 v[144:147], v183 offset:19552
  ds_read_b128 v[148:151], v183 offset:19584
  s_waitcnt lgkmcnt(8)
  v_mfma_f32_32x32x16_bf16 v[64:79], v[116:119], a[24:27], 0
  s_waitcnt lgkmcnt(7)
  v_mfma_f32_32x32x16_bf16 v[64:79], v[120:123], a[32:35], v[64:79]
  s_waitcnt lgkmcnt(6)
  v_mfma_f32_32x32x16_bf16 v[64:79], v[124:127], a[40:43], v[64:79]
  s_waitcnt lgkmcnt(5)
  v_mfma_f32_32x32x16_bf16 v[80:95], v[128:131], a[32:35], 0
  s_waitcnt lgkmcnt(4)
  v_mfma_f32_32x32x16_bf16 v[80:95], v[132:135], a[40:43], v[80:95]
  s_waitcnt lgkmcnt(3)
  v_mfma_f32_32x32x16_bf16 v[80:95], v[136:139], a[48:51], v[80:95]
  s_waitcnt lgkmcnt(2)
  v_mfma_f32_32x32x16_bf16 v[96:111], v[140:143], a[40:43], 0
  s_waitcnt lgkmcnt(1)
  v_mfma_f32_32x32x16_bf16 v[96:111], v[144:147], a[48:51], v[96:111]
  s_waitcnt lgkmcnt(0)
  v_mfma_f32_32x32x16_bf16 v[96:111], v[148:151], a[56:59], v[96:111]
  v_mfma_f32_32x32x16_bf16 v[152:167], v[116:119], a[28:31], 0
  v_mfma_f32_32x32x16_bf16 v[152:167], v[120:123], a[36:39], v[152:167]
  v_mfma_f32_32x32x16_bf16 v[152:167], v[124:127], a[44:47], v[152:167]
  v_add_f32 v74, 0x358637bd, v74
  s_nop 1
  v_add_f32 v86, 0x358637bd, v86
  s_nop 4
  v_add_f32 v98, 0x358637bd, v98
  v_add_f32 v110, 0x358637bd, v110
  v_rcp_f32 v74, v74
  v_rcp_f32 v86, v86
  v_rcp_f32 v98, v98
  v_rcp_f32 v110, v110
  v_mul_f32 v64, v64, v74
  v_mul_f32 v65, v65, v74
  v_mfma_f32_32x32x16_bf16 v[188:203], v[128:131], a[36:39], 0
  v_mul_f32 v66, v66, v74
  v_mul_f32 v67, v67, v74
  v_mul_f32 v68, v68, v74
  v_mul_f32 v69, v69, v74
  v_mul_f32 v70, v70, v74
  v_mul_f32 v71, v71, v74
  v_mul_f32 v72, v72, v74
  v_mul_f32 v73, v73, v74
  v_cvt_pk_bf16_f32 v64, v64, v65
  v_cvt_pk_bf16_f32 v65, v66, v67
  v_mfma_f32_32x32x16_bf16 v[188:203], v[132:135], a[44:47], v[188:203]
  v_cvt_pk_bf16_f32 v66, v68, v69
  v_cvt_pk_bf16_f32 v67, v70, v71
  v_cvt_pk_bf16_f32 v168, v72, v73
  v_mul_f32 v76, v76, v86
  v_mul_f32 v77, v77, v86
  v_mul_f32 v78, v78, v86
  v_mul_f32 v79, v79, v86
  v_mul_f32 v80, v80, v86
  v_mul_f32 v81, v81, v86
  v_mul_f32 v82, v82, v86
  v_mfma_f32_32x32x16_bf16 v[188:203], v[136:139], a[52:55], v[188:203]
  v_mul_f32 v83, v83, v86
  v_mul_f32 v84, v84, v86
  v_mul_f32 v85, v85, v86
  v_cvt_pk_bf16_f32 v76, v76, v77
  v_cvt_pk_bf16_f32 v77, v78, v79
  v_cvt_pk_bf16_f32 v78, v80, v81
  v_cvt_pk_bf16_f32 v79, v82, v83
  v_cvt_pk_bf16_f32 v169, v84, v85
  v_mul_f32 v88, v88, v98
  v_mul_f32 v89, v89, v98
  v_mfma_f32_32x32x16_bf16 v[44:59], v[140:143], a[44:47], 0
  v_mul_f32 v90, v90, v98
  v_mul_f32 v91, v91, v98
  v_mul_f32 v92, v92, v98
  v_mul_f32 v93, v93, v98
  v_mul_f32 v94, v94, v98
  v_mul_f32 v95, v95, v98
  v_mul_f32 v96, v96, v98
  v_mul_f32 v97, v97, v98
  v_cvt_pk_bf16_f32 v88, v88, v89
  v_cvt_pk_bf16_f32 v89, v90, v91
  v_mfma_f32_32x32x16_bf16 v[44:59], v[144:147], a[52:55], v[44:59]
  v_cvt_pk_bf16_f32 v90, v92, v93
  v_cvt_pk_bf16_f32 v91, v94, v95
  v_cvt_pk_bf16_f32 v170, v96, v97
  v_mul_f32 v100, v100, v110
  v_mul_f32 v101, v101, v110
  v_mul_f32 v102, v102, v110
  v_mul_f32 v103, v103, v110
  v_mul_f32 v104, v104, v110
  v_mul_f32 v105, v105, v110
  v_mul_f32 v106, v106, v110
  v_mfma_f32_32x32x16_bf16 v[44:59], v[148:151], a[60:63], v[44:59]
  v_mul_f32 v107, v107, v110
  v_mul_f32 v108, v108, v110
  v_mul_f32 v109, v109, v110
  v_cvt_pk_bf16_f32 v100, v100, v101
  v_cvt_pk_bf16_f32 v101, v102, v103
  v_cvt_pk_bf16_f32 v102, v104, v105
  v_cvt_pk_bf16_f32 v103, v106, v107
  v_cvt_pk_bf16_f32 v171, v108, v109
  buffer_store_dwordx4 v[64:67], v184, s[16:19], s66 offen sc1
  buffer_store_dwordx4 v[76:79], v184, s[16:19], s66 offen offset:512 sc1
  buffer_store_dwordx4 v[88:91], v184, s[16:19], s66 offen offset:1024 sc1
  buffer_store_dwordx4 v[100:103], v184, s[16:19], s66 offen offset:1536 sc1
  buffer_store_dwordx4 v[168:171], v186, s[16:19], s66 offen sc1
  v_add_f32 v162, 0x358637bd, v162
  v_add_f32 v194, 0x358637bd, v194
  v_add_f32 v46, 0x358637bd, v46
  v_add_f32 v58, 0x358637bd, v58
  v_rcp_f32 v162, v162
  v_rcp_f32 v194, v194
  v_rcp_f32 v46, v46
  v_rcp_f32 v58, v58
  v_mul_f32 v152, v152, v162
  v_mul_f32 v153, v153, v162
  v_mul_f32 v154, v154, v162
  v_mul_f32 v155, v155, v162
  v_mul_f32 v156, v156, v162
  v_mul_f32 v157, v157, v162
  v_mul_f32 v158, v158, v162
  v_mul_f32 v159, v159, v162
  v_mul_f32 v160, v160, v162
  v_mul_f32 v161, v161, v162
  v_cvt_pk_bf16_f32 v152, v152, v153
  v_cvt_pk_bf16_f32 v153, v154, v155
  v_cvt_pk_bf16_f32 v154, v156, v157
  v_cvt_pk_bf16_f32 v155, v158, v159
  v_cvt_pk_bf16_f32 v172, v160, v161
  v_mul_f32 v164, v164, v194
  v_mul_f32 v165, v165, v194
  v_mul_f32 v166, v166, v194
  v_mul_f32 v167, v167, v194
  v_mul_f32 v188, v188, v194
  v_mul_f32 v189, v189, v194
  v_mul_f32 v190, v190, v194
  v_mul_f32 v191, v191, v194
  v_mul_f32 v192, v192, v194
  v_mul_f32 v193, v193, v194
  v_cvt_pk_bf16_f32 v164, v164, v165
  v_cvt_pk_bf16_f32 v165, v166, v167
  v_cvt_pk_bf16_f32 v166, v188, v189
  v_cvt_pk_bf16_f32 v167, v190, v191
  v_cvt_pk_bf16_f32 v173, v192, v193
  v_mul_f32 v196, v196, v46
  v_mul_f32 v197, v197, v46
  v_mul_f32 v198, v198, v46
  v_mul_f32 v199, v199, v46
  v_mul_f32 v200, v200, v46
  v_mul_f32 v201, v201, v46
  v_mul_f32 v202, v202, v46
  v_mul_f32 v203, v203, v46
  v_mul_f32 v44, v44, v46
  v_mul_f32 v45, v45, v46
  v_cvt_pk_bf16_f32 v196, v196, v197
  v_cvt_pk_bf16_f32 v197, v198, v199
  v_cvt_pk_bf16_f32 v198, v200, v201
  v_cvt_pk_bf16_f32 v199, v202, v203
  v_cvt_pk_bf16_f32 v174, v44, v45
  v_mul_f32 v48, v48, v58
  v_mul_f32 v49, v49, v58
  v_mul_f32 v50, v50, v58
  v_mul_f32 v51, v51, v58
  v_mul_f32 v52, v52, v58
  v_mul_f32 v53, v53, v58
  v_mul_f32 v54, v54, v58
  v_mul_f32 v55, v55, v58
  v_mul_f32 v56, v56, v58
  v_mul_f32 v57, v57, v58
  v_cvt_pk_bf16_f32 v48, v48, v49
  v_cvt_pk_bf16_f32 v49, v50, v51
  v_cvt_pk_bf16_f32 v50, v52, v53
  v_cvt_pk_bf16_f32 v51, v54, v55
  v_cvt_pk_bf16_f32 v175, v56, v57
  buffer_store_dwordx4 v[152:155], v184, s[16:19], s67 offen sc1
  buffer_store_dwordx4 v[164:167], v184, s[16:19], s67 offen offset:512 sc1
  buffer_store_dwordx4 v[196:199], v184, s[16:19], s67 offen offset:1024 sc1
  buffer_store_dwordx4 v[48:51], v184, s[16:19], s67 offen offset:1536 sc1
  buffer_store_dwordx4 v[172:175], v186, s[16:19], s67 offen sc1
  s_waitcnt vmcnt(0)
  s_barrier
  v_mov_b32 v8, 1
  buffer_store_dword v8, v185, s[16:19], s48 offen sc1
  s_endpgm
L_codeend:
.section .rodata,"a"
.p2align 6
.amdhsa_kernel recurrent_scan__linear_attn_block__dense_activation_gelu__prompt_kernel
  .amdhsa_next_free_vgpr 512
  .amdhsa_next_free_sgpr 102
  .amdhsa_accum_offset 256
  .amdhsa_group_segment_fixed_size 0
  .amdhsa_kernarg_size 88
  .amdhsa_user_sgpr_count 2
  .amdhsa_user_sgpr_kernarg_segment_ptr 1
  .amdhsa_system_sgpr_workgroup_id_x 1
.end_amdhsa_kernel
```
